```python
import torch

def _softmax(x, axis=-1):
    return torch.softmax(x, dim=axis)
def _gelu(x):
    return torch.nn.functional.gelu(x, approximate="tanh")
def _silu(x):
    return torch.nn.functional.silu(x)
def _sigmoid(x):
    return torch.sigmoid(x)
def _layernorm(x, axis=-1, eps=1e-5):
    m = x.mean(dim=axis, keepdim=True)
    v = x.var(dim=axis, keepdim=True, unbiased=False)
    return (x - m) / torch.sqrt(v + eps)
def _scatter_add(tgt, idx, src, axis=0):
    return tgt.clone().index_add_(axis, idx, src)
def _segment_sum(src, seg, n):
    out = torch.zeros((n,) + src.shape[1:], dtype=src.dtype)
    return out.index_add_(0, seg, src)
def _pad(x, pw):
    flat = tuple(v for pair in reversed(pw) for v in pair)
    return torch.nn.functional.pad(x, flat)

kernel_name = 'gated_mix__spectral_gfnet__dense_activation_silu__prompt'

def setup_inputs():

    _w = (lambda a: (lambda t: t.to(torch.bfloat16) if t.is_floating_point() else t)(torch.as_tensor(a)))
    def _A_setup():
        B, S, D = 1, 2048, 576
        Df = D // 2 + 1
        return {
            "x": _w((lambda *s: torch.randn(*s, dtype=torch.bfloat16) * 0.05)(B, S, D)),
            "w_r": _w((lambda *s: torch.randn(*s, dtype=torch.bfloat16) * 0.4)(S, Df) * 0.02),
            "w_i": _w((lambda *s: torch.randn(*s, dtype=torch.bfloat16) * 0.4)(S, Df) * 0.02),
        }
    _A_in = _A_setup()

    def _B_setup():
        B, S, D, F = 1, 2048, 576, 4608
        return {
            "x": _w((lambda *s: torch.randn(*s, dtype=torch.bfloat16) * 0.05)(B, S, D)),
            "w1": _w((lambda *s: torch.randn(*s, dtype=torch.bfloat16) * 3.2)(D, F) * (D ** -0.5)),
            "w2": _w((lambda *s: torch.randn(*s, dtype=torch.bfloat16) * 0.05)(F, D) * (F ** -0.5)),
        }
    _B_in = _B_setup()

    return {
        "A_x": _A_in["x"],
        "A_w_r": _A_in["w_r"],
        "A_w_i": _A_in["w_i"],
        "B_x": _B_in["x"],
        "B_w1": _B_in["w1"],
        "B_w2": _B_in["w2"],
        "gate_w": _w((lambda *s: torch.randn(*s, dtype=torch.bfloat16) * 0.05)(576) * 16.0),
    }

def reference(A_x, A_w_r, A_w_i, B_x, B_w1, B_w2, gate_w):
    def _A_ref(x, w_r, w_i):
        B, S, D = x.shape
        X = (lambda x, axes=(-2,-1): torch.fft.rfft2(x.float(), dim=axes))(x, axes=(-2, -1))
        W = w_r + 1j * w_i
        X = X * W
        y = (lambda x, s, axes=(-2,-1): torch.fft.irfft2(x, s=s, dim=axes).to(torch.bfloat16))(X, (S, D), axes=(-2, -1))
        return y

    def _B_ref(x, w1, w2):
        h = torch.einsum("bsd,df->bsf", x, w1)
        h = _silu(h)
        out = torch.einsum("bsf,fd->bsd", h, w2)
        return out

    x = A_x
    g = _sigmoid((x * gate_w).sum(-1, keepdims=True))
    a = _A_ref(x, A_w_r, A_w_i)
    b = _B_ref(x, B_w1, B_w2)
    return g * a + (1 - g) * b
```

```asm
; @launch grid=(256,1,1) block=(512,1,1) lds=163840
.amdgcn_target "amdgcn-amd-amdhsa--gfx950"
.text
.globl gated_mix__spectral_gfnet__dense_activation_silu__prompt_kernel
.p2align 8
.type gated_mix__spectral_gfnet__dense_activation_silu__prompt_kernel,@function
gated_mix__spectral_gfnet__dense_activation_silu__prompt_kernel:
    s_cmp_ge_u32 s2, 256
    s_cbranch_scc1 M_END
    s_load_dwordx2 s[4:5], s[0:1], 0
    s_load_dwordx2 s[6:7], s[0:1], 32
    s_load_dwordx2 s[8:9], s[0:1], 72
    s_load_dwordx2 s[10:11], s[0:1], 48
    s_load_dwordx2 s[96:97], s[0:1], 40
    s_load_dwordx2 s[98:99], s[0:1], 56
    s_load_dwordx2 s[100:101], s[0:1], 64
    v_lshrrev_b32 v1, 6, v0
    s_nop 0
    v_readfirstlane_b32 s28, v1
    s_and_b32 s3, s2, 7
    s_lshr_b32 s54, s2, 3
    s_or_b32 s41, s2, s28
    s_cmp_lg_u32 s41, 0
    s_cbranch_scc1 M_NONONCE
s_memrealtime s[56:57]
 s_waitcnt lgkmcnt(0)
 s_or_b32 s56, s56, 1
 v_mov_b32 v2, s56
 v_mov_b32 v3, s57
 v_mov_b32 v4, 0
 global_store_dwordx2 v4, v[2:3], s[100:101] sc1
 s_nop 1
M_NONONCE:
    s_cmp_ge_u32 s54, 27
    s_cbranch_scc1 M_FFT
    s_cmp_ge_u32 s54, 24
    s_cbranch_scc1 M_U
    s_and_b32 s29, s3, 1
    s_lshl_b32 s29, s29, 2
    s_and_b32 s42, s54, 3
    s_add_u32 s29, s29, s42
    s_lshr_b32 s30, s3, 1
    s_mul_i32 s30, s30, 6
    s_lshr_b32 s42, s54, 2
    s_add_u32 s30, s30, s42
    s_lshl_b32 s31, s29, 3
    s_add_u32 s31, s31, s28
    s_mul_i32 s32, s31, 1152
    s_add_u32 s33, s32, 589824
    s_add_u32 s34, s32, 1179648
    s_add_u32 s35, s32, 1769472
    s_lshl_b32 s36, s28, 13
    s_add_u32 s36, s36, 98304
    s_mul_i32 s43, s30, 384
    s_and_b32 s41, s28, 3
    s_mul_i32 s37, s41, 147456
    s_lshr_b32 s42, s28, 2
    s_lshl_b32 s44, s42, 7
    s_add_u32 s37, s37, s44
    s_add_u32 s37, s37, s43
    s_lshl_b32 s41, s41, 11
    s_cmp_eq_u32 s42, 0
    s_cselect_b32 s38, 81920, 0
    s_cselect_b32 s40, 24576, 0
    s_add_u32 s38, s38, s41
    s_lshr_b32 s41, s54, 2
    s_and_b32 s42, s54, 3
    s_add_u32 s41, s41, s42
    s_mul_i32 s42, s41, 43
    s_lshr_b32 s42, s42, 7
    s_mul_i32 s42, s42, 3
    s_sub_u32 s59, s41, s42
    s_mul_i32 s57, s59, 384
    s_mul_i32 s58, s59, 1769472
    s_add_u32 s37, s37, s58
    s_add_u32 s32, s32, s57
    s_add_u32 s33, s33, s57
    s_add_u32 s34, s34, s57
    s_add_u32 s35, s35, s57
    s_cmp_eq_u32 s59, 2
    s_cselect_b32 s60, 1152, 0
    s_cselect_b32 s62, 5308416, 0
    s_cmp_eq_u32 s59, 1
    s_cselect_b32 s61, 1152, 0
    s_cselect_b32 s63, 5308416, 0
    s_sub_u32 s60, s60, 384
    s_sub_u32 s61, s61, 384
    s_sub_u32 s62, s62, 1769472
    s_sub_u32 s63, s63, 1769472
    s_mov_b32 s49, s32
    s_add_u32 s50, s43, s58
    v_and_b32 v1, 63, v0
    v_lshrrev_b32 v4, 3, v1
    v_and_b32 v5, 7, v1
    v_lshrrev_b32 v6, 1, v4
    v_xor_b32 v5, v5, v6
    v_lshlrev_b32 v5, 4, v5
    s_mov_b32 s41, 73728
    v_mul_lo_u32 v4, v4, s41
    v_add_u32 v2, v4, v5
    v_xor_b32 v3, 64, v2
    v_lshrrev_b32 v5, 3, v1
    v_mul_u32_u24 v4, 9216, v5
    v_bfe_u32 v5, v1, 4, 1
    v_lshlrev_b32 v5, 2, v5
    v_and_b32 v6, 7, v1
    v_xor_b32 v6, v6, v5
    v_lshl_add_u32 v4, v6, 4, v4
    v_lshrrev_b32 v5, 2, v1
    v_lshrrev_b32 v6, 4, v1
    v_xor_b32 v5, v5, v6
    v_and_b32 v5, 1, v5
    v_and_b32 v6, 3, v1
    v_lshlrev_b32 v6, 5, v6
    v_lshrrev_b32 v7, 5, v1
    v_lshl_add_u32 v7, v7, 4, v6
    v_lshl_add_u32 v7, v5, 30, v7
    s_waitcnt lgkmcnt(0)
    s_mov_b32 s16, s4
    s_mov_b32 s17, s5
    s_mov_b32 s18, 0x240000
    s_mov_b32 s19, 0x20000
    s_mov_b32 s20, s6
    s_mov_b32 s21, s7
    s_mov_b32 s22, 0x510000
    s_mov_b32 s23, 0x20000
    s_mov_b32 s12, s10
    s_mov_b32 s13, s11
    s_mov_b32 s14, 0x480
    s_mov_b32 s15, 0x20000
    s_mov_b32 s24, s8
    s_mov_b32 s25, s9
    s_mov_b32 s26, 0x4000000
    s_mov_b32 s27, 0x20000
    s_add_u32 m0, s36, 0
    s_nop 0
    buffer_load_dwordx4 v2, s[16:19], s32 offen offset:0 lds
    s_add_u32 m0, s36, 1024
    s_nop 0
    buffer_load_dwordx4 v3, s[16:19], s33 offen offset:0 lds
    s_add_u32 m0, s36, 2048
    s_nop 0
    buffer_load_dwordx4 v2, s[16:19], s34 offen offset:0 lds
    s_add_u32 m0, s36, 3072
    s_nop 0
    buffer_load_dwordx4 v3, s[16:19], s35 offen offset:0 lds
    buffer_load_dwordx4 v[16:19], v7, s[12:15], s57 offen offset:0
    s_add_u32 s41, s37, 0
    s_add_u32 m0, s38, 0
    s_nop 0
    buffer_load_dwordx4 v4, s[20:23], s41 offen lds
    s_add_u32 s41, s37, 73728
    s_add_u32 m0, s38, 1024
    s_nop 0
    buffer_load_dwordx4 v4, s[20:23], s41 offen lds
    s_add_u32 m0, s36, 3968
    s_nop 0
    buffer_load_dwordx4 v2, s[16:19], s32 offen offset:128 lds
    s_add_u32 m0, s36, 4992
    s_nop 0
    buffer_load_dwordx4 v3, s[16:19], s33 offen offset:128 lds
    s_add_u32 m0, s36, 6016
    s_nop 0
    buffer_load_dwordx4 v2, s[16:19], s34 offen offset:128 lds
    s_add_u32 m0, s36, 7040
    s_nop 0
    buffer_load_dwordx4 v3, s[16:19], s35 offen offset:128 lds
    buffer_load_dwordx4 v[20:23], v7, s[12:15], s57 offen offset:128
    s_add_u32 s38, s38, 8192
    s_add_u32 s41, s37, 589824
    s_add_u32 m0, s38, 0
    s_nop 0
    buffer_load_dwordx4 v4, s[20:23], s41 offen lds
    s_add_u32 s41, s37, 663552
    s_add_u32 m0, s38, 1024
    s_nop 0
    buffer_load_dwordx4 v4, s[20:23], s41 offen lds
    v_lshlrev_b32 v15, 4, v1
    s_lshr_b32 s41, s54, 2
    s_mul_i32 s41, s41, 6
    v_add_u32 v28, s41, v1
    v_min_u32 v28, 31, v28
    s_mov_b32 s41, 73728
    v_mul_lo_u32 v28, v28, s41
    v_cmp_gt_u32 vcc, 6, v1
    v_mov_b32 v31, 0x7f000000
    s_nop 0
    v_cndmask_b32 v28, v31, v28, vcc
    s_and_b32 s41, s54, 3
    s_lshl_b32 s41, s41, 3
    s_add_u32 s41, s41, s28
    s_lshl_b32 s42, s41, 1
    v_mul_u32_u24 v29, 43, v1
    v_lshrrev_b32 v29, 7, v29
    v_mul_u32_u24 v30, 3, v29
    v_sub_u32 v30, v1, v30
    v_add_u32 v29, s42, v29
    v_mul_u32_u24 v29, 9216, v29
    v_lshl_add_u32 v29, v30, 7, v29
    v_cndmask_b32 v29, v31, v29, vcc
    s_lshl_b32 s42, s41, 2
    v_add_u32 v5, s42, v1
    v_mul_u32_u24 v5, 9216, v5
    v_cmp_gt_u32 vcc, 4, v1
    s_nop 1
    v_cndmask_b32 v5, v31, v5, vcc
    buffer_load_dword v30, v28, s[16:19], s49 offen offset:256
    s_add_u32 s41, s50, 1179648
    buffer_load_dword v31, v29, s[20:23], s41 offen
    s_sub_u32 s49, s49, s60
    s_sub_u32 s50, s50, s62
    buffer_load_dword v30, v28, s[16:19], s49 offen offset:0
    s_add_u32 s41, s50, 0
    buffer_load_dword v31, v29, s[20:23], s41 offen
    v_and_b32 v0, 31, v1
    v_lshrrev_b32 v6, 5, v1
    v_lshrrev_b32 v13, 1, v0
    v_and_b32 v13, 7, v13
    v_xor_b32 v13, v13, v6
    v_lshlrev_b32 v13, 4, v13
    v_lshlrev_b32 v0, 7, v0
    v_add_u32 v0, s36, v0
    v_xor_b32 v8, 0, v13
    v_add_u32 v8, v8, v0
    v_xor_b32 v9, 32, v13
    v_add_u32 v9, v9, v0
    v_xor_b32 v10, 64, v13
    v_add_u32 v10, v10, v0
    v_xor_b32 v11, 96, v13
    v_add_u32 v11, v11, v0
    v_lshrrev_b32 v0, 5, v1
    v_lshlrev_b32 v0, 10, v0
    v_bfe_u32 v6, v1, 2, 2
    v_lshl_add_u32 v0, v6, 7, v0
    v_bfe_u32 v6, v1, 3, 1
    v_lshl_add_u32 v0, v6, 6, v0
    v_bfe_u32 v6, v1, 4, 1
    v_lshl_add_u32 v0, v6, 5, v0
    v_and_b32 v6, 3, v1
    v_lshl_add_u32 v14, v6, 3, v0
    v_add_u32 v12, 73728, v14
    v_xor_b32 v13, 64, v12
    v_mov_b32 v0, 0
    s_lshr_b32 s55, s3, 1
    s_lshr_b32 s42, s54, 2
    s_mul_i32 s45, s31, 294912
    s_mul_i32 s41, s55, 73728
    s_add_u32 s45, s45, s41
    s_lshl_b32 s41, s42, 11
    s_add_u32 s45, s45, s41
    s_lshl_b32 s52, s31, 2
    s_add_u32 s52, s52, s55
    s_lshl_b32 s52, s52, 9
    s_lshl_b32 s41, s42, 3
    s_add_u32 s52, s52, s41
    s_add_u32 s52, s52, 41943040
    s_mov_b32 s46, 0xbfb8aa3b
    s_mul_i32 s47, s28, 73728
    s_add_u32 s47, s47, s43
    s_add_u32 s47, s47, 256
    s_lshl_b32 s48, s28, 10
    s_add_u32 s47, s47, s58
    s_waitcnt vmcnt(11)
    s_barrier
    ds_read_b128 v[112:115], v8 offset:0
    ds_read_b128 v[116:119], v9 offset:0
    ds_read_b128 v[120:123], v10 offset:0
    ds_read_b128 v[124:127], v11 offset:0
    ds_read_b64_tr_b16 v[32:33], v12 offset:8192
    ds_read_b64_tr_b16 v[34:35], v12 offset:8704
    ds_read_b64_tr_b16 v[36:37], v13 offset:8192
    ds_read_b64_tr_b16 v[38:39], v13 offset:8704
    ds_read_b64_tr_b16 v[40:41], v14 offset:0
    ds_read_b64_tr_b16 v[42:43], v14 offset:512
    ds_read_b64_tr_b16 v[44:45], v12 offset:10240
    ds_read_b64_tr_b16 v[46:47], v12 offset:10752
    s_waitcnt lgkmcnt(6)
    v_mfma_f32_32x32x16_bf16 v[48:63], v[32:35], v[112:115], 0
    s_add_u32 s38, s38, 8192
    s_sub_u32 s38, s38, s40
    s_add_u32 s41, s37, 1179648
    s_add_u32 m0, s38, 0
    s_nop 0
    buffer_load_dwordx4 v4, s[20:23], s41 offen lds
    s_add_u32 s41, s37, 1253376
    s_add_u32 m0, s38, 1024
    s_nop 0
    buffer_load_dwordx4 v4, s[20:23], s41 offen lds
    s_add_u32 m0, s36, 4294967040
    s_nop 0
    buffer_load_dwordx4 v2, s[16:19], s32 offen offset:256 lds
    s_add_u32 m0, s36, 768
    s_nop 0
    buffer_load_dwordx4 v3, s[16:19], s33 offen offset:256 lds
    s_add_u32 m0, s36, 1792
    s_nop 0
    buffer_load_dwordx4 v2, s[16:19], s34 offen offset:256 lds
    s_add_u32 m0, s36, 2816
    s_nop 0
    buffer_load_dwordx4 v3, s[16:19], s35 offen offset:256 lds
    ds_read_b64_tr_b16 v[32:33], v13 offset:10240
    ds_read_b64_tr_b16 v[34:35], v13 offset:10752
    s_waitcnt lgkmcnt(6)
    v_mfma_f32_32x32x16_bf16 v[64:79], v[36:39], v[112:115], 0
    buffer_load_dwordx4 v[24:27], v7, s[12:15], s57 offen offset:256
    buffer_load_dword v30, v28, s[16:19], s49 offen offset:128
    s_add_u32 s41, s50, 589824
    buffer_load_dword v31, v29, s[20:23], s41 offen
    ds_read_b64_tr_b16 v[36:37], v14 offset:2048
    ds_read_b64_tr_b16 v[38:39], v14 offset:2560
    s_waitcnt lgkmcnt(6)
    v_mfma_f32_32x32x16_bf16 v[80:95], v[40:43], v[112:115], 0
    v_mfma_f32_16x16x32_bf16 v[96:99], v[16:19], v[112:115], 0
    ds_read_b64_tr_b16 v[40:41], v12 offset:12288
    ds_read_b64_tr_b16 v[42:43], v12 offset:12800
    s_waitcnt lgkmcnt(6)
    v_mfma_f32_32x32x16_bf16 v[48:63], v[44:47], v[116:119], v[48:63]
    ds_read_b64_tr_b16 v[44:45], v13 offset:12288
    ds_read_b64_tr_b16 v[46:47], v13 offset:12800
    s_waitcnt lgkmcnt(6)
    v_mfma_f32_32x32x16_bf16 v[64:79], v[32:35], v[116:119], v[64:79]
    v_mfma_f32_16x16x32_bf16 v[100:103], v[16:19], v[116:119], 0
    ds_read_b64_tr_b16 v[32:33], v14 offset:4096
    ds_read_b64_tr_b16 v[34:35], v14 offset:4608
    s_waitcnt lgkmcnt(6)
    v_mfma_f32_32x32x16_bf16 v[80:95], v[36:39], v[116:119], v[80:95]
    ds_read_b64_tr_b16 v[36:37], v12 offset:14336
    ds_read_b64_tr_b16 v[38:39], v12 offset:14848
    s_waitcnt lgkmcnt(6)
    v_mfma_f32_32x32x16_bf16 v[48:63], v[40:43], v[120:123], v[48:63]
    v_mfma_f32_16x16x32_bf16 v[104:107], v[16:19], v[120:123], 0
    ds_read_b64_tr_b16 v[40:41], v13 offset:14336
    ds_read_b64_tr_b16 v[42:43], v13 offset:14848
    s_waitcnt lgkmcnt(6)
    v_mfma_f32_32x32x16_bf16 v[64:79], v[44:47], v[120:123], v[64:79]
    ds_read_b64_tr_b16 v[44:45], v14 offset:6144
    ds_read_b64_tr_b16 v[46:47], v14 offset:6656
    s_waitcnt lgkmcnt(6)
    v_mfma_f32_32x32x16_bf16 v[80:95], v[32:35], v[120:123], v[80:95]
    v_mfma_f32_16x16x32_bf16 v[108:111], v[16:19], v[124:127], 0
    s_waitcnt vmcnt(13)
    s_waitcnt lgkmcnt(2)
    s_barrier
    ds_read_b128 v[128:131], v8 offset:4096
    ds_read_b128 v[132:135], v9 offset:4096
    ds_read_b128 v[136:139], v10 offset:4096
    ds_read_b128 v[140:143], v11 offset:4096
    ds_read_b64_tr_b16 v[32:33], v12 offset:16384
    ds_read_b64_tr_b16 v[34:35], v12 offset:16896
    v_mfma_f32_32x32x16_bf16 v[48:63], v[36:39], v[124:127], v[48:63]
    ds_read_b64_tr_b16 v[36:37], v13 offset:16384
    ds_read_b64_tr_b16 v[38:39], v13 offset:16896
    v_mfma_f32_32x32x16_bf16 v[64:79], v[40:43], v[124:127], v[64:79]
    s_sub_u32 s37, s37, s62
    s_add_u32 s38, s38, 8192
    s_add_u32 s41, s37, 0
    s_add_u32 m0, s38, 0
    s_nop 0
    buffer_load_dwordx4 v4, s[20:23], s41 offen lds
    s_add_u32 s41, s37, 73728
    s_add_u32 m0, s38, 1024
    s_nop 0
    buffer_load_dwordx4 v4, s[20:23], s41 offen lds
    ds_read_b64_tr_b16 v[40:41], v14 offset:8192
    ds_read_b64_tr_b16 v[42:43], v14 offset:8704
    s_waitcnt lgkmcnt(10)
    v_mfma_f32_32x32x16_bf16 v[80:95], v[44:47], v[124:127], v[80:95]
    s_waitcnt lgkmcnt(6)
    s_sub_u32 s32, s32, s60
    s_add_u32 m0, s36, 4096
    s_nop 0
    buffer_load_dwordx4 v2, s[16:19], s32 offen offset:0 lds
    s_sub_u32 s33, s33, s60
    s_add_u32 m0, s36, 5120
    s_nop 0
    buffer_load_dwordx4 v3, s[16:19], s33 offen offset:0 lds
    ds_read_b64_tr_b16 v[44:45], v12 offset:18432
    ds_read_b64_tr_b16 v[46:47], v12 offset:18944
    s_waitcnt lgkmcnt(6)
    v_mfma_f32_32x32x16_bf16 v[48:63], v[32:35], v[128:131], v[48:63]
    s_sub_u32 s34, s34, s60
    s_add_u32 m0, s36, 6144
    s_nop 0
    buffer_load_dwordx4 v2, s[16:19], s34 offen offset:0 lds
    s_sub_u32 s35, s35, s60
    s_add_u32 m0, s36, 7168
    s_nop 0
    buffer_load_dwordx4 v3, s[16:19], s35 offen offset:0 lds
    ds_read_b64_tr_b16 v[32:33], v13 offset:18432
    ds_read_b64_tr_b16 v[34:35], v13 offset:18944
    s_waitcnt lgkmcnt(6)
    v_mfma_f32_32x32x16_bf16 v[64:79], v[36:39], v[128:131], v[64:79]
    s_sub_u32 s57, s57, s60
    buffer_load_dwordx4 v[16:19], v7, s[12:15], s57 offen offset:0
    buffer_load_dword v30, v28, s[16:19], s49 offen offset:256
    s_add_u32 s41, s50, 1179648
    buffer_load_dword v31, v29, s[20:23], s41 offen
    ds_read_b64_tr_b16 v[36:37], v14 offset:10240
    ds_read_b64_tr_b16 v[38:39], v14 offset:10752
    s_waitcnt lgkmcnt(6)
    v_mfma_f32_32x32x16_bf16 v[80:95], v[40:43], v[128:131], v[80:95]
    v_mfma_f32_16x16x32_bf16 v[96:99], v[20:23], v[128:131], v[96:99]
    ds_read_b64_tr_b16 v[40:41], v12 offset:20480
    ds_read_b64_tr_b16 v[42:43], v12 offset:20992
    s_waitcnt lgkmcnt(6)
    v_mfma_f32_32x32x16_bf16 v[48:63], v[44:47], v[132:135], v[48:63]
    ds_read_b64_tr_b16 v[44:45], v13 offset:20480
    ds_read_b64_tr_b16 v[46:47], v13 offset:20992
    s_waitcnt lgkmcnt(6)
    v_mfma_f32_32x32x16_bf16 v[64:79], v[32:35], v[132:135], v[64:79]
    v_mfma_f32_16x16x32_bf16 v[100:103], v[20:23], v[132:135], v[100:103]
    ds_read_b64_tr_b16 v[32:33], v14 offset:12288
    ds_read_b64_tr_b16 v[34:35], v14 offset:12800
    s_waitcnt lgkmcnt(6)
    v_mfma_f32_32x32x16_bf16 v[80:95], v[36:39], v[132:135], v[80:95]
    ds_read_b64_tr_b16 v[36:37], v12 offset:22528
    ds_read_b64_tr_b16 v[38:39], v12 offset:23040
    s_waitcnt lgkmcnt(6)
    v_mfma_f32_32x32x16_bf16 v[48:63], v[40:43], v[136:139], v[48:63]
    v_mfma_f32_16x16x32_bf16 v[104:107], v[20:23], v[136:139], v[104:107]
    ds_read_b64_tr_b16 v[40:41], v13 offset:22528
    ds_read_b64_tr_b16 v[42:43], v13 offset:23040
    s_waitcnt lgkmcnt(6)
    v_mfma_f32_32x32x16_bf16 v[64:79], v[44:47], v[136:139], v[64:79]
    ds_read_b64_tr_b16 v[44:45], v14 offset:14336
    ds_read_b64_tr_b16 v[46:47], v14 offset:14848
    s_waitcnt lgkmcnt(6)
    v_mfma_f32_32x32x16_bf16 v[80:95], v[32:35], v[136:139], v[80:95]
    v_mfma_f32_16x16x32_bf16 v[108:111], v[20:23], v[140:143], v[108:111]
    s_waitcnt vmcnt(11)
    s_waitcnt lgkmcnt(2)
    s_barrier
    ds_read_b128 v[144:147], v8 offset:0
    ds_read_b128 v[148:151], v9 offset:0
    ds_read_b128 v[152:155], v10 offset:0
    ds_read_b128 v[156:159], v11 offset:0
    ds_read_b64_tr_b16 v[32:33], v12 offset:0
    ds_read_b64_tr_b16 v[34:35], v12 offset:512
    v_mfma_f32_32x32x16_bf16 v[48:63], v[36:39], v[140:143], v[48:63]
    ds_read_b64_tr_b16 v[36:37], v13 offset:0
    ds_read_b64_tr_b16 v[38:39], v13 offset:512
    v_mfma_f32_32x32x16_bf16 v[64:79], v[40:43], v[140:143], v[64:79]
    s_add_u32 s38, s38, 8192
    s_add_u32 s41, s37, 589824
    s_add_u32 m0, s38, 0
    s_nop 0
    buffer_load_dwordx4 v4, s[20:23], s41 offen lds
    s_add_u32 s41, s37, 663552
    s_add_u32 m0, s38, 1024
    s_nop 0
    buffer_load_dwordx4 v4, s[20:23], s41 offen lds
    ds_read_b64_tr_b16 v[40:41], v14 offset:16384
    ds_read_b64_tr_b16 v[42:43], v14 offset:16896
    s_waitcnt lgkmcnt(10)
    v_mfma_f32_32x32x16_bf16 v[80:95], v[44:47], v[140:143], v[80:95]
    s_waitcnt lgkmcnt(6)
    s_add_u32 m0, s36, 4294967168
    s_nop 0
    buffer_load_dwordx4 v2, s[16:19], s32 offen offset:128 lds
    s_add_u32 m0, s36, 896
    s_nop 0
    buffer_load_dwordx4 v3, s[16:19], s33 offen offset:128 lds
    ds_read_b64_tr_b16 v[44:45], v12 offset:2048
    ds_read_b64_tr_b16 v[46:47], v12 offset:2560
    s_waitcnt lgkmcnt(6)
    v_mfma_f32_32x32x16_bf16 v[48:63], v[32:35], v[144:147], v[48:63]
    s_add_u32 m0, s36, 1920
    s_nop 0
    buffer_load_dwordx4 v2, s[16:19], s34 offen offset:128 lds
    s_add_u32 m0, s36, 2944
    s_nop 0
    buffer_load_dwordx4 v3, s[16:19], s35 offen offset:128 lds
    ds_read_b64_tr_b16 v[32:33], v13 offset:2048
    ds_read_b64_tr_b16 v[34:35], v13 offset:2560
    s_waitcnt lgkmcnt(6)
    v_mfma_f32_32x32x16_bf16 v[64:79], v[36:39], v[144:147], v[64:79]
    buffer_load_dwordx4 v[20:23], v7, s[12:15], s57 offen offset:128
    s_sub_u32 s49, s49, s61
    s_sub_u32 s50, s50, s63
    buffer_load_dword v30, v28, s[16:19], s49 offen offset:0
    s_add_u32 s41, s50, 0
    buffer_load_dword v31, v29, s[20:23], s41 offen
    ds_read_b64_tr_b16 v[36:37], v14 offset:18432
    ds_read_b64_tr_b16 v[38:39], v14 offset:18944
    s_waitcnt lgkmcnt(6)
    v_mfma_f32_32x32x16_bf16 v[80:95], v[40:43], v[144:147], v[80:95]
    v_mfma_f32_16x16x32_bf16 v[96:99], v[24:27], v[144:147], v[96:99]
    ds_read_b64_tr_b16 v[40:41], v12 offset:4096
    ds_read_b64_tr_b16 v[42:43], v12 offset:4608
    s_waitcnt lgkmcnt(6)
    v_mfma_f32_32x32x16_bf16 v[48:63], v[44:47], v[148:151], v[48:63]
    ds_read_b64_tr_b16 v[44:45], v13 offset:4096
    ds_read_b64_tr_b16 v[46:47], v13 offset:4608
    s_waitcnt lgkmcnt(6)
    v_mfma_f32_32x32x16_bf16 v[64:79], v[32:35], v[148:151], v[64:79]
    v_mfma_f32_16x16x32_bf16 v[100:103], v[24:27], v[148:151], v[100:103]
    ds_read_b64_tr_b16 v[32:33], v14 offset:20480
    ds_read_b64_tr_b16 v[34:35], v14 offset:20992
    s_waitcnt lgkmcnt(6)
    v_mfma_f32_32x32x16_bf16 v[80:95], v[36:39], v[148:151], v[80:95]
    ds_read_b64_tr_b16 v[36:37], v12 offset:6144
    ds_read_b64_tr_b16 v[38:39], v12 offset:6656
    s_waitcnt lgkmcnt(6)
    v_mfma_f32_32x32x16_bf16 v[48:63], v[40:43], v[152:155], v[48:63]
    v_mfma_f32_16x16x32_bf16 v[104:107], v[24:27], v[152:155], v[104:107]
    ds_read_b64_tr_b16 v[40:41], v13 offset:6144
    ds_read_b64_tr_b16 v[42:43], v13 offset:6656
    s_waitcnt lgkmcnt(6)
    v_mfma_f32_32x32x16_bf16 v[64:79], v[44:47], v[152:155], v[64:79]
    ds_read_b64_tr_b16 v[44:45], v14 offset:22528
    ds_read_b64_tr_b16 v[46:47], v14 offset:23040
    s_waitcnt lgkmcnt(6)
    v_mfma_f32_32x32x16_bf16 v[80:95], v[32:35], v[152:155], v[80:95]
    v_mfma_f32_16x16x32_bf16 v[108:111], v[24:27], v[156:159], v[108:111]
    s_waitcnt vmcnt(11)
    s_waitcnt lgkmcnt(2)
    s_barrier
    ds_read_b128 v[160:163], v8 offset:4096
    ds_read_b128 v[164:167], v9 offset:4096
    ds_read_b128 v[168:171], v10 offset:4096
    ds_read_b128 v[172:175], v11 offset:4096
    ds_read_b64_tr_b16 v[32:33], v12 offset:8192
    ds_read_b64_tr_b16 v[34:35], v12 offset:8704
    v_mfma_f32_32x32x16_bf16 v[48:63], v[36:39], v[156:159], v[48:63]
    ds_read_b64_tr_b16 v[36:37], v13 offset:8192
    ds_read_b64_tr_b16 v[38:39], v13 offset:8704
    v_mfma_f32_32x32x16_bf16 v[64:79], v[40:43], v[156:159], v[64:79]
    s_add_u32 s38, s38, 8192
    s_sub_u32 s38, s38, s40
    s_add_u32 s41, s37, 1179648
    s_add_u32 m0, s38, 0
    s_nop 0
    buffer_load_dwordx4 v4, s[20:23], s41 offen lds
    s_add_u32 s41, s37, 1253376
    s_add_u32 m0, s38, 1024
    s_nop 0
    buffer_load_dwordx4 v4, s[20:23], s41 offen lds
    ds_read_b64_tr_b16 v[40:41], v14 offset:24576
    ds_read_b64_tr_b16 v[42:43], v14 offset:25088
    s_waitcnt lgkmcnt(10)
    v_mfma_f32_32x32x16_bf16 v[80:95], v[44:47], v[156:159], v[80:95]
    s_waitcnt lgkmcnt(6)
    s_add_u32 m0, s36, 3840
    s_nop 0
    buffer_load_dwordx4 v2, s[16:19], s32 offen offset:256 lds
    s_add_u32 m0, s36, 4864
    s_nop 0
    buffer_load_dwordx4 v3, s[16:19], s33 offen offset:256 lds
    ds_read_b64_tr_b16 v[44:45], v12 offset:10240
    ds_read_b64_tr_b16 v[46:47], v12 offset:10752
    s_waitcnt lgkmcnt(6)
    v_mfma_f32_32x32x16_bf16 v[48:63], v[32:35], v[160:163], v[48:63]
    s_add_u32 m0, s36, 5888
    s_nop 0
    buffer_load_dwordx4 v2, s[16:19], s34 offen offset:256 lds
    s_add_u32 m0, s36, 6912
    s_nop 0
    buffer_load_dwordx4 v3, s[16:19], s35 offen offset:256 lds
    ds_read_b64_tr_b16 v[32:33], v13 offset:10240
    ds_read_b64_tr_b16 v[34:35], v13 offset:10752
    s_waitcnt lgkmcnt(6)
    v_mfma_f32_32x32x16_bf16 v[64:79], v[36:39], v[160:163], v[64:79]
    buffer_load_dwordx4 v[24:27], v7, s[12:15], s57 offen offset:256
    buffer_load_dword v30, v28, s[16:19], s49 offen offset:128
    s_add_u32 s41, s50, 589824
    buffer_load_dword v31, v29, s[20:23], s41 offen
    ds_read_b64_tr_b16 v[36:37], v14 offset:26624
    ds_read_b64_tr_b16 v[38:39], v14 offset:27136
    s_waitcnt lgkmcnt(6)
    v_mfma_f32_32x32x16_bf16 v[80:95], v[40:43], v[160:163], v[80:95]
    v_mfma_f32_16x16x32_bf16 v[96:99], v[16:19], v[160:163], v[96:99]
    ds_read_b64_tr_b16 v[40:41], v12 offset:12288
    ds_read_b64_tr_b16 v[42:43], v12 offset:12800
    s_waitcnt lgkmcnt(6)
    v_mfma_f32_32x32x16_bf16 v[48:63], v[44:47], v[164:167], v[48:63]
    ds_read_b64_tr_b16 v[44:45], v13 offset:12288
    ds_read_b64_tr_b16 v[46:47], v13 offset:12800
    s_waitcnt lgkmcnt(6)
    v_mfma_f32_32x32x16_bf16 v[64:79], v[32:35], v[164:167], v[64:79]
    s_add_u32 s41, s43, s58
    buffer_load_dword v5, v5, s[20:23], s41 offen offset:256
    v_mfma_f32_16x16x32_bf16 v[100:103], v[16:19], v[164:167], v[100:103]
    ds_read_b64_tr_b16 v[32:33], v14 offset:28672
    ds_read_b64_tr_b16 v[34:35], v14 offset:29184
    s_waitcnt lgkmcnt(6)
    v_mfma_f32_32x32x16_bf16 v[80:95], v[36:39], v[164:167], v[80:95]
    ds_read_b64_tr_b16 v[36:37], v12 offset:14336
    ds_read_b64_tr_b16 v[38:39], v12 offset:14848
    s_waitcnt lgkmcnt(6)
    v_mfma_f32_32x32x16_bf16 v[48:63], v[40:43], v[168:171], v[48:63]
    v_mfma_f32_16x16x32_bf16 v[104:107], v[16:19], v[168:171], v[104:107]
    ds_read_b64_tr_b16 v[40:41], v13 offset:14336
    ds_read_b64_tr_b16 v[42:43], v13 offset:14848
    s_waitcnt lgkmcnt(6)
    v_mfma_f32_32x32x16_bf16 v[64:79], v[44:47], v[168:171], v[64:79]
    ds_read_b64_tr_b16 v[44:45], v14 offset:30720
    ds_read_b64_tr_b16 v[46:47], v14 offset:31232
    s_waitcnt lgkmcnt(6)
    v_mfma_f32_32x32x16_bf16 v[80:95], v[32:35], v[168:171], v[80:95]
    v_mfma_f32_16x16x32_bf16 v[108:111], v[16:19], v[172:175], v[108:111]
    s_waitcnt vmcnt(12)
    s_waitcnt lgkmcnt(2)
    s_barrier
    ds_read_b128 v[176:179], v8 offset:0
    ds_read_b128 v[180:183], v9 offset:0
    ds_read_b128 v[184:187], v10 offset:0
    ds_read_b128 v[188:191], v11 offset:0
    ds_read_b64_tr_b16 v[32:33], v12 offset:16384
    ds_read_b64_tr_b16 v[34:35], v12 offset:16896
    v_mfma_f32_32x32x16_bf16 v[48:63], v[36:39], v[172:175], v[48:63]
    ds_read_b64_tr_b16 v[36:37], v13 offset:16384
    ds_read_b64_tr_b16 v[38:39], v13 offset:16896
    v_mfma_f32_32x32x16_bf16 v[64:79], v[40:43], v[172:175], v[64:79]
    s_sub_u32 s37, s37, s63
    s_add_u32 s38, s38, 8192
    s_add_u32 s41, s37, 0
    s_add_u32 m0, s38, 0
    s_nop 0
    buffer_load_dwordx4 v4, s[20:23], s41 offen lds
    s_add_u32 s41, s37, 73728
    s_add_u32 m0, s38, 1024
    s_nop 0
    buffer_load_dwordx4 v4, s[20:23], s41 offen lds
    ds_read_b64_tr_b16 v[40:41], v14 offset:32768
    ds_read_b64_tr_b16 v[42:43], v14 offset:33280
    s_waitcnt lgkmcnt(10)
    v_mfma_f32_32x32x16_bf16 v[80:95], v[44:47], v[172:175], v[80:95]
    s_waitcnt lgkmcnt(6)
    s_sub_u32 s32, s32, s61
    s_add_u32 m0, s36, 0
    s_nop 0
    buffer_load_dwordx4 v2, s[16:19], s32 offen offset:0 lds
    s_sub_u32 s33, s33, s61
    s_add_u32 m0, s36, 1024
    s_nop 0
    buffer_load_dwordx4 v3, s[16:19], s33 offen offset:0 lds
    ds_read_b64_tr_b16 v[44:45], v12 offset:18432
    ds_read_b64_tr_b16 v[46:47], v12 offset:18944
    s_waitcnt lgkmcnt(6)
    v_mfma_f32_32x32x16_bf16 v[48:63], v[32:35], v[176:179], v[48:63]
    s_sub_u32 s34, s34, s61
    s_add_u32 m0, s36, 2048
    s_nop 0
    buffer_load_dwordx4 v2, s[16:19], s34 offen offset:0 lds
    s_sub_u32 s35, s35, s61
    s_add_u32 m0, s36, 3072
    s_nop 0
    buffer_load_dwordx4 v3, s[16:19], s35 offen offset:0 lds
    ds_read_b64_tr_b16 v[32:33], v13 offset:18432
    ds_read_b64_tr_b16 v[34:35], v13 offset:18944
    s_waitcnt lgkmcnt(6)
    v_mfma_f32_32x32x16_bf16 v[64:79], v[36:39], v[176:179], v[64:79]
    s_sub_u32 s57, s57, s61
    buffer_load_dwordx4 v[16:19], v7, s[12:15], s57 offen offset:0
    buffer_load_dword v30, v28, s[16:19], s49 offen offset:256
    s_add_u32 s41, s50, 1179648
    buffer_load_dword v31, v29, s[20:23], s41 offen
    ds_read_b64_tr_b16 v[36:37], v14 offset:34816
    ds_read_b64_tr_b16 v[38:39], v14 offset:35328
    s_waitcnt lgkmcnt(6)
    v_mfma_f32_32x32x16_bf16 v[80:95], v[40:43], v[176:179], v[80:95]
    v_mfma_f32_16x16x32_bf16 v[96:99], v[20:23], v[176:179], v[96:99]
    ds_read_b64_tr_b16 v[40:41], v12 offset:20480
    ds_read_b64_tr_b16 v[42:43], v12 offset:20992
    s_waitcnt lgkmcnt(6)
    v_mfma_f32_32x32x16_bf16 v[48:63], v[44:47], v[180:183], v[48:63]
    ds_read_b64_tr_b16 v[44:45], v13 offset:20480
    ds_read_b64_tr_b16 v[46:47], v13 offset:20992
    s_waitcnt lgkmcnt(6)
    v_mfma_f32_32x32x16_bf16 v[64:79], v[32:35], v[180:183], v[64:79]
    v_mfma_f32_16x16x32_bf16 v[100:103], v[20:23], v[180:183], v[100:103]
    ds_read_b64_tr_b16 v[32:33], v14 offset:36864
    ds_read_b64_tr_b16 v[34:35], v14 offset:37376
    s_waitcnt lgkmcnt(6)
    v_mfma_f32_32x32x16_bf16 v[80:95], v[36:39], v[180:183], v[80:95]
    ds_read_b64_tr_b16 v[36:37], v12 offset:22528
    ds_read_b64_tr_b16 v[38:39], v12 offset:23040
    s_waitcnt lgkmcnt(6)
    v_mfma_f32_32x32x16_bf16 v[48:63], v[40:43], v[184:187], v[48:63]
    v_mfma_f32_16x16x32_bf16 v[104:107], v[20:23], v[184:187], v[104:107]
    ds_read_b64_tr_b16 v[40:41], v13 offset:22528
    ds_read_b64_tr_b16 v[42:43], v13 offset:23040
    s_waitcnt lgkmcnt(6)
    v_mfma_f32_32x32x16_bf16 v[64:79], v[44:47], v[184:187], v[64:79]
    ds_read_b64_tr_b16 v[44:45], v14 offset:38912
    ds_read_b64_tr_b16 v[46:47], v14 offset:39424
    s_waitcnt lgkmcnt(6)
    v_mfma_f32_32x32x16_bf16 v[80:95], v[32:35], v[184:187], v[80:95]
    v_mfma_f32_16x16x32_bf16 v[108:111], v[20:23], v[188:191], v[108:111]
    s_waitcnt vmcnt(12)
    s_waitcnt lgkmcnt(2)
    s_barrier
    ds_read_b128 v[192:195], v8 offset:4096
    ds_read_b128 v[196:199], v9 offset:4096
    ds_read_b128 v[200:203], v10 offset:4096
    ds_read_b128 v[204:207], v11 offset:4096
    ds_read_b64_tr_b16 v[32:33], v12 offset:0
    ds_read_b64_tr_b16 v[34:35], v12 offset:512
    v_mfma_f32_32x32x16_bf16 v[48:63], v[36:39], v[188:191], v[48:63]
    ds_read_b64_tr_b16 v[36:37], v13 offset:0
    ds_read_b64_tr_b16 v[38:39], v13 offset:512
    v_mfma_f32_32x32x16_bf16 v[64:79], v[40:43], v[188:191], v[64:79]
    s_add_u32 s38, s38, 8192
    s_add_u32 s41, s37, 589824
    s_add_u32 m0, s38, 0
    s_nop 0
    buffer_load_dwordx4 v4, s[20:23], s41 offen lds
    s_add_u32 s41, s37, 663552
    s_add_u32 m0, s38, 1024
    s_nop 0
    buffer_load_dwordx4 v4, s[20:23], s41 offen lds
    ds_read_b64_tr_b16 v[40:41], v14 offset:40960
    ds_read_b64_tr_b16 v[42:43], v14 offset:41472
    s_waitcnt lgkmcnt(10)
    v_mfma_f32_32x32x16_bf16 v[80:95], v[44:47], v[188:191], v[80:95]
    s_waitcnt lgkmcnt(6)
    s_add_u32 m0, s36, 3968
    s_nop 0
    buffer_load_dwordx4 v2, s[16:19], s32 offen offset:128 lds
    s_add_u32 m0, s36, 4992
    s_nop 0
    buffer_load_dwordx4 v3, s[16:19], s33 offen offset:128 lds
    ds_read_b64_tr_b16 v[44:45], v12 offset:2048
    ds_read_b64_tr_b16 v[46:47], v12 offset:2560
    s_waitcnt lgkmcnt(6)
    v_mfma_f32_32x32x16_bf16 v[48:63], v[32:35], v[192:195], v[48:63]
    s_add_u32 m0, s36, 6016
    s_nop 0
    buffer_load_dwordx4 v2, s[16:19], s34 offen offset:128 lds
    s_add_u32 m0, s36, 7040
    s_nop 0
    buffer_load_dwordx4 v3, s[16:19], s35 offen offset:128 lds
    ds_read_b64_tr_b16 v[32:33], v13 offset:2048
    ds_read_b64_tr_b16 v[34:35], v13 offset:2560
    s_waitcnt lgkmcnt(6)
    v_mfma_f32_32x32x16_bf16 v[64:79], v[36:39], v[192:195], v[64:79]
    buffer_load_dwordx4 v[20:23], v7, s[12:15], s57 offen offset:128
    ds_read_b64_tr_b16 v[36:37], v14 offset:43008
    ds_read_b64_tr_b16 v[38:39], v14 offset:43520
    s_waitcnt lgkmcnt(6)
    v_mfma_f32_32x32x16_bf16 v[80:95], v[40:43], v[192:195], v[80:95]
    v_mfma_f32_16x16x32_bf16 v[96:99], v[24:27], v[192:195], v[96:99]
    ds_read_b64_tr_b16 v[40:41], v12 offset:4096
    ds_read_b64_tr_b16 v[42:43], v12 offset:4608
    s_waitcnt lgkmcnt(6)
    v_mfma_f32_32x32x16_bf16 v[48:63], v[44:47], v[196:199], v[48:63]
    ds_read_b64_tr_b16 v[44:45], v13 offset:4096
    ds_read_b64_tr_b16 v[46:47], v13 offset:4608
    s_waitcnt lgkmcnt(6)
    v_mfma_f32_32x32x16_bf16 v[64:79], v[32:35], v[196:199], v[64:79]
    v_mfma_f32_16x16x32_bf16 v[100:103], v[24:27], v[196:199], v[100:103]
    ds_read_b64_tr_b16 v[32:33], v14 offset:45056
    ds_read_b64_tr_b16 v[34:35], v14 offset:45568
    s_waitcnt lgkmcnt(6)
    v_mfma_f32_32x32x16_bf16 v[80:95], v[36:39], v[196:199], v[80:95]
    ds_read_b64_tr_b16 v[36:37], v12 offset:6144
    ds_read_b64_tr_b16 v[38:39], v12 offset:6656
    s_waitcnt lgkmcnt(6)
    v_mfma_f32_32x32x16_bf16 v[48:63], v[40:43], v[200:203], v[48:63]
    v_mfma_f32_16x16x32_bf16 v[104:107], v[24:27], v[200:203], v[104:107]
    ds_read_b64_tr_b16 v[40:41], v13 offset:6144
    ds_read_b64_tr_b16 v[42:43], v13 offset:6656
    s_waitcnt lgkmcnt(6)
    v_mfma_f32_32x32x16_bf16 v[64:79], v[44:47], v[200:203], v[64:79]
    ds_read_b64_tr_b16 v[44:45], v14 offset:47104
    ds_read_b64_tr_b16 v[46:47], v14 offset:47616
    s_waitcnt lgkmcnt(6)
    v_mfma_f32_32x32x16_bf16 v[80:95], v[32:35], v[200:203], v[80:95]
    v_mfma_f32_16x16x32_bf16 v[108:111], v[24:27], v[204:207], v[108:111]
    s_waitcnt vmcnt(9)
    s_waitcnt lgkmcnt(2)
    s_barrier
    ds_read_b128 v[208:211], v8 offset:0
    ds_read_b128 v[212:215], v9 offset:0
    ds_read_b128 v[216:219], v10 offset:0
    ds_read_b128 v[220:223], v11 offset:0
    ds_read_b64_tr_b16 v[32:33], v12 offset:8192
    ds_read_b64_tr_b16 v[34:35], v12 offset:8704
    v_mfma_f32_32x32x16_bf16 v[48:63], v[36:39], v[204:207], v[48:63]
    ds_read_b64_tr_b16 v[36:37], v13 offset:8192
    ds_read_b64_tr_b16 v[38:39], v13 offset:8704
    v_mfma_f32_32x32x16_bf16 v[64:79], v[40:43], v[204:207], v[64:79]
    s_add_u32 s38, s38, 8192
    s_sub_u32 s38, s38, s40
    s_add_u32 s41, s37, 1179648
    s_add_u32 m0, s38, 0
    s_nop 0
    buffer_load_dwordx4 v4, s[20:23], s41 offen lds
    s_add_u32 s41, s37, 1253376
    s_add_u32 m0, s38, 1024
    s_nop 0
    buffer_load_dwordx4 v4, s[20:23], s41 offen lds
    ds_read_b64_tr_b16 v[40:41], v14 offset:49152
    ds_read_b64_tr_b16 v[42:43], v14 offset:49664
    s_waitcnt lgkmcnt(10)
    v_mfma_f32_32x32x16_bf16 v[80:95], v[44:47], v[204:207], v[80:95]
    s_waitcnt lgkmcnt(6)
    s_add_u32 m0, s36, 4294967040
    s_nop 0
    buffer_load_dwordx4 v2, s[16:19], s32 offen offset:256 lds
    s_add_u32 m0, s36, 768
    s_nop 0
    buffer_load_dwordx4 v3, s[16:19], s33 offen offset:256 lds
    ds_read_b64_tr_b16 v[44:45], v12 offset:10240
    ds_read_b64_tr_b16 v[46:47], v12 offset:10752
    s_waitcnt lgkmcnt(6)
    v_mfma_f32_32x32x16_bf16 v[48:63], v[32:35], v[208:211], v[48:63]
    s_add_u32 m0, s36, 1792
    s_nop 0
    buffer_load_dwordx4 v2, s[16:19], s34 offen offset:256 lds
    s_add_u32 m0, s36, 2816
    s_nop 0
    buffer_load_dwordx4 v3, s[16:19], s35 offen offset:256 lds
    ds_read_b64_tr_b16 v[32:33], v13 offset:10240
    ds_read_b64_tr_b16 v[34:35], v13 offset:10752
    s_waitcnt lgkmcnt(6)
    v_mfma_f32_32x32x16_bf16 v[64:79], v[36:39], v[208:211], v[64:79]
    buffer_load_dwordx4 v[24:27], v7, s[12:15], s57 offen offset:256
    ds_read_b64_tr_b16 v[36:37], v14 offset:51200
    ds_read_b64_tr_b16 v[38:39], v14 offset:51712
    s_waitcnt lgkmcnt(6)
    v_mfma_f32_32x32x16_bf16 v[80:95], v[40:43], v[208:211], v[80:95]
    v_mfma_f32_16x16x32_bf16 v[96:99], v[16:19], v[208:211], v[96:99]
    global_load_dwordx2 v[2:3], v0, s[100:101] sc1
    ds_read_b64_tr_b16 v[40:41], v12 offset:12288
    ds_read_b64_tr_b16 v[42:43], v12 offset:12800
    s_waitcnt lgkmcnt(6)
    v_mfma_f32_32x32x16_bf16 v[48:63], v[44:47], v[212:215], v[48:63]
    s_mov_b32 s12, s96
    s_mov_b32 s13, s97
    s_mov_b32 s14, 0x510000
    s_mov_b32 s15, 0x20000
    s_getpc_b64 s[16:17]
    s_add_u32 s16, s16, GTR@rel32@lo+4
    s_addc_u32 s17, s17, GTR@rel32@hi+12
    s_mov_b32 s18, 663552
    s_mov_b32 s19, 0x20000
    s_and_b32 s41, s28, 3
    s_lshl_b32 s42, s54, 2
    s_add_u32 s41, s41, s42
    s_lshr_b32 s42, s41, 4
    s_mul_i32 s42, s42, 221184
    s_and_b32 s41, s41, 15
    s_mul_i32 s41, s41, 2304
    s_add_u32 s42, s42, s41
    s_mul_i32 s56, s55, 1327104
    s_add_u32 s56, s56, s42
    s_lshr_b32 s41, s28, 2
    s_mul_i32 s41, s41, 36864
    s_add_u32 s41, s41, s56
    v_min_u32 v7, 17, v1
    v_lshlrev_b32 v7, 7, v7
    buffer_load_dword v7, v7, s[12:15], s41 offen
    ds_read_b64_tr_b16 v[44:45], v13 offset:12288
    ds_read_b64_tr_b16 v[46:47], v13 offset:12800
    s_waitcnt lgkmcnt(6)
    v_mfma_f32_32x32x16_bf16 v[64:79], v[32:35], v[212:215], v[64:79]
    v_mfma_f32_16x16x32_bf16 v[100:103], v[16:19], v[212:215], v[100:103]
    ds_read_b64_tr_b16 v[32:33], v14 offset:53248
    ds_read_b64_tr_b16 v[34:35], v14 offset:53760
    s_waitcnt lgkmcnt(6)
    v_mfma_f32_32x32x16_bf16 v[80:95], v[36:39], v[212:215], v[80:95]
    ds_read_b64_tr_b16 v[36:37], v12 offset:14336
    ds_read_b64_tr_b16 v[38:39], v12 offset:14848
    s_waitcnt lgkmcnt(6)
    v_mfma_f32_32x32x16_bf16 v[48:63], v[40:43], v[216:219], v[48:63]
    v_mfma_f32_16x16x32_bf16 v[104:107], v[16:19], v[216:219], v[104:107]
    ds_read_b64_tr_b16 v[40:41], v13 offset:14336
    ds_read_b64_tr_b16 v[42:43], v13 offset:14848
    s_waitcnt lgkmcnt(6)
    v_mfma_f32_32x32x16_bf16 v[64:79], v[44:47], v[216:219], v[64:79]
    ds_read_b64_tr_b16 v[44:45], v14 offset:55296
    ds_read_b64_tr_b16 v[46:47], v14 offset:55808
    s_waitcnt lgkmcnt(6)
    v_mfma_f32_32x32x16_bf16 v[80:95], v[32:35], v[216:219], v[80:95]
    v_mfma_f32_16x16x32_bf16 v[108:111], v[16:19], v[220:223], v[108:111]
    s_waitcnt vmcnt(9)
    s_waitcnt lgkmcnt(2)
    s_barrier
    ds_read_b128 v[224:227], v8 offset:4096
    ds_read_b128 v[228:231], v9 offset:4096
    ds_read_b128 v[232:235], v10 offset:4096
    ds_read_b128 v[236:239], v11 offset:4096
    ds_read_b64_tr_b16 v[32:33], v12 offset:16384
    ds_read_b64_tr_b16 v[34:35], v12 offset:16896
    v_mfma_f32_32x32x16_bf16 v[48:63], v[36:39], v[220:223], v[48:63]
    ds_read_b64_tr_b16 v[36:37], v13 offset:16384
    ds_read_b64_tr_b16 v[38:39], v13 offset:16896
    v_mfma_f32_32x32x16_bf16 v[64:79], v[40:43], v[220:223], v[64:79]
    ds_read_b64_tr_b16 v[40:41], v14 offset:57344
    ds_read_b64_tr_b16 v[42:43], v14 offset:57856
    s_waitcnt lgkmcnt(10)
    v_mfma_f32_32x32x16_bf16 v[80:95], v[44:47], v[220:223], v[80:95]
    ds_read_b64_tr_b16 v[44:45], v12 offset:18432
    ds_read_b64_tr_b16 v[46:47], v12 offset:18944
    s_waitcnt lgkmcnt(6)
    v_mfma_f32_32x32x16_bf16 v[48:63], v[32:35], v[224:227], v[48:63]
    ds_read_b64_tr_b16 v[32:33], v13 offset:18432
    ds_read_b64_tr_b16 v[34:35], v13 offset:18944
    s_waitcnt lgkmcnt(6)
    v_mfma_f32_32x32x16_bf16 v[64:79], v[36:39], v[224:227], v[64:79]
    ds_read_b64_tr_b16 v[36:37], v14 offset:59392
    ds_read_b64_tr_b16 v[38:39], v14 offset:59904
    s_waitcnt lgkmcnt(6)
    v_mfma_f32_32x32x16_bf16 v[80:95], v[40:43], v[224:227], v[80:95]
    v_mfma_f32_16x16x32_bf16 v[96:99], v[20:23], v[224:227], v[96:99]
    ds_read_b64_tr_b16 v[40:41], v12 offset:20480
    ds_read_b64_tr_b16 v[42:43], v12 offset:20992
    s_waitcnt lgkmcnt(6)
    v_mfma_f32_32x32x16_bf16 v[48:63], v[44:47], v[228:231], v[48:63]
    ds_read_b64_tr_b16 v[44:45], v13 offset:20480
    ds_read_b64_tr_b16 v[46:47], v13 offset:20992
    s_waitcnt lgkmcnt(6)
    v_mfma_f32_32x32x16_bf16 v[64:79], v[32:35], v[228:231], v[64:79]
    v_mfma_f32_16x16x32_bf16 v[100:103], v[20:23], v[228:231], v[100:103]
    ds_read_b64_tr_b16 v[32:33], v14 offset:61440
    ds_read_b64_tr_b16 v[34:35], v14 offset:61952
    s_waitcnt lgkmcnt(6)
    v_mfma_f32_32x32x16_bf16 v[80:95], v[36:39], v[228:231], v[80:95]
    ds_read_b64_tr_b16 v[36:37], v12 offset:22528
    ds_read_b64_tr_b16 v[38:39], v12 offset:23040
    s_waitcnt lgkmcnt(6)
    v_mfma_f32_32x32x16_bf16 v[48:63], v[40:43], v[232:235], v[48:63]
    v_mfma_f32_16x16x32_bf16 v[104:107], v[20:23], v[232:235], v[104:107]
    ds_read_b64_tr_b16 v[40:41], v13 offset:22528
    ds_read_b64_tr_b16 v[42:43], v13 offset:23040
    s_waitcnt lgkmcnt(6)
    v_mfma_f32_32x32x16_bf16 v[64:79], v[44:47], v[232:235], v[64:79]
    ds_read_b64_tr_b16 v[44:45], v14 offset:63488
    ds_read_b64_tr_b16 v[46:47], v14 offset:64000
    s_waitcnt lgkmcnt(6)
    v_mfma_f32_32x32x16_bf16 v[80:95], v[32:35], v[232:235], v[80:95]
    v_mfma_f32_16x16x32_bf16 v[108:111], v[20:23], v[236:239], v[108:111]
    s_waitcnt vmcnt(2)
    s_waitcnt lgkmcnt(2)
    s_barrier
    ds_read_b128 v[240:243], v8 offset:0
    ds_read_b128 v[244:247], v9 offset:0
    ds_read_b128 v[248:251], v10 offset:0
    ds_read_b128 v[252:255], v11 offset:0
    ds_read_b64_tr_b16 v[32:33], v12 offset:0
    ds_read_b64_tr_b16 v[34:35], v12 offset:512
    v_mfma_f32_32x32x16_bf16 v[48:63], v[36:39], v[236:239], v[48:63]
    ds_read_b64_tr_b16 v[36:37], v13 offset:0
    ds_read_b64_tr_b16 v[38:39], v13 offset:512
    v_mfma_f32_32x32x16_bf16 v[64:79], v[40:43], v[236:239], v[64:79]
    v_add_u32 v14, 65536, v14
    ds_read_b64_tr_b16 v[40:41], v14 offset:0
    ds_read_b64_tr_b16 v[42:43], v14 offset:512
    s_waitcnt lgkmcnt(10)
    v_mfma_f32_32x32x16_bf16 v[80:95], v[44:47], v[236:239], v[80:95]
    ds_read_b64_tr_b16 v[44:45], v12 offset:2048
    ds_read_b64_tr_b16 v[46:47], v12 offset:2560
    s_waitcnt lgkmcnt(6)
    v_mfma_f32_32x32x16_bf16 v[48:63], v[32:35], v[240:243], v[48:63]
    v_cmp_eq_u32 vcc, 0, v1
    v_mov_b32 v9, 0x7f000000
    s_nop 0
    v_cndmask_b32 v8, v9, v0, vcc
    s_barrier
    ds_read_b64_tr_b16 v[32:33], v13 offset:2048
    ds_read_b64_tr_b16 v[34:35], v13 offset:2560
    s_waitcnt lgkmcnt(6)
    v_mfma_f32_32x32x16_bf16 v[64:79], v[36:39], v[240:243], v[64:79]
    ds_read_b64_tr_b16 v[36:37], v14 offset:2048
    ds_read_b64_tr_b16 v[38:39], v14 offset:2560
    s_waitcnt lgkmcnt(6)
    v_mfma_f32_32x32x16_bf16 v[80:95], v[40:43], v[240:243], v[80:95]
    s_add_u32 s41, s47, 0
    s_add_u32 m0, s48, 90112
    s_nop 0
    buffer_load_dwordx4 v4, s[20:23], s41 offen lds
    v_mfma_f32_16x16x32_bf16 v[96:99], v[24:27], v[240:243], v[96:99]
    ds_read_b64_tr_b16 v[40:41], v12 offset:4096
    ds_read_b64_tr_b16 v[42:43], v12 offset:4608
    s_waitcnt lgkmcnt(6)
    v_mfma_f32_32x32x16_bf16 v[48:63], v[44:47], v[244:247], v[48:63]
    ds_read_b64_tr_b16 v[44:45], v13 offset:4096
    ds_read_b64_tr_b16 v[46:47], v13 offset:4608
    s_waitcnt lgkmcnt(6)
    v_mfma_f32_32x32x16_bf16 v[64:79], v[32:35], v[244:247], v[64:79]
    s_add_u32 s41, s47, 589824
    s_add_u32 m0, s48, 98304
    s_nop 0
    buffer_load_dwordx4 v4, s[20:23], s41 offen lds
    v_mfma_f32_16x16x32_bf16 v[100:103], v[24:27], v[244:247], v[100:103]
    ds_read_b64_tr_b16 v[32:33], v14 offset:4096
    ds_read_b64_tr_b16 v[34:35], v14 offset:4608
    s_waitcnt lgkmcnt(6)
    v_mfma_f32_32x32x16_bf16 v[80:95], v[36:39], v[244:247], v[80:95]
    ds_read_b64_tr_b16 v[36:37], v12 offset:6144
    ds_read_b64_tr_b16 v[38:39], v12 offset:6656
    s_waitcnt lgkmcnt(6)
    v_mfma_f32_32x32x16_bf16 v[48:63], v[40:43], v[248:251], v[48:63]
    s_add_u32 s41, s47, 1179648
    s_add_u32 m0, s48, 106496
    s_nop 0
    buffer_load_dwordx4 v4, s[20:23], s41 offen lds
    v_mfma_f32_16x16x32_bf16 v[104:107], v[24:27], v[248:251], v[104:107]
    ds_read_b64_tr_b16 v[40:41], v13 offset:6144
    ds_read_b64_tr_b16 v[42:43], v13 offset:6656
    s_waitcnt lgkmcnt(6)
    v_mfma_f32_32x32x16_bf16 v[64:79], v[44:47], v[248:251], v[64:79]
    ds_read_b64_tr_b16 v[44:45], v14 offset:6144
    ds_read_b64_tr_b16 v[46:47], v14 offset:6656
    s_waitcnt lgkmcnt(6)
    v_mfma_f32_32x32x16_bf16 v[80:95], v[32:35], v[248:251], v[80:95]
    s_sub_u32 s47, s47, s62
    s_add_u32 s41, s47, 0
    s_add_u32 m0, s48, 114688
    s_nop 0
    buffer_load_dwordx4 v4, s[20:23], s41 offen lds
    v_mfma_f32_16x16x32_bf16 v[108:111], v[24:27], v[252:255], v[108:111]
    v_subrev_u32 v14, 73728, v13
    ds_read_b64_tr_b16 v[32:33], v14 offset:0
    ds_read_b64_tr_b16 v[34:35], v14 offset:512
    s_waitcnt lgkmcnt(6)
    v_mfma_f32_32x32x16_bf16 v[48:63], v[36:39], v[252:255], v[48:63]
    ds_read_b64_tr_b16 v[36:37], v14 offset:2048
    ds_read_b64_tr_b16 v[38:39], v14 offset:2560
    s_waitcnt lgkmcnt(6)
    v_mfma_f32_32x32x16_bf16 v[64:79], v[40:43], v[252:255], v[64:79]
    s_add_u32 s41, s47, 589824
    s_add_u32 m0, s48, 122880
    s_nop 0
    buffer_load_dwordx4 v4, s[20:23], s41 offen lds
    ds_read_b64_tr_b16 v[40:41], v14 offset:4096
    ds_read_b64_tr_b16 v[42:43], v14 offset:4608
    s_waitcnt lgkmcnt(6)
    v_mfma_f32_32x32x16_bf16 v[80:95], v[44:47], v[252:255], v[80:95]
    v_add_f32 v5, v96, v101
    v_add_f32 v6, v106, v111
    v_add_f32 v5, v5, v6
    ds_read_b64_tr_b16 v[44:45], v14 offset:6144
    ds_read_b64_tr_b16 v[46:47], v14 offset:6656
    s_waitcnt lgkmcnt(6)
    v_mfma_f32_32x32x16_bf16 v[96:111], v[32:35], v[112:115], 0
    s_add_u32 s41, s47, 1179648
    s_add_u32 m0, s48, 131072
    s_nop 0
    buffer_load_dwordx4 v4, s[20:23], s41 offen lds
    v_mul_f32 v5, 0x3fb8aa3b, v5
    v_exp_f32 v5, v5
    s_nop 0
    v_add_f32 v5, 1.0, v5
    v_min_f32 v6, 0x7e967699, v5
    s_waitcnt vmcnt(7)
    v_cmp_ne_u64 vcc, 0, v[2:3]
    s_nop 0
    s_cmp_eq_u64 vcc, -1
    s_cbranch_scc1 NOK1
s_mov_b32 s53, 0
NSP1:
 s_sleep 2
 global_load_dwordx2 v[2:3], v0, s[100:101] sc1
 s_add_u32 s53, s53, 1
 s_waitcnt vmcnt(0)
 v_cmp_ne_u64 vcc, 0, v[2:3]
 s_cmp_ge_u32 s53, 0x40000
 s_cbranch_scc1 NOK1
 s_nop 1
 s_cmp_eq_u64 vcc, -1
 s_cbranch_scc0 NSP1
NOK1:
    ds_read_b64_tr_b16 v[32:33], v14 offset:8192
    ds_read_b64_tr_b16 v[34:35], v14 offset:8704
    s_waitcnt lgkmcnt(6)
    v_mfma_f32_32x32x16_bf16 v[96:111], v[36:39], v[116:119], v[96:111]
    v_mul_f32 v24, s46, v48
    v_mul_f32 v25, s46, v49
    v_mul_f32 v26, s46, v50
    v_mul_f32 v27, s46, v51
    v_exp_f32 v24, v24
    ds_read_b64_tr_b16 v[36:37], v14 offset:10240
    ds_read_b64_tr_b16 v[38:39], v14 offset:10752
    s_waitcnt lgkmcnt(6)
    v_mfma_f32_32x32x16_bf16 v[96:111], v[40:43], v[120:123], v[96:111]
    s_sub_u32 s47, s47, s63
    s_add_u32 s41, s47, 0
    s_add_u32 m0, s48, 139264
    s_nop 0
    buffer_load_dwordx4 v4, s[20:23], s41 offen lds
    v_exp_f32 v25, v25
    v_exp_f32 v26, v26
    v_exp_f32 v27, v27
    v_fma_f32 v24, v24, v6, v6
    ds_read_b64_tr_b16 v[40:41], v14 offset:12288
    ds_read_b64_tr_b16 v[42:43], v14 offset:12800
    s_waitcnt lgkmcnt(6)
    v_mfma_f32_32x32x16_bf16 v[96:111], v[44:47], v[124:127], v[96:111]
    v_fma_f32 v25, v25, v6, v6
    v_fma_f32 v26, v26, v6, v6
    v_fma_f32 v27, v27, v6, v6
    v_rcp_f32 v24, v24
    ds_read_b64_tr_b16 v[44:45], v14 offset:14336
    ds_read_b64_tr_b16 v[46:47], v14 offset:14848
    s_waitcnt lgkmcnt(6)
    v_mfma_f32_32x32x16_bf16 v[96:111], v[32:35], v[128:131], v[96:111]
    s_add_u32 s41, s47, 589824
    s_add_u32 m0, s48, 147456
    s_nop 0
    buffer_load_dwordx4 v4, s[20:23], s41 offen lds
    v_rcp_f32 v25, v25
    v_rcp_f32 v26, v26
    v_rcp_f32 v27, v27
    v_mul_f32 v24, v48, v24
    ds_read_b64_tr_b16 v[32:33], v14 offset:16384
    ds_read_b64_tr_b16 v[34:35], v14 offset:16896
    s_waitcnt lgkmcnt(6)
    v_mfma_f32_32x32x16_bf16 v[96:111], v[36:39], v[132:135], v[96:111]
    v_mul_f32 v25, v49, v25
    v_mul_f32 v26, v50, v26
    v_mul_f32 v27, v51, v27
    v_cvt_pk_bf16_f32 v16, v24, v25
    v_cvt_pk_bf16_f32 v17, v26, v27
    ds_read_b64_tr_b16 v[36:37], v14 offset:18432
    ds_read_b64_tr_b16 v[38:39], v14 offset:18944
    s_waitcnt lgkmcnt(6)
    v_mfma_f32_32x32x16_bf16 v[96:111], v[40:43], v[136:139], v[96:111]
    s_add_u32 s41, s47, 1179648
    s_add_u32 m0, s48, 155648
    s_nop 0
    buffer_load_dwordx4 v4, s[20:23], s41 offen lds
    v_mul_f32 v28, s46, v52
    v_mul_f32 v29, s46, v53
    v_mul_f32 v30, s46, v54
    v_mul_f32 v31, s46, v55
    ds_read_b64_tr_b16 v[40:41], v14 offset:20480
    ds_read_b64_tr_b16 v[42:43], v14 offset:20992
    s_waitcnt lgkmcnt(6)
    v_mfma_f32_32x32x16_bf16 v[96:111], v[44:47], v[140:143], v[96:111]
    v_exp_f32 v28, v28
    v_exp_f32 v29, v29
    v_exp_f32 v30, v30
    v_exp_f32 v31, v31
    ds_read_b64_tr_b16 v[44:45], v14 offset:22528
    ds_read_b64_tr_b16 v[46:47], v14 offset:23040
    s_waitcnt lgkmcnt(6)
    v_mfma_f32_32x32x16_bf16 v[96:111], v[32:35], v[144:147], v[96:111]
    v_fma_f32 v28, v28, v6, v6
    v_fma_f32 v29, v29, v6, v6
    v_fma_f32 v30, v30, v6, v6
    v_fma_f32 v31, v31, v6, v6
    ds_read_b64_tr_b16 v[32:33], v14 offset:24576
    ds_read_b64_tr_b16 v[34:35], v14 offset:25088
    s_waitcnt lgkmcnt(6)
    v_mfma_f32_32x32x16_bf16 v[96:111], v[36:39], v[148:151], v[96:111]
    v_rcp_f32 v28, v28
    v_rcp_f32 v29, v29
    v_rcp_f32 v30, v30
    v_rcp_f32 v31, v31
    ds_read_b64_tr_b16 v[36:37], v14 offset:26624
    ds_read_b64_tr_b16 v[38:39], v14 offset:27136
    s_waitcnt lgkmcnt(6)
    v_mfma_f32_32x32x16_bf16 v[96:111], v[40:43], v[152:155], v[96:111]
    v_mul_f32 v28, v52, v28
    v_mul_f32 v29, v53, v29
    v_mul_f32 v30, v54, v30
    v_mul_f32 v31, v55, v31
    v_cvt_pk_bf16_f32 v18, v28, v29
    ds_read_b64_tr_b16 v[40:41], v14 offset:28672
    ds_read_b64_tr_b16 v[42:43], v14 offset:29184
    s_waitcnt lgkmcnt(6)
    v_mfma_f32_32x32x16_bf16 v[96:111], v[44:47], v[156:159], v[96:111]
    v_cvt_pk_bf16_f32 v19, v30, v31
    s_add_u32 s51, s45, 0
    buffer_store_dwordx4 v[16:19], v15, s[24:27], s51 offen offset:0 sc1
    v_mul_f32 v24, s46, v56
    v_mul_f32 v25, s46, v57
    ds_read_b64_tr_b16 v[44:45], v14 offset:30720
    ds_read_b64_tr_b16 v[46:47], v14 offset:31232
    s_waitcnt lgkmcnt(6)
    v_mfma_f32_32x32x16_bf16 v[96:111], v[32:35], v[160:163], v[96:111]
    v_mul_f32 v26, s46, v58
    v_mul_f32 v27, s46, v59
    v_exp_f32 v24, v24
    v_exp_f32 v25, v25
    ds_read_b64_tr_b16 v[32:33], v14 offset:32768
    ds_read_b64_tr_b16 v[34:35], v14 offset:33280
    s_waitcnt lgkmcnt(6)
    v_mfma_f32_32x32x16_bf16 v[96:111], v[36:39], v[164:167], v[96:111]
    v_exp_f32 v26, v26
    v_exp_f32 v27, v27
    v_fma_f32 v24, v24, v6, v6
    v_fma_f32 v25, v25, v6, v6
    ds_read_b64_tr_b16 v[36:37], v14 offset:34816
    ds_read_b64_tr_b16 v[38:39], v14 offset:35328
    s_waitcnt lgkmcnt(6)
    v_mfma_f32_32x32x16_bf16 v[96:111], v[40:43], v[168:171], v[96:111]
    v_fma_f32 v26, v26, v6, v6
    v_fma_f32 v27, v27, v6, v6
    v_rcp_f32 v24, v24
    v_rcp_f32 v25, v25
    ds_read_b64_tr_b16 v[40:41], v14 offset:36864
    ds_read_b64_tr_b16 v[42:43], v14 offset:37376
    s_waitcnt lgkmcnt(6)
    v_mfma_f32_32x32x16_bf16 v[96:111], v[44:47], v[172:175], v[96:111]
    v_rcp_f32 v26, v26
    v_rcp_f32 v27, v27
    v_mul_f32 v24, v56, v24
    v_mul_f32 v25, v57, v25
    v_mul_f32 v26, v58, v26
    ds_read_b64_tr_b16 v[44:45], v14 offset:38912
    ds_read_b64_tr_b16 v[46:47], v14 offset:39424
    s_waitcnt lgkmcnt(6)
    v_mfma_f32_32x32x16_bf16 v[96:111], v[32:35], v[176:179], v[96:111]
    v_mul_f32 v27, v59, v27
    v_cvt_pk_bf16_f32 v20, v24, v25
    v_cvt_pk_bf16_f32 v21, v26, v27
    v_mul_f32 v28, s46, v60
    ds_read_b64_tr_b16 v[32:33], v14 offset:40960
    ds_read_b64_tr_b16 v[34:35], v14 offset:41472
    s_waitcnt lgkmcnt(6)
    v_mfma_f32_32x32x16_bf16 v[96:111], v[36:39], v[180:183], v[96:111]
    v_mul_f32 v29, s46, v61
    v_mul_f32 v30, s46, v62
    v_mul_f32 v31, s46, v63
    v_exp_f32 v28, v28
    ds_read_b64_tr_b16 v[36:37], v14 offset:43008
    ds_read_b64_tr_b16 v[38:39], v14 offset:43520
    s_waitcnt lgkmcnt(6)
    v_mfma_f32_32x32x16_bf16 v[96:111], v[40:43], v[184:187], v[96:111]
    v_exp_f32 v29, v29
    v_exp_f32 v30, v30
    v_exp_f32 v31, v31
    v_fma_f32 v28, v28, v6, v6
    ds_read_b64_tr_b16 v[40:41], v14 offset:45056
    ds_read_b64_tr_b16 v[42:43], v14 offset:45568
    s_waitcnt lgkmcnt(6)
    v_mfma_f32_32x32x16_bf16 v[96:111], v[44:47], v[188:191], v[96:111]
    v_fma_f32 v29, v29, v6, v6
    v_fma_f32 v30, v30, v6, v6
    v_fma_f32 v31, v31, v6, v6
    v_rcp_f32 v28, v28
    ds_read_b64_tr_b16 v[44:45], v14 offset:47104
    ds_read_b64_tr_b16 v[46:47], v14 offset:47616
    s_waitcnt lgkmcnt(6)
    v_mfma_f32_32x32x16_bf16 v[96:111], v[32:35], v[192:195], v[96:111]
    v_rcp_f32 v29, v29
    v_rcp_f32 v30, v30
    v_rcp_f32 v31, v31
    v_mul_f32 v28, v60, v28
    v_mul_f32 v29, v61, v29
    ds_read_b64_tr_b16 v[32:33], v14 offset:49152
    ds_read_b64_tr_b16 v[34:35], v14 offset:49664
    s_waitcnt lgkmcnt(6)
    v_mfma_f32_32x32x16_bf16 v[96:111], v[36:39], v[196:199], v[96:111]
    v_mul_f32 v30, v62, v30
    v_mul_f32 v31, v63, v31
    v_cvt_pk_bf16_f32 v22, v28, v29
    v_cvt_pk_bf16_f32 v23, v30, v31
    ds_read_b64_tr_b16 v[36:37], v14 offset:51200
    ds_read_b64_tr_b16 v[38:39], v14 offset:51712
    s_waitcnt lgkmcnt(6)
    v_mfma_f32_32x32x16_bf16 v[96:111], v[40:43], v[200:203], v[96:111]
    buffer_store_dwordx4 v[20:23], v15, s[24:27], s51 offen offset:1024 sc1
    v_mul_f32 v24, s46, v64
    v_mul_f32 v25, s46, v65
    v_mul_f32 v26, s46, v66
    ds_read_b64_tr_b16 v[40:41], v14 offset:53248
    ds_read_b64_tr_b16 v[42:43], v14 offset:53760
    s_waitcnt lgkmcnt(6)
    v_mfma_f32_32x32x16_bf16 v[96:111], v[44:47], v[204:207], v[96:111]
    v_mul_f32 v27, s46, v67
    v_exp_f32 v24, v24
    v_exp_f32 v25, v25
    v_exp_f32 v26, v26
    ds_read_b64_tr_b16 v[44:45], v14 offset:55296
    ds_read_b64_tr_b16 v[46:47], v14 offset:55808
    s_waitcnt lgkmcnt(6)
    v_mfma_f32_32x32x16_bf16 v[96:111], v[32:35], v[208:211], v[96:111]
    v_exp_f32 v27, v27
    v_fma_f32 v24, v24, v6, v6
    v_fma_f32 v25, v25, v6, v6
    v_fma_f32 v26, v26, v6, v6
    ds_read_b64_tr_b16 v[32:33], v14 offset:57344
    ds_read_b64_tr_b16 v[34:35], v14 offset:57856
    s_waitcnt lgkmcnt(6)
    v_mfma_f32_32x32x16_bf16 v[96:111], v[36:39], v[212:215], v[96:111]
    v_fma_f32 v27, v27, v6, v6
    v_rcp_f32 v24, v24
    v_rcp_f32 v25, v25
    v_rcp_f32 v26, v26
    v_rcp_f32 v27, v27
    ds_read_b64_tr_b16 v[36:37], v14 offset:59392
    ds_read_b64_tr_b16 v[38:39], v14 offset:59904
    s_waitcnt lgkmcnt(6)
    v_mfma_f32_32x32x16_bf16 v[96:111], v[40:43], v[216:219], v[96:111]
    v_mul_f32 v24, v64, v24
    v_mul_f32 v25, v65, v25
    v_mul_f32 v26, v66, v26
    v_mul_f32 v27, v67, v27
    ds_read_b64_tr_b16 v[40:41], v14 offset:61440
    ds_read_b64_tr_b16 v[42:43], v14 offset:61952
    s_waitcnt lgkmcnt(6)
    v_mfma_f32_32x32x16_bf16 v[96:111], v[44:47], v[220:223], v[96:111]
    v_cvt_pk_bf16_f32 v16, v24, v25
    v_cvt_pk_bf16_f32 v17, v26, v27
    v_mul_f32 v28, s46, v68
    v_mul_f32 v29, s46, v69
    s_lshr_b32 s41, s28, 2
    s_mul_i32 s41, s41, 36864
    s_add_u32 s41, s41, s56
    s_add_u32 s41, s41, 73728
    s_waitcnt vmcnt(11)
    v_min_u32 v7, 17, v1
    v_lshlrev_b32 v7, 7, v7
    buffer_load_dword v7, v7, s[12:15], s41 offen
    ds_read_b64_tr_b16 v[44:45], v14 offset:63488
    ds_read_b64_tr_b16 v[46:47], v14 offset:64000
    s_waitcnt lgkmcnt(6)
    v_mfma_f32_32x32x16_bf16 v[96:111], v[32:35], v[224:227], v[96:111]
    v_mul_f32 v30, s46, v70
    v_mul_f32 v31, s46, v71
    v_exp_f32 v28, v28
    v_exp_f32 v29, v29
    v_add_u32 v14, 65536, v14
    ds_read_b64_tr_b16 v[32:33], v14 offset:0
    ds_read_b64_tr_b16 v[34:35], v14 offset:512
    s_waitcnt lgkmcnt(6)
    v_mfma_f32_32x32x16_bf16 v[96:111], v[36:39], v[228:231], v[96:111]
    v_exp_f32 v30, v30
    v_exp_f32 v31, v31
    v_fma_f32 v28, v28, v6, v6
    v_fma_f32 v29, v29, v6, v6
    ds_read_b64_tr_b16 v[36:37], v14 offset:2048
    ds_read_b64_tr_b16 v[38:39], v14 offset:2560
    s_waitcnt lgkmcnt(6)
    v_mfma_f32_32x32x16_bf16 v[96:111], v[40:43], v[232:235], v[96:111]
    v_fma_f32 v30, v30, v6, v6
    v_fma_f32 v31, v31, v6, v6
    v_rcp_f32 v28, v28
    v_rcp_f32 v29, v29
    v_rcp_f32 v30, v30
    ds_read_b64_tr_b16 v[40:41], v14 offset:4096
    ds_read_b64_tr_b16 v[42:43], v14 offset:4608
    s_waitcnt lgkmcnt(6)
    v_mfma_f32_32x32x16_bf16 v[96:111], v[44:47], v[236:239], v[96:111]
    v_rcp_f32 v31, v31
    v_mul_f32 v28, v68, v28
    v_mul_f32 v29, v69, v29
    v_mul_f32 v30, v70, v30
    ds_read_b64_tr_b16 v[44:45], v14 offset:6144
    ds_read_b64_tr_b16 v[46:47], v14 offset:6656
    s_waitcnt lgkmcnt(6)
    v_mfma_f32_32x32x16_bf16 v[96:111], v[32:35], v[240:243], v[96:111]
    v_mul_f32 v31, v71, v31
    v_cvt_pk_bf16_f32 v18, v28, v29
    v_cvt_pk_bf16_f32 v19, v30, v31
    s_add_u32 s51, s45, 12288
    buffer_store_dwordx4 v[16:19], v15, s[24:27], s51 offen offset:0 sc1
    s_waitcnt vmcnt(4)
    s_waitcnt lgkmcnt(0)
    s_barrier
    v_add_u32 v12, 16384, v12
    ds_read_b64_tr_b16 v[32:33], v12 offset:0
    ds_read_b64_tr_b16 v[34:35], v12 offset:512
    v_mfma_f32_32x32x16_bf16 v[96:111], v[36:39], v[244:247], v[96:111]
    v_mul_f32 v24, s46, v72
    v_mul_f32 v25, s46, v73
    v_mul_f32 v26, s46, v74
    v_mul_f32 v27, s46, v75
    ds_read_b64_tr_b16 v[36:37], v12 offset:2048
    ds_read_b64_tr_b16 v[38:39], v12 offset:2560
    v_mfma_f32_32x32x16_bf16 v[96:111], v[40:43], v[248:251], v[96:111]
    v_exp_f32 v24, v24
    v_exp_f32 v25, v25
    v_exp_f32 v26, v26
    v_exp_f32 v27, v27
    ds_read_b64_tr_b16 v[40:41], v12 offset:4096
    ds_read_b64_tr_b16 v[42:43], v12 offset:4608
    v_mfma_f32_32x32x16_bf16 v[96:111], v[44:47], v[252:255], v[96:111]
    v_fma_f32 v24, v24, v6, v6
    v_fma_f32 v25, v25, v6, v6
    v_fma_f32 v26, v26, v6, v6
    v_fma_f32 v27, v27, v6, v6
    v_rcp_f32 v24, v24
    ds_read_b64_tr_b16 v[44:45], v12 offset:6144
    ds_read_b64_tr_b16 v[46:47], v12 offset:6656
    s_waitcnt lgkmcnt(6)
    v_mfma_f32_32x32x16_bf16 v[48:63], v[32:35], v[112:115], 0
    v_rcp_f32 v25, v25
    v_rcp_f32 v26, v26
    v_rcp_f32 v27, v27
    v_mul_f32 v24, v72, v24
s_cmp_lt_u32 s28, 4
 s_cbranch_scc1 SPX
 s_setprio 1
SPX:
    ds_read_b64_tr_b16 v[32:33], v12 offset:8192
    ds_read_b64_tr_b16 v[34:35], v12 offset:8704
    s_waitcnt lgkmcnt(6)
    v_mfma_f32_32x32x16_bf16 v[48:63], v[36:39], v[116:119], v[48:63]
    v_mul_f32 v25, v73, v25
    v_mul_f32 v26, v74, v26
    v_mul_f32 v27, v75, v27
    v_cvt_pk_bf16_f32 v20, v24, v25
    ds_read_b64_tr_b16 v[36:37], v12 offset:10240
    ds_read_b64_tr_b16 v[38:39], v12 offset:10752
    s_waitcnt lgkmcnt(6)
    v_mfma_f32_32x32x16_bf16 v[48:63], v[40:43], v[120:123], v[48:63]
    v_cvt_pk_bf16_f32 v21, v26, v27
    v_mul_f32 v28, s46, v76
    v_mul_f32 v29, s46, v77
    v_mul_f32 v30, s46, v78
    ds_read_b64_tr_b16 v[40:41], v12 offset:12288
    ds_read_b64_tr_b16 v[42:43], v12 offset:12800
    s_waitcnt lgkmcnt(6)
    v_mfma_f32_32x32x16_bf16 v[48:63], v[44:47], v[124:127], v[48:63]
    v_mul_f32 v31, s46, v79
    v_exp_f32 v28, v28
    v_exp_f32 v29, v29
    v_exp_f32 v30, v30
    v_exp_f32 v31, v31
    ds_read_b64_tr_b16 v[44:45], v12 offset:14336
    ds_read_b64_tr_b16 v[46:47], v12 offset:14848
    s_waitcnt lgkmcnt(6)
    v_mfma_f32_32x32x16_bf16 v[48:63], v[32:35], v[128:131], v[48:63]
    v_fma_f32 v28, v28, v6, v6
    v_fma_f32 v29, v29, v6, v6
    v_fma_f32 v30, v30, v6, v6
    v_fma_f32 v31, v31, v6, v6
    ds_read_b64_tr_b16 v[32:33], v12 offset:16384
    ds_read_b64_tr_b16 v[34:35], v12 offset:16896
    s_waitcnt lgkmcnt(6)
    v_mfma_f32_32x32x16_bf16 v[48:63], v[36:39], v[132:135], v[48:63]
    v_rcp_f32 v28, v28
    v_rcp_f32 v29, v29
    v_rcp_f32 v30, v30
    v_rcp_f32 v31, v31
    ds_read_b64_tr_b16 v[36:37], v12 offset:18432
    ds_read_b64_tr_b16 v[38:39], v12 offset:18944
    s_waitcnt lgkmcnt(6)
    v_mfma_f32_32x32x16_bf16 v[48:63], v[40:43], v[136:139], v[48:63]
    v_mul_f32 v28, v76, v28
    v_mul_f32 v29, v77, v29
    v_mul_f32 v30, v78, v30
    v_mul_f32 v31, v79, v31
    s_waitcnt vmcnt(2)
    buffer_store_dwordx2 v[2:3], v8, s[24:27], s52 offen offset:0 sc1
    ds_read_b64_tr_b16 v[40:41], v12 offset:20480
    ds_read_b64_tr_b16 v[42:43], v12 offset:20992
    s_waitcnt lgkmcnt(6)
    v_mfma_f32_32x32x16_bf16 v[48:63], v[44:47], v[140:143], v[48:63]
    v_cvt_pk_bf16_f32 v22, v28, v29
    v_cvt_pk_bf16_f32 v23, v30, v31
    buffer_store_dwordx4 v[20:23], v15, s[24:27], s51 offen offset:1024 sc1
    v_mul_f32 v24, s46, v80
    ds_read_b64_tr_b16 v[44:45], v12 offset:22528
    ds_read_b64_tr_b16 v[46:47], v12 offset:23040
    s_waitcnt lgkmcnt(6)
    v_mfma_f32_32x32x16_bf16 v[48:63], v[32:35], v[144:147], v[48:63]
    v_mul_f32 v25, s46, v81
    v_mul_f32 v26, s46, v82
    v_mul_f32 v27, s46, v83
    v_exp_f32 v24, v24
    v_exp_f32 v25, v25
    ds_read_b64_tr_b16 v[32:33], v12 offset:24576
    ds_read_b64_tr_b16 v[34:35], v12 offset:25088
    s_waitcnt lgkmcnt(6)
    v_mfma_f32_32x32x16_bf16 v[48:63], v[36:39], v[148:151], v[48:63]
    v_exp_f32 v26, v26
    v_exp_f32 v27, v27
    v_fma_f32 v24, v24, v6, v6
    v_fma_f32 v25, v25, v6, v6
    ds_read_b64_tr_b16 v[36:37], v12 offset:26624
    ds_read_b64_tr_b16 v[38:39], v12 offset:27136
    s_waitcnt lgkmcnt(6)
    v_mfma_f32_32x32x16_bf16 v[48:63], v[40:43], v[152:155], v[48:63]
    v_fma_f32 v26, v26, v6, v6
    v_fma_f32 v27, v27, v6, v6
    v_rcp_f32 v24, v24
    v_rcp_f32 v25, v25
    ds_read_b64_tr_b16 v[40:41], v12 offset:28672
    ds_read_b64_tr_b16 v[42:43], v12 offset:29184
    s_waitcnt lgkmcnt(6)
    v_mfma_f32_32x32x16_bf16 v[48:63], v[44:47], v[156:159], v[48:63]
    v_rcp_f32 v26, v26
    v_rcp_f32 v27, v27
    v_mul_f32 v24, v80, v24
    v_mul_f32 v25, v81, v25
    ds_read_b64_tr_b16 v[44:45], v12 offset:30720
    ds_read_b64_tr_b16 v[46:47], v12 offset:31232
    s_waitcnt lgkmcnt(6)
    v_mfma_f32_32x32x16_bf16 v[48:63], v[32:35], v[160:163], v[48:63]
    v_mul_f32 v26, v82, v26
    v_mul_f32 v27, v83, v27
    v_cvt_pk_bf16_f32 v16, v24, v25
    v_cvt_pk_bf16_f32 v17, v26, v27
    ds_read_b64_tr_b16 v[32:33], v12 offset:32768
    ds_read_b64_tr_b16 v[34:35], v12 offset:33280
    s_waitcnt lgkmcnt(6)
    v_mfma_f32_32x32x16_bf16 v[48:63], v[36:39], v[164:167], v[48:63]
    v_mul_f32 v28, s46, v84
    v_mul_f32 v29, s46, v85
    v_mul_f32 v30, s46, v86
    v_mul_f32 v31, s46, v87
    v_exp_f32 v28, v28
    ds_read_b64_tr_b16 v[36:37], v12 offset:34816
    ds_read_b64_tr_b16 v[38:39], v12 offset:35328
    s_waitcnt lgkmcnt(6)
    v_mfma_f32_32x32x16_bf16 v[48:63], v[40:43], v[168:171], v[48:63]
    v_exp_f32 v29, v29
    v_exp_f32 v30, v30
    v_exp_f32 v31, v31
    v_fma_f32 v28, v28, v6, v6
    ds_read_b64_tr_b16 v[40:41], v12 offset:36864
    ds_read_b64_tr_b16 v[42:43], v12 offset:37376
    s_waitcnt lgkmcnt(6)
    v_mfma_f32_32x32x16_bf16 v[48:63], v[44:47], v[172:175], v[48:63]
    v_fma_f32 v29, v29, v6, v6
    v_fma_f32 v30, v30, v6, v6
    v_fma_f32 v31, v31, v6, v6
    v_rcp_f32 v28, v28
    ds_read_b64_tr_b16 v[44:45], v12 offset:38912
    ds_read_b64_tr_b16 v[46:47], v12 offset:39424
    s_waitcnt lgkmcnt(6)
    v_mfma_f32_32x32x16_bf16 v[48:63], v[32:35], v[176:179], v[48:63]
    v_rcp_f32 v29, v29
    v_rcp_f32 v30, v30
    v_rcp_f32 v31, v31
    v_mul_f32 v28, v84, v28
    ds_read_b64_tr_b16 v[32:33], v12 offset:40960
    ds_read_b64_tr_b16 v[34:35], v12 offset:41472
    s_waitcnt lgkmcnt(6)
    v_mfma_f32_32x32x16_bf16 v[48:63], v[36:39], v[180:183], v[48:63]
    v_mul_f32 v29, v85, v29
    v_mul_f32 v30, v86, v30
    v_mul_f32 v31, v87, v31
    v_cvt_pk_bf16_f32 v18, v28, v29
    ds_read_b64_tr_b16 v[36:37], v12 offset:43008
    ds_read_b64_tr_b16 v[38:39], v12 offset:43520
    s_waitcnt lgkmcnt(6)
    v_mfma_f32_32x32x16_bf16 v[48:63], v[40:43], v[184:187], v[48:63]
    v_cvt_pk_bf16_f32 v19, v30, v31
    s_add_u32 s51, s45, 24576
    buffer_store_dwordx4 v[16:19], v15, s[24:27], s51 offen offset:0 sc1
    v_mul_f32 v24, s46, v88
    v_mul_f32 v25, s46, v89
    v_mul_f32 v26, s46, v90
    ds_read_b64_tr_b16 v[40:41], v12 offset:45056
    ds_read_b64_tr_b16 v[42:43], v12 offset:45568
    s_waitcnt lgkmcnt(6)
    v_mfma_f32_32x32x16_bf16 v[48:63], v[44:47], v[188:191], v[48:63]
    v_mul_f32 v27, s46, v91
    v_exp_f32 v24, v24
    v_exp_f32 v25, v25
    v_exp_f32 v26, v26
    ds_read_b64_tr_b16 v[44:45], v12 offset:47104
    ds_read_b64_tr_b16 v[46:47], v12 offset:47616
    s_waitcnt lgkmcnt(6)
    v_mfma_f32_32x32x16_bf16 v[48:63], v[32:35], v[192:195], v[48:63]
    v_exp_f32 v27, v27
    v_fma_f32 v24, v24, v6, v6
    v_fma_f32 v25, v25, v6, v6
    v_fma_f32 v26, v26, v6, v6
    ds_read_b64_tr_b16 v[32:33], v12 offset:49152
    ds_read_b64_tr_b16 v[34:35], v12 offset:49664
    s_waitcnt lgkmcnt(6)
    v_mfma_f32_32x32x16_bf16 v[48:63], v[36:39], v[196:199], v[48:63]
    v_fma_f32 v27, v27, v6, v6
    v_rcp_f32 v24, v24
    v_rcp_f32 v25, v25
    v_rcp_f32 v26, v26
    s_lshr_b32 s41, s28, 2
    s_mul_i32 s41, s41, 36864
    s_add_u32 s41, s41, s56
    s_add_u32 s41, s41, 147456
    s_waitcnt vmcnt(4)
    v_min_u32 v7, 17, v1
    v_lshlrev_b32 v7, 7, v7
    buffer_load_dword v7, v7, s[12:15], s41 offen
    ds_read_b64_tr_b16 v[36:37], v12 offset:51200
    ds_read_b64_tr_b16 v[38:39], v12 offset:51712
    s_waitcnt lgkmcnt(6)
    v_mfma_f32_32x32x16_bf16 v[48:63], v[40:43], v[200:203], v[48:63]
    v_rcp_f32 v27, v27
    v_mul_f32 v24, v88, v24
    v_mul_f32 v25, v89, v25
    v_mul_f32 v26, v90, v26
    ds_read_b64_tr_b16 v[40:41], v12 offset:53248
    ds_read_b64_tr_b16 v[42:43], v12 offset:53760
    s_waitcnt lgkmcnt(6)
    v_mfma_f32_32x32x16_bf16 v[48:63], v[44:47], v[204:207], v[48:63]
    v_mul_f32 v27, v91, v27
    v_cvt_pk_bf16_f32 v20, v24, v25
    v_cvt_pk_bf16_f32 v21, v26, v27
    v_mul_f32 v28, s46, v92
    v_mul_f32 v29, s46, v93
    ds_read_b64_tr_b16 v[44:45], v12 offset:55296
    ds_read_b64_tr_b16 v[46:47], v12 offset:55808
    s_waitcnt lgkmcnt(6)
    v_mfma_f32_32x32x16_bf16 v[48:63], v[32:35], v[208:211], v[48:63]
    v_mul_f32 v30, s46, v94
    v_mul_f32 v31, s46, v95
    v_exp_f32 v28, v28
    v_exp_f32 v29, v29
    ds_read_b64_tr_b16 v[32:33], v12 offset:57344
    ds_read_b64_tr_b16 v[34:35], v12 offset:57856
    s_waitcnt lgkmcnt(6)
    v_mfma_f32_32x32x16_bf16 v[48:63], v[36:39], v[212:215], v[48:63]
    v_exp_f32 v30, v30
    v_exp_f32 v31, v31
    v_fma_f32 v28, v28, v6, v6
    v_fma_f32 v29, v29, v6, v6
    ds_read_b64_tr_b16 v[36:37], v12 offset:59392
    ds_read_b64_tr_b16 v[38:39], v12 offset:59904
    s_waitcnt lgkmcnt(6)
    v_mfma_f32_32x32x16_bf16 v[48:63], v[40:43], v[216:219], v[48:63]
    v_fma_f32 v30, v30, v6, v6
    v_fma_f32 v31, v31, v6, v6
    v_rcp_f32 v28, v28
    v_rcp_f32 v29, v29
    ds_read_b64_tr_b16 v[40:41], v12 offset:61440
    ds_read_b64_tr_b16 v[42:43], v12 offset:61952
    s_waitcnt lgkmcnt(6)
    v_mfma_f32_32x32x16_bf16 v[48:63], v[44:47], v[220:223], v[48:63]
    v_rcp_f32 v30, v30
    v_rcp_f32 v31, v31
    v_mul_f32 v28, v92, v28
    v_mul_f32 v29, v93, v29
    s_waitcnt vmcnt(2)
    buffer_store_dwordx2 v[2:3], v8, s[24:27], s52 offen offset:48 sc1
    ds_read_b64_tr_b16 v[44:45], v12 offset:63488
    ds_read_b64_tr_b16 v[46:47], v12 offset:64000
    s_waitcnt lgkmcnt(6)
    v_mfma_f32_32x32x16_bf16 v[48:63], v[32:35], v[224:227], v[48:63]
    v_mul_f32 v30, v94, v30
    v_mul_f32 v31, v95, v31
    v_cvt_pk_bf16_f32 v22, v28, v29
    v_cvt_pk_bf16_f32 v23, v30, v31
    buffer_store_dwordx4 v[20:23], v15, s[24:27], s51 offen offset:1024 sc1
    v_add_u32 v12, 65536, v12
    ds_read_b64_tr_b16 v[32:33], v12 offset:0
    ds_read_b64_tr_b16 v[34:35], v12 offset:512
    s_waitcnt lgkmcnt(6)
    v_mfma_f32_32x32x16_bf16 v[48:63], v[36:39], v[228:231], v[48:63]
    v_mul_f32 v24, s46, v96
    v_mul_f32 v25, s46, v97
    v_mul_f32 v26, s46, v98
    v_mul_f32 v27, s46, v99
    ds_read_b64_tr_b16 v[36:37], v12 offset:2048
    ds_read_b64_tr_b16 v[38:39], v12 offset:2560
    s_waitcnt lgkmcnt(6)
    v_mfma_f32_32x32x16_bf16 v[48:63], v[40:43], v[232:235], v[48:63]
    v_exp_f32 v24, v24
    v_exp_f32 v25, v25
    v_exp_f32 v26, v26
    v_exp_f32 v27, v27
    ds_read_b64_tr_b16 v[40:41], v12 offset:4096
    ds_read_b64_tr_b16 v[42:43], v12 offset:4608
    s_waitcnt lgkmcnt(6)
    v_mfma_f32_32x32x16_bf16 v[48:63], v[44:47], v[236:239], v[48:63]
    v_fma_f32 v24, v24, v6, v6
    v_fma_f32 v25, v25, v6, v6
    v_fma_f32 v26, v26, v6, v6
    v_fma_f32 v27, v27, v6, v6
    ds_read_b64_tr_b16 v[44:45], v12 offset:6144
    ds_read_b64_tr_b16 v[46:47], v12 offset:6656
    s_waitcnt lgkmcnt(6)
    v_mfma_f32_32x32x16_bf16 v[48:63], v[32:35], v[240:243], v[48:63]
    v_rcp_f32 v24, v24
    v_rcp_f32 v25, v25
    v_rcp_f32 v26, v26
    v_rcp_f32 v27, v27
    v_add_u32 v13, 16384, v13
    ds_read_b64_tr_b16 v[32:33], v13 offset:0
    ds_read_b64_tr_b16 v[34:35], v13 offset:512
    s_waitcnt lgkmcnt(6)
    v_mfma_f32_32x32x16_bf16 v[48:63], v[36:39], v[244:247], v[48:63]
    v_mul_f32 v24, v96, v24
    v_mul_f32 v25, v97, v25
    v_mul_f32 v26, v98, v26
    v_mul_f32 v27, v99, v27
    v_cvt_pk_bf16_f32 v16, v24, v25
    ds_read_b64_tr_b16 v[36:37], v13 offset:2048
    ds_read_b64_tr_b16 v[38:39], v13 offset:2560
    s_waitcnt lgkmcnt(6)
    v_mfma_f32_32x32x16_bf16 v[48:63], v[40:43], v[248:251], v[48:63]
    v_cvt_pk_bf16_f32 v17, v26, v27
    v_mul_f32 v28, s46, v100
    v_mul_f32 v29, s46, v101
    v_mul_f32 v30, s46, v102
    ds_read_b64_tr_b16 v[40:41], v13 offset:4096
    ds_read_b64_tr_b16 v[42:43], v13 offset:4608
    s_waitcnt lgkmcnt(6)
    v_mfma_f32_32x32x16_bf16 v[48:63], v[44:47], v[252:255], v[48:63]
    v_mul_f32 v31, s46, v103
    v_exp_f32 v28, v28
    v_exp_f32 v29, v29
    v_exp_f32 v30, v30
    s_cmp_ge_u32 s28, 4
    s_cbranch_scc1 G2_LOAD
    ds_read_b64_tr_b16 v[44:45], v13 offset:6144
    ds_read_b64_tr_b16 v[46:47], v13 offset:6656
    s_waitcnt lgkmcnt(6)
    v_mfma_f32_32x32x16_bf16 v[64:79], v[32:35], v[112:115], 0
    v_exp_f32 v31, v31
    v_fma_f32 v28, v28, v6, v6
    v_fma_f32 v29, v29, v6, v6
    v_fma_f32 v30, v30, v6, v6
    ds_read_b64_tr_b16 v[32:33], v13 offset:8192
    ds_read_b64_tr_b16 v[34:35], v13 offset:8704
    s_waitcnt lgkmcnt(6)
    v_mfma_f32_32x32x16_bf16 v[64:79], v[36:39], v[116:119], v[64:79]
    v_fma_f32 v31, v31, v6, v6
    v_rcp_f32 v28, v28
    v_rcp_f32 v29, v29
    v_rcp_f32 v30, v30
    v_rcp_f32 v31, v31
    ds_read_b64_tr_b16 v[36:37], v13 offset:10240
    ds_read_b64_tr_b16 v[38:39], v13 offset:10752
    s_waitcnt lgkmcnt(6)
    v_mfma_f32_32x32x16_bf16 v[64:79], v[40:43], v[120:123], v[64:79]
    v_mul_f32 v28, v100, v28
    v_mul_f32 v29, v101, v29
    v_mul_f32 v30, v102, v30
    v_mul_f32 v31, v103, v31
    ds_read_b64_tr_b16 v[40:41], v13 offset:12288
    ds_read_b64_tr_b16 v[42:43], v13 offset:12800
    s_waitcnt lgkmcnt(6)
    v_mfma_f32_32x32x16_bf16 v[64:79], v[44:47], v[124:127], v[64:79]
    v_cvt_pk_bf16_f32 v18, v28, v29
    v_cvt_pk_bf16_f32 v19, v30, v31
    s_add_u32 s51, s45, 36864
    buffer_store_dwordx4 v[16:19], v15, s[24:27], s51 offen offset:0 sc1
    v_mul_f32 v24, s46, v104
    ds_read_b64_tr_b16 v[44:45], v13 offset:14336
    ds_read_b64_tr_b16 v[46:47], v13 offset:14848
    s_waitcnt lgkmcnt(6)
    v_mfma_f32_32x32x16_bf16 v[64:79], v[32:35], v[128:131], v[64:79]
    v_mul_f32 v25, s46, v105
    v_mul_f32 v26, s46, v106
    v_mul_f32 v27, s46, v107
    v_exp_f32 v24, v24
    ds_read_b64_tr_b16 v[32:33], v13 offset:16384
    ds_read_b64_tr_b16 v[34:35], v13 offset:16896
    s_waitcnt lgkmcnt(6)
    v_mfma_f32_32x32x16_bf16 v[64:79], v[36:39], v[132:135], v[64:79]
    v_exp_f32 v25, v25
    v_exp_f32 v26, v26
    v_exp_f32 v27, v27
    v_fma_f32 v24, v24, v6, v6
    ds_read_b64_tr_b16 v[36:37], v13 offset:18432
    ds_read_b64_tr_b16 v[38:39], v13 offset:18944
    s_waitcnt lgkmcnt(6)
    v_mfma_f32_32x32x16_bf16 v[64:79], v[40:43], v[136:139], v[64:79]
    v_fma_f32 v25, v25, v6, v6
    v_fma_f32 v26, v26, v6, v6
    v_fma_f32 v27, v27, v6, v6
    v_rcp_f32 v24, v24
    v_rcp_f32 v25, v25
    ds_read_b64_tr_b16 v[40:41], v13 offset:20480
    ds_read_b64_tr_b16 v[42:43], v13 offset:20992
    s_waitcnt lgkmcnt(6)
    v_mfma_f32_32x32x16_bf16 v[64:79], v[44:47], v[140:143], v[64:79]
    v_rcp_f32 v26, v26
    v_rcp_f32 v27, v27
    v_mul_f32 v24, v104, v24
    v_mul_f32 v25, v105, v25
    ds_read_b64_tr_b16 v[44:45], v13 offset:22528
    ds_read_b64_tr_b16 v[46:47], v13 offset:23040
    s_waitcnt lgkmcnt(6)
    v_mfma_f32_32x32x16_bf16 v[64:79], v[32:35], v[144:147], v[64:79]
    v_mul_f32 v26, v106, v26
    v_mul_f32 v27, v107, v27
    v_cvt_pk_bf16_f32 v20, v24, v25
    v_cvt_pk_bf16_f32 v21, v26, v27
    ds_read_b64_tr_b16 v[32:33], v13 offset:24576
    ds_read_b64_tr_b16 v[34:35], v13 offset:25088
    s_waitcnt lgkmcnt(6)
    v_mfma_f32_32x32x16_bf16 v[64:79], v[36:39], v[148:151], v[64:79]
    v_mul_f32 v28, s46, v108
    v_mul_f32 v29, s46, v109
    v_mul_f32 v30, s46, v110
    v_mul_f32 v31, s46, v111
    ds_read_b64_tr_b16 v[36:37], v13 offset:26624
    ds_read_b64_tr_b16 v[38:39], v13 offset:27136
    s_waitcnt lgkmcnt(6)
    v_mfma_f32_32x32x16_bf16 v[64:79], v[40:43], v[152:155], v[64:79]
    v_exp_f32 v28, v28
    v_exp_f32 v29, v29
    v_exp_f32 v30, v30
    v_exp_f32 v31, v31
    ds_read_b64_tr_b16 v[40:41], v13 offset:28672
    ds_read_b64_tr_b16 v[42:43], v13 offset:29184
    s_waitcnt lgkmcnt(6)
    v_mfma_f32_32x32x16_bf16 v[64:79], v[44:47], v[156:159], v[64:79]
    v_fma_f32 v28, v28, v6, v6
    v_fma_f32 v29, v29, v6, v6
    v_fma_f32 v30, v30, v6, v6
    v_fma_f32 v31, v31, v6, v6
    v_rcp_f32 v28, v28
    ds_read_b64_tr_b16 v[44:45], v13 offset:30720
    ds_read_b64_tr_b16 v[46:47], v13 offset:31232
    s_waitcnt lgkmcnt(6)
    v_mfma_f32_32x32x16_bf16 v[64:79], v[32:35], v[160:163], v[64:79]
    v_rcp_f32 v29, v29
    v_rcp_f32 v30, v30
    v_rcp_f32 v31, v31
    v_mul_f32 v28, v108, v28
    s_waitcnt vmcnt(1)
    buffer_store_dwordx2 v[2:3], v8, s[24:27], s52 offen offset:96 sc1
    ds_read_b64_tr_b16 v[32:33], v13 offset:32768
    ds_read_b64_tr_b16 v[34:35], v13 offset:33280
    s_waitcnt lgkmcnt(6)
    v_mfma_f32_32x32x16_bf16 v[64:79], v[36:39], v[164:167], v[64:79]
    v_mul_f32 v29, v109, v29
    v_mul_f32 v30, v110, v30
    v_mul_f32 v31, v111, v31
    v_cvt_pk_bf16_f32 v22, v28, v29
    ds_read_b64_tr_b16 v[36:37], v13 offset:34816
    ds_read_b64_tr_b16 v[38:39], v13 offset:35328
    s_waitcnt lgkmcnt(6)
    v_mfma_f32_32x32x16_bf16 v[64:79], v[40:43], v[168:171], v[64:79]
    v_cvt_pk_bf16_f32 v23, v30, v31
    buffer_store_dwordx4 v[20:23], v15, s[24:27], s51 offen offset:1024 sc1
    v_mul_f32 v24, s46, v48
    v_mul_f32 v25, s46, v49
    ds_read_b64_tr_b16 v[40:41], v13 offset:36864
    ds_read_b64_tr_b16 v[42:43], v13 offset:37376
    s_waitcnt lgkmcnt(6)
    v_mfma_f32_32x32x16_bf16 v[64:79], v[44:47], v[172:175], v[64:79]
    v_mul_f32 v26, s46, v50
    v_mul_f32 v27, s46, v51
    v_exp_f32 v24, v24
    v_exp_f32 v25, v25
    ds_read_b64_tr_b16 v[44:45], v13 offset:38912
    ds_read_b64_tr_b16 v[46:47], v13 offset:39424
    s_waitcnt lgkmcnt(6)
    v_mfma_f32_32x32x16_bf16 v[64:79], v[32:35], v[176:179], v[64:79]
    v_exp_f32 v26, v26
    v_exp_f32 v27, v27
    v_fma_f32 v24, v24, v6, v6
    v_fma_f32 v25, v25, v6, v6
    v_fma_f32 v26, v26, v6, v6
    ds_read_b64_tr_b16 v[32:33], v13 offset:40960
    ds_read_b64_tr_b16 v[34:35], v13 offset:41472
    s_waitcnt lgkmcnt(6)
    v_mfma_f32_32x32x16_bf16 v[64:79], v[36:39], v[180:183], v[64:79]
    v_fma_f32 v27, v27, v6, v6
    v_rcp_f32 v24, v24
    v_rcp_f32 v25, v25
    v_rcp_f32 v26, v26
    ds_read_b64_tr_b16 v[36:37], v13 offset:43008
    ds_read_b64_tr_b16 v[38:39], v13 offset:43520
    s_waitcnt lgkmcnt(6)
    v_mfma_f32_32x32x16_bf16 v[64:79], v[40:43], v[184:187], v[64:79]
    v_rcp_f32 v27, v27
    v_mul_f32 v24, v48, v24
    v_mul_f32 v25, v49, v25
    v_mul_f32 v26, v50, v26
    ds_read_b64_tr_b16 v[40:41], v13 offset:45056
    ds_read_b64_tr_b16 v[42:43], v13 offset:45568
    s_waitcnt lgkmcnt(6)
    v_mfma_f32_32x32x16_bf16 v[64:79], v[44:47], v[188:191], v[64:79]
    v_mul_f32 v27, v51, v27
    v_cvt_pk_bf16_f32 v16, v24, v25
    v_cvt_pk_bf16_f32 v17, v26, v27
    v_mul_f32 v28, s46, v52
    ds_read_b64_tr_b16 v[44:45], v13 offset:47104
    ds_read_b64_tr_b16 v[46:47], v13 offset:47616
    s_waitcnt lgkmcnt(6)
    v_mfma_f32_32x32x16_bf16 v[64:79], v[32:35], v[192:195], v[64:79]
    v_mul_f32 v29, s46, v53
    v_mul_f32 v30, s46, v54
    v_mul_f32 v31, s46, v55
    v_exp_f32 v28, v28
    ds_read_b64_tr_b16 v[32:33], v13 offset:49152
    ds_read_b64_tr_b16 v[34:35], v13 offset:49664
    s_waitcnt lgkmcnt(6)
    v_mfma_f32_32x32x16_bf16 v[64:79], v[36:39], v[196:199], v[64:79]
    v_exp_f32 v29, v29
    v_exp_f32 v30, v30
    v_exp_f32 v31, v31
    v_fma_f32 v28, v28, v6, v6
    v_fma_f32 v29, v29, v6, v6
    ds_read_b64_tr_b16 v[36:37], v13 offset:51200
    ds_read_b64_tr_b16 v[38:39], v13 offset:51712
    s_waitcnt lgkmcnt(6)
    v_mfma_f32_32x32x16_bf16 v[64:79], v[40:43], v[200:203], v[64:79]
    v_fma_f32 v30, v30, v6, v6
    v_fma_f32 v31, v31, v6, v6
    v_rcp_f32 v28, v28
    v_rcp_f32 v29, v29
    ds_read_b64_tr_b16 v[40:41], v13 offset:53248
    ds_read_b64_tr_b16 v[42:43], v13 offset:53760
    s_waitcnt lgkmcnt(6)
    v_mfma_f32_32x32x16_bf16 v[64:79], v[44:47], v[204:207], v[64:79]
    v_rcp_f32 v30, v30
    v_rcp_f32 v31, v31
    v_mul_f32 v28, v52, v28
    v_mul_f32 v29, v53, v29
    ds_read_b64_tr_b16 v[44:45], v13 offset:55296
    ds_read_b64_tr_b16 v[46:47], v13 offset:55808
    s_waitcnt lgkmcnt(6)
    v_mfma_f32_32x32x16_bf16 v[64:79], v[32:35], v[208:211], v[64:79]
    v_mul_f32 v30, v54, v30
    v_mul_f32 v31, v55, v31
    v_cvt_pk_bf16_f32 v18, v28, v29
    v_cvt_pk_bf16_f32 v19, v30, v31
    ds_read_b64_tr_b16 v[32:33], v13 offset:57344
    ds_read_b64_tr_b16 v[34:35], v13 offset:57856
    s_waitcnt lgkmcnt(6)
    v_mfma_f32_32x32x16_bf16 v[64:79], v[36:39], v[212:215], v[64:79]
    s_add_u32 s51, s45, 49152
    buffer_store_dwordx4 v[16:19], v15, s[24:27], s51 offen offset:0 sc1
    v_mul_f32 v24, s46, v56
    v_mul_f32 v25, s46, v57
    v_mul_f32 v26, s46, v58
    ds_read_b64_tr_b16 v[36:37], v13 offset:59392
    ds_read_b64_tr_b16 v[38:39], v13 offset:59904
    s_waitcnt lgkmcnt(6)
    v_mfma_f32_32x32x16_bf16 v[64:79], v[40:43], v[216:219], v[64:79]
    v_mul_f32 v27, s46, v59
    v_exp_f32 v24, v24
    v_exp_f32 v25, v25
    v_exp_f32 v26, v26
    v_exp_f32 v27, v27
    ds_read_b64_tr_b16 v[40:41], v13 offset:61440
    ds_read_b64_tr_b16 v[42:43], v13 offset:61952
    s_waitcnt lgkmcnt(6)
    v_mfma_f32_32x32x16_bf16 v[64:79], v[44:47], v[220:223], v[64:79]
    v_fma_f32 v24, v24, v6, v6
    v_fma_f32 v25, v25, v6, v6
    v_fma_f32 v26, v26, v6, v6
    v_fma_f32 v27, v27, v6, v6
    ds_read_b64_tr_b16 v[44:45], v13 offset:63488
    ds_read_b64_tr_b16 v[46:47], v13 offset:64000
    s_waitcnt lgkmcnt(6)
    v_mfma_f32_32x32x16_bf16 v[64:79], v[32:35], v[224:227], v[64:79]
    v_rcp_f32 v24, v24
    v_rcp_f32 v25, v25
    v_rcp_f32 v26, v26
    v_rcp_f32 v27, v27
    v_add_u32 v13, 65536, v13
    ds_read_b64_tr_b16 v[32:33], v13 offset:0
    ds_read_b64_tr_b16 v[34:35], v13 offset:512
    s_waitcnt lgkmcnt(6)
    v_mfma_f32_32x32x16_bf16 v[64:79], v[36:39], v[228:231], v[64:79]
    v_mul_f32 v24, v56, v24
    v_mul_f32 v25, v57, v25
    v_mul_f32 v26, v58, v26
    v_mul_f32 v27, v59, v27
    ds_read_b64_tr_b16 v[36:37], v13 offset:2048
    ds_read_b64_tr_b16 v[38:39], v13 offset:2560
    s_waitcnt lgkmcnt(6)
    v_mfma_f32_32x32x16_bf16 v[64:79], v[40:43], v[232:235], v[64:79]
    v_cvt_pk_bf16_f32 v20, v24, v25
    v_cvt_pk_bf16_f32 v21, v26, v27
    v_mul_f32 v28, s46, v60
    v_mul_f32 v29, s46, v61
    ds_read_b64_tr_b16 v[40:41], v13 offset:4096
    ds_read_b64_tr_b16 v[42:43], v13 offset:4608
    s_waitcnt lgkmcnt(6)
    v_mfma_f32_32x32x16_bf16 v[64:79], v[44:47], v[236:239], v[64:79]
    v_mul_f32 v30, s46, v62
    v_mul_f32 v31, s46, v63
    v_exp_f32 v28, v28
    v_exp_f32 v29, v29
    v_exp_f32 v30, v30
    ds_read_b64_tr_b16 v[44:45], v13 offset:6144
    ds_read_b64_tr_b16 v[46:47], v13 offset:6656
    s_waitcnt lgkmcnt(6)
    v_mfma_f32_32x32x16_bf16 v[64:79], v[32:35], v[240:243], v[64:79]
    v_exp_f32 v31, v31
    v_fma_f32 v28, v28, v6, v6
    v_fma_f32 v29, v29, v6, v6
    v_fma_f32 v30, v30, v6, v6
    s_waitcnt lgkmcnt(4)
    v_mfma_f32_32x32x16_bf16 v[64:79], v[36:39], v[244:247], v[64:79]
    v_fma_f32 v31, v31, v6, v6
    v_rcp_f32 v28, v28
    v_rcp_f32 v29, v29
    v_rcp_f32 v30, v30
    s_waitcnt lgkmcnt(2)
    v_mfma_f32_32x32x16_bf16 v[64:79], v[40:43], v[248:251], v[64:79]
    v_rcp_f32 v31, v31
    v_mul_f32 v28, v60, v28
    v_mul_f32 v29, v61, v29
    v_mul_f32 v30, v62, v30
    s_waitcnt vmcnt(1)
    buffer_store_dwordx2 v[2:3], v8, s[24:27], s52 offen offset:144 sc1
    s_waitcnt lgkmcnt(0)
    v_mfma_f32_32x32x16_bf16 v[64:79], v[44:47], v[252:255], v[64:79]
    v_mul_f32 v31, v63, v31
    v_cvt_pk_bf16_f32 v22, v28, v29
    v_cvt_pk_bf16_f32 v23, v30, v31
    buffer_store_dwordx4 v[20:23], v15, s[24:27], s51 offen offset:1024 sc1
    s_and_b32 s29, s3, 1
    s_lshl_b32 s29, s29, 3
    s_and_b32 s42, s54, 7
    s_add_u32 s29, s29, s42
    s_lshr_b32 s30, s54, 3
    v_lshrrev_b32 v9, 5, v1
    v_lshlrev_b32 v11, 10, v9
    v_bfe_u32 v10, v1, 2, 3
    v_lshlrev_b32 v12, 7, v10
    v_lshl_add_u32 v12, v9, 11, v12
    v_bfe_u32 v13, v1, 3, 1
    v_lshl_add_u32 v12, v13, 6, v12
    v_bfe_u32 v13, v1, 4, 1
    v_lshl_add_u32 v12, v13, 5, v12
    v_and_b32 v14, 3, v1
    v_lshl_add_u32 v12, v14, 3, v12
    s_and_b32 s43, s28, 1
    s_lshl_b32 s44, s43, 6
    v_xor_b32 v12, s44, v12
    v_xor_b32 v96, 0, v12
    s_mul_i32 s44, s43, 8192
    s_add_u32 s44, s44, 0
    v_add_u32 v96, s44, v96
    v_add_u32 v97, 81920, v96
    v_xor_b32 v98, 32, v12
    s_mul_i32 s44, s43, 8192
    s_add_u32 s44, s44, 0
    v_add_u32 v98, s44, v98
    v_add_u32 v99, 81920, v98
    v_xor_b32 v100, 64, v12
    s_mul_i32 s44, s43, 16384
    s_add_u32 s44, s44, 0
    v_add_u32 v100, s44, v100
    v_add_u32 v101, 81920, v100
    v_xor_b32 v102, 96, v12
    s_mul_i32 s44, s43, 16384
    s_add_u32 s44, s44, 0
    v_add_u32 v102, s44, v102
    v_add_u32 v103, 81920, v102
    v_xor_b32 v104, 0, v12
    s_mul_i32 s44, s43, 8192
    s_add_u32 s44, s44, 8192
    v_add_u32 v104, s44, v104
    v_add_u32 v105, 81920, v104
    v_xor_b32 v106, 32, v12
    s_mul_i32 s44, s43, 8192
    s_add_u32 s44, s44, 8192
    v_add_u32 v106, s44, v106
    v_add_u32 v107, 81920, v106
    s_and_b32 s42, s28, 2
    s_lshl_b32 s42, s42, 12
    s_add_u32 s42, s42, 24576
    v_add_u32 v11, s42, v11
    v_and_b32 v14, 15, v1
    v_lshl_add_u32 v14, v13, 5, v14
    v_lshl_add_u32 v108, v14, 4, v11
    v_add_u32 v109, 81920, v108
    v_lshl_add_u32 v11, v10, 6, v11
    v_and_b32 v14, 1, v1
    v_lshl_add_u32 v11, v14, 5, v11
    v_bfe_u32 v14, v1, 1, 1
    v_lshl_add_u32 v110, v14, 3, v11
    v_add_u32 v111, 81920, v110
    s_barrier
    ds_read_b64_tr_b16 v[144:145], v96 offset:0
    ds_read_b64_tr_b16 v[146:147], v96 offset:1024
    ds_read_b128 v[112:115], v108 offset:0
    ds_read_b128 v[116:119], v108 offset:256
    ds_read_b64_tr_b16 v[148:149], v98 offset:0
    ds_read_b64_tr_b16 v[150:151], v98 offset:1024
    ds_read_b128 v[120:123], v108 offset:4096
    ds_read_b128 v[124:127], v108 offset:4352
    ds_read_b64_tr_b16 v[152:153], v100 offset:0
    ds_read_b64_tr_b16 v[154:155], v100 offset:1024
    ds_read_b64_tr_b16 v[156:157], v102 offset:0
    s_waitcnt lgkmcnt(8)
    v_mfma_f32_16x16x32_bf16 v[160:163], v[144:147], v[112:115], 0
    ds_read_b64_tr_b16 v[158:159], v102 offset:1024
    s_waitcnt lgkmcnt(8)
    v_mfma_f32_16x16x32_bf16 v[184:187], v[144:147], v[116:119], 0
    s_waitcnt lgkmcnt(5)
    v_mfma_f32_16x16x32_bf16 v[208:211], v[144:147], v[120:123], 0
    v_mul_f32 v24, s46, v64
    s_waitcnt lgkmcnt(4)
    v_mfma_f32_16x16x32_bf16 v[232:235], v[144:147], v[124:127], 0
    ds_read_b64_tr_b16 v[144:145], v104 offset:0
    v_mfma_f32_16x16x32_bf16 v[164:167], v[148:151], v[112:115], 0
    v_mul_f32 v25, s46, v65
    ds_read_b64_tr_b16 v[146:147], v104 offset:1024
    v_mfma_f32_16x16x32_bf16 v[188:191], v[148:151], v[116:119], 0
    v_mfma_f32_16x16x32_bf16 v[212:215], v[148:151], v[120:123], 0
    v_mul_f32 v26, s46, v66
    v_mfma_f32_16x16x32_bf16 v[236:239], v[148:151], v[124:127], 0
    ds_read_b64_tr_b16 v[148:149], v106 offset:0
    s_waitcnt lgkmcnt(5)
    v_mfma_f32_16x16x32_bf16 v[168:171], v[152:155], v[112:115], 0
    v_mul_f32 v27, s46, v67
    ds_read_b64_tr_b16 v[150:151], v106 offset:1024
    v_mfma_f32_16x16x32_bf16 v[192:195], v[152:155], v[116:119], 0
    v_mfma_f32_16x16x32_bf16 v[216:219], v[152:155], v[120:123], 0
    v_exp_f32 v24, v24
    v_mfma_f32_16x16x32_bf16 v[240:243], v[152:155], v[124:127], 0
    ds_read_b64_tr_b16 v[152:153], v96 offset:4096
    s_waitcnt lgkmcnt(5)
    v_mfma_f32_16x16x32_bf16 v[172:175], v[156:159], v[112:115], 0
    v_exp_f32 v25, v25
    ds_read_b64_tr_b16 v[154:155], v96 offset:5120
    v_mfma_f32_16x16x32_bf16 v[196:199], v[156:159], v[116:119], 0
    ds_read_b128 v[128:131], v108 offset:2048
    v_mfma_f32_16x16x32_bf16 v[220:223], v[156:159], v[120:123], 0
    v_exp_f32 v26, v26
    ds_read_b128 v[132:135], v108 offset:2304
    v_mfma_f32_16x16x32_bf16 v[244:247], v[156:159], v[124:127], 0
    ds_read_b64_tr_b16 v[156:157], v98 offset:4096
    s_waitcnt lgkmcnt(7)
    v_mfma_f32_16x16x32_bf16 v[176:179], v[144:147], v[112:115], 0
    v_exp_f32 v27, v27
    ds_read_b64_tr_b16 v[158:159], v98 offset:5120
    v_mfma_f32_16x16x32_bf16 v[200:203], v[144:147], v[116:119], 0
    ds_read_b128 v[136:139], v108 offset:6144
    v_mfma_f32_16x16x32_bf16 v[224:227], v[144:147], v[120:123], 0
    v_fma_f32 v24, v24, v6, v6
    ds_read_b128 v[140:143], v108 offset:6400
    v_mfma_f32_16x16x32_bf16 v[248:251], v[144:147], v[124:127], 0
    ds_read_b64_tr_b16 v[144:145], v100 offset:4096
    s_waitcnt lgkmcnt(9)
    v_mfma_f32_16x16x32_bf16 v[180:183], v[148:151], v[112:115], 0
    v_fma_f32 v25, v25, v6, v6
    ds_read_b64_tr_b16 v[146:147], v100 offset:5120
    v_mfma_f32_16x16x32_bf16 v[204:207], v[148:151], v[116:119], 0
    v_mfma_f32_16x16x32_bf16 v[228:231], v[148:151], v[120:123], 0
    v_fma_f32 v26, v26, v6, v6
    v_mfma_f32_16x16x32_bf16 v[252:255], v[148:151], v[124:127], 0
    ds_read_b64_tr_b16 v[148:149], v102 offset:4096
    s_waitcnt lgkmcnt(8)
    v_mfma_f32_16x16x32_bf16 v[160:163], v[152:155], v[128:131], v[160:163]
    v_fma_f32 v27, v27, v6, v6
    ds_read_b64_tr_b16 v[150:151], v102 offset:5120
    s_waitcnt lgkmcnt(8)
    v_mfma_f32_16x16x32_bf16 v[184:187], v[152:155], v[132:135], v[184:187]
    s_waitcnt lgkmcnt(5)
    v_mfma_f32_16x16x32_bf16 v[208:211], v[152:155], v[136:139], v[208:211]
    s_waitcnt lgkmcnt(4)
    v_mfma_f32_16x16x32_bf16 v[232:235], v[152:155], v[140:143], v[232:235]
    v_rcp_f32 v24, v24
    ds_read_b64_tr_b16 v[152:153], v104 offset:4096
    v_mfma_f32_16x16x32_bf16 v[164:167], v[156:159], v[128:131], v[164:167]
    ds_read_b64_tr_b16 v[154:155], v104 offset:5120
    v_mfma_f32_16x16x32_bf16 v[188:191], v[156:159], v[132:135], v[188:191]
    v_rcp_f32 v25, v25
    v_mfma_f32_16x16x32_bf16 v[212:215], v[156:159], v[136:139], v[212:215]
    v_mfma_f32_16x16x32_bf16 v[236:239], v[156:159], v[140:143], v[236:239]
    v_rcp_f32 v26, v26
    ds_read_b64_tr_b16 v[156:157], v106 offset:4096
    s_waitcnt lgkmcnt(5)
    v_mfma_f32_16x16x32_bf16 v[168:171], v[144:147], v[128:131], v[168:171]
    ds_read_b64_tr_b16 v[158:159], v106 offset:5120
    v_mfma_f32_16x16x32_bf16 v[192:195], v[144:147], v[132:135], v[192:195]
    v_rcp_f32 v27, v27
    v_mfma_f32_16x16x32_bf16 v[216:219], v[144:147], v[136:139], v[216:219]
    v_mfma_f32_16x16x32_bf16 v[240:243], v[144:147], v[140:143], v[240:243]
    v_mul_f32 v24, v64, v24
    s_barrier
    ds_read_b64_tr_b16 v[144:145], v96 offset:40960
    s_waitcnt lgkmcnt(5)
    v_mfma_f32_16x16x32_bf16 v[172:175], v[148:151], v[128:131], v[172:175]
    ds_read_b64_tr_b16 v[146:147], v96 offset:41984
    v_mfma_f32_16x16x32_bf16 v[196:199], v[148:151], v[132:135], v[196:199]
    v_mul_f32 v25, v65, v25
    ds_read_b128 v[112:115], v108 offset:40960
    v_mfma_f32_16x16x32_bf16 v[220:223], v[148:151], v[136:139], v[220:223]
    ds_read_b128 v[116:119], v108 offset:41216
    v_mfma_f32_16x16x32_bf16 v[244:247], v[148:151], v[140:143], v[244:247]
    v_mul_f32 v26, v66, v26
    ds_read_b64_tr_b16 v[148:149], v98 offset:40960
    s_waitcnt lgkmcnt(7)
    v_mfma_f32_16x16x32_bf16 v[176:179], v[152:155], v[128:131], v[176:179]
    ds_read_b64_tr_b16 v[150:151], v98 offset:41984
    v_mfma_f32_16x16x32_bf16 v[200:203], v[152:155], v[132:135], v[200:203]
    v_mul_f32 v27, v67, v27
    ds_read_b128 v[120:123], v108 offset:45056
    v_mfma_f32_16x16x32_bf16 v[224:227], v[152:155], v[136:139], v[224:227]
    ds_read_b128 v[124:127], v108 offset:45312
    v_mfma_f32_16x16x32_bf16 v[248:251], v[152:155], v[140:143], v[248:251]
    v_cvt_pk_bf16_f32 v16, v24, v25
    ds_read_b64_tr_b16 v[152:153], v100 offset:40960
    s_waitcnt lgkmcnt(9)
    v_mfma_f32_16x16x32_bf16 v[180:183], v[156:159], v[128:131], v[180:183]
    ds_read_b64_tr_b16 v[154:155], v100 offset:41984
    v_mfma_f32_16x16x32_bf16 v[204:207], v[156:159], v[132:135], v[204:207]
    v_cvt_pk_bf16_f32 v17, v26, v27
    v_mfma_f32_16x16x32_bf16 v[228:231], v[156:159], v[136:139], v[228:231]
    v_mfma_f32_16x16x32_bf16 v[252:255], v[156:159], v[140:143], v[252:255]
    v_mul_f32 v28, s46, v68
    ds_read_b64_tr_b16 v[156:157], v102 offset:40960
    s_waitcnt lgkmcnt(8)
    v_mfma_f32_16x16x32_bf16 v[160:163], v[144:147], v[112:115], v[160:163]
    ds_read_b64_tr_b16 v[158:159], v102 offset:41984
    s_waitcnt lgkmcnt(8)
    v_mfma_f32_16x16x32_bf16 v[184:187], v[144:147], v[116:119], v[184:187]
    s_waitcnt lgkmcnt(5)
    v_mfma_f32_16x16x32_bf16 v[208:211], v[144:147], v[120:123], v[208:211]
    v_mul_f32 v29, s46, v69
    s_waitcnt lgkmcnt(4)
    v_mfma_f32_16x16x32_bf16 v[232:235], v[144:147], v[124:127], v[232:235]
    ds_read_b64_tr_b16 v[144:145], v104 offset:40960
    v_mfma_f32_16x16x32_bf16 v[164:167], v[148:151], v[112:115], v[164:167]
    v_mul_f32 v30, s46, v70
    ds_read_b64_tr_b16 v[146:147], v104 offset:41984
    v_mfma_f32_16x16x32_bf16 v[188:191], v[148:151], v[116:119], v[188:191]
    v_mfma_f32_16x16x32_bf16 v[212:215], v[148:151], v[120:123], v[212:215]
    v_mul_f32 v31, s46, v71
    v_mfma_f32_16x16x32_bf16 v[236:239], v[148:151], v[124:127], v[236:239]
    ds_read_b64_tr_b16 v[148:149], v106 offset:40960
    s_waitcnt lgkmcnt(5)
    v_mfma_f32_16x16x32_bf16 v[168:171], v[152:155], v[112:115], v[168:171]
    v_exp_f32 v28, v28
    ds_read_b64_tr_b16 v[150:151], v106 offset:41984
    v_mfma_f32_16x16x32_bf16 v[192:195], v[152:155], v[116:119], v[192:195]
    v_mfma_f32_16x16x32_bf16 v[216:219], v[152:155], v[120:123], v[216:219]
    v_exp_f32 v29, v29
    v_mfma_f32_16x16x32_bf16 v[240:243], v[152:155], v[124:127], v[240:243]
    ds_read_b64_tr_b16 v[152:153], v96 offset:45056
    s_waitcnt lgkmcnt(5)
    v_mfma_f32_16x16x32_bf16 v[172:175], v[156:159], v[112:115], v[172:175]
    v_exp_f32 v30, v30
    ds_read_b64_tr_b16 v[154:155], v96 offset:46080
    v_mfma_f32_16x16x32_bf16 v[196:199], v[156:159], v[116:119], v[196:199]
    ds_read_b128 v[128:131], v108 offset:43008
    v_mfma_f32_16x16x32_bf16 v[220:223], v[156:159], v[120:123], v[220:223]
    v_exp_f32 v31, v31
    ds_read_b128 v[132:135], v108 offset:43264
    v_mfma_f32_16x16x32_bf16 v[244:247], v[156:159], v[124:127], v[244:247]
    ds_read_b64_tr_b16 v[156:157], v98 offset:45056
    s_waitcnt lgkmcnt(7)
    v_mfma_f32_16x16x32_bf16 v[176:179], v[144:147], v[112:115], v[176:179]
    v_fma_f32 v28, v28, v6, v6
    ds_read_b64_tr_b16 v[158:159], v98 offset:46080
    v_mfma_f32_16x16x32_bf16 v[200:203], v[144:147], v[116:119], v[200:203]
    ds_read_b128 v[136:139], v108 offset:47104
    v_mfma_f32_16x16x32_bf16 v[224:227], v[144:147], v[120:123], v[224:227]
    v_fma_f32 v29, v29, v6, v6
    ds_read_b128 v[140:143], v108 offset:47360
    v_mfma_f32_16x16x32_bf16 v[248:251], v[144:147], v[124:127], v[248:251]
    ds_read_b64_tr_b16 v[144:145], v100 offset:45056
    s_waitcnt lgkmcnt(9)
    v_mfma_f32_16x16x32_bf16 v[180:183], v[148:151], v[112:115], v[180:183]
    v_fma_f32 v30, v30, v6, v6
    ds_read_b64_tr_b16 v[146:147], v100 offset:46080
    v_mfma_f32_16x16x32_bf16 v[204:207], v[148:151], v[116:119], v[204:207]
    v_mfma_f32_16x16x32_bf16 v[228:231], v[148:151], v[120:123], v[228:231]
    v_fma_f32 v31, v31, v6, v6
    v_mfma_f32_16x16x32_bf16 v[252:255], v[148:151], v[124:127], v[252:255]
    ds_read_b64_tr_b16 v[148:149], v102 offset:45056
    s_waitcnt lgkmcnt(8)
    v_mfma_f32_16x16x32_bf16 v[160:163], v[152:155], v[128:131], v[160:163]
    ds_read_b64_tr_b16 v[150:151], v102 offset:46080
    s_waitcnt lgkmcnt(8)
    v_mfma_f32_16x16x32_bf16 v[184:187], v[152:155], v[132:135], v[184:187]
    v_rcp_f32 v28, v28
    s_waitcnt lgkmcnt(5)
    v_mfma_f32_16x16x32_bf16 v[208:211], v[152:155], v[136:139], v[208:211]
    s_waitcnt lgkmcnt(4)
    v_mfma_f32_16x16x32_bf16 v[232:235], v[152:155], v[140:143], v[232:235]
    v_rcp_f32 v29, v29
    ds_read_b64_tr_b16 v[152:153], v104 offset:45056
    v_mfma_f32_16x16x32_bf16 v[164:167], v[156:159], v[128:131], v[164:167]
    ds_read_b64_tr_b16 v[154:155], v104 offset:46080
    v_mfma_f32_16x16x32_bf16 v[188:191], v[156:159], v[132:135], v[188:191]
    v_rcp_f32 v30, v30
    v_mfma_f32_16x16x32_bf16 v[212:215], v[156:159], v[136:139], v[212:215]
    v_mfma_f32_16x16x32_bf16 v[236:239], v[156:159], v[140:143], v[236:239]
    v_rcp_f32 v31, v31
    ds_read_b64_tr_b16 v[156:157], v106 offset:45056
    s_waitcnt lgkmcnt(5)
    v_mfma_f32_16x16x32_bf16 v[168:171], v[144:147], v[128:131], v[168:171]
    ds_read_b64_tr_b16 v[158:159], v106 offset:46080
    v_mfma_f32_16x16x32_bf16 v[192:195], v[144:147], v[132:135], v[192:195]
    v_mul_f32 v28, v68, v28
    v_mfma_f32_16x16x32_bf16 v[216:219], v[144:147], v[136:139], v[216:219]
    v_mfma_f32_16x16x32_bf16 v[240:243], v[144:147], v[140:143], v[240:243]
    v_mul_f32 v29, v69, v29
    s_barrier
    ds_read_b64_tr_b16 v[144:145], v97 offset:0
    s_waitcnt lgkmcnt(5)
    v_mfma_f32_16x16x32_bf16 v[172:175], v[148:151], v[128:131], v[172:175]
    ds_read_b64_tr_b16 v[146:147], v97 offset:1024
    v_mfma_f32_16x16x32_bf16 v[196:199], v[148:151], v[132:135], v[196:199]
    v_mul_f32 v30, v70, v30
    ds_read_b128 v[112:115], v109 offset:0
    v_mfma_f32_16x16x32_bf16 v[220:223], v[148:151], v[136:139], v[220:223]
    ds_read_b128 v[116:119], v109 offset:256
    v_mfma_f32_16x16x32_bf16 v[244:247], v[148:151], v[140:143], v[244:247]
    v_mul_f32 v31, v71, v31
    ds_read_b64_tr_b16 v[148:149], v99 offset:0
    s_waitcnt lgkmcnt(7)
    v_mfma_f32_16x16x32_bf16 v[176:179], v[152:155], v[128:131], v[176:179]
    ds_read_b64_tr_b16 v[150:151], v99 offset:1024
    v_mfma_f32_16x16x32_bf16 v[200:203], v[152:155], v[132:135], v[200:203]
    v_cvt_pk_bf16_f32 v18, v28, v29
    ds_read_b128 v[120:123], v109 offset:4096
    v_mfma_f32_16x16x32_bf16 v[224:227], v[152:155], v[136:139], v[224:227]
    ds_read_b128 v[124:127], v109 offset:4352
    v_mfma_f32_16x16x32_bf16 v[248:251], v[152:155], v[140:143], v[248:251]
    v_cvt_pk_bf16_f32 v19, v30, v31
    ds_read_b64_tr_b16 v[152:153], v101 offset:0
    s_waitcnt lgkmcnt(9)
    v_mfma_f32_16x16x32_bf16 v[180:183], v[156:159], v[128:131], v[180:183]
    ds_read_b64_tr_b16 v[154:155], v101 offset:1024
    v_mfma_f32_16x16x32_bf16 v[204:207], v[156:159], v[132:135], v[204:207]
    s_add_u32 s51, s45, 61440
    buffer_store_dwordx4 v[16:19], v15, s[24:27], s51 offen offset:0 sc1
    v_mfma_f32_16x16x32_bf16 v[228:231], v[156:159], v[136:139], v[228:231]
    v_mfma_f32_16x16x32_bf16 v[252:255], v[156:159], v[140:143], v[252:255]
    ds_read_b64_tr_b16 v[156:157], v103 offset:0
    s_waitcnt lgkmcnt(8)
    v_mfma_f32_16x16x32_bf16 v[160:163], v[144:147], v[112:115], v[160:163]
    v_mul_f32 v24, s46, v72
    ds_read_b64_tr_b16 v[158:159], v103 offset:1024
    s_waitcnt lgkmcnt(8)
    v_mfma_f32_16x16x32_bf16 v[184:187], v[144:147], v[116:119], v[184:187]
    s_waitcnt lgkmcnt(5)
    v_mfma_f32_16x16x32_bf16 v[208:211], v[144:147], v[120:123], v[208:211]
    v_mul_f32 v25, s46, v73
    s_waitcnt lgkmcnt(4)
    v_mfma_f32_16x16x32_bf16 v[232:235], v[144:147], v[124:127], v[232:235]
    ds_read_b64_tr_b16 v[144:145], v105 offset:0
    v_mfma_f32_16x16x32_bf16 v[164:167], v[148:151], v[112:115], v[164:167]
    v_mul_f32 v26, s46, v74
    ds_read_b64_tr_b16 v[146:147], v105 offset:1024
    v_mfma_f32_16x16x32_bf16 v[188:191], v[148:151], v[116:119], v[188:191]
    v_mfma_f32_16x16x32_bf16 v[212:215], v[148:151], v[120:123], v[212:215]
    v_mul_f32 v27, s46, v75
    v_mfma_f32_16x16x32_bf16 v[236:239], v[148:151], v[124:127], v[236:239]
    ds_read_b64_tr_b16 v[148:149], v107 offset:0
    s_waitcnt lgkmcnt(5)
    v_mfma_f32_16x16x32_bf16 v[168:171], v[152:155], v[112:115], v[168:171]
    v_exp_f32 v24, v24
    ds_read_b64_tr_b16 v[150:151], v107 offset:1024
    v_mfma_f32_16x16x32_bf16 v[192:195], v[152:155], v[116:119], v[192:195]
    v_mfma_f32_16x16x32_bf16 v[216:219], v[152:155], v[120:123], v[216:219]
    v_exp_f32 v25, v25
    v_mfma_f32_16x16x32_bf16 v[240:243], v[152:155], v[124:127], v[240:243]
    ds_read_b64_tr_b16 v[152:153], v97 offset:4096
    s_waitcnt lgkmcnt(5)
    v_mfma_f32_16x16x32_bf16 v[172:175], v[156:159], v[112:115], v[172:175]
    v_exp_f32 v26, v26
    ds_read_b64_tr_b16 v[154:155], v97 offset:5120
    v_mfma_f32_16x16x32_bf16 v[196:199], v[156:159], v[116:119], v[196:199]
    ds_read_b128 v[128:131], v109 offset:2048
    v_mfma_f32_16x16x32_bf16 v[220:223], v[156:159], v[120:123], v[220:223]
    v_exp_f32 v27, v27
    ds_read_b128 v[132:135], v109 offset:2304
    v_mfma_f32_16x16x32_bf16 v[244:247], v[156:159], v[124:127], v[244:247]
    ds_read_b64_tr_b16 v[156:157], v99 offset:4096
    s_waitcnt lgkmcnt(7)
    v_mfma_f32_16x16x32_bf16 v[176:179], v[144:147], v[112:115], v[176:179]
    v_fma_f32 v24, v24, v6, v6
    ds_read_b64_tr_b16 v[158:159], v99 offset:5120
    v_mfma_f32_16x16x32_bf16 v[200:203], v[144:147], v[116:119], v[200:203]
    ds_read_b128 v[136:139], v109 offset:6144
    v_mfma_f32_16x16x32_bf16 v[224:227], v[144:147], v[120:123], v[224:227]
    v_fma_f32 v25, v25, v6, v6
    ds_read_b128 v[140:143], v109 offset:6400
    v_mfma_f32_16x16x32_bf16 v[248:251], v[144:147], v[124:127], v[248:251]
    ds_read_b64_tr_b16 v[144:145], v101 offset:4096
    s_waitcnt lgkmcnt(9)
    v_mfma_f32_16x16x32_bf16 v[180:183], v[148:151], v[112:115], v[180:183]
    v_fma_f32 v26, v26, v6, v6
    ds_read_b64_tr_b16 v[146:147], v101 offset:5120
    v_mfma_f32_16x16x32_bf16 v[204:207], v[148:151], v[116:119], v[204:207]
    v_mfma_f32_16x16x32_bf16 v[228:231], v[148:151], v[120:123], v[228:231]
    v_fma_f32 v27, v27, v6, v6
    v_mfma_f32_16x16x32_bf16 v[252:255], v[148:151], v[124:127], v[252:255]
    ds_read_b64_tr_b16 v[148:149], v103 offset:4096
    s_waitcnt lgkmcnt(8)
    v_mfma_f32_16x16x32_bf16 v[160:163], v[152:155], v[128:131], v[160:163]
    ds_read_b64_tr_b16 v[150:151], v103 offset:5120
    s_waitcnt lgkmcnt(8)
    v_mfma_f32_16x16x32_bf16 v[184:187], v[152:155], v[132:135], v[184:187]
    v_rcp_f32 v24, v24
    s_waitcnt lgkmcnt(5)
    v_mfma_f32_16x16x32_bf16 v[208:211], v[152:155], v[136:139], v[208:211]
    s_waitcnt lgkmcnt(4)
    v_mfma_f32_16x16x32_bf16 v[232:235], v[152:155], v[140:143], v[232:235]
    v_rcp_f32 v25, v25
    ds_read_b64_tr_b16 v[152:153], v105 offset:4096
    v_mfma_f32_16x16x32_bf16 v[164:167], v[156:159], v[128:131], v[164:167]
    ds_read_b64_tr_b16 v[154:155], v105 offset:5120
    v_mfma_f32_16x16x32_bf16 v[188:191], v[156:159], v[132:135], v[188:191]
    v_rcp_f32 v26, v26
    v_mfma_f32_16x16x32_bf16 v[212:215], v[156:159], v[136:139], v[212:215]
    v_mfma_f32_16x16x32_bf16 v[236:239], v[156:159], v[140:143], v[236:239]
    v_rcp_f32 v27, v27
    ds_read_b64_tr_b16 v[156:157], v107 offset:4096
    s_waitcnt lgkmcnt(5)
    v_mfma_f32_16x16x32_bf16 v[168:171], v[144:147], v[128:131], v[168:171]
    ds_read_b64_tr_b16 v[158:159], v107 offset:5120
    v_mfma_f32_16x16x32_bf16 v[192:195], v[144:147], v[132:135], v[192:195]
    v_mul_f32 v24, v72, v24
    v_mfma_f32_16x16x32_bf16 v[216:219], v[144:147], v[136:139], v[216:219]
    v_mfma_f32_16x16x32_bf16 v[240:243], v[144:147], v[140:143], v[240:243]
    v_mul_f32 v25, v73, v25
    s_barrier
    ds_read_b64_tr_b16 v[144:145], v97 offset:40960
    s_waitcnt lgkmcnt(5)
    v_mfma_f32_16x16x32_bf16 v[172:175], v[148:151], v[128:131], v[172:175]
    ds_read_b64_tr_b16 v[146:147], v97 offset:41984
    v_mfma_f32_16x16x32_bf16 v[196:199], v[148:151], v[132:135], v[196:199]
    v_mul_f32 v26, v74, v26
    ds_read_b128 v[112:115], v109 offset:40960
    v_mfma_f32_16x16x32_bf16 v[220:223], v[148:151], v[136:139], v[220:223]
    ds_read_b128 v[116:119], v109 offset:41216
    v_mfma_f32_16x16x32_bf16 v[244:247], v[148:151], v[140:143], v[244:247]
    v_mul_f32 v27, v75, v27
    ds_read_b64_tr_b16 v[148:149], v99 offset:40960
    s_waitcnt lgkmcnt(7)
    v_mfma_f32_16x16x32_bf16 v[176:179], v[152:155], v[128:131], v[176:179]
    ds_read_b64_tr_b16 v[150:151], v99 offset:41984
    v_mfma_f32_16x16x32_bf16 v[200:203], v[152:155], v[132:135], v[200:203]
    v_cvt_pk_bf16_f32 v20, v24, v25
    ds_read_b128 v[120:123], v109 offset:45056
    v_mfma_f32_16x16x32_bf16 v[224:227], v[152:155], v[136:139], v[224:227]
    ds_read_b128 v[124:127], v109 offset:45312
    v_mfma_f32_16x16x32_bf16 v[248:251], v[152:155], v[140:143], v[248:251]
    v_cvt_pk_bf16_f32 v21, v26, v27
    ds_read_b64_tr_b16 v[152:153], v101 offset:40960
    s_waitcnt lgkmcnt(9)
    v_mfma_f32_16x16x32_bf16 v[180:183], v[156:159], v[128:131], v[180:183]
    ds_read_b64_tr_b16 v[154:155], v101 offset:41984
    v_mfma_f32_16x16x32_bf16 v[204:207], v[156:159], v[132:135], v[204:207]
    v_mul_f32 v28, s46, v76
    v_mfma_f32_16x16x32_bf16 v[228:231], v[156:159], v[136:139], v[228:231]
    v_mfma_f32_16x16x32_bf16 v[252:255], v[156:159], v[140:143], v[252:255]
    ds_read_b64_tr_b16 v[156:157], v103 offset:40960
    s_waitcnt lgkmcnt(8)
    v_mfma_f32_16x16x32_bf16 v[160:163], v[144:147], v[112:115], v[160:163]
    v_mul_f32 v29, s46, v77
    ds_read_b64_tr_b16 v[158:159], v103 offset:41984
    s_waitcnt lgkmcnt(8)
    v_mfma_f32_16x16x32_bf16 v[184:187], v[144:147], v[116:119], v[184:187]
    s_waitcnt lgkmcnt(5)
    v_mfma_f32_16x16x32_bf16 v[208:211], v[144:147], v[120:123], v[208:211]
    v_mul_f32 v30, s46, v78
    s_waitcnt lgkmcnt(4)
    v_mfma_f32_16x16x32_bf16 v[232:235], v[144:147], v[124:127], v[232:235]
    ds_read_b64_tr_b16 v[144:145], v105 offset:40960
    v_mfma_f32_16x16x32_bf16 v[164:167], v[148:151], v[112:115], v[164:167]
    v_mul_f32 v31, s46, v79
    ds_read_b64_tr_b16 v[146:147], v105 offset:41984
    v_mfma_f32_16x16x32_bf16 v[188:191], v[148:151], v[116:119], v[188:191]
    v_mfma_f32_16x16x32_bf16 v[212:215], v[148:151], v[120:123], v[212:215]
    v_exp_f32 v28, v28
    v_mfma_f32_16x16x32_bf16 v[236:239], v[148:151], v[124:127], v[236:239]
    ds_read_b64_tr_b16 v[148:149], v107 offset:40960
    s_waitcnt lgkmcnt(5)
    v_mfma_f32_16x16x32_bf16 v[168:171], v[152:155], v[112:115], v[168:171]
    v_exp_f32 v29, v29
    ds_read_b64_tr_b16 v[150:151], v107 offset:41984
    v_mfma_f32_16x16x32_bf16 v[192:195], v[152:155], v[116:119], v[192:195]
    v_mfma_f32_16x16x32_bf16 v[216:219], v[152:155], v[120:123], v[216:219]
    v_exp_f32 v30, v30
    v_mfma_f32_16x16x32_bf16 v[240:243], v[152:155], v[124:127], v[240:243]
    ds_read_b64_tr_b16 v[152:153], v97 offset:45056
    s_waitcnt lgkmcnt(5)
    v_mfma_f32_16x16x32_bf16 v[172:175], v[156:159], v[112:115], v[172:175]
    v_exp_f32 v31, v31
    ds_read_b64_tr_b16 v[154:155], v97 offset:46080
    v_mfma_f32_16x16x32_bf16 v[196:199], v[156:159], v[116:119], v[196:199]
    ds_read_b128 v[128:131], v109 offset:43008
    v_mfma_f32_16x16x32_bf16 v[220:223], v[156:159], v[120:123], v[220:223]
    v_fma_f32 v28, v28, v6, v6
    ds_read_b128 v[132:135], v109 offset:43264
    v_mfma_f32_16x16x32_bf16 v[244:247], v[156:159], v[124:127], v[244:247]
    ds_read_b64_tr_b16 v[156:157], v99 offset:45056
    s_waitcnt lgkmcnt(7)
    v_mfma_f32_16x16x32_bf16 v[176:179], v[144:147], v[112:115], v[176:179]
    v_fma_f32 v29, v29, v6, v6
    ds_read_b64_tr_b16 v[158:159], v99 offset:46080
    v_mfma_f32_16x16x32_bf16 v[200:203], v[144:147], v[116:119], v[200:203]
    ds_read_b128 v[136:139], v109 offset:47104
    v_mfma_f32_16x16x32_bf16 v[224:227], v[144:147], v[120:123], v[224:227]
    v_fma_f32 v30, v30, v6, v6
    ds_read_b128 v[140:143], v109 offset:47360
    v_mfma_f32_16x16x32_bf16 v[248:251], v[144:147], v[124:127], v[248:251]
    ds_read_b64_tr_b16 v[144:145], v101 offset:45056
    s_waitcnt lgkmcnt(9)
    v_mfma_f32_16x16x32_bf16 v[180:183], v[148:151], v[112:115], v[180:183]
    v_fma_f32 v31, v31, v6, v6
    ds_read_b64_tr_b16 v[146:147], v101 offset:46080
    v_mfma_f32_16x16x32_bf16 v[204:207], v[148:151], v[116:119], v[204:207]
    v_mfma_f32_16x16x32_bf16 v[228:231], v[148:151], v[120:123], v[228:231]
    v_mfma_f32_16x16x32_bf16 v[252:255], v[148:151], v[124:127], v[252:255]
    v_rcp_f32 v28, v28
    ds_read_b64_tr_b16 v[148:149], v103 offset:45056
    s_waitcnt lgkmcnt(8)
    v_mfma_f32_16x16x32_bf16 v[160:163], v[152:155], v[128:131], v[160:163]
    ds_read_b64_tr_b16 v[150:151], v103 offset:46080
    s_waitcnt lgkmcnt(8)
    v_mfma_f32_16x16x32_bf16 v[184:187], v[152:155], v[132:135], v[184:187]
    v_rcp_f32 v29, v29
    s_waitcnt lgkmcnt(5)
    v_mfma_f32_16x16x32_bf16 v[208:211], v[152:155], v[136:139], v[208:211]
    s_waitcnt lgkmcnt(4)
    v_mfma_f32_16x16x32_bf16 v[232:235], v[152:155], v[140:143], v[232:235]
    v_rcp_f32 v30, v30
    ds_read_b64_tr_b16 v[152:153], v105 offset:45056
    v_mfma_f32_16x16x32_bf16 v[164:167], v[156:159], v[128:131], v[164:167]
    ds_read_b64_tr_b16 v[154:155], v105 offset:46080
    v_mfma_f32_16x16x32_bf16 v[188:191], v[156:159], v[132:135], v[188:191]
    v_rcp_f32 v31, v31
    v_mfma_f32_16x16x32_bf16 v[212:215], v[156:159], v[136:139], v[212:215]
    v_mfma_f32_16x16x32_bf16 v[236:239], v[156:159], v[140:143], v[236:239]
    v_mul_f32 v28, v76, v28
    ds_read_b64_tr_b16 v[156:157], v107 offset:45056
    s_waitcnt lgkmcnt(5)
    v_mfma_f32_16x16x32_bf16 v[168:171], v[144:147], v[128:131], v[168:171]
    ds_read_b64_tr_b16 v[158:159], v107 offset:46080
    v_mfma_f32_16x16x32_bf16 v[192:195], v[144:147], v[132:135], v[192:195]
    v_mul_f32 v29, v77, v29
    v_mfma_f32_16x16x32_bf16 v[216:219], v[144:147], v[136:139], v[216:219]
    v_mfma_f32_16x16x32_bf16 v[240:243], v[144:147], v[140:143], v[240:243]
    v_mul_f32 v30, v78, v30
    s_barrier
    ds_read_b64_tr_b16 v[144:145], v96 offset:0
    s_waitcnt lgkmcnt(5)
    v_mfma_f32_16x16x32_bf16 v[172:175], v[148:151], v[128:131], v[172:175]
    ds_read_b64_tr_b16 v[146:147], v96 offset:1024
    v_mfma_f32_16x16x32_bf16 v[196:199], v[148:151], v[132:135], v[196:199]
    v_mul_f32 v31, v79, v31
    ds_read_b128 v[112:115], v108 offset:0
    v_mfma_f32_16x16x32_bf16 v[220:223], v[148:151], v[136:139], v[220:223]
    ds_read_b128 v[116:119], v108 offset:256
    v_mfma_f32_16x16x32_bf16 v[244:247], v[148:151], v[140:143], v[244:247]
    v_cvt_pk_bf16_f32 v22, v28, v29
    ds_read_b64_tr_b16 v[148:149], v98 offset:0
    s_waitcnt lgkmcnt(7)
    v_mfma_f32_16x16x32_bf16 v[176:179], v[152:155], v[128:131], v[176:179]
    ds_read_b64_tr_b16 v[150:151], v98 offset:1024
    v_mfma_f32_16x16x32_bf16 v[200:203], v[152:155], v[132:135], v[200:203]
    v_cvt_pk_bf16_f32 v23, v30, v31
    ds_read_b128 v[120:123], v108 offset:4096
    v_mfma_f32_16x16x32_bf16 v[224:227], v[152:155], v[136:139], v[224:227]
    ds_read_b128 v[124:127], v108 offset:4352
    v_mfma_f32_16x16x32_bf16 v[248:251], v[152:155], v[140:143], v[248:251]
    buffer_store_dwordx4 v[20:23], v15, s[24:27], s51 offen offset:1024 sc1
    ds_read_b64_tr_b16 v[152:153], v100 offset:0
    s_waitcnt lgkmcnt(9)
    v_mfma_f32_16x16x32_bf16 v[180:183], v[156:159], v[128:131], v[180:183]
    ds_read_b64_tr_b16 v[154:155], v100 offset:1024
    v_mfma_f32_16x16x32_bf16 v[204:207], v[156:159], v[132:135], v[204:207]
    v_mfma_f32_16x16x32_bf16 v[228:231], v[156:159], v[136:139], v[228:231]
    v_mfma_f32_16x16x32_bf16 v[252:255], v[156:159], v[140:143], v[252:255]
    ds_read_b64_tr_b16 v[156:157], v102 offset:0
    s_waitcnt lgkmcnt(8)
    v_mfma_f32_16x16x32_bf16 v[160:163], v[144:147], v[112:115], v[160:163]
    ds_read_b64_tr_b16 v[158:159], v102 offset:1024
    s_waitcnt lgkmcnt(8)
    v_mfma_f32_16x16x32_bf16 v[184:187], v[144:147], v[116:119], v[184:187]
    s_waitcnt lgkmcnt(5)
    v_mfma_f32_16x16x32_bf16 v[208:211], v[144:147], v[120:123], v[208:211]
    s_waitcnt lgkmcnt(4)
    v_mfma_f32_16x16x32_bf16 v[232:235], v[144:147], v[124:127], v[232:235]
    ds_read_b64_tr_b16 v[144:145], v104 offset:0
    v_mfma_f32_16x16x32_bf16 v[164:167], v[148:151], v[112:115], v[164:167]
    ds_read_b64_tr_b16 v[146:147], v104 offset:1024
    v_mfma_f32_16x16x32_bf16 v[188:191], v[148:151], v[116:119], v[188:191]
    v_mfma_f32_16x16x32_bf16 v[212:215], v[148:151], v[120:123], v[212:215]
    v_mfma_f32_16x16x32_bf16 v[236:239], v[148:151], v[124:127], v[236:239]
    ds_read_b64_tr_b16 v[148:149], v106 offset:0
    s_waitcnt lgkmcnt(5)
    v_mfma_f32_16x16x32_bf16 v[168:171], v[152:155], v[112:115], v[168:171]
    s_waitcnt vmcnt(2)
    buffer_store_dwordx2 v[2:3], v8, s[24:27], s52 offen offset:192 sc1
    ds_read_b64_tr_b16 v[150:151], v106 offset:1024
    v_mfma_f32_16x16x32_bf16 v[192:195], v[152:155], v[116:119], v[192:195]
    v_mfma_f32_16x16x32_bf16 v[216:219], v[152:155], v[120:123], v[216:219]
    v_mfma_f32_16x16x32_bf16 v[240:243], v[152:155], v[124:127], v[240:243]
    ds_read_b64_tr_b16 v[152:153], v96 offset:4096
    s_waitcnt lgkmcnt(5)
    v_mfma_f32_16x16x32_bf16 v[172:175], v[156:159], v[112:115], v[172:175]
    ds_read_b64_tr_b16 v[154:155], v96 offset:5120
    v_mfma_f32_16x16x32_bf16 v[196:199], v[156:159], v[116:119], v[196:199]
    ds_read_b128 v[128:131], v108 offset:2048
    v_mfma_f32_16x16x32_bf16 v[220:223], v[156:159], v[120:123], v[220:223]
    ds_read_b128 v[132:135], v108 offset:2304
    v_mfma_f32_16x16x32_bf16 v[244:247], v[156:159], v[124:127], v[244:247]
    ds_read_b64_tr_b16 v[156:157], v98 offset:4096
    s_waitcnt lgkmcnt(7)
    v_mfma_f32_16x16x32_bf16 v[176:179], v[144:147], v[112:115], v[176:179]
    ds_read_b64_tr_b16 v[158:159], v98 offset:5120
    v_mfma_f32_16x16x32_bf16 v[200:203], v[144:147], v[116:119], v[200:203]
    ds_read_b128 v[136:139], v108 offset:6144
    v_mfma_f32_16x16x32_bf16 v[224:227], v[144:147], v[120:123], v[224:227]
    ds_read_b128 v[140:143], v108 offset:6400
    v_mfma_f32_16x16x32_bf16 v[248:251], v[144:147], v[124:127], v[248:251]
    ds_read_b64_tr_b16 v[144:145], v100 offset:4096
    s_waitcnt lgkmcnt(9)
    v_mfma_f32_16x16x32_bf16 v[180:183], v[148:151], v[112:115], v[180:183]
    ds_read_b64_tr_b16 v[146:147], v100 offset:5120
    v_mfma_f32_16x16x32_bf16 v[204:207], v[148:151], v[116:119], v[204:207]
    v_mfma_f32_16x16x32_bf16 v[228:231], v[148:151], v[120:123], v[228:231]
    v_mfma_f32_16x16x32_bf16 v[252:255], v[148:151], v[124:127], v[252:255]
    ds_read_b64_tr_b16 v[148:149], v102 offset:4096
    s_waitcnt lgkmcnt(8)
    v_mfma_f32_16x16x32_bf16 v[160:163], v[152:155], v[128:131], v[160:163]
    ds_read_b64_tr_b16 v[150:151], v102 offset:5120
    s_waitcnt lgkmcnt(8)
    v_mfma_f32_16x16x32_bf16 v[184:187], v[152:155], v[132:135], v[184:187]
    s_waitcnt lgkmcnt(5)
    v_mfma_f32_16x16x32_bf16 v[208:211], v[152:155], v[136:139], v[208:211]
    s_waitcnt lgkmcnt(4)
    v_mfma_f32_16x16x32_bf16 v[232:235], v[152:155], v[140:143], v[232:235]
    ds_read_b64_tr_b16 v[152:153], v104 offset:4096
    v_mfma_f32_16x16x32_bf16 v[164:167], v[156:159], v[128:131], v[164:167]
    ds_read_b64_tr_b16 v[154:155], v104 offset:5120
    v_mfma_f32_16x16x32_bf16 v[188:191], v[156:159], v[132:135], v[188:191]
    v_mfma_f32_16x16x32_bf16 v[212:215], v[156:159], v[136:139], v[212:215]
    v_mfma_f32_16x16x32_bf16 v[236:239], v[156:159], v[140:143], v[236:239]
    ds_read_b64_tr_b16 v[156:157], v106 offset:4096
    s_waitcnt lgkmcnt(5)
    v_mfma_f32_16x16x32_bf16 v[168:171], v[144:147], v[128:131], v[168:171]
    ds_read_b64_tr_b16 v[158:159], v106 offset:5120
    v_mfma_f32_16x16x32_bf16 v[192:195], v[144:147], v[132:135], v[192:195]
    v_mfma_f32_16x16x32_bf16 v[216:219], v[144:147], v[136:139], v[216:219]
    v_mfma_f32_16x16x32_bf16 v[240:243], v[144:147], v[140:143], v[240:243]
    s_barrier
    ds_read_b64_tr_b16 v[144:145], v96 offset:40960
    s_waitcnt lgkmcnt(5)
    v_mfma_f32_16x16x32_bf16 v[172:175], v[148:151], v[128:131], v[172:175]
    ds_read_b64_tr_b16 v[146:147], v96 offset:41984
    v_mfma_f32_16x16x32_bf16 v[196:199], v[148:151], v[132:135], v[196:199]
    ds_read_b128 v[112:115], v108 offset:40960
    v_mfma_f32_16x16x32_bf16 v[220:223], v[148:151], v[136:139], v[220:223]
    ds_read_b128 v[116:119], v108 offset:41216
    v_mfma_f32_16x16x32_bf16 v[244:247], v[148:151], v[140:143], v[244:247]
    ds_read_b64_tr_b16 v[148:149], v98 offset:40960
    s_waitcnt lgkmcnt(7)
    v_mfma_f32_16x16x32_bf16 v[176:179], v[152:155], v[128:131], v[176:179]
    ds_read_b64_tr_b16 v[150:151], v98 offset:41984
    v_mfma_f32_16x16x32_bf16 v[200:203], v[152:155], v[132:135], v[200:203]
    ds_read_b128 v[120:123], v108 offset:45056
    v_mfma_f32_16x16x32_bf16 v[224:227], v[152:155], v[136:139], v[224:227]
    ds_read_b128 v[124:127], v108 offset:45312
    v_mfma_f32_16x16x32_bf16 v[248:251], v[152:155], v[140:143], v[248:251]
    ds_read_b64_tr_b16 v[152:153], v100 offset:40960
    s_waitcnt lgkmcnt(9)
    v_mfma_f32_16x16x32_bf16 v[180:183], v[156:159], v[128:131], v[180:183]
    ds_read_b64_tr_b16 v[154:155], v100 offset:41984
    v_mfma_f32_16x16x32_bf16 v[204:207], v[156:159], v[132:135], v[204:207]
    v_mfma_f32_16x16x32_bf16 v[228:231], v[156:159], v[136:139], v[228:231]
    v_mfma_f32_16x16x32_bf16 v[252:255], v[156:159], v[140:143], v[252:255]
    ds_read_b64_tr_b16 v[156:157], v102 offset:40960
    s_waitcnt lgkmcnt(8)
    v_mfma_f32_16x16x32_bf16 v[160:163], v[144:147], v[112:115], v[160:163]
    ds_read_b64_tr_b16 v[158:159], v102 offset:41984
    s_waitcnt lgkmcnt(8)
    v_mfma_f32_16x16x32_bf16 v[184:187], v[144:147], v[116:119], v[184:187]
    s_waitcnt lgkmcnt(5)
    v_mfma_f32_16x16x32_bf16 v[208:211], v[144:147], v[120:123], v[208:211]
    s_waitcnt lgkmcnt(4)
    v_mfma_f32_16x16x32_bf16 v[232:235], v[144:147], v[124:127], v[232:235]
    ds_read_b64_tr_b16 v[144:145], v104 offset:40960
    v_mfma_f32_16x16x32_bf16 v[164:167], v[148:151], v[112:115], v[164:167]
    ds_read_b64_tr_b16 v[146:147], v104 offset:41984
    v_mfma_f32_16x16x32_bf16 v[188:191], v[148:151], v[116:119], v[188:191]
    v_mfma_f32_16x16x32_bf16 v[212:215], v[148:151], v[120:123], v[212:215]
    v_mfma_f32_16x16x32_bf16 v[236:239], v[148:151], v[124:127], v[236:239]
    ds_read_b64_tr_b16 v[148:149], v106 offset:40960
    s_waitcnt lgkmcnt(5)
    v_mfma_f32_16x16x32_bf16 v[168:171], v[152:155], v[112:115], v[168:171]
    ds_read_b64_tr_b16 v[150:151], v106 offset:41984
    v_mfma_f32_16x16x32_bf16 v[192:195], v[152:155], v[116:119], v[192:195]
    v_mfma_f32_16x16x32_bf16 v[216:219], v[152:155], v[120:123], v[216:219]
    v_mfma_f32_16x16x32_bf16 v[240:243], v[152:155], v[124:127], v[240:243]
    ds_read_b64_tr_b16 v[152:153], v96 offset:45056
    s_waitcnt lgkmcnt(5)
    v_mfma_f32_16x16x32_bf16 v[172:175], v[156:159], v[112:115], v[172:175]
    ds_read_b64_tr_b16 v[154:155], v96 offset:46080
    v_mfma_f32_16x16x32_bf16 v[196:199], v[156:159], v[116:119], v[196:199]
    ds_read_b128 v[128:131], v108 offset:43008
    v_mfma_f32_16x16x32_bf16 v[220:223], v[156:159], v[120:123], v[220:223]
    ds_read_b128 v[132:135], v108 offset:43264
    v_mfma_f32_16x16x32_bf16 v[244:247], v[156:159], v[124:127], v[244:247]
    ds_read_b64_tr_b16 v[156:157], v98 offset:45056
    s_waitcnt lgkmcnt(7)
    v_mfma_f32_16x16x32_bf16 v[176:179], v[144:147], v[112:115], v[176:179]
    ds_read_b64_tr_b16 v[158:159], v98 offset:46080
    v_mfma_f32_16x16x32_bf16 v[200:203], v[144:147], v[116:119], v[200:203]
    ds_read_b128 v[136:139], v108 offset:47104
    v_mfma_f32_16x16x32_bf16 v[224:227], v[144:147], v[120:123], v[224:227]
    ds_read_b128 v[140:143], v108 offset:47360
    v_mfma_f32_16x16x32_bf16 v[248:251], v[144:147], v[124:127], v[248:251]
    ds_read_b64_tr_b16 v[144:145], v100 offset:45056
    s_waitcnt lgkmcnt(9)
    v_mfma_f32_16x16x32_bf16 v[180:183], v[148:151], v[112:115], v[180:183]
    ds_read_b64_tr_b16 v[146:147], v100 offset:46080
    v_mfma_f32_16x16x32_bf16 v[204:207], v[148:151], v[116:119], v[204:207]
    v_mfma_f32_16x16x32_bf16 v[228:231], v[148:151], v[120:123], v[228:231]
    v_mfma_f32_16x16x32_bf16 v[252:255], v[148:151], v[124:127], v[252:255]
    ds_read_b64_tr_b16 v[148:149], v102 offset:45056
    s_waitcnt lgkmcnt(8)
    v_mfma_f32_16x16x32_bf16 v[160:163], v[152:155], v[128:131], v[160:163]
    ds_read_b64_tr_b16 v[150:151], v102 offset:46080
    s_waitcnt lgkmcnt(8)
    v_mfma_f32_16x16x32_bf16 v[184:187], v[152:155], v[132:135], v[184:187]
    s_waitcnt lgkmcnt(5)
    v_mfma_f32_16x16x32_bf16 v[208:211], v[152:155], v[136:139], v[208:211]
    s_waitcnt lgkmcnt(4)
    v_mfma_f32_16x16x32_bf16 v[232:235], v[152:155], v[140:143], v[232:235]
    ds_read_b64_tr_b16 v[152:153], v104 offset:45056
    v_mfma_f32_16x16x32_bf16 v[164:167], v[156:159], v[128:131], v[164:167]
    ds_read_b64_tr_b16 v[154:155], v104 offset:46080
    v_mfma_f32_16x16x32_bf16 v[188:191], v[156:159], v[132:135], v[188:191]
    v_mfma_f32_16x16x32_bf16 v[212:215], v[156:159], v[136:139], v[212:215]
    v_mfma_f32_16x16x32_bf16 v[236:239], v[156:159], v[140:143], v[236:239]
    ds_read_b64_tr_b16 v[156:157], v106 offset:45056
    s_waitcnt lgkmcnt(5)
    v_mfma_f32_16x16x32_bf16 v[168:171], v[144:147], v[128:131], v[168:171]
    ds_read_b64_tr_b16 v[158:159], v106 offset:46080
    v_mfma_f32_16x16x32_bf16 v[192:195], v[144:147], v[132:135], v[192:195]
    v_mfma_f32_16x16x32_bf16 v[216:219], v[144:147], v[136:139], v[216:219]
    v_mfma_f32_16x16x32_bf16 v[240:243], v[144:147], v[140:143], v[240:243]
    s_barrier
    ds_read_b64_tr_b16 v[144:145], v97 offset:0
    s_waitcnt lgkmcnt(5)
    v_mfma_f32_16x16x32_bf16 v[172:175], v[148:151], v[128:131], v[172:175]
    ds_read_b64_tr_b16 v[146:147], v97 offset:1024
    v_mfma_f32_16x16x32_bf16 v[196:199], v[148:151], v[132:135], v[196:199]
    ds_read_b128 v[112:115], v109 offset:0
    v_mfma_f32_16x16x32_bf16 v[220:223], v[148:151], v[136:139], v[220:223]
    ds_read_b128 v[116:119], v109 offset:256
    v_mfma_f32_16x16x32_bf16 v[244:247], v[148:151], v[140:143], v[244:247]
    ds_read_b64_tr_b16 v[148:149], v99 offset:0
    s_waitcnt lgkmcnt(7)
    v_mfma_f32_16x16x32_bf16 v[176:179], v[152:155], v[128:131], v[176:179]
    ds_read_b64_tr_b16 v[150:151], v99 offset:1024
    v_mfma_f32_16x16x32_bf16 v[200:203], v[152:155], v[132:135], v[200:203]
    ds_read_b128 v[120:123], v109 offset:4096
    v_mfma_f32_16x16x32_bf16 v[224:227], v[152:155], v[136:139], v[224:227]
    ds_read_b128 v[124:127], v109 offset:4352
    v_mfma_f32_16x16x32_bf16 v[248:251], v[152:155], v[140:143], v[248:251]
    ds_read_b64_tr_b16 v[152:153], v101 offset:0
    s_waitcnt lgkmcnt(9)
    v_mfma_f32_16x16x32_bf16 v[180:183], v[156:159], v[128:131], v[180:183]
    ds_read_b64_tr_b16 v[154:155], v101 offset:1024
    v_mfma_f32_16x16x32_bf16 v[204:207], v[156:159], v[132:135], v[204:207]
    v_mfma_f32_16x16x32_bf16 v[228:231], v[156:159], v[136:139], v[228:231]
    v_mfma_f32_16x16x32_bf16 v[252:255], v[156:159], v[140:143], v[252:255]
    ds_read_b64_tr_b16 v[156:157], v103 offset:0
    s_waitcnt lgkmcnt(8)
    v_mfma_f32_16x16x32_bf16 v[160:163], v[144:147], v[112:115], v[160:163]
    ds_read_b64_tr_b16 v[158:159], v103 offset:1024
    s_waitcnt lgkmcnt(8)
    v_mfma_f32_16x16x32_bf16 v[184:187], v[144:147], v[116:119], v[184:187]
    s_waitcnt lgkmcnt(5)
    v_mfma_f32_16x16x32_bf16 v[208:211], v[144:147], v[120:123], v[208:211]
    s_waitcnt lgkmcnt(4)
    v_mfma_f32_16x16x32_bf16 v[232:235], v[144:147], v[124:127], v[232:235]
    ds_read_b64_tr_b16 v[144:145], v105 offset:0
    v_mfma_f32_16x16x32_bf16 v[164:167], v[148:151], v[112:115], v[164:167]
    ds_read_b64_tr_b16 v[146:147], v105 offset:1024
    v_mfma_f32_16x16x32_bf16 v[188:191], v[148:151], v[116:119], v[188:191]
    v_mfma_f32_16x16x32_bf16 v[212:215], v[148:151], v[120:123], v[212:215]
    v_mfma_f32_16x16x32_bf16 v[236:239], v[148:151], v[124:127], v[236:239]
    ds_read_b64_tr_b16 v[148:149], v107 offset:0
    s_waitcnt lgkmcnt(5)
    v_mfma_f32_16x16x32_bf16 v[168:171], v[152:155], v[112:115], v[168:171]
    ds_read_b64_tr_b16 v[150:151], v107 offset:1024
    v_mfma_f32_16x16x32_bf16 v[192:195], v[152:155], v[116:119], v[192:195]
    v_mfma_f32_16x16x32_bf16 v[216:219], v[152:155], v[120:123], v[216:219]
    v_mfma_f32_16x16x32_bf16 v[240:243], v[152:155], v[124:127], v[240:243]
    ds_read_b64_tr_b16 v[152:153], v97 offset:4096
    s_waitcnt lgkmcnt(5)
    v_mfma_f32_16x16x32_bf16 v[172:175], v[156:159], v[112:115], v[172:175]
    ds_read_b64_tr_b16 v[154:155], v97 offset:5120
    v_mfma_f32_16x16x32_bf16 v[196:199], v[156:159], v[116:119], v[196:199]
    ds_read_b128 v[128:131], v109 offset:2048
    v_mfma_f32_16x16x32_bf16 v[220:223], v[156:159], v[120:123], v[220:223]
    ds_read_b128 v[132:135], v109 offset:2304
    v_mfma_f32_16x16x32_bf16 v[244:247], v[156:159], v[124:127], v[244:247]
    ds_read_b64_tr_b16 v[156:157], v99 offset:4096
    s_waitcnt lgkmcnt(7)
    v_mfma_f32_16x16x32_bf16 v[176:179], v[144:147], v[112:115], v[176:179]
    ds_read_b64_tr_b16 v[158:159], v99 offset:5120
    v_mfma_f32_16x16x32_bf16 v[200:203], v[144:147], v[116:119], v[200:203]
    ds_read_b128 v[136:139], v109 offset:6144
    v_mfma_f32_16x16x32_bf16 v[224:227], v[144:147], v[120:123], v[224:227]
    ds_read_b128 v[140:143], v109 offset:6400
    v_mfma_f32_16x16x32_bf16 v[248:251], v[144:147], v[124:127], v[248:251]
    ds_read_b64_tr_b16 v[144:145], v101 offset:4096
    s_waitcnt lgkmcnt(9)
    v_mfma_f32_16x16x32_bf16 v[180:183], v[148:151], v[112:115], v[180:183]
    ds_read_b64_tr_b16 v[146:147], v101 offset:5120
    v_mfma_f32_16x16x32_bf16 v[204:207], v[148:151], v[116:119], v[204:207]
    v_mfma_f32_16x16x32_bf16 v[228:231], v[148:151], v[120:123], v[228:231]
    v_mfma_f32_16x16x32_bf16 v[252:255], v[148:151], v[124:127], v[252:255]
    ds_read_b64_tr_b16 v[148:149], v103 offset:4096
    s_waitcnt lgkmcnt(8)
    v_mfma_f32_16x16x32_bf16 v[160:163], v[152:155], v[128:131], v[160:163]
    ds_read_b64_tr_b16 v[150:151], v103 offset:5120
    s_waitcnt lgkmcnt(8)
    v_mfma_f32_16x16x32_bf16 v[184:187], v[152:155], v[132:135], v[184:187]
    s_waitcnt lgkmcnt(5)
    v_mfma_f32_16x16x32_bf16 v[208:211], v[152:155], v[136:139], v[208:211]
    s_waitcnt lgkmcnt(4)
    v_mfma_f32_16x16x32_bf16 v[232:235], v[152:155], v[140:143], v[232:235]
    ds_read_b64_tr_b16 v[152:153], v105 offset:4096
    v_mfma_f32_16x16x32_bf16 v[164:167], v[156:159], v[128:131], v[164:167]
    ds_read_b64_tr_b16 v[154:155], v105 offset:5120
    v_mfma_f32_16x16x32_bf16 v[188:191], v[156:159], v[132:135], v[188:191]
    v_mfma_f32_16x16x32_bf16 v[212:215], v[156:159], v[136:139], v[212:215]
    v_mfma_f32_16x16x32_bf16 v[236:239], v[156:159], v[140:143], v[236:239]
    ds_read_b64_tr_b16 v[156:157], v107 offset:4096
    s_waitcnt lgkmcnt(5)
    v_mfma_f32_16x16x32_bf16 v[168:171], v[144:147], v[128:131], v[168:171]
    ds_read_b64_tr_b16 v[158:159], v107 offset:5120
    v_mfma_f32_16x16x32_bf16 v[192:195], v[144:147], v[132:135], v[192:195]
    v_mfma_f32_16x16x32_bf16 v[216:219], v[144:147], v[136:139], v[216:219]
    v_mfma_f32_16x16x32_bf16 v[240:243], v[144:147], v[140:143], v[240:243]
    s_barrier
    ds_read_b64_tr_b16 v[144:145], v97 offset:40960
    s_waitcnt lgkmcnt(5)
    v_mfma_f32_16x16x32_bf16 v[172:175], v[148:151], v[128:131], v[172:175]
    ds_read_b64_tr_b16 v[146:147], v97 offset:41984
    v_mfma_f32_16x16x32_bf16 v[196:199], v[148:151], v[132:135], v[196:199]
    ds_read_b128 v[112:115], v109 offset:40960
    v_mfma_f32_16x16x32_bf16 v[220:223], v[148:151], v[136:139], v[220:223]
    ds_read_b128 v[116:119], v109 offset:41216
    v_mfma_f32_16x16x32_bf16 v[244:247], v[148:151], v[140:143], v[244:247]
    ds_read_b64_tr_b16 v[148:149], v99 offset:40960
    s_waitcnt lgkmcnt(7)
    v_mfma_f32_16x16x32_bf16 v[176:179], v[152:155], v[128:131], v[176:179]
    ds_read_b64_tr_b16 v[150:151], v99 offset:41984
    v_mfma_f32_16x16x32_bf16 v[200:203], v[152:155], v[132:135], v[200:203]
    ds_read_b128 v[120:123], v109 offset:45056
    v_mfma_f32_16x16x32_bf16 v[224:227], v[152:155], v[136:139], v[224:227]
    ds_read_b128 v[124:127], v109 offset:45312
    v_mfma_f32_16x16x32_bf16 v[248:251], v[152:155], v[140:143], v[248:251]
    ds_read_b64_tr_b16 v[152:153], v101 offset:40960
    s_waitcnt lgkmcnt(9)
    v_mfma_f32_16x16x32_bf16 v[180:183], v[156:159], v[128:131], v[180:183]
    ds_read_b64_tr_b16 v[154:155], v101 offset:41984
    v_mfma_f32_16x16x32_bf16 v[204:207], v[156:159], v[132:135], v[204:207]
    v_mfma_f32_16x16x32_bf16 v[228:231], v[156:159], v[136:139], v[228:231]
    v_mfma_f32_16x16x32_bf16 v[252:255], v[156:159], v[140:143], v[252:255]
    ds_read_b64_tr_b16 v[156:157], v103 offset:40960
    s_waitcnt lgkmcnt(8)
    v_mfma_f32_16x16x32_bf16 v[160:163], v[144:147], v[112:115], v[160:163]
    ds_read_b64_tr_b16 v[158:159], v103 offset:41984
    s_waitcnt lgkmcnt(8)
    v_mfma_f32_16x16x32_bf16 v[184:187], v[144:147], v[116:119], v[184:187]
    s_waitcnt lgkmcnt(5)
    v_mfma_f32_16x16x32_bf16 v[208:211], v[144:147], v[120:123], v[208:211]
    s_waitcnt lgkmcnt(4)
    v_mfma_f32_16x16x32_bf16 v[232:235], v[144:147], v[124:127], v[232:235]
    ds_read_b64_tr_b16 v[144:145], v105 offset:40960
    v_mfma_f32_16x16x32_bf16 v[164:167], v[148:151], v[112:115], v[164:167]
    ds_read_b64_tr_b16 v[146:147], v105 offset:41984
    v_mfma_f32_16x16x32_bf16 v[188:191], v[148:151], v[116:119], v[188:191]
    v_mfma_f32_16x16x32_bf16 v[212:215], v[148:151], v[120:123], v[212:215]
    v_mfma_f32_16x16x32_bf16 v[236:239], v[148:151], v[124:127], v[236:239]
    ds_read_b64_tr_b16 v[148:149], v107 offset:40960
    s_waitcnt lgkmcnt(5)
    v_mfma_f32_16x16x32_bf16 v[168:171], v[152:155], v[112:115], v[168:171]
    ds_read_b64_tr_b16 v[150:151], v107 offset:41984
    v_mfma_f32_16x16x32_bf16 v[192:195], v[152:155], v[116:119], v[192:195]
    v_mfma_f32_16x16x32_bf16 v[216:219], v[152:155], v[120:123], v[216:219]
    v_mfma_f32_16x16x32_bf16 v[240:243], v[152:155], v[124:127], v[240:243]
    ds_read_b64_tr_b16 v[152:153], v97 offset:45056
    s_waitcnt lgkmcnt(5)
    v_mfma_f32_16x16x32_bf16 v[172:175], v[156:159], v[112:115], v[172:175]
    ds_read_b64_tr_b16 v[154:155], v97 offset:46080
    v_mfma_f32_16x16x32_bf16 v[196:199], v[156:159], v[116:119], v[196:199]
    ds_read_b128 v[128:131], v109 offset:43008
    v_mfma_f32_16x16x32_bf16 v[220:223], v[156:159], v[120:123], v[220:223]
    ds_read_b128 v[132:135], v109 offset:43264
    v_mfma_f32_16x16x32_bf16 v[244:247], v[156:159], v[124:127], v[244:247]
    ds_read_b64_tr_b16 v[156:157], v99 offset:45056
    s_waitcnt lgkmcnt(7)
    v_mfma_f32_16x16x32_bf16 v[176:179], v[144:147], v[112:115], v[176:179]
    ds_read_b64_tr_b16 v[158:159], v99 offset:46080
    v_mfma_f32_16x16x32_bf16 v[200:203], v[144:147], v[116:119], v[200:203]
    ds_read_b128 v[136:139], v109 offset:47104
    v_mfma_f32_16x16x32_bf16 v[224:227], v[144:147], v[120:123], v[224:227]
    ds_read_b128 v[140:143], v109 offset:47360
    v_mfma_f32_16x16x32_bf16 v[248:251], v[144:147], v[124:127], v[248:251]
    ds_read_b64_tr_b16 v[144:145], v101 offset:45056
    s_waitcnt lgkmcnt(9)
    v_mfma_f32_16x16x32_bf16 v[180:183], v[148:151], v[112:115], v[180:183]
    ds_read_b64_tr_b16 v[146:147], v101 offset:46080
    v_mfma_f32_16x16x32_bf16 v[204:207], v[148:151], v[116:119], v[204:207]
    v_mfma_f32_16x16x32_bf16 v[228:231], v[148:151], v[120:123], v[228:231]
    v_mfma_f32_16x16x32_bf16 v[252:255], v[148:151], v[124:127], v[252:255]
    ds_read_b64_tr_b16 v[148:149], v103 offset:45056
    s_waitcnt lgkmcnt(8)
    v_mfma_f32_16x16x32_bf16 v[160:163], v[152:155], v[128:131], v[160:163]
    ds_read_b64_tr_b16 v[150:151], v103 offset:46080
    s_waitcnt lgkmcnt(8)
    v_mfma_f32_16x16x32_bf16 v[184:187], v[152:155], v[132:135], v[184:187]
    s_waitcnt lgkmcnt(5)
    v_mfma_f32_16x16x32_bf16 v[208:211], v[152:155], v[136:139], v[208:211]
    s_waitcnt lgkmcnt(4)
    v_mfma_f32_16x16x32_bf16 v[232:235], v[152:155], v[140:143], v[232:235]
    ds_read_b64_tr_b16 v[152:153], v105 offset:45056
    v_mfma_f32_16x16x32_bf16 v[164:167], v[156:159], v[128:131], v[164:167]
    ds_read_b64_tr_b16 v[154:155], v105 offset:46080
    v_mfma_f32_16x16x32_bf16 v[188:191], v[156:159], v[132:135], v[188:191]
    v_mfma_f32_16x16x32_bf16 v[212:215], v[156:159], v[136:139], v[212:215]
    v_mfma_f32_16x16x32_bf16 v[236:239], v[156:159], v[140:143], v[236:239]
    ds_read_b64_tr_b16 v[156:157], v107 offset:45056
    s_waitcnt lgkmcnt(5)
    v_mfma_f32_16x16x32_bf16 v[168:171], v[144:147], v[128:131], v[168:171]
    ds_read_b64_tr_b16 v[158:159], v107 offset:46080
    v_mfma_f32_16x16x32_bf16 v[192:195], v[144:147], v[132:135], v[192:195]
    v_mfma_f32_16x16x32_bf16 v[216:219], v[144:147], v[136:139], v[216:219]
    v_mfma_f32_16x16x32_bf16 v[240:243], v[144:147], v[140:143], v[240:243]
    s_barrier
    ds_read_b64_tr_b16 v[144:145], v96 offset:0
    s_waitcnt lgkmcnt(5)
    v_mfma_f32_16x16x32_bf16 v[172:175], v[148:151], v[128:131], v[172:175]
    ds_read_b64_tr_b16 v[146:147], v96 offset:1024
    v_mfma_f32_16x16x32_bf16 v[196:199], v[148:151], v[132:135], v[196:199]
    ds_read_b128 v[112:115], v108 offset:0
    v_mfma_f32_16x16x32_bf16 v[220:223], v[148:151], v[136:139], v[220:223]
    ds_read_b128 v[116:119], v108 offset:256
    v_mfma_f32_16x16x32_bf16 v[244:247], v[148:151], v[140:143], v[244:247]
    ds_read_b64_tr_b16 v[148:149], v98 offset:0
    s_waitcnt lgkmcnt(7)
    v_mfma_f32_16x16x32_bf16 v[176:179], v[152:155], v[128:131], v[176:179]
    ds_read_b64_tr_b16 v[150:151], v98 offset:1024
    v_mfma_f32_16x16x32_bf16 v[200:203], v[152:155], v[132:135], v[200:203]
    ds_read_b128 v[120:123], v108 offset:4096
    v_mfma_f32_16x16x32_bf16 v[224:227], v[152:155], v[136:139], v[224:227]
    ds_read_b128 v[124:127], v108 offset:4352
    v_mfma_f32_16x16x32_bf16 v[248:251], v[152:155], v[140:143], v[248:251]
    ds_read_b64_tr_b16 v[152:153], v100 offset:0
    s_waitcnt lgkmcnt(9)
    v_mfma_f32_16x16x32_bf16 v[180:183], v[156:159], v[128:131], v[180:183]
    s_waitcnt vmcnt(1)
    buffer_store_dwordx2 v[2:3], v8, s[24:27], s52 offen offset:240 sc1
    ds_read_b64_tr_b16 v[154:155], v100 offset:1024
    v_mfma_f32_16x16x32_bf16 v[204:207], v[156:159], v[132:135], v[204:207]
    v_mfma_f32_16x16x32_bf16 v[228:231], v[156:159], v[136:139], v[228:231]
    v_mfma_f32_16x16x32_bf16 v[252:255], v[156:159], v[140:143], v[252:255]
    ds_read_b64_tr_b16 v[156:157], v102 offset:0
    s_waitcnt lgkmcnt(8)
    v_mfma_f32_16x16x32_bf16 v[160:163], v[144:147], v[112:115], v[160:163]
    ds_read_b64_tr_b16 v[158:159], v102 offset:1024
    s_waitcnt lgkmcnt(8)
    v_mfma_f32_16x16x32_bf16 v[184:187], v[144:147], v[116:119], v[184:187]
    s_waitcnt lgkmcnt(5)
    v_mfma_f32_16x16x32_bf16 v[208:211], v[144:147], v[120:123], v[208:211]
    s_waitcnt lgkmcnt(4)
    v_mfma_f32_16x16x32_bf16 v[232:235], v[144:147], v[124:127], v[232:235]
    ds_read_b64_tr_b16 v[144:145], v104 offset:0
    v_mfma_f32_16x16x32_bf16 v[164:167], v[148:151], v[112:115], v[164:167]
    ds_read_b64_tr_b16 v[146:147], v104 offset:1024
    v_mfma_f32_16x16x32_bf16 v[188:191], v[148:151], v[116:119], v[188:191]
    v_mfma_f32_16x16x32_bf16 v[212:215], v[148:151], v[120:123], v[212:215]
    v_mfma_f32_16x16x32_bf16 v[236:239], v[148:151], v[124:127], v[236:239]
    ds_read_b64_tr_b16 v[148:149], v106 offset:0
    s_waitcnt lgkmcnt(5)
    v_mfma_f32_16x16x32_bf16 v[168:171], v[152:155], v[112:115], v[168:171]
    ds_read_b64_tr_b16 v[150:151], v106 offset:1024
    v_mfma_f32_16x16x32_bf16 v[192:195], v[152:155], v[116:119], v[192:195]
    v_mfma_f32_16x16x32_bf16 v[216:219], v[152:155], v[120:123], v[216:219]
    v_mfma_f32_16x16x32_bf16 v[240:243], v[152:155], v[124:127], v[240:243]
    ds_read_b64_tr_b16 v[152:153], v96 offset:4096
    s_waitcnt lgkmcnt(5)
    v_mfma_f32_16x16x32_bf16 v[172:175], v[156:159], v[112:115], v[172:175]
    ds_read_b64_tr_b16 v[154:155], v96 offset:5120
    v_mfma_f32_16x16x32_bf16 v[196:199], v[156:159], v[116:119], v[196:199]
    ds_read_b128 v[128:131], v108 offset:2048
    v_mfma_f32_16x16x32_bf16 v[220:223], v[156:159], v[120:123], v[220:223]
    ds_read_b128 v[132:135], v108 offset:2304
    v_mfma_f32_16x16x32_bf16 v[244:247], v[156:159], v[124:127], v[244:247]
    ds_read_b64_tr_b16 v[156:157], v98 offset:4096
    s_waitcnt lgkmcnt(7)
    v_mfma_f32_16x16x32_bf16 v[176:179], v[144:147], v[112:115], v[176:179]
    ds_read_b64_tr_b16 v[158:159], v98 offset:5120
    v_mfma_f32_16x16x32_bf16 v[200:203], v[144:147], v[116:119], v[200:203]
    ds_read_b128 v[136:139], v108 offset:6144
    v_mfma_f32_16x16x32_bf16 v[224:227], v[144:147], v[120:123], v[224:227]
    ds_read_b128 v[140:143], v108 offset:6400
    v_mfma_f32_16x16x32_bf16 v[248:251], v[144:147], v[124:127], v[248:251]
    ds_read_b64_tr_b16 v[144:145], v100 offset:4096
    s_waitcnt lgkmcnt(9)
    v_mfma_f32_16x16x32_bf16 v[180:183], v[148:151], v[112:115], v[180:183]
    ds_read_b64_tr_b16 v[146:147], v100 offset:5120
    v_mfma_f32_16x16x32_bf16 v[204:207], v[148:151], v[116:119], v[204:207]
    v_mfma_f32_16x16x32_bf16 v[228:231], v[148:151], v[120:123], v[228:231]
    v_mfma_f32_16x16x32_bf16 v[252:255], v[148:151], v[124:127], v[252:255]
    ds_read_b64_tr_b16 v[148:149], v102 offset:4096
    s_waitcnt lgkmcnt(8)
    v_mfma_f32_16x16x32_bf16 v[160:163], v[152:155], v[128:131], v[160:163]
    ds_read_b64_tr_b16 v[150:151], v102 offset:5120
    s_waitcnt lgkmcnt(8)
    v_mfma_f32_16x16x32_bf16 v[184:187], v[152:155], v[132:135], v[184:187]
    s_waitcnt lgkmcnt(5)
    v_mfma_f32_16x16x32_bf16 v[208:211], v[152:155], v[136:139], v[208:211]
    s_waitcnt lgkmcnt(4)
    v_mfma_f32_16x16x32_bf16 v[232:235], v[152:155], v[140:143], v[232:235]
    ds_read_b64_tr_b16 v[152:153], v104 offset:4096
    v_mfma_f32_16x16x32_bf16 v[164:167], v[156:159], v[128:131], v[164:167]
    ds_read_b64_tr_b16 v[154:155], v104 offset:5120
    v_mfma_f32_16x16x32_bf16 v[188:191], v[156:159], v[132:135], v[188:191]
    v_mfma_f32_16x16x32_bf16 v[212:215], v[156:159], v[136:139], v[212:215]
    v_mfma_f32_16x16x32_bf16 v[236:239], v[156:159], v[140:143], v[236:239]
    ds_read_b64_tr_b16 v[156:157], v106 offset:4096
    s_waitcnt lgkmcnt(5)
    v_mfma_f32_16x16x32_bf16 v[168:171], v[144:147], v[128:131], v[168:171]
    ds_read_b64_tr_b16 v[158:159], v106 offset:5120
    v_mfma_f32_16x16x32_bf16 v[192:195], v[144:147], v[132:135], v[192:195]
    v_mfma_f32_16x16x32_bf16 v[216:219], v[144:147], v[136:139], v[216:219]
    v_mfma_f32_16x16x32_bf16 v[240:243], v[144:147], v[140:143], v[240:243]
    s_barrier
    ds_read_b64_tr_b16 v[144:145], v96 offset:40960
    s_waitcnt lgkmcnt(5)
    v_mfma_f32_16x16x32_bf16 v[172:175], v[148:151], v[128:131], v[172:175]
    ds_read_b64_tr_b16 v[146:147], v96 offset:41984
    v_mfma_f32_16x16x32_bf16 v[196:199], v[148:151], v[132:135], v[196:199]
    ds_read_b128 v[112:115], v108 offset:40960
    v_mfma_f32_16x16x32_bf16 v[220:223], v[148:151], v[136:139], v[220:223]
    ds_read_b128 v[116:119], v108 offset:41216
    v_mfma_f32_16x16x32_bf16 v[244:247], v[148:151], v[140:143], v[244:247]
    ds_read_b64_tr_b16 v[148:149], v98 offset:40960
    s_waitcnt lgkmcnt(7)
    v_mfma_f32_16x16x32_bf16 v[176:179], v[152:155], v[128:131], v[176:179]
    ds_read_b64_tr_b16 v[150:151], v98 offset:41984
    v_mfma_f32_16x16x32_bf16 v[200:203], v[152:155], v[132:135], v[200:203]
    ds_read_b128 v[120:123], v108 offset:45056
    v_mfma_f32_16x16x32_bf16 v[224:227], v[152:155], v[136:139], v[224:227]
    ds_read_b128 v[124:127], v108 offset:45312
    v_mfma_f32_16x16x32_bf16 v[248:251], v[152:155], v[140:143], v[248:251]
    ds_read_b64_tr_b16 v[152:153], v100 offset:40960
    s_waitcnt lgkmcnt(9)
    v_mfma_f32_16x16x32_bf16 v[180:183], v[156:159], v[128:131], v[180:183]
    ds_read_b64_tr_b16 v[154:155], v100 offset:41984
    v_mfma_f32_16x16x32_bf16 v[204:207], v[156:159], v[132:135], v[204:207]
    v_mfma_f32_16x16x32_bf16 v[228:231], v[156:159], v[136:139], v[228:231]
    v_mfma_f32_16x16x32_bf16 v[252:255], v[156:159], v[140:143], v[252:255]
    ds_read_b64_tr_b16 v[156:157], v102 offset:40960
    s_waitcnt lgkmcnt(8)
    v_mfma_f32_16x16x32_bf16 v[160:163], v[144:147], v[112:115], v[160:163]
    ds_read_b64_tr_b16 v[158:159], v102 offset:41984
    s_waitcnt lgkmcnt(8)
    v_mfma_f32_16x16x32_bf16 v[184:187], v[144:147], v[116:119], v[184:187]
    s_waitcnt lgkmcnt(5)
    v_mfma_f32_16x16x32_bf16 v[208:211], v[144:147], v[120:123], v[208:211]
    s_waitcnt lgkmcnt(4)
    v_mfma_f32_16x16x32_bf16 v[232:235], v[144:147], v[124:127], v[232:235]
    ds_read_b64_tr_b16 v[144:145], v104 offset:40960
    v_mfma_f32_16x16x32_bf16 v[164:167], v[148:151], v[112:115], v[164:167]
    ds_read_b64_tr_b16 v[146:147], v104 offset:41984
    v_mfma_f32_16x16x32_bf16 v[188:191], v[148:151], v[116:119], v[188:191]
    v_mfma_f32_16x16x32_bf16 v[212:215], v[148:151], v[120:123], v[212:215]
    v_mfma_f32_16x16x32_bf16 v[236:239], v[148:151], v[124:127], v[236:239]
    ds_read_b64_tr_b16 v[148:149], v106 offset:40960
    s_waitcnt lgkmcnt(5)
    v_mfma_f32_16x16x32_bf16 v[168:171], v[152:155], v[112:115], v[168:171]
    ds_read_b64_tr_b16 v[150:151], v106 offset:41984
    v_mfma_f32_16x16x32_bf16 v[192:195], v[152:155], v[116:119], v[192:195]
    v_mfma_f32_16x16x32_bf16 v[216:219], v[152:155], v[120:123], v[216:219]
    v_mfma_f32_16x16x32_bf16 v[240:243], v[152:155], v[124:127], v[240:243]
    ds_read_b64_tr_b16 v[152:153], v96 offset:45056
    s_waitcnt lgkmcnt(5)
    v_mfma_f32_16x16x32_bf16 v[172:175], v[156:159], v[112:115], v[172:175]
    ds_read_b64_tr_b16 v[154:155], v96 offset:46080
    v_mfma_f32_16x16x32_bf16 v[196:199], v[156:159], v[116:119], v[196:199]
    ds_read_b128 v[128:131], v108 offset:43008
    v_mfma_f32_16x16x32_bf16 v[220:223], v[156:159], v[120:123], v[220:223]
    ds_read_b128 v[132:135], v108 offset:43264
    v_mfma_f32_16x16x32_bf16 v[244:247], v[156:159], v[124:127], v[244:247]
    ds_read_b64_tr_b16 v[156:157], v98 offset:45056
    s_waitcnt lgkmcnt(7)
    v_mfma_f32_16x16x32_bf16 v[176:179], v[144:147], v[112:115], v[176:179]
    ds_read_b64_tr_b16 v[158:159], v98 offset:46080
    v_mfma_f32_16x16x32_bf16 v[200:203], v[144:147], v[116:119], v[200:203]
    ds_read_b128 v[136:139], v108 offset:47104
    v_mfma_f32_16x16x32_bf16 v[224:227], v[144:147], v[120:123], v[224:227]
    ds_read_b128 v[140:143], v108 offset:47360
    v_mfma_f32_16x16x32_bf16 v[248:251], v[144:147], v[124:127], v[248:251]
    ds_read_b64_tr_b16 v[144:145], v100 offset:45056
    s_waitcnt lgkmcnt(9)
    v_mfma_f32_16x16x32_bf16 v[180:183], v[148:151], v[112:115], v[180:183]
    ds_read_b64_tr_b16 v[146:147], v100 offset:46080
    v_mfma_f32_16x16x32_bf16 v[204:207], v[148:151], v[116:119], v[204:207]
    v_mfma_f32_16x16x32_bf16 v[228:231], v[148:151], v[120:123], v[228:231]
    v_mfma_f32_16x16x32_bf16 v[252:255], v[148:151], v[124:127], v[252:255]
    ds_read_b64_tr_b16 v[148:149], v102 offset:45056
    s_waitcnt lgkmcnt(8)
    v_mfma_f32_16x16x32_bf16 v[160:163], v[152:155], v[128:131], v[160:163]
    ds_read_b64_tr_b16 v[150:151], v102 offset:46080
    s_waitcnt lgkmcnt(8)
    v_mfma_f32_16x16x32_bf16 v[184:187], v[152:155], v[132:135], v[184:187]
    s_waitcnt lgkmcnt(5)
    v_mfma_f32_16x16x32_bf16 v[208:211], v[152:155], v[136:139], v[208:211]
    s_waitcnt lgkmcnt(4)
    v_mfma_f32_16x16x32_bf16 v[232:235], v[152:155], v[140:143], v[232:235]
    ds_read_b64_tr_b16 v[152:153], v104 offset:45056
    v_mfma_f32_16x16x32_bf16 v[164:167], v[156:159], v[128:131], v[164:167]
    ds_read_b64_tr_b16 v[154:155], v104 offset:46080
    v_mfma_f32_16x16x32_bf16 v[188:191], v[156:159], v[132:135], v[188:191]
    v_mfma_f32_16x16x32_bf16 v[212:215], v[156:159], v[136:139], v[212:215]
    v_mfma_f32_16x16x32_bf16 v[236:239], v[156:159], v[140:143], v[236:239]
    ds_read_b64_tr_b16 v[156:157], v106 offset:45056
    s_waitcnt lgkmcnt(5)
    v_mfma_f32_16x16x32_bf16 v[168:171], v[144:147], v[128:131], v[168:171]
    ds_read_b64_tr_b16 v[158:159], v106 offset:46080
    v_mfma_f32_16x16x32_bf16 v[192:195], v[144:147], v[132:135], v[192:195]
    v_mfma_f32_16x16x32_bf16 v[216:219], v[144:147], v[136:139], v[216:219]
    v_mfma_f32_16x16x32_bf16 v[240:243], v[144:147], v[140:143], v[240:243]
    s_barrier
    ds_read_b64_tr_b16 v[144:145], v97 offset:0
    s_waitcnt lgkmcnt(5)
    v_mfma_f32_16x16x32_bf16 v[172:175], v[148:151], v[128:131], v[172:175]
    ds_read_b64_tr_b16 v[146:147], v97 offset:1024
    v_mfma_f32_16x16x32_bf16 v[196:199], v[148:151], v[132:135], v[196:199]
    ds_read_b128 v[112:115], v109 offset:0
    v_mfma_f32_16x16x32_bf16 v[220:223], v[148:151], v[136:139], v[220:223]
    ds_read_b128 v[116:119], v109 offset:256
    v_mfma_f32_16x16x32_bf16 v[244:247], v[148:151], v[140:143], v[244:247]
    ds_read_b64_tr_b16 v[148:149], v99 offset:0
    s_waitcnt lgkmcnt(7)
    v_mfma_f32_16x16x32_bf16 v[176:179], v[152:155], v[128:131], v[176:179]
    ds_read_b64_tr_b16 v[150:151], v99 offset:1024
    v_mfma_f32_16x16x32_bf16 v[200:203], v[152:155], v[132:135], v[200:203]
    ds_read_b128 v[120:123], v109 offset:4096
    v_mfma_f32_16x16x32_bf16 v[224:227], v[152:155], v[136:139], v[224:227]
    ds_read_b128 v[124:127], v109 offset:4352
    v_mfma_f32_16x16x32_bf16 v[248:251], v[152:155], v[140:143], v[248:251]
    ds_read_b64_tr_b16 v[152:153], v101 offset:0
    s_waitcnt lgkmcnt(9)
    v_mfma_f32_16x16x32_bf16 v[180:183], v[156:159], v[128:131], v[180:183]
    ds_read_b64_tr_b16 v[154:155], v101 offset:1024
    v_mfma_f32_16x16x32_bf16 v[204:207], v[156:159], v[132:135], v[204:207]
    v_mfma_f32_16x16x32_bf16 v[228:231], v[156:159], v[136:139], v[228:231]
    v_mfma_f32_16x16x32_bf16 v[252:255], v[156:159], v[140:143], v[252:255]
    ds_read_b64_tr_b16 v[156:157], v103 offset:0
    s_waitcnt lgkmcnt(8)
    v_mfma_f32_16x16x32_bf16 v[160:163], v[144:147], v[112:115], v[160:163]
    ds_read_b64_tr_b16 v[158:159], v103 offset:1024
    s_waitcnt lgkmcnt(8)
    v_mfma_f32_16x16x32_bf16 v[184:187], v[144:147], v[116:119], v[184:187]
    s_waitcnt lgkmcnt(5)
    v_mfma_f32_16x16x32_bf16 v[208:211], v[144:147], v[120:123], v[208:211]
    s_waitcnt lgkmcnt(4)
    v_mfma_f32_16x16x32_bf16 v[232:235], v[144:147], v[124:127], v[232:235]
    ds_read_b64_tr_b16 v[144:145], v105 offset:0
    v_mfma_f32_16x16x32_bf16 v[164:167], v[148:151], v[112:115], v[164:167]
    ds_read_b64_tr_b16 v[146:147], v105 offset:1024
    v_mfma_f32_16x16x32_bf16 v[188:191], v[148:151], v[116:119], v[188:191]
    v_mfma_f32_16x16x32_bf16 v[212:215], v[148:151], v[120:123], v[212:215]
    v_mfma_f32_16x16x32_bf16 v[236:239], v[148:151], v[124:127], v[236:239]
    ds_read_b64_tr_b16 v[148:149], v107 offset:0
    s_waitcnt lgkmcnt(5)
    v_mfma_f32_16x16x32_bf16 v[168:171], v[152:155], v[112:115], v[168:171]
    ds_read_b64_tr_b16 v[150:151], v107 offset:1024
    v_mfma_f32_16x16x32_bf16 v[192:195], v[152:155], v[116:119], v[192:195]
    v_mfma_f32_16x16x32_bf16 v[216:219], v[152:155], v[120:123], v[216:219]
    v_mfma_f32_16x16x32_bf16 v[240:243], v[152:155], v[124:127], v[240:243]
    ds_read_b64_tr_b16 v[152:153], v97 offset:4096
    s_waitcnt lgkmcnt(5)
    v_mfma_f32_16x16x32_bf16 v[172:175], v[156:159], v[112:115], v[172:175]
    ds_read_b64_tr_b16 v[154:155], v97 offset:5120
    v_mfma_f32_16x16x32_bf16 v[196:199], v[156:159], v[116:119], v[196:199]
    ds_read_b128 v[128:131], v109 offset:2048
    v_mfma_f32_16x16x32_bf16 v[220:223], v[156:159], v[120:123], v[220:223]
    ds_read_b128 v[132:135], v109 offset:2304
    v_mfma_f32_16x16x32_bf16 v[244:247], v[156:159], v[124:127], v[244:247]
    ds_read_b64_tr_b16 v[156:157], v99 offset:4096
    s_waitcnt lgkmcnt(7)
    v_mfma_f32_16x16x32_bf16 v[176:179], v[144:147], v[112:115], v[176:179]
    ds_read_b64_tr_b16 v[158:159], v99 offset:5120
    v_mfma_f32_16x16x32_bf16 v[200:203], v[144:147], v[116:119], v[200:203]
    ds_read_b128 v[136:139], v109 offset:6144
    v_mfma_f32_16x16x32_bf16 v[224:227], v[144:147], v[120:123], v[224:227]
    ds_read_b128 v[140:143], v109 offset:6400
    v_mfma_f32_16x16x32_bf16 v[248:251], v[144:147], v[124:127], v[248:251]
    ds_read_b64_tr_b16 v[144:145], v101 offset:4096
    s_waitcnt lgkmcnt(9)
    v_mfma_f32_16x16x32_bf16 v[180:183], v[148:151], v[112:115], v[180:183]
    s_mul_i32 s44, s29, 3
    s_add_u32 s44, s44, s30
    s_lshl_b32 s45, s44, 18
    s_lshl_b32 s42, s28, 12
    s_add_u32 s45, s45, s42
    s_add_u32 s45, s45, 52428800
    s_lshl_b32 s42, s55, 16
    s_add_u32 s46, s45, s42
    s_lshl_b32 s42, s55, 14
    s_add_u32 s45, s45, s42
    s_lshl_b32 s48, s29, 2
    s_and_b32 s42, s28, 2
    s_add_u32 s48, s48, s42
    s_lshr_b32 s42, s55, 1
    s_add_u32 s48, s48, s42
    s_mul_i32 s48, s48, 1152
    s_mul_i32 s42, s30, 384
    s_add_u32 s48, s48, s42
    s_and_b32 s42, s28, 1
    s_mul_i32 s42, s42, 192
    s_add_u32 s48, s48, s42
    s_and_b32 s42, s55, 1
    s_mul_i32 s42, s42, 1179648
    s_add_u32 s48, s48, s42
    s_mov_b32 s20, s98
    s_mov_b32 s21, s99
    s_mov_b32 s22, 0x240000
    s_mov_b32 s23, 0x20000
    ds_read_b64_tr_b16 v[146:147], v101 offset:5120
    v_mfma_f32_16x16x32_bf16 v[204:207], v[148:151], v[116:119], v[204:207]
    v_mfma_f32_16x16x32_bf16 v[228:231], v[148:151], v[120:123], v[228:231]
    v_mfma_f32_16x16x32_bf16 v[252:255], v[148:151], v[124:127], v[252:255]
    ds_read_b64_tr_b16 v[148:149], v103 offset:4096
    s_waitcnt lgkmcnt(8)
    v_mfma_f32_16x16x32_bf16 v[160:163], v[152:155], v[128:131], v[160:163]
    v_lshlrev_b32 v5, 13, v3
    ds_read_b64_tr_b16 v[150:151], v103 offset:5120
    s_waitcnt lgkmcnt(8)
    v_mfma_f32_16x16x32_bf16 v[184:187], v[152:155], v[132:135], v[184:187]
    s_waitcnt lgkmcnt(5)
    v_mfma_f32_16x16x32_bf16 v[208:211], v[152:155], v[136:139], v[208:211]
    v_xor_b32 v51, v5, v2
    s_waitcnt lgkmcnt(4)
    v_mfma_f32_16x16x32_bf16 v[232:235], v[152:155], v[140:143], v[232:235]
    ds_read_b64_tr_b16 v[152:153], v105 offset:4096
    v_mfma_f32_16x16x32_bf16 v[164:167], v[156:159], v[128:131], v[164:167]
    v_mov_b32 v55, v51
    ds_read_b64_tr_b16 v[154:155], v105 offset:5120
    v_mfma_f32_16x16x32_bf16 v[188:191], v[156:159], v[132:135], v[188:191]
    v_mfma_f32_16x16x32_bf16 v[212:215], v[156:159], v[136:139], v[212:215]
    v_mov_b32 v59, v51
    v_mfma_f32_16x16x32_bf16 v[236:239], v[156:159], v[140:143], v[236:239]
    ds_read_b64_tr_b16 v[156:157], v107 offset:4096
    s_waitcnt lgkmcnt(5)
    v_mfma_f32_16x16x32_bf16 v[168:171], v[144:147], v[128:131], v[168:171]
    v_mov_b32 v63, v51
    ds_read_b64_tr_b16 v[158:159], v107 offset:5120
    v_mfma_f32_16x16x32_bf16 v[192:195], v[144:147], v[132:135], v[192:195]
    v_mfma_f32_16x16x32_bf16 v[216:219], v[144:147], v[136:139], v[216:219]
    v_mov_b32 v67, v51
    v_mfma_f32_16x16x32_bf16 v[240:243], v[144:147], v[140:143], v[240:243]
    s_barrier
    ds_read_b64_tr_b16 v[144:145], v97 offset:40960
    s_waitcnt lgkmcnt(5)
    v_mfma_f32_16x16x32_bf16 v[172:175], v[148:151], v[128:131], v[172:175]
    v_mov_b32 v71, v51
    ds_read_b64_tr_b16 v[146:147], v97 offset:41984
    v_mfma_f32_16x16x32_bf16 v[196:199], v[148:151], v[132:135], v[196:199]
    ds_read_b128 v[112:115], v109 offset:40960
    v_mfma_f32_16x16x32_bf16 v[220:223], v[148:151], v[136:139], v[220:223]
    v_mov_b32 v75, v51
    ds_read_b128 v[116:119], v109 offset:41216
    v_mfma_f32_16x16x32_bf16 v[244:247], v[148:151], v[140:143], v[244:247]
    ds_read_b64_tr_b16 v[148:149], v99 offset:40960
    s_waitcnt lgkmcnt(7)
    v_mfma_f32_16x16x32_bf16 v[176:179], v[152:155], v[128:131], v[176:179]
    v_mov_b32 v79, v51
    ds_read_b64_tr_b16 v[150:151], v99 offset:41984
    v_mfma_f32_16x16x32_bf16 v[200:203], v[152:155], v[132:135], v[200:203]
    ds_read_b128 v[120:123], v109 offset:45056
    v_mfma_f32_16x16x32_bf16 v[224:227], v[152:155], v[136:139], v[224:227]
    v_mov_b32 v83, v51
    ds_read_b128 v[124:127], v109 offset:45312
    v_mfma_f32_16x16x32_bf16 v[248:251], v[152:155], v[140:143], v[248:251]
    ds_read_b64_tr_b16 v[152:153], v101 offset:40960
    s_waitcnt lgkmcnt(9)
    v_mfma_f32_16x16x32_bf16 v[180:183], v[156:159], v[128:131], v[180:183]
    v_mov_b32 v87, v51
    ds_read_b64_tr_b16 v[154:155], v101 offset:41984
    v_mfma_f32_16x16x32_bf16 v[204:207], v[156:159], v[132:135], v[204:207]
    v_mfma_f32_16x16x32_bf16 v[228:231], v[156:159], v[136:139], v[228:231]
    v_mov_b32 v91, v51
    v_mfma_f32_16x16x32_bf16 v[252:255], v[156:159], v[140:143], v[252:255]
    ds_read_b64_tr_b16 v[156:157], v103 offset:40960
    s_waitcnt lgkmcnt(8)
    v_mfma_f32_16x16x32_bf16 v[160:163], v[144:147], v[112:115], v[160:163]
    v_mov_b32 v95, v51
    ds_read_b64_tr_b16 v[158:159], v103 offset:41984
    s_waitcnt lgkmcnt(8)
    v_mfma_f32_16x16x32_bf16 v[184:187], v[144:147], v[116:119], v[184:187]
    s_waitcnt lgkmcnt(5)
    v_mfma_f32_16x16x32_bf16 v[208:211], v[144:147], v[120:123], v[208:211]
    v_and_b32 v5, 15, v1
    s_waitcnt lgkmcnt(4)
    v_mfma_f32_16x16x32_bf16 v[232:235], v[144:147], v[124:127], v[232:235]
    ds_read_b64_tr_b16 v[144:145], v105 offset:40960
    v_mfma_f32_16x16x32_bf16 v[164:167], v[148:151], v[112:115], v[164:167]
    s_mov_b32 s42, 73728
    v_mul_lo_u32 v7, v5, s42
    ds_read_b64_tr_b16 v[146:147], v105 offset:41984
    v_mfma_f32_16x16x32_bf16 v[188:191], v[148:151], v[116:119], v[188:191]
    v_mfma_f32_16x16x32_bf16 v[212:215], v[148:151], v[120:123], v[212:215]
    v_bfe_u32 v5, v1, 4, 1
    v_mfma_f32_16x16x32_bf16 v[236:239], v[148:151], v[124:127], v[236:239]
    ds_read_b64_tr_b16 v[148:149], v107 offset:40960
    s_waitcnt lgkmcnt(5)
    v_mfma_f32_16x16x32_bf16 v[168:171], v[152:155], v[112:115], v[168:171]
    v_lshl_add_u32 v7, v5, 5, v7
    ds_read_b64_tr_b16 v[150:151], v107 offset:41984
    v_mfma_f32_16x16x32_bf16 v[192:195], v[152:155], v[116:119], v[192:195]
    v_mfma_f32_16x16x32_bf16 v[216:219], v[152:155], v[120:123], v[216:219]
    v_lshrrev_b32 v5, 5, v1
    v_mfma_f32_16x16x32_bf16 v[240:243], v[152:155], v[124:127], v[240:243]
    ds_read_b64_tr_b16 v[152:153], v97 offset:45056
    s_waitcnt lgkmcnt(5)
    v_mfma_f32_16x16x32_bf16 v[172:175], v[156:159], v[112:115], v[172:175]
    v_lshl_add_u32 v7, v5, 4, v7
    ds_read_b64_tr_b16 v[154:155], v97 offset:46080
    v_mfma_f32_16x16x32_bf16 v[196:199], v[156:159], v[116:119], v[196:199]
    ds_read_b128 v[128:131], v109 offset:43008
    v_mfma_f32_16x16x32_bf16 v[220:223], v[156:159], v[120:123], v[220:223]
    ds_read_b128 v[132:135], v109 offset:43264
    v_mfma_f32_16x16x32_bf16 v[244:247], v[156:159], v[124:127], v[244:247]
    ds_read_b64_tr_b16 v[156:157], v99 offset:45056
    s_waitcnt lgkmcnt(7)
    v_mfma_f32_16x16x32_bf16 v[176:179], v[144:147], v[112:115], v[176:179]
    ds_read_b64_tr_b16 v[158:159], v99 offset:46080
    v_mfma_f32_16x16x32_bf16 v[200:203], v[144:147], v[116:119], v[200:203]
    ds_read_b128 v[136:139], v109 offset:47104
    v_mfma_f32_16x16x32_bf16 v[224:227], v[144:147], v[120:123], v[224:227]
    ds_read_b128 v[140:143], v109 offset:47360
    v_mfma_f32_16x16x32_bf16 v[248:251], v[144:147], v[124:127], v[248:251]
    ds_read_b64_tr_b16 v[144:145], v101 offset:45056
    s_waitcnt lgkmcnt(9)
    v_mfma_f32_16x16x32_bf16 v[180:183], v[148:151], v[112:115], v[180:183]
    ds_read_b64_tr_b16 v[146:147], v101 offset:46080
    v_mfma_f32_16x16x32_bf16 v[204:207], v[148:151], v[116:119], v[204:207]
    v_mfma_f32_16x16x32_bf16 v[228:231], v[148:151], v[120:123], v[228:231]
    v_mfma_f32_16x16x32_bf16 v[252:255], v[148:151], v[124:127], v[252:255]
    ds_read_b64_tr_b16 v[148:149], v103 offset:45056
    s_waitcnt lgkmcnt(8)
    v_mfma_f32_16x16x32_bf16 v[160:163], v[152:155], v[128:131], v[160:163]
    ds_read_b64_tr_b16 v[150:151], v103 offset:46080
    s_waitcnt lgkmcnt(8)
    v_mfma_f32_16x16x32_bf16 v[184:187], v[152:155], v[132:135], v[184:187]
    s_waitcnt lgkmcnt(5)
    v_mfma_f32_16x16x32_bf16 v[208:211], v[152:155], v[136:139], v[208:211]
    s_waitcnt lgkmcnt(4)
    v_mfma_f32_16x16x32_bf16 v[232:235], v[152:155], v[140:143], v[232:235]
    ds_read_b64_tr_b16 v[152:153], v105 offset:45056
    v_mfma_f32_16x16x32_bf16 v[164:167], v[156:159], v[128:131], v[164:167]
    ds_read_b64_tr_b16 v[154:155], v105 offset:46080
    v_mfma_f32_16x16x32_bf16 v[188:191], v[156:159], v[132:135], v[188:191]
    v_mfma_f32_16x16x32_bf16 v[212:215], v[156:159], v[136:139], v[212:215]
    v_mfma_f32_16x16x32_bf16 v[236:239], v[156:159], v[140:143], v[236:239]
    ds_read_b64_tr_b16 v[156:157], v107 offset:45056
    s_waitcnt lgkmcnt(5)
    v_mfma_f32_16x16x32_bf16 v[168:171], v[144:147], v[128:131], v[168:171]
    ds_read_b64_tr_b16 v[158:159], v107 offset:46080
    v_mfma_f32_16x16x32_bf16 v[192:195], v[144:147], v[132:135], v[192:195]
    v_mfma_f32_16x16x32_bf16 v[216:219], v[144:147], v[136:139], v[216:219]
    v_mfma_f32_16x16x32_bf16 v[240:243], v[144:147], v[140:143], v[240:243]
    s_barrier
    ds_read_b64_tr_b16 v[144:145], v96 offset:0
    s_waitcnt lgkmcnt(5)
    v_mfma_f32_16x16x32_bf16 v[172:175], v[148:151], v[128:131], v[172:175]
    ds_read_b64_tr_b16 v[146:147], v96 offset:1024
    v_mfma_f32_16x16x32_bf16 v[196:199], v[148:151], v[132:135], v[196:199]
    ds_read_b128 v[112:115], v108 offset:0
    v_mfma_f32_16x16x32_bf16 v[220:223], v[148:151], v[136:139], v[220:223]
    ds_read_b128 v[116:119], v108 offset:256
    v_mfma_f32_16x16x32_bf16 v[244:247], v[148:151], v[140:143], v[244:247]
    ds_read_b64_tr_b16 v[148:149], v98 offset:0
    s_waitcnt lgkmcnt(7)
    v_mfma_f32_16x16x32_bf16 v[176:179], v[152:155], v[128:131], v[176:179]
    ds_read_b64_tr_b16 v[150:151], v98 offset:1024
    v_mfma_f32_16x16x32_bf16 v[200:203], v[152:155], v[132:135], v[200:203]
    ds_read_b128 v[120:123], v108 offset:4096
    v_mfma_f32_16x16x32_bf16 v[224:227], v[152:155], v[136:139], v[224:227]
    ds_read_b128 v[124:127], v108 offset:4352
    v_mfma_f32_16x16x32_bf16 v[248:251], v[152:155], v[140:143], v[248:251]
    ds_read_b64_tr_b16 v[152:153], v100 offset:0
    s_waitcnt lgkmcnt(9)
    v_mfma_f32_16x16x32_bf16 v[180:183], v[156:159], v[128:131], v[180:183]
    ds_read_b64_tr_b16 v[154:155], v100 offset:1024
    v_mfma_f32_16x16x32_bf16 v[204:207], v[156:159], v[132:135], v[204:207]
    v_mfma_f32_16x16x32_bf16 v[228:231], v[156:159], v[136:139], v[228:231]
    v_mfma_f32_16x16x32_bf16 v[252:255], v[156:159], v[140:143], v[252:255]
    ds_read_b64_tr_b16 v[156:157], v102 offset:0
    s_waitcnt lgkmcnt(8)
    v_mfma_f32_16x16x32_bf16 v[160:163], v[144:147], v[112:115], v[160:163]
    ds_read_b64_tr_b16 v[158:159], v102 offset:1024
    s_waitcnt lgkmcnt(8)
    v_mfma_f32_16x16x32_bf16 v[184:187], v[144:147], v[116:119], v[184:187]
    s_waitcnt lgkmcnt(5)
    v_mfma_f32_16x16x32_bf16 v[208:211], v[144:147], v[120:123], v[208:211]
    s_waitcnt lgkmcnt(4)
    v_mfma_f32_16x16x32_bf16 v[232:235], v[144:147], v[124:127], v[232:235]
    ds_read_b64_tr_b16 v[144:145], v104 offset:0
    v_mfma_f32_16x16x32_bf16 v[164:167], v[148:151], v[112:115], v[164:167]
    ds_read_b64_tr_b16 v[146:147], v104 offset:1024
    v_mfma_f32_16x16x32_bf16 v[188:191], v[148:151], v[116:119], v[188:191]
    v_mfma_f32_16x16x32_bf16 v[212:215], v[148:151], v[120:123], v[212:215]
    v_mfma_f32_16x16x32_bf16 v[236:239], v[148:151], v[124:127], v[236:239]
    ds_read_b64_tr_b16 v[148:149], v106 offset:0
    s_waitcnt lgkmcnt(5)
    v_mfma_f32_16x16x32_bf16 v[168:171], v[152:155], v[112:115], v[168:171]
    ds_read_b64_tr_b16 v[150:151], v106 offset:1024
    v_mfma_f32_16x16x32_bf16 v[192:195], v[152:155], v[116:119], v[192:195]
    v_mfma_f32_16x16x32_bf16 v[216:219], v[152:155], v[120:123], v[216:219]
    v_mfma_f32_16x16x32_bf16 v[240:243], v[152:155], v[124:127], v[240:243]
    ds_read_b64_tr_b16 v[152:153], v96 offset:4096
    s_waitcnt lgkmcnt(5)
    v_mfma_f32_16x16x32_bf16 v[172:175], v[156:159], v[112:115], v[172:175]
    ds_read_b64_tr_b16 v[154:155], v96 offset:5120
    v_mfma_f32_16x16x32_bf16 v[196:199], v[156:159], v[116:119], v[196:199]
    ds_read_b128 v[128:131], v108 offset:2048
    v_mfma_f32_16x16x32_bf16 v[220:223], v[156:159], v[120:123], v[220:223]
    ds_read_b128 v[132:135], v108 offset:2304
    v_mfma_f32_16x16x32_bf16 v[244:247], v[156:159], v[124:127], v[244:247]
    ds_read_b64_tr_b16 v[156:157], v98 offset:4096
    s_waitcnt lgkmcnt(7)
    v_mfma_f32_16x16x32_bf16 v[176:179], v[144:147], v[112:115], v[176:179]
    ds_read_b64_tr_b16 v[158:159], v98 offset:5120
    v_mfma_f32_16x16x32_bf16 v[200:203], v[144:147], v[116:119], v[200:203]
    ds_read_b128 v[136:139], v108 offset:6144
    v_mfma_f32_16x16x32_bf16 v[224:227], v[144:147], v[120:123], v[224:227]
    ds_read_b128 v[140:143], v108 offset:6400
    v_mfma_f32_16x16x32_bf16 v[248:251], v[144:147], v[124:127], v[248:251]
    ds_read_b64_tr_b16 v[144:145], v100 offset:4096
    s_waitcnt lgkmcnt(9)
    v_mfma_f32_16x16x32_bf16 v[180:183], v[148:151], v[112:115], v[180:183]
    ds_read_b64_tr_b16 v[146:147], v100 offset:5120
    v_mfma_f32_16x16x32_bf16 v[204:207], v[148:151], v[116:119], v[204:207]
    v_mfma_f32_16x16x32_bf16 v[228:231], v[148:151], v[120:123], v[228:231]
    v_mfma_f32_16x16x32_bf16 v[252:255], v[148:151], v[124:127], v[252:255]
    ds_read_b64_tr_b16 v[148:149], v102 offset:4096
    s_waitcnt lgkmcnt(8)
    v_mfma_f32_16x16x32_bf16 v[160:163], v[152:155], v[128:131], v[160:163]
    ds_read_b64_tr_b16 v[150:151], v102 offset:5120
    s_waitcnt lgkmcnt(8)
    v_mfma_f32_16x16x32_bf16 v[184:187], v[152:155], v[132:135], v[184:187]
    s_waitcnt lgkmcnt(5)
    v_mfma_f32_16x16x32_bf16 v[208:211], v[152:155], v[136:139], v[208:211]
    s_waitcnt lgkmcnt(4)
    v_mfma_f32_16x16x32_bf16 v[232:235], v[152:155], v[140:143], v[232:235]
    ds_read_b64_tr_b16 v[152:153], v104 offset:4096
    v_mfma_f32_16x16x32_bf16 v[164:167], v[156:159], v[128:131], v[164:167]
    ds_read_b64_tr_b16 v[154:155], v104 offset:5120
    v_mfma_f32_16x16x32_bf16 v[188:191], v[156:159], v[132:135], v[188:191]
    v_mfma_f32_16x16x32_bf16 v[212:215], v[156:159], v[136:139], v[212:215]
    v_mfma_f32_16x16x32_bf16 v[236:239], v[156:159], v[140:143], v[236:239]
    ds_read_b64_tr_b16 v[156:157], v106 offset:4096
    s_waitcnt lgkmcnt(5)
    v_mfma_f32_16x16x32_bf16 v[168:171], v[144:147], v[128:131], v[168:171]
    ds_read_b64_tr_b16 v[158:159], v106 offset:5120
    v_mfma_f32_16x16x32_bf16 v[192:195], v[144:147], v[132:135], v[192:195]
    v_mfma_f32_16x16x32_bf16 v[216:219], v[144:147], v[136:139], v[216:219]
    v_mfma_f32_16x16x32_bf16 v[240:243], v[144:147], v[140:143], v[240:243]
    s_barrier
    ds_read_b64_tr_b16 v[144:145], v96 offset:40960
    s_waitcnt lgkmcnt(5)
    v_mfma_f32_16x16x32_bf16 v[172:175], v[148:151], v[128:131], v[172:175]
    ds_read_b64_tr_b16 v[146:147], v96 offset:41984
    v_mfma_f32_16x16x32_bf16 v[196:199], v[148:151], v[132:135], v[196:199]
    ds_read_b128 v[112:115], v108 offset:40960
    v_mfma_f32_16x16x32_bf16 v[220:223], v[148:151], v[136:139], v[220:223]
    ds_read_b128 v[116:119], v108 offset:41216
    v_mfma_f32_16x16x32_bf16 v[244:247], v[148:151], v[140:143], v[244:247]
    ds_read_b64_tr_b16 v[148:149], v98 offset:40960
    s_waitcnt lgkmcnt(7)
    v_mfma_f32_16x16x32_bf16 v[176:179], v[152:155], v[128:131], v[176:179]
    ds_read_b64_tr_b16 v[150:151], v98 offset:41984
    v_mfma_f32_16x16x32_bf16 v[200:203], v[152:155], v[132:135], v[200:203]
    ds_read_b128 v[120:123], v108 offset:45056
    v_mfma_f32_16x16x32_bf16 v[224:227], v[152:155], v[136:139], v[224:227]
    ds_read_b128 v[124:127], v108 offset:45312
    v_mfma_f32_16x16x32_bf16 v[248:251], v[152:155], v[140:143], v[248:251]
    ds_read_b64_tr_b16 v[152:153], v100 offset:40960
    s_waitcnt lgkmcnt(9)
    v_mfma_f32_16x16x32_bf16 v[180:183], v[156:159], v[128:131], v[180:183]
    ds_read_b64_tr_b16 v[154:155], v100 offset:41984
    v_mfma_f32_16x16x32_bf16 v[204:207], v[156:159], v[132:135], v[204:207]
    v_mfma_f32_16x16x32_bf16 v[228:231], v[156:159], v[136:139], v[228:231]
    v_mfma_f32_16x16x32_bf16 v[252:255], v[156:159], v[140:143], v[252:255]
    ds_read_b64_tr_b16 v[156:157], v102 offset:40960
    s_waitcnt lgkmcnt(8)
    v_mfma_f32_16x16x32_bf16 v[160:163], v[144:147], v[112:115], v[160:163]
    ds_read_b64_tr_b16 v[158:159], v102 offset:41984
    s_waitcnt lgkmcnt(8)
    v_mfma_f32_16x16x32_bf16 v[184:187], v[144:147], v[116:119], v[184:187]
    s_waitcnt lgkmcnt(5)
    v_mfma_f32_16x16x32_bf16 v[208:211], v[144:147], v[120:123], v[208:211]
    s_waitcnt lgkmcnt(4)
    v_mfma_f32_16x16x32_bf16 v[232:235], v[144:147], v[124:127], v[232:235]
    ds_read_b64_tr_b16 v[144:145], v104 offset:40960
    v_mfma_f32_16x16x32_bf16 v[164:167], v[148:151], v[112:115], v[164:167]
    ds_read_b64_tr_b16 v[146:147], v104 offset:41984
    v_mfma_f32_16x16x32_bf16 v[188:191], v[148:151], v[116:119], v[188:191]
    v_mfma_f32_16x16x32_bf16 v[212:215], v[148:151], v[120:123], v[212:215]
    v_mfma_f32_16x16x32_bf16 v[236:239], v[148:151], v[124:127], v[236:239]
    ds_read_b64_tr_b16 v[148:149], v106 offset:40960
    s_waitcnt lgkmcnt(5)
    v_mfma_f32_16x16x32_bf16 v[168:171], v[152:155], v[112:115], v[168:171]
    ds_read_b64_tr_b16 v[150:151], v106 offset:41984
    v_mfma_f32_16x16x32_bf16 v[192:195], v[152:155], v[116:119], v[192:195]
    v_mfma_f32_16x16x32_bf16 v[216:219], v[152:155], v[120:123], v[216:219]
    v_mfma_f32_16x16x32_bf16 v[240:243], v[152:155], v[124:127], v[240:243]
    ds_read_b64_tr_b16 v[152:153], v96 offset:45056
    s_waitcnt lgkmcnt(5)
    v_mfma_f32_16x16x32_bf16 v[172:175], v[156:159], v[112:115], v[172:175]
    ds_read_b64_tr_b16 v[154:155], v96 offset:46080
    v_mfma_f32_16x16x32_bf16 v[196:199], v[156:159], v[116:119], v[196:199]
    ds_read_b128 v[128:131], v108 offset:43008
    v_mfma_f32_16x16x32_bf16 v[220:223], v[156:159], v[120:123], v[220:223]
    ds_read_b128 v[132:135], v108 offset:43264
    v_mfma_f32_16x16x32_bf16 v[244:247], v[156:159], v[124:127], v[244:247]
    ds_read_b64_tr_b16 v[156:157], v98 offset:45056
    s_waitcnt lgkmcnt(7)
    v_mfma_f32_16x16x32_bf16 v[176:179], v[144:147], v[112:115], v[176:179]
    ds_read_b64_tr_b16 v[158:159], v98 offset:46080
    v_mfma_f32_16x16x32_bf16 v[200:203], v[144:147], v[116:119], v[200:203]
    ds_read_b128 v[136:139], v108 offset:47104
    v_mfma_f32_16x16x32_bf16 v[224:227], v[144:147], v[120:123], v[224:227]
    ds_read_b128 v[140:143], v108 offset:47360
    v_mfma_f32_16x16x32_bf16 v[248:251], v[144:147], v[124:127], v[248:251]
    ds_read_b64_tr_b16 v[144:145], v100 offset:45056
    s_waitcnt lgkmcnt(9)
    v_mfma_f32_16x16x32_bf16 v[180:183], v[148:151], v[112:115], v[180:183]
    ds_read_b64_tr_b16 v[146:147], v100 offset:46080
    v_mfma_f32_16x16x32_bf16 v[204:207], v[148:151], v[116:119], v[204:207]
    v_mfma_f32_16x16x32_bf16 v[228:231], v[148:151], v[120:123], v[228:231]
    v_mfma_f32_16x16x32_bf16 v[252:255], v[148:151], v[124:127], v[252:255]
    ds_read_b64_tr_b16 v[148:149], v102 offset:45056
    s_waitcnt lgkmcnt(8)
    v_mfma_f32_16x16x32_bf16 v[160:163], v[152:155], v[128:131], v[160:163]
    ds_read_b64_tr_b16 v[150:151], v102 offset:46080
    s_waitcnt lgkmcnt(8)
    v_mfma_f32_16x16x32_bf16 v[184:187], v[152:155], v[132:135], v[184:187]
    s_waitcnt lgkmcnt(5)
    v_mfma_f32_16x16x32_bf16 v[208:211], v[152:155], v[136:139], v[208:211]
    s_waitcnt lgkmcnt(4)
    v_mfma_f32_16x16x32_bf16 v[232:235], v[152:155], v[140:143], v[232:235]
    ds_read_b64_tr_b16 v[152:153], v104 offset:45056
    v_mfma_f32_16x16x32_bf16 v[164:167], v[156:159], v[128:131], v[164:167]
    ds_read_b64_tr_b16 v[154:155], v104 offset:46080
    v_mfma_f32_16x16x32_bf16 v[188:191], v[156:159], v[132:135], v[188:191]
    v_mfma_f32_16x16x32_bf16 v[212:215], v[156:159], v[136:139], v[212:215]
    v_mfma_f32_16x16x32_bf16 v[236:239], v[156:159], v[140:143], v[236:239]
    ds_read_b64_tr_b16 v[156:157], v106 offset:45056
    s_waitcnt lgkmcnt(5)
    v_mfma_f32_16x16x32_bf16 v[168:171], v[144:147], v[128:131], v[168:171]
    ds_read_b64_tr_b16 v[158:159], v106 offset:46080
    v_mfma_f32_16x16x32_bf16 v[192:195], v[144:147], v[132:135], v[192:195]
    v_mfma_f32_16x16x32_bf16 v[216:219], v[144:147], v[136:139], v[216:219]
    v_mfma_f32_16x16x32_bf16 v[240:243], v[144:147], v[140:143], v[240:243]
    s_barrier
    ds_read_b64_tr_b16 v[144:145], v97 offset:0
    s_waitcnt lgkmcnt(5)
    v_mfma_f32_16x16x32_bf16 v[172:175], v[148:151], v[128:131], v[172:175]
    ds_read_b64_tr_b16 v[146:147], v97 offset:1024
    v_mfma_f32_16x16x32_bf16 v[196:199], v[148:151], v[132:135], v[196:199]
    ds_read_b128 v[112:115], v109 offset:0
    v_mfma_f32_16x16x32_bf16 v[220:223], v[148:151], v[136:139], v[220:223]
    ds_read_b128 v[116:119], v109 offset:256
    v_mfma_f32_16x16x32_bf16 v[244:247], v[148:151], v[140:143], v[244:247]
    ds_read_b64_tr_b16 v[148:149], v99 offset:0
    s_waitcnt lgkmcnt(7)
    v_mfma_f32_16x16x32_bf16 v[176:179], v[152:155], v[128:131], v[176:179]
    ds_read_b64_tr_b16 v[150:151], v99 offset:1024
    v_mfma_f32_16x16x32_bf16 v[200:203], v[152:155], v[132:135], v[200:203]
    ds_read_b128 v[120:123], v109 offset:4096
    v_mfma_f32_16x16x32_bf16 v[224:227], v[152:155], v[136:139], v[224:227]
    ds_read_b128 v[124:127], v109 offset:4352
    v_mfma_f32_16x16x32_bf16 v[248:251], v[152:155], v[140:143], v[248:251]
    ds_read_b64_tr_b16 v[152:153], v101 offset:0
    s_waitcnt lgkmcnt(9)
    v_mfma_f32_16x16x32_bf16 v[180:183], v[156:159], v[128:131], v[180:183]
    ds_read_b64_tr_b16 v[154:155], v101 offset:1024
    v_mfma_f32_16x16x32_bf16 v[204:207], v[156:159], v[132:135], v[204:207]
    v_mfma_f32_16x16x32_bf16 v[228:231], v[156:159], v[136:139], v[228:231]
    v_mfma_f32_16x16x32_bf16 v[252:255], v[156:159], v[140:143], v[252:255]
    ds_read_b64_tr_b16 v[156:157], v103 offset:0
    s_waitcnt lgkmcnt(8)
    v_mfma_f32_16x16x32_bf16 v[160:163], v[144:147], v[112:115], v[160:163]
    ds_read_b64_tr_b16 v[158:159], v103 offset:1024
    s_waitcnt lgkmcnt(8)
    v_mfma_f32_16x16x32_bf16 v[184:187], v[144:147], v[116:119], v[184:187]
    s_waitcnt lgkmcnt(5)
    v_mfma_f32_16x16x32_bf16 v[208:211], v[144:147], v[120:123], v[208:211]
    s_waitcnt lgkmcnt(4)
    v_mfma_f32_16x16x32_bf16 v[232:235], v[144:147], v[124:127], v[232:235]
    ds_read_b64_tr_b16 v[144:145], v105 offset:0
    v_mfma_f32_16x16x32_bf16 v[164:167], v[148:151], v[112:115], v[164:167]
    ds_read_b64_tr_b16 v[146:147], v105 offset:1024
    v_mfma_f32_16x16x32_bf16 v[188:191], v[148:151], v[116:119], v[188:191]
    v_mfma_f32_16x16x32_bf16 v[212:215], v[148:151], v[120:123], v[212:215]
    v_mfma_f32_16x16x32_bf16 v[236:239], v[148:151], v[124:127], v[236:239]
    ds_read_b64_tr_b16 v[148:149], v107 offset:0
    s_waitcnt lgkmcnt(5)
    v_mfma_f32_16x16x32_bf16 v[168:171], v[152:155], v[112:115], v[168:171]
    ds_read_b64_tr_b16 v[150:151], v107 offset:1024
    v_mfma_f32_16x16x32_bf16 v[192:195], v[152:155], v[116:119], v[192:195]
    v_mfma_f32_16x16x32_bf16 v[216:219], v[152:155], v[120:123], v[216:219]
    v_mfma_f32_16x16x32_bf16 v[240:243], v[152:155], v[124:127], v[240:243]
    ds_read_b64_tr_b16 v[152:153], v97 offset:4096
    s_waitcnt lgkmcnt(5)
    v_mfma_f32_16x16x32_bf16 v[172:175], v[156:159], v[112:115], v[172:175]
    ds_read_b64_tr_b16 v[154:155], v97 offset:5120
    v_mfma_f32_16x16x32_bf16 v[196:199], v[156:159], v[116:119], v[196:199]
    ds_read_b128 v[128:131], v109 offset:2048
    v_mfma_f32_16x16x32_bf16 v[220:223], v[156:159], v[120:123], v[220:223]
    ds_read_b128 v[132:135], v109 offset:2304
    v_mfma_f32_16x16x32_bf16 v[244:247], v[156:159], v[124:127], v[244:247]
    ds_read_b64_tr_b16 v[156:157], v99 offset:4096
    s_waitcnt lgkmcnt(7)
    v_mfma_f32_16x16x32_bf16 v[176:179], v[144:147], v[112:115], v[176:179]
    ds_read_b64_tr_b16 v[158:159], v99 offset:5120
    v_mfma_f32_16x16x32_bf16 v[200:203], v[144:147], v[116:119], v[200:203]
    ds_read_b128 v[136:139], v109 offset:6144
    v_mfma_f32_16x16x32_bf16 v[224:227], v[144:147], v[120:123], v[224:227]
    ds_read_b128 v[140:143], v109 offset:6400
    v_mfma_f32_16x16x32_bf16 v[248:251], v[144:147], v[124:127], v[248:251]
    ds_read_b64_tr_b16 v[144:145], v101 offset:4096
    s_waitcnt lgkmcnt(9)
    v_mfma_f32_16x16x32_bf16 v[180:183], v[148:151], v[112:115], v[180:183]
    ds_read_b64_tr_b16 v[146:147], v101 offset:5120
    v_mfma_f32_16x16x32_bf16 v[204:207], v[148:151], v[116:119], v[204:207]
    v_mfma_f32_16x16x32_bf16 v[228:231], v[148:151], v[120:123], v[228:231]
    v_mfma_f32_16x16x32_bf16 v[252:255], v[148:151], v[124:127], v[252:255]
    ds_read_b64_tr_b16 v[148:149], v103 offset:4096
    s_waitcnt lgkmcnt(8)
    v_mfma_f32_16x16x32_bf16 v[160:163], v[152:155], v[128:131], v[160:163]
    ds_read_b64_tr_b16 v[150:151], v103 offset:5120
    s_waitcnt lgkmcnt(8)
    v_mfma_f32_16x16x32_bf16 v[184:187], v[152:155], v[132:135], v[184:187]
    s_waitcnt lgkmcnt(5)
    v_mfma_f32_16x16x32_bf16 v[208:211], v[152:155], v[136:139], v[208:211]
    s_waitcnt lgkmcnt(4)
    v_mfma_f32_16x16x32_bf16 v[232:235], v[152:155], v[140:143], v[232:235]
    ds_read_b64_tr_b16 v[152:153], v105 offset:4096
    v_mfma_f32_16x16x32_bf16 v[164:167], v[156:159], v[128:131], v[164:167]
    ds_read_b64_tr_b16 v[154:155], v105 offset:5120
    v_mfma_f32_16x16x32_bf16 v[188:191], v[156:159], v[132:135], v[188:191]
    v_mfma_f32_16x16x32_bf16 v[212:215], v[156:159], v[136:139], v[212:215]
    v_mfma_f32_16x16x32_bf16 v[236:239], v[156:159], v[140:143], v[236:239]
    ds_read_b64_tr_b16 v[156:157], v107 offset:4096
    s_waitcnt lgkmcnt(5)
    v_mfma_f32_16x16x32_bf16 v[168:171], v[144:147], v[128:131], v[168:171]
    ds_read_b64_tr_b16 v[158:159], v107 offset:5120
    v_mfma_f32_16x16x32_bf16 v[192:195], v[144:147], v[132:135], v[192:195]
    v_mfma_f32_16x16x32_bf16 v[216:219], v[144:147], v[136:139], v[216:219]
    v_mfma_f32_16x16x32_bf16 v[240:243], v[144:147], v[140:143], v[240:243]
    s_barrier
    ds_read_b64_tr_b16 v[144:145], v97 offset:40960
    s_waitcnt lgkmcnt(5)
    v_mfma_f32_16x16x32_bf16 v[172:175], v[148:151], v[128:131], v[172:175]
    ds_read_b64_tr_b16 v[146:147], v97 offset:41984
    v_mfma_f32_16x16x32_bf16 v[196:199], v[148:151], v[132:135], v[196:199]
    ds_read_b128 v[112:115], v109 offset:40960
    v_mfma_f32_16x16x32_bf16 v[220:223], v[148:151], v[136:139], v[220:223]
    ds_read_b128 v[116:119], v109 offset:41216
    v_mfma_f32_16x16x32_bf16 v[244:247], v[148:151], v[140:143], v[244:247]
    ds_read_b64_tr_b16 v[148:149], v99 offset:40960
    s_waitcnt lgkmcnt(7)
    v_mfma_f32_16x16x32_bf16 v[176:179], v[152:155], v[128:131], v[176:179]
    ds_read_b64_tr_b16 v[150:151], v99 offset:41984
    v_mfma_f32_16x16x32_bf16 v[200:203], v[152:155], v[132:135], v[200:203]
    ds_read_b128 v[120:123], v109 offset:45056
    v_mfma_f32_16x16x32_bf16 v[224:227], v[152:155], v[136:139], v[224:227]
    ds_read_b128 v[124:127], v109 offset:45312
    v_mfma_f32_16x16x32_bf16 v[248:251], v[152:155], v[140:143], v[248:251]
    ds_read_b64_tr_b16 v[152:153], v101 offset:40960
    s_waitcnt lgkmcnt(9)
    v_mfma_f32_16x16x32_bf16 v[180:183], v[156:159], v[128:131], v[180:183]
    ds_read_b64_tr_b16 v[154:155], v101 offset:41984
    v_mfma_f32_16x16x32_bf16 v[204:207], v[156:159], v[132:135], v[204:207]
    v_mfma_f32_16x16x32_bf16 v[228:231], v[156:159], v[136:139], v[228:231]
    v_mfma_f32_16x16x32_bf16 v[252:255], v[156:159], v[140:143], v[252:255]
    ds_read_b64_tr_b16 v[156:157], v103 offset:40960
    s_waitcnt lgkmcnt(8)
    v_mfma_f32_16x16x32_bf16 v[160:163], v[144:147], v[112:115], v[160:163]
    ds_read_b64_tr_b16 v[158:159], v103 offset:41984
    s_waitcnt lgkmcnt(8)
    v_mfma_f32_16x16x32_bf16 v[184:187], v[144:147], v[116:119], v[184:187]
    s_waitcnt lgkmcnt(5)
    v_mfma_f32_16x16x32_bf16 v[208:211], v[144:147], v[120:123], v[208:211]
    s_waitcnt lgkmcnt(4)
    v_mfma_f32_16x16x32_bf16 v[232:235], v[144:147], v[124:127], v[232:235]
    ds_read_b64_tr_b16 v[144:145], v105 offset:40960
    v_mfma_f32_16x16x32_bf16 v[164:167], v[148:151], v[112:115], v[164:167]
    ds_read_b64_tr_b16 v[146:147], v105 offset:41984
    v_mfma_f32_16x16x32_bf16 v[188:191], v[148:151], v[116:119], v[188:191]
    v_mfma_f32_16x16x32_bf16 v[212:215], v[148:151], v[120:123], v[212:215]
    v_mfma_f32_16x16x32_bf16 v[236:239], v[148:151], v[124:127], v[236:239]
    ds_read_b64_tr_b16 v[148:149], v107 offset:40960
    s_waitcnt lgkmcnt(5)
    v_mfma_f32_16x16x32_bf16 v[168:171], v[152:155], v[112:115], v[168:171]
    ds_read_b64_tr_b16 v[150:151], v107 offset:41984
    v_mfma_f32_16x16x32_bf16 v[192:195], v[152:155], v[116:119], v[192:195]
    v_mfma_f32_16x16x32_bf16 v[216:219], v[152:155], v[120:123], v[216:219]
    v_mfma_f32_16x16x32_bf16 v[240:243], v[152:155], v[124:127], v[240:243]
    ds_read_b64_tr_b16 v[152:153], v97 offset:45056
    s_waitcnt lgkmcnt(5)
    v_mfma_f32_16x16x32_bf16 v[172:175], v[156:159], v[112:115], v[172:175]
    ds_read_b64_tr_b16 v[154:155], v97 offset:46080
    v_mfma_f32_16x16x32_bf16 v[196:199], v[156:159], v[116:119], v[196:199]
    ds_read_b128 v[128:131], v109 offset:43008
    v_mfma_f32_16x16x32_bf16 v[220:223], v[156:159], v[120:123], v[220:223]
    ds_read_b128 v[132:135], v109 offset:43264
    v_mfma_f32_16x16x32_bf16 v[244:247], v[156:159], v[124:127], v[244:247]
    ds_read_b64_tr_b16 v[156:157], v99 offset:45056
    s_waitcnt lgkmcnt(7)
    v_mfma_f32_16x16x32_bf16 v[176:179], v[144:147], v[112:115], v[176:179]
    ds_read_b64_tr_b16 v[158:159], v99 offset:46080
    v_mfma_f32_16x16x32_bf16 v[200:203], v[144:147], v[116:119], v[200:203]
    ds_read_b128 v[136:139], v109 offset:47104
    v_mfma_f32_16x16x32_bf16 v[224:227], v[144:147], v[120:123], v[224:227]
    ds_read_b128 v[140:143], v109 offset:47360
    v_mfma_f32_16x16x32_bf16 v[248:251], v[144:147], v[124:127], v[248:251]
    ds_read_b64_tr_b16 v[144:145], v101 offset:45056
    s_waitcnt lgkmcnt(9)
    v_mfma_f32_16x16x32_bf16 v[180:183], v[148:151], v[112:115], v[180:183]
    ds_read_b64_tr_b16 v[146:147], v101 offset:46080
    v_mfma_f32_16x16x32_bf16 v[204:207], v[148:151], v[116:119], v[204:207]
    v_mfma_f32_16x16x32_bf16 v[228:231], v[148:151], v[120:123], v[228:231]
    v_mfma_f32_16x16x32_bf16 v[252:255], v[148:151], v[124:127], v[252:255]
    ds_read_b64_tr_b16 v[148:149], v103 offset:45056
    s_waitcnt lgkmcnt(8)
    v_mfma_f32_16x16x32_bf16 v[160:163], v[152:155], v[128:131], v[160:163]
    ds_read_b64_tr_b16 v[150:151], v103 offset:46080
    s_waitcnt lgkmcnt(8)
    v_mfma_f32_16x16x32_bf16 v[184:187], v[152:155], v[132:135], v[184:187]
    s_waitcnt lgkmcnt(5)
    v_mfma_f32_16x16x32_bf16 v[208:211], v[152:155], v[136:139], v[208:211]
    s_waitcnt lgkmcnt(4)
    v_mfma_f32_16x16x32_bf16 v[232:235], v[152:155], v[140:143], v[232:235]
    ds_read_b64_tr_b16 v[152:153], v105 offset:45056
    v_mfma_f32_16x16x32_bf16 v[164:167], v[156:159], v[128:131], v[164:167]
    ds_read_b64_tr_b16 v[154:155], v105 offset:46080
    v_mfma_f32_16x16x32_bf16 v[188:191], v[156:159], v[132:135], v[188:191]
    v_mfma_f32_16x16x32_bf16 v[212:215], v[156:159], v[136:139], v[212:215]
    v_mfma_f32_16x16x32_bf16 v[236:239], v[156:159], v[140:143], v[236:239]
    ds_read_b64_tr_b16 v[156:157], v107 offset:45056
    s_waitcnt lgkmcnt(5)
    v_mfma_f32_16x16x32_bf16 v[168:171], v[144:147], v[128:131], v[168:171]
    ds_read_b64_tr_b16 v[158:159], v107 offset:46080
    v_mfma_f32_16x16x32_bf16 v[192:195], v[144:147], v[132:135], v[192:195]
    v_mfma_f32_16x16x32_bf16 v[216:219], v[144:147], v[136:139], v[216:219]
    v_mfma_f32_16x16x32_bf16 v[240:243], v[144:147], v[140:143], v[240:243]
    s_barrier
    ds_read_b64_tr_b16 v[144:145], v96 offset:0
    s_waitcnt lgkmcnt(5)
    v_mfma_f32_16x16x32_bf16 v[172:175], v[148:151], v[128:131], v[172:175]
    ds_read_b64_tr_b16 v[146:147], v96 offset:1024
    v_mfma_f32_16x16x32_bf16 v[196:199], v[148:151], v[132:135], v[196:199]
    ds_read_b128 v[112:115], v108 offset:0
    v_mfma_f32_16x16x32_bf16 v[220:223], v[148:151], v[136:139], v[220:223]
    ds_read_b128 v[116:119], v108 offset:256
    v_mfma_f32_16x16x32_bf16 v[244:247], v[148:151], v[140:143], v[244:247]
    ds_read_b64_tr_b16 v[148:149], v98 offset:0
    s_waitcnt lgkmcnt(7)
    v_mfma_f32_16x16x32_bf16 v[176:179], v[152:155], v[128:131], v[176:179]
    ds_read_b64_tr_b16 v[150:151], v98 offset:1024
    v_mfma_f32_16x16x32_bf16 v[200:203], v[152:155], v[132:135], v[200:203]
    ds_read_b128 v[120:123], v108 offset:4096
    v_mfma_f32_16x16x32_bf16 v[224:227], v[152:155], v[136:139], v[224:227]
    ds_read_b128 v[124:127], v108 offset:4352
    v_mfma_f32_16x16x32_bf16 v[248:251], v[152:155], v[140:143], v[248:251]
    ds_read_b64_tr_b16 v[152:153], v100 offset:0
    s_waitcnt lgkmcnt(9)
    v_mfma_f32_16x16x32_bf16 v[180:183], v[156:159], v[128:131], v[180:183]
    ds_read_b64_tr_b16 v[154:155], v100 offset:1024
    v_mfma_f32_16x16x32_bf16 v[204:207], v[156:159], v[132:135], v[204:207]
    v_mfma_f32_16x16x32_bf16 v[228:231], v[156:159], v[136:139], v[228:231]
    v_mfma_f32_16x16x32_bf16 v[252:255], v[156:159], v[140:143], v[252:255]
    ds_read_b64_tr_b16 v[156:157], v102 offset:0
    s_waitcnt lgkmcnt(8)
    v_mfma_f32_16x16x32_bf16 v[160:163], v[144:147], v[112:115], v[160:163]
    ds_read_b64_tr_b16 v[158:159], v102 offset:1024
    s_waitcnt lgkmcnt(8)
    v_mfma_f32_16x16x32_bf16 v[184:187], v[144:147], v[116:119], v[184:187]
    s_waitcnt lgkmcnt(5)
    v_mfma_f32_16x16x32_bf16 v[208:211], v[144:147], v[120:123], v[208:211]
    s_waitcnt lgkmcnt(4)
    v_mfma_f32_16x16x32_bf16 v[232:235], v[144:147], v[124:127], v[232:235]
    ds_read_b64_tr_b16 v[144:145], v104 offset:0
    v_mfma_f32_16x16x32_bf16 v[164:167], v[148:151], v[112:115], v[164:167]
    ds_read_b64_tr_b16 v[146:147], v104 offset:1024
    v_mfma_f32_16x16x32_bf16 v[188:191], v[148:151], v[116:119], v[188:191]
    v_mfma_f32_16x16x32_bf16 v[212:215], v[148:151], v[120:123], v[212:215]
    v_mfma_f32_16x16x32_bf16 v[236:239], v[148:151], v[124:127], v[236:239]
    ds_read_b64_tr_b16 v[148:149], v106 offset:0
    s_waitcnt lgkmcnt(5)
    v_mfma_f32_16x16x32_bf16 v[168:171], v[152:155], v[112:115], v[168:171]
    ds_read_b64_tr_b16 v[150:151], v106 offset:1024
    v_mfma_f32_16x16x32_bf16 v[192:195], v[152:155], v[116:119], v[192:195]
    v_mfma_f32_16x16x32_bf16 v[216:219], v[152:155], v[120:123], v[216:219]
    v_mfma_f32_16x16x32_bf16 v[240:243], v[152:155], v[124:127], v[240:243]
    ds_read_b64_tr_b16 v[152:153], v96 offset:4096
    s_waitcnt lgkmcnt(5)
    v_mfma_f32_16x16x32_bf16 v[172:175], v[156:159], v[112:115], v[172:175]
    ds_read_b64_tr_b16 v[154:155], v96 offset:5120
    v_mfma_f32_16x16x32_bf16 v[196:199], v[156:159], v[116:119], v[196:199]
    ds_read_b128 v[128:131], v108 offset:2048
    v_mfma_f32_16x16x32_bf16 v[220:223], v[156:159], v[120:123], v[220:223]
    ds_read_b128 v[132:135], v108 offset:2304
    v_mfma_f32_16x16x32_bf16 v[244:247], v[156:159], v[124:127], v[244:247]
    ds_read_b64_tr_b16 v[156:157], v98 offset:4096
    s_waitcnt lgkmcnt(7)
    v_mfma_f32_16x16x32_bf16 v[176:179], v[144:147], v[112:115], v[176:179]
    ds_read_b64_tr_b16 v[158:159], v98 offset:5120
    v_mfma_f32_16x16x32_bf16 v[200:203], v[144:147], v[116:119], v[200:203]
    ds_read_b128 v[136:139], v108 offset:6144
    v_mfma_f32_16x16x32_bf16 v[224:227], v[144:147], v[120:123], v[224:227]
    ds_read_b128 v[140:143], v108 offset:6400
    v_mfma_f32_16x16x32_bf16 v[248:251], v[144:147], v[124:127], v[248:251]
    ds_read_b64_tr_b16 v[144:145], v100 offset:4096
    s_waitcnt lgkmcnt(9)
    v_mfma_f32_16x16x32_bf16 v[180:183], v[148:151], v[112:115], v[180:183]
    ds_read_b64_tr_b16 v[146:147], v100 offset:5120
    v_mfma_f32_16x16x32_bf16 v[204:207], v[148:151], v[116:119], v[204:207]
    v_mfma_f32_16x16x32_bf16 v[228:231], v[148:151], v[120:123], v[228:231]
    v_mfma_f32_16x16x32_bf16 v[252:255], v[148:151], v[124:127], v[252:255]
    ds_read_b64_tr_b16 v[148:149], v102 offset:4096
    s_waitcnt lgkmcnt(8)
    v_mfma_f32_16x16x32_bf16 v[160:163], v[152:155], v[128:131], v[160:163]
    ds_read_b64_tr_b16 v[150:151], v102 offset:5120
    s_waitcnt lgkmcnt(8)
    v_mfma_f32_16x16x32_bf16 v[184:187], v[152:155], v[132:135], v[184:187]
    s_waitcnt lgkmcnt(5)
    v_mfma_f32_16x16x32_bf16 v[208:211], v[152:155], v[136:139], v[208:211]
    s_waitcnt lgkmcnt(4)
    v_mfma_f32_16x16x32_bf16 v[232:235], v[152:155], v[140:143], v[232:235]
    ds_read_b64_tr_b16 v[152:153], v104 offset:4096
    v_mfma_f32_16x16x32_bf16 v[164:167], v[156:159], v[128:131], v[164:167]
    ds_read_b64_tr_b16 v[154:155], v104 offset:5120
    v_mfma_f32_16x16x32_bf16 v[188:191], v[156:159], v[132:135], v[188:191]
    v_mfma_f32_16x16x32_bf16 v[212:215], v[156:159], v[136:139], v[212:215]
    v_mfma_f32_16x16x32_bf16 v[236:239], v[156:159], v[140:143], v[236:239]
    ds_read_b64_tr_b16 v[156:157], v106 offset:4096
    s_waitcnt lgkmcnt(5)
    v_mfma_f32_16x16x32_bf16 v[168:171], v[144:147], v[128:131], v[168:171]
    ds_read_b64_tr_b16 v[158:159], v106 offset:5120
    v_mfma_f32_16x16x32_bf16 v[192:195], v[144:147], v[132:135], v[192:195]
    v_mfma_f32_16x16x32_bf16 v[216:219], v[144:147], v[136:139], v[216:219]
    v_mfma_f32_16x16x32_bf16 v[240:243], v[144:147], v[140:143], v[240:243]
    s_barrier
    ds_read_b64_tr_b16 v[144:145], v96 offset:40960
    s_waitcnt lgkmcnt(5)
    v_mfma_f32_16x16x32_bf16 v[172:175], v[148:151], v[128:131], v[172:175]
    ds_read_b64_tr_b16 v[146:147], v96 offset:41984
    v_mfma_f32_16x16x32_bf16 v[196:199], v[148:151], v[132:135], v[196:199]
    ds_read_b128 v[112:115], v108 offset:40960
    v_mfma_f32_16x16x32_bf16 v[220:223], v[148:151], v[136:139], v[220:223]
    ds_read_b128 v[116:119], v108 offset:41216
    v_mfma_f32_16x16x32_bf16 v[244:247], v[148:151], v[140:143], v[244:247]
    ds_read_b64_tr_b16 v[148:149], v98 offset:40960
    s_waitcnt lgkmcnt(7)
    v_mfma_f32_16x16x32_bf16 v[176:179], v[152:155], v[128:131], v[176:179]
    ds_read_b64_tr_b16 v[150:151], v98 offset:41984
    v_mfma_f32_16x16x32_bf16 v[200:203], v[152:155], v[132:135], v[200:203]
    ds_read_b128 v[120:123], v108 offset:45056
    v_mfma_f32_16x16x32_bf16 v[224:227], v[152:155], v[136:139], v[224:227]
    ds_read_b128 v[124:127], v108 offset:45312
    v_mfma_f32_16x16x32_bf16 v[248:251], v[152:155], v[140:143], v[248:251]
    ds_read_b64_tr_b16 v[152:153], v100 offset:40960
    s_waitcnt lgkmcnt(9)
    v_mfma_f32_16x16x32_bf16 v[180:183], v[156:159], v[128:131], v[180:183]
    ds_read_b64_tr_b16 v[154:155], v100 offset:41984
    v_mfma_f32_16x16x32_bf16 v[204:207], v[156:159], v[132:135], v[204:207]
    v_mfma_f32_16x16x32_bf16 v[228:231], v[156:159], v[136:139], v[228:231]
    v_mfma_f32_16x16x32_bf16 v[252:255], v[156:159], v[140:143], v[252:255]
    ds_read_b64_tr_b16 v[156:157], v102 offset:40960
    s_waitcnt lgkmcnt(8)
    v_mfma_f32_16x16x32_bf16 v[160:163], v[144:147], v[112:115], v[160:163]
    ds_read_b64_tr_b16 v[158:159], v102 offset:41984
    s_waitcnt lgkmcnt(8)
    v_mfma_f32_16x16x32_bf16 v[184:187], v[144:147], v[116:119], v[184:187]
    s_waitcnt lgkmcnt(5)
    v_mfma_f32_16x16x32_bf16 v[208:211], v[144:147], v[120:123], v[208:211]
    s_waitcnt lgkmcnt(4)
    v_mfma_f32_16x16x32_bf16 v[232:235], v[144:147], v[124:127], v[232:235]
    ds_read_b64_tr_b16 v[144:145], v104 offset:40960
    v_mfma_f32_16x16x32_bf16 v[164:167], v[148:151], v[112:115], v[164:167]
    ds_read_b64_tr_b16 v[146:147], v104 offset:41984
    v_mfma_f32_16x16x32_bf16 v[188:191], v[148:151], v[116:119], v[188:191]
    v_mfma_f32_16x16x32_bf16 v[212:215], v[148:151], v[120:123], v[212:215]
    v_mfma_f32_16x16x32_bf16 v[236:239], v[148:151], v[124:127], v[236:239]
    ds_read_b64_tr_b16 v[148:149], v106 offset:40960
    s_waitcnt lgkmcnt(5)
    v_mfma_f32_16x16x32_bf16 v[168:171], v[152:155], v[112:115], v[168:171]
    ds_read_b64_tr_b16 v[150:151], v106 offset:41984
    v_mfma_f32_16x16x32_bf16 v[192:195], v[152:155], v[116:119], v[192:195]
    v_mfma_f32_16x16x32_bf16 v[216:219], v[152:155], v[120:123], v[216:219]
    v_mfma_f32_16x16x32_bf16 v[240:243], v[152:155], v[124:127], v[240:243]
    ds_read_b64_tr_b16 v[152:153], v96 offset:45056
    s_waitcnt lgkmcnt(5)
    v_mfma_f32_16x16x32_bf16 v[172:175], v[156:159], v[112:115], v[172:175]
    ds_read_b64_tr_b16 v[154:155], v96 offset:46080
    v_mfma_f32_16x16x32_bf16 v[196:199], v[156:159], v[116:119], v[196:199]
    ds_read_b128 v[128:131], v108 offset:43008
    v_mfma_f32_16x16x32_bf16 v[220:223], v[156:159], v[120:123], v[220:223]
    ds_read_b128 v[132:135], v108 offset:43264
    v_mfma_f32_16x16x32_bf16 v[244:247], v[156:159], v[124:127], v[244:247]
    ds_read_b64_tr_b16 v[156:157], v98 offset:45056
    s_waitcnt lgkmcnt(7)
    v_mfma_f32_16x16x32_bf16 v[176:179], v[144:147], v[112:115], v[176:179]
    ds_read_b64_tr_b16 v[158:159], v98 offset:46080
    v_mfma_f32_16x16x32_bf16 v[200:203], v[144:147], v[116:119], v[200:203]
    ds_read_b128 v[136:139], v108 offset:47104
    v_mfma_f32_16x16x32_bf16 v[224:227], v[144:147], v[120:123], v[224:227]
    ds_read_b128 v[140:143], v108 offset:47360
    v_mfma_f32_16x16x32_bf16 v[248:251], v[144:147], v[124:127], v[248:251]
    ds_read_b64_tr_b16 v[144:145], v100 offset:45056
    s_waitcnt lgkmcnt(9)
    v_mfma_f32_16x16x32_bf16 v[180:183], v[148:151], v[112:115], v[180:183]
    ds_read_b64_tr_b16 v[146:147], v100 offset:46080
    v_mfma_f32_16x16x32_bf16 v[204:207], v[148:151], v[116:119], v[204:207]
    v_mfma_f32_16x16x32_bf16 v[228:231], v[148:151], v[120:123], v[228:231]
    v_mfma_f32_16x16x32_bf16 v[252:255], v[148:151], v[124:127], v[252:255]
    ds_read_b64_tr_b16 v[148:149], v102 offset:45056
    s_waitcnt lgkmcnt(8)
    v_mfma_f32_16x16x32_bf16 v[160:163], v[152:155], v[128:131], v[160:163]
    ds_read_b64_tr_b16 v[150:151], v102 offset:46080
    s_waitcnt lgkmcnt(8)
    v_mfma_f32_16x16x32_bf16 v[184:187], v[152:155], v[132:135], v[184:187]
    s_waitcnt lgkmcnt(5)
    v_mfma_f32_16x16x32_bf16 v[208:211], v[152:155], v[136:139], v[208:211]
    s_waitcnt lgkmcnt(4)
    v_mfma_f32_16x16x32_bf16 v[232:235], v[152:155], v[140:143], v[232:235]
    ds_read_b64_tr_b16 v[152:153], v104 offset:45056
    v_mfma_f32_16x16x32_bf16 v[164:167], v[156:159], v[128:131], v[164:167]
    ds_read_b64_tr_b16 v[154:155], v104 offset:46080
    v_mfma_f32_16x16x32_bf16 v[188:191], v[156:159], v[132:135], v[188:191]
    v_mfma_f32_16x16x32_bf16 v[212:215], v[156:159], v[136:139], v[212:215]
    v_mfma_f32_16x16x32_bf16 v[236:239], v[156:159], v[140:143], v[236:239]
    ds_read_b64_tr_b16 v[156:157], v106 offset:45056
    s_waitcnt lgkmcnt(5)
    v_mfma_f32_16x16x32_bf16 v[168:171], v[144:147], v[128:131], v[168:171]
    ds_read_b64_tr_b16 v[158:159], v106 offset:46080
    v_mfma_f32_16x16x32_bf16 v[192:195], v[144:147], v[132:135], v[192:195]
    v_mfma_f32_16x16x32_bf16 v[216:219], v[144:147], v[136:139], v[216:219]
    v_mfma_f32_16x16x32_bf16 v[240:243], v[144:147], v[140:143], v[240:243]
    s_barrier
    ds_read_b64_tr_b16 v[144:145], v97 offset:0
    s_waitcnt lgkmcnt(5)
    v_mfma_f32_16x16x32_bf16 v[172:175], v[148:151], v[128:131], v[172:175]
    ds_read_b64_tr_b16 v[146:147], v97 offset:1024
    v_mfma_f32_16x16x32_bf16 v[196:199], v[148:151], v[132:135], v[196:199]
    ds_read_b64_tr_b16 v[112:113], v111 offset:0
    ds_read_b64_tr_b16 v[114:115], v111 offset:512
    v_mfma_f32_16x16x32_bf16 v[220:223], v[148:151], v[136:139], v[220:223]
    ds_read_b64_tr_b16 v[116:117], v111 offset:16
    ds_read_b64_tr_b16 v[118:119], v111 offset:528
    v_mfma_f32_16x16x32_bf16 v[244:247], v[148:151], v[140:143], v[244:247]
    ds_read_b64_tr_b16 v[148:149], v99 offset:0
    s_waitcnt lgkmcnt(9)
    v_mfma_f32_16x16x32_bf16 v[176:179], v[152:155], v[128:131], v[176:179]
    ds_read_b64_tr_b16 v[150:151], v99 offset:1024
    v_mfma_f32_16x16x32_bf16 v[200:203], v[152:155], v[132:135], v[200:203]
    ds_read_b64_tr_b16 v[120:121], v111 offset:4096
    ds_read_b64_tr_b16 v[122:123], v111 offset:4608
    v_mfma_f32_16x16x32_bf16 v[224:227], v[152:155], v[136:139], v[224:227]
    ds_read_b64_tr_b16 v[124:125], v111 offset:4112
    ds_read_b64_tr_b16 v[126:127], v111 offset:4624
    v_mfma_f32_16x16x32_bf16 v[248:251], v[152:155], v[140:143], v[248:251]
    ds_read_b64_tr_b16 v[152:153], v101 offset:0
    s_waitcnt lgkmcnt(13)
    v_mfma_f32_16x16x32_bf16 v[180:183], v[156:159], v[128:131], v[180:183]
    ds_read_b64_tr_b16 v[154:155], v101 offset:1024
    v_mfma_f32_16x16x32_bf16 v[204:207], v[156:159], v[132:135], v[204:207]
    v_mfma_f32_16x16x32_bf16 v[228:231], v[156:159], v[136:139], v[228:231]
    v_mfma_f32_16x16x32_bf16 v[252:255], v[156:159], v[140:143], v[252:255]
    ds_read_b64_tr_b16 v[156:157], v103 offset:0
    s_waitcnt lgkmcnt(11)
    v_mfma_f32_16x16x32_bf16 v[160:163], v[144:147], v[112:115], v[160:163]
    ds_read_b64_tr_b16 v[158:159], v103 offset:1024
    s_waitcnt lgkmcnt(10)
    v_mfma_f32_16x16x32_bf16 v[184:187], v[144:147], v[116:119], v[184:187]
    s_waitcnt lgkmcnt(6)
    v_mfma_f32_16x16x32_bf16 v[208:211], v[144:147], v[120:123], v[208:211]
    s_waitcnt lgkmcnt(4)
    v_mfma_f32_16x16x32_bf16 v[232:235], v[144:147], v[124:127], v[232:235]
    ds_read_b64_tr_b16 v[144:145], v105 offset:0
    v_mfma_f32_16x16x32_bf16 v[164:167], v[148:151], v[112:115], v[164:167]
    v_lshrrev_b32 v5, 5, v1
    ds_read_b64_tr_b16 v[146:147], v105 offset:1024
    v_mfma_f32_16x16x32_bf16 v[188:191], v[148:151], v[116:119], v[188:191]
    v_mfma_f32_16x16x32_bf16 v[212:215], v[148:151], v[120:123], v[212:215]
    v_lshlrev_b32 v6, 10, v5
    v_mfma_f32_16x16x32_bf16 v[236:239], v[148:151], v[124:127], v[236:239]
    ds_read_b64_tr_b16 v[148:149], v107 offset:0
    s_waitcnt lgkmcnt(5)
    v_mfma_f32_16x16x32_bf16 v[168:171], v[152:155], v[112:115], v[168:171]
    v_sub_u32 v96, v96, v6
    ds_read_b64_tr_b16 v[150:151], v107 offset:1024
    v_mfma_f32_16x16x32_bf16 v[192:195], v[152:155], v[116:119], v[192:195]
    v_mfma_f32_16x16x32_bf16 v[216:219], v[152:155], v[120:123], v[216:219]
    v_sub_u32 v98, v98, v6
    v_mfma_f32_16x16x32_bf16 v[240:243], v[152:155], v[124:127], v[240:243]
    ds_read_b64_tr_b16 v[152:153], v97 offset:4096
    s_waitcnt lgkmcnt(5)
    v_mfma_f32_16x16x32_bf16 v[172:175], v[156:159], v[112:115], v[172:175]
    v_sub_u32 v100, v100, v6
    ds_read_b64_tr_b16 v[154:155], v97 offset:5120
    v_mfma_f32_16x16x32_bf16 v[196:199], v[156:159], v[116:119], v[196:199]
    ds_read_b64_tr_b16 v[128:129], v111 offset:2048
    ds_read_b64_tr_b16 v[130:131], v111 offset:2560
    v_mfma_f32_16x16x32_bf16 v[220:223], v[156:159], v[120:123], v[220:223]
    v_sub_u32 v102, v102, v6
    ds_read_b64_tr_b16 v[132:133], v111 offset:2064
    ds_read_b64_tr_b16 v[134:135], v111 offset:2576
    v_mfma_f32_16x16x32_bf16 v[244:247], v[156:159], v[124:127], v[244:247]
    ds_read_b64_tr_b16 v[156:157], v99 offset:4096
    s_waitcnt lgkmcnt(9)
    v_mfma_f32_16x16x32_bf16 v[176:179], v[144:147], v[112:115], v[176:179]
    v_sub_u32 v104, v104, v6
    ds_read_b64_tr_b16 v[158:159], v99 offset:5120
    v_mfma_f32_16x16x32_bf16 v[200:203], v[144:147], v[116:119], v[200:203]
    ds_read_b64_tr_b16 v[136:137], v111 offset:6144
    ds_read_b64_tr_b16 v[138:139], v111 offset:6656
    v_mfma_f32_16x16x32_bf16 v[224:227], v[144:147], v[120:123], v[224:227]
    v_sub_u32 v106, v106, v6
    ds_read_b64_tr_b16 v[140:141], v111 offset:6160
    ds_read_b64_tr_b16 v[142:143], v111 offset:6672
    v_mfma_f32_16x16x32_bf16 v[248:251], v[144:147], v[124:127], v[248:251]
    ds_read_b64_tr_b16 v[144:145], v101 offset:4096
    s_waitcnt lgkmcnt(13)
    v_mfma_f32_16x16x32_bf16 v[180:183], v[148:151], v[112:115], v[180:183]
    v_lshlrev_b32 v6, 9, v5
    ds_read_b64_tr_b16 v[146:147], v101 offset:5120
    v_mfma_f32_16x16x32_bf16 v[204:207], v[148:151], v[116:119], v[204:207]
    v_mfma_f32_16x16x32_bf16 v[228:231], v[148:151], v[120:123], v[228:231]
    v_sub_u32 v110, v110, v6
    v_mfma_f32_16x16x32_bf16 v[252:255], v[148:151], v[124:127], v[252:255]
    ds_read_b64_tr_b16 v[148:149], v103 offset:4096
    s_waitcnt lgkmcnt(11)
    v_mfma_f32_16x16x32_bf16 v[160:163], v[152:155], v[128:131], v[160:163]
    ds_read_b64_tr_b16 v[150:151], v103 offset:5120
    s_waitcnt lgkmcnt(10)
    v_mfma_f32_16x16x32_bf16 v[184:187], v[152:155], v[132:135], v[184:187]
    s_waitcnt lgkmcnt(6)
    v_mfma_f32_16x16x32_bf16 v[208:211], v[152:155], v[136:139], v[208:211]
    s_waitcnt lgkmcnt(4)
    v_mfma_f32_16x16x32_bf16 v[232:235], v[152:155], v[140:143], v[232:235]
    ds_read_b64_tr_b16 v[152:153], v105 offset:4096
    v_mfma_f32_16x16x32_bf16 v[164:167], v[156:159], v[128:131], v[164:167]
    ds_read_b64_tr_b16 v[154:155], v105 offset:5120
    v_mfma_f32_16x16x32_bf16 v[188:191], v[156:159], v[132:135], v[188:191]
    v_mfma_f32_16x16x32_bf16 v[212:215], v[156:159], v[136:139], v[212:215]
    v_mfma_f32_16x16x32_bf16 v[236:239], v[156:159], v[140:143], v[236:239]
    ds_read_b64_tr_b16 v[156:157], v107 offset:4096
    s_waitcnt lgkmcnt(5)
    v_mfma_f32_16x16x32_bf16 v[168:171], v[144:147], v[128:131], v[168:171]
    ds_read_b64_tr_b16 v[158:159], v107 offset:5120
    v_mfma_f32_16x16x32_bf16 v[192:195], v[144:147], v[132:135], v[192:195]
    v_mfma_f32_16x16x32_bf16 v[216:219], v[144:147], v[136:139], v[216:219]
    v_mfma_f32_16x16x32_bf16 v[240:243], v[144:147], v[140:143], v[240:243]
    s_barrier
    ds_read_b64_tr_b16 v[144:145], v97 offset:40960
    s_waitcnt lgkmcnt(5)
    v_mfma_f32_16x16x32_bf16 v[172:175], v[148:151], v[128:131], v[172:175]
    ds_read_b64_tr_b16 v[146:147], v97 offset:41984
    v_mfma_f32_16x16x32_bf16 v[196:199], v[148:151], v[132:135], v[196:199]
    ds_read_b64_tr_b16 v[112:113], v111 offset:40960
    ds_read_b64_tr_b16 v[114:115], v111 offset:41472
    v_mfma_f32_16x16x32_bf16 v[220:223], v[148:151], v[136:139], v[220:223]
    ds_read_b64_tr_b16 v[116:117], v111 offset:40976
    ds_read_b64_tr_b16 v[118:119], v111 offset:41488
    v_mfma_f32_16x16x32_bf16 v[244:247], v[148:151], v[140:143], v[244:247]
    ds_read_b64_tr_b16 v[148:149], v99 offset:40960
    s_waitcnt lgkmcnt(9)
    v_mfma_f32_16x16x32_bf16 v[176:179], v[152:155], v[128:131], v[176:179]
    ds_read_b64_tr_b16 v[150:151], v99 offset:41984
    v_mfma_f32_16x16x32_bf16 v[200:203], v[152:155], v[132:135], v[200:203]
    ds_read_b64_tr_b16 v[120:121], v111 offset:45056
    ds_read_b64_tr_b16 v[122:123], v111 offset:45568
    v_mfma_f32_16x16x32_bf16 v[224:227], v[152:155], v[136:139], v[224:227]
    ds_read_b64_tr_b16 v[124:125], v111 offset:45072
    ds_read_b64_tr_b16 v[126:127], v111 offset:45584
    v_mfma_f32_16x16x32_bf16 v[248:251], v[152:155], v[140:143], v[248:251]
    ds_read_b64_tr_b16 v[152:153], v101 offset:40960
    s_waitcnt lgkmcnt(13)
    v_mfma_f32_16x16x32_bf16 v[180:183], v[156:159], v[128:131], v[180:183]
    ds_read_b64_tr_b16 v[154:155], v101 offset:41984
    v_mfma_f32_16x16x32_bf16 v[204:207], v[156:159], v[132:135], v[204:207]
    v_mfma_f32_16x16x32_bf16 v[228:231], v[156:159], v[136:139], v[228:231]
    v_mfma_f32_16x16x32_bf16 v[252:255], v[156:159], v[140:143], v[252:255]
    ds_read_b64_tr_b16 v[156:157], v103 offset:40960
    s_waitcnt lgkmcnt(11)
    v_mfma_f32_16x16x32_bf16 v[160:163], v[144:147], v[112:115], v[160:163]
    ds_read_b64_tr_b16 v[158:159], v103 offset:41984
    s_waitcnt lgkmcnt(10)
    v_mfma_f32_16x16x32_bf16 v[184:187], v[144:147], v[116:119], v[184:187]
    s_waitcnt lgkmcnt(6)
    v_mfma_f32_16x16x32_bf16 v[208:211], v[144:147], v[120:123], v[208:211]
    s_waitcnt lgkmcnt(4)
    v_mfma_f32_16x16x32_bf16 v[232:235], v[144:147], v[124:127], v[232:235]
    ds_read_b64_tr_b16 v[144:145], v105 offset:40960
    v_mfma_f32_16x16x32_bf16 v[164:167], v[148:151], v[112:115], v[164:167]
    ds_read_b64_tr_b16 v[146:147], v105 offset:41984
    v_mfma_f32_16x16x32_bf16 v[188:191], v[148:151], v[116:119], v[188:191]
    v_mfma_f32_16x16x32_bf16 v[212:215], v[148:151], v[120:123], v[212:215]
    v_mfma_f32_16x16x32_bf16 v[236:239], v[148:151], v[124:127], v[236:239]
    ds_read_b64_tr_b16 v[148:149], v107 offset:40960
    s_waitcnt lgkmcnt(5)
    v_mfma_f32_16x16x32_bf16 v[168:171], v[152:155], v[112:115], v[168:171]
    ds_read_b64_tr_b16 v[150:151], v107 offset:41984
    v_mfma_f32_16x16x32_bf16 v[192:195], v[152:155], v[116:119], v[192:195]
    v_mfma_f32_16x16x32_bf16 v[216:219], v[152:155], v[120:123], v[216:219]
    v_mfma_f32_16x16x32_bf16 v[240:243], v[152:155], v[124:127], v[240:243]
    ds_read_b64_tr_b16 v[152:153], v97 offset:45056
    s_waitcnt lgkmcnt(5)
    v_mfma_f32_16x16x32_bf16 v[172:175], v[156:159], v[112:115], v[172:175]
    ds_read_b64_tr_b16 v[154:155], v97 offset:46080
    v_mfma_f32_16x16x32_bf16 v[196:199], v[156:159], v[116:119], v[196:199]
    ds_read_b64_tr_b16 v[128:129], v111 offset:43008
    ds_read_b64_tr_b16 v[130:131], v111 offset:43520
    v_mfma_f32_16x16x32_bf16 v[220:223], v[156:159], v[120:123], v[220:223]
    ds_read_b64_tr_b16 v[132:133], v111 offset:43024
    ds_read_b64_tr_b16 v[134:135], v111 offset:43536
    v_mfma_f32_16x16x32_bf16 v[244:247], v[156:159], v[124:127], v[244:247]
    ds_read_b64_tr_b16 v[156:157], v99 offset:45056
    s_waitcnt lgkmcnt(9)
    v_mfma_f32_16x16x32_bf16 v[176:179], v[144:147], v[112:115], v[176:179]
    ds_read_b64_tr_b16 v[158:159], v99 offset:46080
    v_mfma_f32_16x16x32_bf16 v[200:203], v[144:147], v[116:119], v[200:203]
    ds_read_b64_tr_b16 v[136:137], v111 offset:47104
    ds_read_b64_tr_b16 v[138:139], v111 offset:47616
    v_mfma_f32_16x16x32_bf16 v[224:227], v[144:147], v[120:123], v[224:227]
    ds_read_b64_tr_b16 v[140:141], v111 offset:47120
    ds_read_b64_tr_b16 v[142:143], v111 offset:47632
    v_mfma_f32_16x16x32_bf16 v[248:251], v[144:147], v[124:127], v[248:251]
    ds_read_b64_tr_b16 v[144:145], v101 offset:45056
    s_waitcnt lgkmcnt(13)
    v_mfma_f32_16x16x32_bf16 v[180:183], v[148:151], v[112:115], v[180:183]
    ds_read_b64_tr_b16 v[146:147], v101 offset:46080
    v_mfma_f32_16x16x32_bf16 v[204:207], v[148:151], v[116:119], v[204:207]
    v_mfma_f32_16x16x32_bf16 v[228:231], v[148:151], v[120:123], v[228:231]
    v_mfma_f32_16x16x32_bf16 v[252:255], v[148:151], v[124:127], v[252:255]
    ds_read_b64_tr_b16 v[148:149], v103 offset:45056
    s_waitcnt lgkmcnt(11)
    v_mfma_f32_16x16x32_bf16 v[160:163], v[152:155], v[128:131], v[160:163]
    ds_read_b64_tr_b16 v[150:151], v103 offset:46080
    s_waitcnt lgkmcnt(10)
    v_mfma_f32_16x16x32_bf16 v[184:187], v[152:155], v[132:135], v[184:187]
    s_waitcnt lgkmcnt(6)
    v_mfma_f32_16x16x32_bf16 v[208:211], v[152:155], v[136:139], v[208:211]
    s_waitcnt lgkmcnt(4)
    v_mfma_f32_16x16x32_bf16 v[232:235], v[152:155], v[140:143], v[232:235]
    ds_read_b64_tr_b16 v[152:153], v105 offset:45056
    v_mfma_f32_16x16x32_bf16 v[164:167], v[156:159], v[128:131], v[164:167]
    ds_read_b64_tr_b16 v[154:155], v105 offset:46080
    v_mfma_f32_16x16x32_bf16 v[188:191], v[156:159], v[132:135], v[188:191]
    v_mfma_f32_16x16x32_bf16 v[212:215], v[156:159], v[136:139], v[212:215]
    v_mfma_f32_16x16x32_bf16 v[236:239], v[156:159], v[140:143], v[236:239]
    ds_read_b64_tr_b16 v[156:157], v107 offset:45056
    s_waitcnt lgkmcnt(5)
    v_mfma_f32_16x16x32_bf16 v[168:171], v[144:147], v[128:131], v[168:171]
    ds_read_b64_tr_b16 v[158:159], v107 offset:46080
    v_mfma_f32_16x16x32_bf16 v[192:195], v[144:147], v[132:135], v[192:195]
    v_mfma_f32_16x16x32_bf16 v[216:219], v[144:147], v[136:139], v[216:219]
    v_mfma_f32_16x16x32_bf16 v[240:243], v[144:147], v[140:143], v[240:243]
    s_barrier
    ds_read_b64_tr_b16 v[144:145], v96 offset:0
    s_waitcnt lgkmcnt(5)
    v_mfma_f32_16x16x32_bf16 v[172:175], v[148:151], v[128:131], v[172:175]
    v_mfma_f32_16x16x32_bf16 v[196:199], v[148:151], v[132:135], v[196:199]
    ds_read_b64_tr_b16 v[112:113], v110 offset:0
    v_mfma_f32_16x16x32_bf16 v[220:223], v[148:151], v[136:139], v[220:223]
    ds_read_b64_tr_b16 v[116:117], v110 offset:16
    v_mfma_f32_16x16x32_bf16 v[244:247], v[148:151], v[140:143], v[244:247]
    ds_read_b64_tr_b16 v[148:149], v98 offset:0
    s_waitcnt lgkmcnt(6)
    v_mfma_f32_16x16x32_bf16 v[176:179], v[152:155], v[128:131], v[176:179]
    v_mfma_f32_16x16x32_bf16 v[200:203], v[152:155], v[132:135], v[200:203]
    ds_read_b64_tr_b16 v[120:121], v110 offset:4096
    v_mfma_f32_16x16x32_bf16 v[224:227], v[152:155], v[136:139], v[224:227]
    ds_read_b64_tr_b16 v[124:125], v110 offset:4112
    v_mfma_f32_16x16x32_bf16 v[248:251], v[152:155], v[140:143], v[248:251]
    ds_read_b64_tr_b16 v[152:153], v100 offset:0
    s_waitcnt lgkmcnt(7)
    v_mfma_f32_16x16x32_bf16 v[180:183], v[156:159], v[128:131], v[180:183]
    v_mfma_f32_16x16x32_bf16 v[204:207], v[156:159], v[132:135], v[204:207]
    v_mfma_f32_16x16x32_bf16 v[228:231], v[156:159], v[136:139], v[228:231]
    v_mfma_f32_16x16x32_bf16 v[252:255], v[156:159], v[140:143], v[252:255]
    ds_read_b64_tr_b16 v[156:157], v102 offset:0
    s_waitcnt lgkmcnt(6)
    v_mfma_f32_16x16x16_bf16 v[160:163], v[144:145], v[112:113], v[160:163]
    s_waitcnt lgkmcnt(5)
    v_mfma_f32_16x16x16_bf16 v[184:187], v[144:145], v[116:117], v[184:187]
    s_waitcnt lgkmcnt(3)
    v_mfma_f32_16x16x16_bf16 v[208:211], v[144:145], v[120:121], v[208:211]
    s_waitcnt lgkmcnt(2)
    v_mfma_f32_16x16x16_bf16 v[232:235], v[144:145], v[124:125], v[232:235]
    ds_read_b64_tr_b16 v[144:145], v104 offset:0
    v_mfma_f32_16x16x16_bf16 v[164:167], v[148:149], v[112:113], v[164:167]
    v_mfma_f32_16x16x16_bf16 v[188:191], v[148:149], v[116:117], v[188:191]
    v_mfma_f32_16x16x16_bf16 v[212:215], v[148:149], v[120:121], v[212:215]
    v_mfma_f32_16x16x16_bf16 v[236:239], v[148:149], v[124:125], v[236:239]
    ds_read_b64_tr_b16 v[148:149], v106 offset:0
    s_waitcnt lgkmcnt(3)
    v_mfma_f32_16x16x16_bf16 v[168:171], v[152:153], v[112:113], v[168:171]
    v_mfma_f32_16x16x16_bf16 v[192:195], v[152:153], v[116:117], v[192:195]
    v_mfma_f32_16x16x16_bf16 v[216:219], v[152:153], v[120:121], v[216:219]
    v_mfma_f32_16x16x16_bf16 v[240:243], v[152:153], v[124:125], v[240:243]
    s_waitcnt lgkmcnt(2)
    v_mfma_f32_16x16x16_bf16 v[172:175], v[156:157], v[112:113], v[172:175]
    v_mfma_f32_16x16x16_bf16 v[196:199], v[156:157], v[116:117], v[196:199]
    v_mfma_f32_16x16x16_bf16 v[220:223], v[156:157], v[120:121], v[220:223]
    v_mfma_f32_16x16x16_bf16 v[244:247], v[156:157], v[124:125], v[244:247]
    s_waitcnt lgkmcnt(1)
    v_mfma_f32_16x16x16_bf16 v[176:179], v[144:145], v[112:113], v[176:179]
    v_mfma_f32_16x16x16_bf16 v[200:203], v[144:145], v[116:117], v[200:203]
    v_mfma_f32_16x16x16_bf16 v[224:227], v[144:145], v[120:121], v[224:227]
    v_mfma_f32_16x16x16_bf16 v[248:251], v[144:145], v[124:125], v[248:251]
    s_waitcnt lgkmcnt(0)
    v_mfma_f32_16x16x16_bf16 v[180:183], v[148:149], v[112:113], v[180:183]
    v_mfma_f32_16x16x16_bf16 v[204:207], v[148:149], v[116:117], v[204:207]
    v_mfma_f32_16x16x16_bf16 v[228:231], v[148:149], v[120:121], v[228:231]
    v_mfma_f32_16x16x16_bf16 v[252:255], v[148:149], v[124:125], v[252:255]
    s_cmp_eq_u32 s55, 1
    s_cbranch_scc1 XV1
    s_cmp_eq_u32 s55, 2
    s_cbranch_scc1 XV2
    s_cmp_eq_u32 s55, 3
    s_cbranch_scc1 XV3
    s_add_u32 s42, s45, 65536
    v_cvt_pk_bf16_f32 v48, v184, v185
    v_cvt_pk_bf16_f32 v49, v186, v187
    v_cvt_pk_bf16_f32 v50, v188, v189
    buffer_store_dwordx4 v[48:51], v15, s[24:27], s42 offen offset:0 sc1
    v_cvt_pk_bf16_f32 v52, v190, v191
    v_cvt_pk_bf16_f32 v53, v192, v193
    v_cvt_pk_bf16_f32 v54, v194, v195
    buffer_store_dwordx4 v[52:55], v15, s[24:27], s42 offen offset:1024 sc1
    v_cvt_pk_bf16_f32 v56, v196, v197
    v_cvt_pk_bf16_f32 v57, v198, v199
    v_cvt_pk_bf16_f32 v58, v200, v201
    buffer_store_dwordx4 v[56:59], v15, s[24:27], s42 offen offset:2048 sc1
    v_cvt_pk_bf16_f32 v60, v202, v203
    v_cvt_pk_bf16_f32 v61, v204, v205
    v_cvt_pk_bf16_f32 v62, v206, v207
    buffer_store_dwordx4 v[60:63], v15, s[24:27], s42 offen offset:3072 sc1
    s_add_u32 s42, s45, 131072
    v_cvt_pk_bf16_f32 v64, v208, v209
    v_cvt_pk_bf16_f32 v65, v210, v211
    v_cvt_pk_bf16_f32 v66, v212, v213
    buffer_store_dwordx4 v[64:67], v15, s[24:27], s42 offen offset:0 sc1
    v_cvt_pk_bf16_f32 v68, v214, v215
    v_cvt_pk_bf16_f32 v69, v216, v217
    v_cvt_pk_bf16_f32 v70, v218, v219
    buffer_store_dwordx4 v[68:71], v15, s[24:27], s42 offen offset:1024 sc1
    v_cvt_pk_bf16_f32 v72, v220, v221
    v_cvt_pk_bf16_f32 v73, v222, v223
    v_cvt_pk_bf16_f32 v74, v224, v225
    buffer_store_dwordx4 v[72:75], v15, s[24:27], s42 offen offset:2048 sc1
    v_cvt_pk_bf16_f32 v76, v226, v227
    v_cvt_pk_bf16_f32 v77, v228, v229
    v_cvt_pk_bf16_f32 v78, v230, v231
    buffer_store_dwordx4 v[76:79], v15, s[24:27], s42 offen offset:3072 sc1
    s_add_u32 s42, s45, 196608
    v_cvt_pk_bf16_f32 v80, v232, v233
    v_cvt_pk_bf16_f32 v81, v234, v235
    v_cvt_pk_bf16_f32 v82, v236, v237
    buffer_store_dwordx4 v[80:83], v15, s[24:27], s42 offen offset:0 sc1
    v_cvt_pk_bf16_f32 v84, v238, v239
    v_cvt_pk_bf16_f32 v85, v240, v241
    v_cvt_pk_bf16_f32 v86, v242, v243
    buffer_store_dwordx4 v[84:87], v15, s[24:27], s42 offen offset:1024 sc1
    v_cvt_pk_bf16_f32 v88, v244, v245
    v_cvt_pk_bf16_f32 v89, v246, v247
    v_cvt_pk_bf16_f32 v90, v248, v249
    buffer_store_dwordx4 v[88:91], v15, s[24:27], s42 offen offset:2048 sc1
    v_cvt_pk_bf16_f32 v92, v250, v251
    v_cvt_pk_bf16_f32 v93, v252, v253
    v_cvt_pk_bf16_f32 v94, v254, v255
    buffer_store_dwordx4 v[92:95], v15, s[24:27], s42 offen offset:3072 sc1
    s_add_u32 s50, s46, 16384
    buffer_load_dwordx4 v[96:99], v15, s[24:27], s50 offen offset:0 sc1
    buffer_load_dwordx4 v[100:103], v15, s[24:27], s50 offen offset:1024 sc1
    buffer_load_dwordx4 v[104:107], v15, s[24:27], s50 offen offset:2048 sc1
    buffer_load_dwordx4 v[108:111], v15, s[24:27], s50 offen offset:3072 sc1
    s_add_u32 s51, s46, 32768
    buffer_load_dwordx4 v[112:115], v15, s[24:27], s51 offen offset:0 sc1
    buffer_load_dwordx4 v[116:119], v15, s[24:27], s51 offen offset:1024 sc1
    buffer_load_dwordx4 v[120:123], v15, s[24:27], s51 offen offset:2048 sc1
    buffer_load_dwordx4 v[124:127], v15, s[24:27], s51 offen offset:3072 sc1
    s_add_u32 s52, s46, 49152
    buffer_load_dwordx4 v[128:131], v15, s[24:27], s52 offen offset:0 sc1
    buffer_load_dwordx4 v[132:135], v15, s[24:27], s52 offen offset:1024 sc1
    buffer_load_dwordx4 v[136:139], v15, s[24:27], s52 offen offset:2048 sc1
    buffer_load_dwordx4 v[140:143], v15, s[24:27], s52 offen offset:3072 sc1
    s_waitcnt vmcnt(8)
    v_xor_b32 v16, v51, v99
    v_xor_b32 v17, v51, v103
    v_xor_b32 v18, v51, v107
    v_xor_b32 v19, v51, v111
    v_or3_b32 v16, v16, v17, v18
    v_or_b32 v16, v16, v19
    v_cmp_eq_u32 vcc, 0, v16
    s_nop 0
    s_cmp_eq_u64 vcc, -1
    s_cbranch_scc1 XOK2
s_mov_b32 s53, 0
XSP2:
 s_sleep 1
 buffer_load_dwordx4 v[96:99], v15, s[24:27], s50 offen offset:0 sc1
 buffer_load_dwordx4 v[100:103], v15, s[24:27], s50 offen offset:1024 sc1
 buffer_load_dwordx4 v[104:107], v15, s[24:27], s50 offen offset:2048 sc1
 buffer_load_dwordx4 v[108:111], v15, s[24:27], s50 offen offset:3072 sc1
 s_add_u32 s53, s53, 1
 s_waitcnt vmcnt(0)
 v_xor_b32 v16, v51, v99
 v_xor_b32 v17, v51, v103
 v_xor_b32 v18, v51, v107
 v_xor_b32 v19, v51, v111
 v_or3_b32 v16, v16, v17, v18
 v_or_b32 v16, v16, v19
 v_cmp_eq_u32 vcc, 0, v16
 s_cmp_ge_u32 s53, 0x40000
 s_cbranch_scc1 XOK2
 s_nop 1
 s_cmp_eq_u64 vcc, -1
 s_cbranch_scc0 XSP2
XOK2:
    v_lshlrev_b32 v16, 16, v96
    v_and_b32 v17, 0xffff0000, v96
    v_add_f32 v160, v160, v16
    v_add_f32 v161, v161, v17
    v_lshlrev_b32 v18, 16, v97
    v_and_b32 v19, 0xffff0000, v97
    v_add_f32 v162, v162, v18
    v_add_f32 v163, v163, v19
    v_lshlrev_b32 v20, 16, v98
    v_and_b32 v21, 0xffff0000, v98
    v_add_f32 v164, v164, v20
    v_add_f32 v165, v165, v21
    v_lshlrev_b32 v22, 16, v100
    v_and_b32 v23, 0xffff0000, v100
    v_add_f32 v166, v166, v22
    v_add_f32 v167, v167, v23
    v_lshlrev_b32 v16, 16, v101
    v_and_b32 v17, 0xffff0000, v101
    v_add_f32 v168, v168, v16
    v_add_f32 v169, v169, v17
    v_lshlrev_b32 v18, 16, v102
    v_and_b32 v19, 0xffff0000, v102
    v_add_f32 v170, v170, v18
    v_add_f32 v171, v171, v19
    v_lshlrev_b32 v20, 16, v104
    v_and_b32 v21, 0xffff0000, v104
    v_add_f32 v172, v172, v20
    v_add_f32 v173, v173, v21
    v_lshlrev_b32 v22, 16, v105
    v_and_b32 v23, 0xffff0000, v105
    v_add_f32 v174, v174, v22
    v_add_f32 v175, v175, v23
    v_lshlrev_b32 v16, 16, v106
    v_and_b32 v17, 0xffff0000, v106
    v_add_f32 v176, v176, v16
    v_add_f32 v177, v177, v17
    v_lshlrev_b32 v18, 16, v108
    v_and_b32 v19, 0xffff0000, v108
    v_add_f32 v178, v178, v18
    v_add_f32 v179, v179, v19
    v_lshlrev_b32 v20, 16, v109
    v_and_b32 v21, 0xffff0000, v109
    v_add_f32 v180, v180, v20
    v_add_f32 v181, v181, v21
    v_lshlrev_b32 v22, 16, v110
    v_and_b32 v23, 0xffff0000, v110
    v_add_f32 v182, v182, v22
    v_add_f32 v183, v183, v23
    s_waitcnt vmcnt(4)
    v_xor_b32 v16, v51, v115
    v_xor_b32 v17, v51, v119
    v_xor_b32 v18, v51, v123
    v_xor_b32 v19, v51, v127
    v_or3_b32 v16, v16, v17, v18
    v_or_b32 v16, v16, v19
    v_cmp_eq_u32 vcc, 0, v16
    s_nop 0
    s_cmp_eq_u64 vcc, -1
    s_cbranch_scc1 XOK3
s_mov_b32 s53, 0
XSP3:
 s_sleep 1
 buffer_load_dwordx4 v[112:115], v15, s[24:27], s51 offen offset:0 sc1
 buffer_load_dwordx4 v[116:119], v15, s[24:27], s51 offen offset:1024 sc1
 buffer_load_dwordx4 v[120:123], v15, s[24:27], s51 offen offset:2048 sc1
 buffer_load_dwordx4 v[124:127], v15, s[24:27], s51 offen offset:3072 sc1
 s_add_u32 s53, s53, 1
 s_waitcnt vmcnt(0)
 v_xor_b32 v16, v51, v115
 v_xor_b32 v17, v51, v119
 v_xor_b32 v18, v51, v123
 v_xor_b32 v19, v51, v127
 v_or3_b32 v16, v16, v17, v18
 v_or_b32 v16, v16, v19
 v_cmp_eq_u32 vcc, 0, v16
 s_cmp_ge_u32 s53, 0x40000
 s_cbranch_scc1 XOK3
 s_nop 1
 s_cmp_eq_u64 vcc, -1
 s_cbranch_scc0 XSP3
XOK3:
    v_lshlrev_b32 v16, 16, v112
    v_and_b32 v17, 0xffff0000, v112
    v_add_f32 v160, v160, v16
    v_add_f32 v161, v161, v17
    v_lshlrev_b32 v18, 16, v113
    v_and_b32 v19, 0xffff0000, v113
    v_add_f32 v162, v162, v18
    v_add_f32 v163, v163, v19
    v_lshlrev_b32 v20, 16, v114
    v_and_b32 v21, 0xffff0000, v114
    v_add_f32 v164, v164, v20
    v_add_f32 v165, v165, v21
    v_lshlrev_b32 v22, 16, v116
    v_and_b32 v23, 0xffff0000, v116
    v_add_f32 v166, v166, v22
    v_add_f32 v167, v167, v23
    v_lshlrev_b32 v16, 16, v117
    v_and_b32 v17, 0xffff0000, v117
    v_add_f32 v168, v168, v16
    v_add_f32 v169, v169, v17
    v_lshlrev_b32 v18, 16, v118
    v_and_b32 v19, 0xffff0000, v118
    v_add_f32 v170, v170, v18
    v_add_f32 v171, v171, v19
    v_lshlrev_b32 v20, 16, v120
    v_and_b32 v21, 0xffff0000, v120
    v_add_f32 v172, v172, v20
    v_add_f32 v173, v173, v21
    v_lshlrev_b32 v22, 16, v121
    v_and_b32 v23, 0xffff0000, v121
    v_add_f32 v174, v174, v22
    v_add_f32 v175, v175, v23
    v_lshlrev_b32 v16, 16, v122
    v_and_b32 v17, 0xffff0000, v122
    v_add_f32 v176, v176, v16
    v_add_f32 v177, v177, v17
    v_lshlrev_b32 v18, 16, v124
    v_and_b32 v19, 0xffff0000, v124
    v_add_f32 v178, v178, v18
    v_add_f32 v179, v179, v19
    v_lshlrev_b32 v20, 16, v125
    v_and_b32 v21, 0xffff0000, v125
    v_add_f32 v180, v180, v20
    v_add_f32 v181, v181, v21
    v_lshlrev_b32 v22, 16, v126
    v_and_b32 v23, 0xffff0000, v126
    v_add_f32 v182, v182, v22
    v_add_f32 v183, v183, v23
    s_waitcnt vmcnt(0)
    v_xor_b32 v16, v51, v131
    v_xor_b32 v17, v51, v135
    v_xor_b32 v18, v51, v139
    v_xor_b32 v19, v51, v143
    v_or3_b32 v16, v16, v17, v18
    v_or_b32 v16, v16, v19
    v_cmp_eq_u32 vcc, 0, v16
    s_nop 0
    s_cmp_eq_u64 vcc, -1
    s_cbranch_scc1 XOK4
s_mov_b32 s53, 0
XSP4:
 s_sleep 1
 buffer_load_dwordx4 v[128:131], v15, s[24:27], s52 offen offset:0 sc1
 buffer_load_dwordx4 v[132:135], v15, s[24:27], s52 offen offset:1024 sc1
 buffer_load_dwordx4 v[136:139], v15, s[24:27], s52 offen offset:2048 sc1
 buffer_load_dwordx4 v[140:143], v15, s[24:27], s52 offen offset:3072 sc1
 s_add_u32 s53, s53, 1
 s_waitcnt vmcnt(0)
 v_xor_b32 v16, v51, v131
 v_xor_b32 v17, v51, v135
 v_xor_b32 v18, v51, v139
 v_xor_b32 v19, v51, v143
 v_or3_b32 v16, v16, v17, v18
 v_or_b32 v16, v16, v19
 v_cmp_eq_u32 vcc, 0, v16
 s_cmp_ge_u32 s53, 0x40000
 s_cbranch_scc1 XOK4
 s_nop 1
 s_cmp_eq_u64 vcc, -1
 s_cbranch_scc0 XSP4
XOK4:
    v_lshlrev_b32 v16, 16, v128
    v_and_b32 v17, 0xffff0000, v128
    v_add_f32 v160, v160, v16
    v_add_f32 v161, v161, v17
    v_lshlrev_b32 v18, 16, v129
    v_and_b32 v19, 0xffff0000, v129
    v_add_f32 v162, v162, v18
    v_add_f32 v163, v163, v19
    v_lshlrev_b32 v20, 16, v130
    v_and_b32 v21, 0xffff0000, v130
    v_add_f32 v164, v164, v20
    v_add_f32 v165, v165, v21
    v_lshlrev_b32 v22, 16, v132
    v_and_b32 v23, 0xffff0000, v132
    v_add_f32 v166, v166, v22
    v_add_f32 v167, v167, v23
    v_cvt_pk_bf16_f32 v32, v160, v161
    v_cvt_pk_bf16_f32 v33, v162, v163
    v_cvt_pk_bf16_f32 v34, v164, v165
    v_cvt_pk_bf16_f32 v35, v166, v167
    s_nop 0
    v_permlane16_swap_b32 v32, v34
    v_permlane16_swap_b32 v33, v35
    buffer_store_dwordx4 v[32:35], v7, s[20:23], s48 offen offset:0
    v_lshlrev_b32 v16, 16, v133
    v_and_b32 v17, 0xffff0000, v133
    v_add_f32 v168, v168, v16
    v_add_f32 v169, v169, v17
    v_lshlrev_b32 v18, 16, v134
    v_and_b32 v19, 0xffff0000, v134
    v_add_f32 v170, v170, v18
    v_add_f32 v171, v171, v19
    v_lshlrev_b32 v20, 16, v136
    v_and_b32 v21, 0xffff0000, v136
    v_add_f32 v172, v172, v20
    v_add_f32 v173, v173, v21
    v_lshlrev_b32 v22, 16, v137
    v_and_b32 v23, 0xffff0000, v137
    v_add_f32 v174, v174, v22
    v_add_f32 v175, v175, v23
    v_cvt_pk_bf16_f32 v36, v168, v169
    v_cvt_pk_bf16_f32 v37, v170, v171
    v_cvt_pk_bf16_f32 v38, v172, v173
    v_cvt_pk_bf16_f32 v39, v174, v175
    s_nop 0
    v_permlane16_swap_b32 v36, v38
    v_permlane16_swap_b32 v37, v39
    buffer_store_dwordx4 v[36:39], v7, s[20:23], s48 offen offset:64
    v_lshlrev_b32 v16, 16, v138
    v_and_b32 v17, 0xffff0000, v138
    v_add_f32 v176, v176, v16
    v_add_f32 v177, v177, v17
    v_lshlrev_b32 v18, 16, v140
    v_and_b32 v19, 0xffff0000, v140
    v_add_f32 v178, v178, v18
    v_add_f32 v179, v179, v19
    v_lshlrev_b32 v20, 16, v141
    v_and_b32 v21, 0xffff0000, v141
    v_add_f32 v180, v180, v20
    v_add_f32 v181, v181, v21
    v_lshlrev_b32 v22, 16, v142
    v_and_b32 v23, 0xffff0000, v142
    v_add_f32 v182, v182, v22
    v_add_f32 v183, v183, v23
    v_cvt_pk_bf16_f32 v40, v176, v177
    v_cvt_pk_bf16_f32 v41, v178, v179
    v_cvt_pk_bf16_f32 v42, v180, v181
    v_cvt_pk_bf16_f32 v43, v182, v183
    s_nop 0
    v_permlane16_swap_b32 v40, v42
    v_permlane16_swap_b32 v41, v43
    buffer_store_dwordx4 v[40:43], v7, s[20:23], s48 offen offset:128
    s_endpgm
XV1:
    s_add_u32 s42, s45, 0
    v_cvt_pk_bf16_f32 v48, v160, v161
    v_cvt_pk_bf16_f32 v49, v162, v163
    v_cvt_pk_bf16_f32 v50, v164, v165
    buffer_store_dwordx4 v[48:51], v15, s[24:27], s42 offen offset:0 sc1
    v_cvt_pk_bf16_f32 v52, v166, v167
    v_cvt_pk_bf16_f32 v53, v168, v169
    v_cvt_pk_bf16_f32 v54, v170, v171
    buffer_store_dwordx4 v[52:55], v15, s[24:27], s42 offen offset:1024 sc1
    v_cvt_pk_bf16_f32 v56, v172, v173
    v_cvt_pk_bf16_f32 v57, v174, v175
    v_cvt_pk_bf16_f32 v58, v176, v177
    buffer_store_dwordx4 v[56:59], v15, s[24:27], s42 offen offset:2048 sc1
    v_cvt_pk_bf16_f32 v60, v178, v179
    v_cvt_pk_bf16_f32 v61, v180, v181
    v_cvt_pk_bf16_f32 v62, v182, v183
    buffer_store_dwordx4 v[60:63], v15, s[24:27], s42 offen offset:3072 sc1
    s_add_u32 s42, s45, 131072
    v_cvt_pk_bf16_f32 v64, v208, v209
    v_cvt_pk_bf16_f32 v65, v210, v211
    v_cvt_pk_bf16_f32 v66, v212, v213
    buffer_store_dwordx4 v[64:67], v15, s[24:27], s42 offen offset:0 sc1
    v_cvt_pk_bf16_f32 v68, v214, v215
    v_cvt_pk_bf16_f32 v69, v216, v217
    v_cvt_pk_bf16_f32 v70, v218, v219
    buffer_store_dwordx4 v[68:71], v15, s[24:27], s42 offen offset:1024 sc1
    v_cvt_pk_bf16_f32 v72, v220, v221
    v_cvt_pk_bf16_f32 v73, v222, v223
    v_cvt_pk_bf16_f32 v74, v224, v225
    buffer_store_dwordx4 v[72:75], v15, s[24:27], s42 offen offset:2048 sc1
    v_cvt_pk_bf16_f32 v76, v226, v227
    v_cvt_pk_bf16_f32 v77, v228, v229
    v_cvt_pk_bf16_f32 v78, v230, v231
    buffer_store_dwordx4 v[76:79], v15, s[24:27], s42 offen offset:3072 sc1
    s_add_u32 s42, s45, 196608
    v_cvt_pk_bf16_f32 v80, v232, v233
    v_cvt_pk_bf16_f32 v81, v234, v235
    v_cvt_pk_bf16_f32 v82, v236, v237
    buffer_store_dwordx4 v[80:83], v15, s[24:27], s42 offen offset:0 sc1
    v_cvt_pk_bf16_f32 v84, v238, v239
    v_cvt_pk_bf16_f32 v85, v240, v241
    v_cvt_pk_bf16_f32 v86, v242, v243
    buffer_store_dwordx4 v[84:87], v15, s[24:27], s42 offen offset:1024 sc1
    v_cvt_pk_bf16_f32 v88, v244, v245
    v_cvt_pk_bf16_f32 v89, v246, v247
    v_cvt_pk_bf16_f32 v90, v248, v249
    buffer_store_dwordx4 v[88:91], v15, s[24:27], s42 offen offset:2048 sc1
    v_cvt_pk_bf16_f32 v92, v250, v251
    v_cvt_pk_bf16_f32 v93, v252, v253
    v_cvt_pk_bf16_f32 v94, v254, v255
    buffer_store_dwordx4 v[92:95], v15, s[24:27], s42 offen offset:3072 sc1
    s_add_u32 s50, s46, 0
    buffer_load_dwordx4 v[96:99], v15, s[24:27], s50 offen offset:0 sc1
    buffer_load_dwordx4 v[100:103], v15, s[24:27], s50 offen offset:1024 sc1
    buffer_load_dwordx4 v[104:107], v15, s[24:27], s50 offen offset:2048 sc1
    buffer_load_dwordx4 v[108:111], v15, s[24:27], s50 offen offset:3072 sc1
    s_add_u32 s51, s46, 32768
    buffer_load_dwordx4 v[112:115], v15, s[24:27], s51 offen offset:0 sc1
    buffer_load_dwordx4 v[116:119], v15, s[24:27], s51 offen offset:1024 sc1
    buffer_load_dwordx4 v[120:123], v15, s[24:27], s51 offen offset:2048 sc1
    buffer_load_dwordx4 v[124:127], v15, s[24:27], s51 offen offset:3072 sc1
    s_add_u32 s52, s46, 49152
    buffer_load_dwordx4 v[128:131], v15, s[24:27], s52 offen offset:0 sc1
    buffer_load_dwordx4 v[132:135], v15, s[24:27], s52 offen offset:1024 sc1
    buffer_load_dwordx4 v[136:139], v15, s[24:27], s52 offen offset:2048 sc1
    buffer_load_dwordx4 v[140:143], v15, s[24:27], s52 offen offset:3072 sc1
    s_waitcnt vmcnt(8)
    v_xor_b32 v16, v51, v99
    v_xor_b32 v17, v51, v103
    v_xor_b32 v18, v51, v107
    v_xor_b32 v19, v51, v111
    v_or3_b32 v16, v16, v17, v18
    v_or_b32 v16, v16, v19
    v_cmp_eq_u32 vcc, 0, v16
    s_nop 0
    s_cmp_eq_u64 vcc, -1
    s_cbranch_scc1 XOK5
s_mov_b32 s53, 0
XSP5:
 s_sleep 1
 buffer_load_dwordx4 v[96:99], v15, s[24:27], s50 offen offset:0 sc1
 buffer_load_dwordx4 v[100:103], v15, s[24:27], s50 offen offset:1024 sc1
 buffer_load_dwordx4 v[104:107], v15, s[24:27], s50 offen offset:2048 sc1
 buffer_load_dwordx4 v[108:111], v15, s[24:27], s50 offen offset:3072 sc1
 s_add_u32 s53, s53, 1
 s_waitcnt vmcnt(0)
 v_xor_b32 v16, v51, v99
 v_xor_b32 v17, v51, v103
 v_xor_b32 v18, v51, v107
 v_xor_b32 v19, v51, v111
 v_or3_b32 v16, v16, v17, v18
 v_or_b32 v16, v16, v19
 v_cmp_eq_u32 vcc, 0, v16
 s_cmp_ge_u32 s53, 0x40000
 s_cbranch_scc1 XOK5
 s_nop 1
 s_cmp_eq_u64 vcc, -1
 s_cbranch_scc0 XSP5
XOK5:
    v_lshlrev_b32 v16, 16, v96
    v_and_b32 v17, 0xffff0000, v96
    v_add_f32 v184, v184, v16
    v_add_f32 v185, v185, v17
    v_lshlrev_b32 v18, 16, v97
    v_and_b32 v19, 0xffff0000, v97
    v_add_f32 v186, v186, v18
    v_add_f32 v187, v187, v19
    v_lshlrev_b32 v20, 16, v98
    v_and_b32 v21, 0xffff0000, v98
    v_add_f32 v188, v188, v20
    v_add_f32 v189, v189, v21
    v_lshlrev_b32 v22, 16, v100
    v_and_b32 v23, 0xffff0000, v100
    v_add_f32 v190, v190, v22
    v_add_f32 v191, v191, v23
    v_lshlrev_b32 v16, 16, v101
    v_and_b32 v17, 0xffff0000, v101
    v_add_f32 v192, v192, v16
    v_add_f32 v193, v193, v17
    v_lshlrev_b32 v18, 16, v102
    v_and_b32 v19, 0xffff0000, v102
    v_add_f32 v194, v194, v18
    v_add_f32 v195, v195, v19
    v_lshlrev_b32 v20, 16, v104
    v_and_b32 v21, 0xffff0000, v104
    v_add_f32 v196, v196, v20
    v_add_f32 v197, v197, v21
    v_lshlrev_b32 v22, 16, v105
    v_and_b32 v23, 0xffff0000, v105
    v_add_f32 v198, v198, v22
    v_add_f32 v199, v199, v23
    v_lshlrev_b32 v16, 16, v106
    v_and_b32 v17, 0xffff0000, v106
    v_add_f32 v200, v200, v16
    v_add_f32 v201, v201, v17
    v_lshlrev_b32 v18, 16, v108
    v_and_b32 v19, 0xffff0000, v108
    v_add_f32 v202, v202, v18
    v_add_f32 v203, v203, v19
    v_lshlrev_b32 v20, 16, v109
    v_and_b32 v21, 0xffff0000, v109
    v_add_f32 v204, v204, v20
    v_add_f32 v205, v205, v21
    v_lshlrev_b32 v22, 16, v110
    v_and_b32 v23, 0xffff0000, v110
    v_add_f32 v206, v206, v22
    v_add_f32 v207, v207, v23
    s_waitcnt vmcnt(4)
    v_xor_b32 v16, v51, v115
    v_xor_b32 v17, v51, v119
    v_xor_b32 v18, v51, v123
    v_xor_b32 v19, v51, v127
    v_or3_b32 v16, v16, v17, v18
    v_or_b32 v16, v16, v19
    v_cmp_eq_u32 vcc, 0, v16
    s_nop 0
    s_cmp_eq_u64 vcc, -1
    s_cbranch_scc1 XOK6
s_mov_b32 s53, 0
XSP6:
 s_sleep 1
 buffer_load_dwordx4 v[112:115], v15, s[24:27], s51 offen offset:0 sc1
 buffer_load_dwordx4 v[116:119], v15, s[24:27], s51 offen offset:1024 sc1
 buffer_load_dwordx4 v[120:123], v15, s[24:27], s51 offen offset:2048 sc1
 buffer_load_dwordx4 v[124:127], v15, s[24:27], s51 offen offset:3072 sc1
 s_add_u32 s53, s53, 1
 s_waitcnt vmcnt(0)
 v_xor_b32 v16, v51, v115
 v_xor_b32 v17, v51, v119
 v_xor_b32 v18, v51, v123
 v_xor_b32 v19, v51, v127
 v_or3_b32 v16, v16, v17, v18
 v_or_b32 v16, v16, v19
 v_cmp_eq_u32 vcc, 0, v16
 s_cmp_ge_u32 s53, 0x40000
 s_cbranch_scc1 XOK6
 s_nop 1
 s_cmp_eq_u64 vcc, -1
 s_cbranch_scc0 XSP6
XOK6:
    v_lshlrev_b32 v16, 16, v112
    v_and_b32 v17, 0xffff0000, v112
    v_add_f32 v184, v184, v16
    v_add_f32 v185, v185, v17
    v_lshlrev_b32 v18, 16, v113
    v_and_b32 v19, 0xffff0000, v113
    v_add_f32 v186, v186, v18
    v_add_f32 v187, v187, v19
    v_lshlrev_b32 v20, 16, v114
    v_and_b32 v21, 0xffff0000, v114
    v_add_f32 v188, v188, v20
    v_add_f32 v189, v189, v21
    v_lshlrev_b32 v22, 16, v116
    v_and_b32 v23, 0xffff0000, v116
    v_add_f32 v190, v190, v22
    v_add_f32 v191, v191, v23
    v_lshlrev_b32 v16, 16, v117
    v_and_b32 v17, 0xffff0000, v117
    v_add_f32 v192, v192, v16
    v_add_f32 v193, v193, v17
    v_lshlrev_b32 v18, 16, v118
    v_and_b32 v19, 0xffff0000, v118
    v_add_f32 v194, v194, v18
    v_add_f32 v195, v195, v19
    v_lshlrev_b32 v20, 16, v120
    v_and_b32 v21, 0xffff0000, v120
    v_add_f32 v196, v196, v20
    v_add_f32 v197, v197, v21
    v_lshlrev_b32 v22, 16, v121
    v_and_b32 v23, 0xffff0000, v121
    v_add_f32 v198, v198, v22
    v_add_f32 v199, v199, v23
    v_lshlrev_b32 v16, 16, v122
    v_and_b32 v17, 0xffff0000, v122
    v_add_f32 v200, v200, v16
    v_add_f32 v201, v201, v17
    v_lshlrev_b32 v18, 16, v124
    v_and_b32 v19, 0xffff0000, v124
    v_add_f32 v202, v202, v18
    v_add_f32 v203, v203, v19
    v_lshlrev_b32 v20, 16, v125
    v_and_b32 v21, 0xffff0000, v125
    v_add_f32 v204, v204, v20
    v_add_f32 v205, v205, v21
    v_lshlrev_b32 v22, 16, v126
    v_and_b32 v23, 0xffff0000, v126
    v_add_f32 v206, v206, v22
    v_add_f32 v207, v207, v23
    s_waitcnt vmcnt(0)
    v_xor_b32 v16, v51, v131
    v_xor_b32 v17, v51, v135
    v_xor_b32 v18, v51, v139
    v_xor_b32 v19, v51, v143
    v_or3_b32 v16, v16, v17, v18
    v_or_b32 v16, v16, v19
    v_cmp_eq_u32 vcc, 0, v16
    s_nop 0
    s_cmp_eq_u64 vcc, -1
    s_cbranch_scc1 XOK7
s_mov_b32 s53, 0
XSP7:
 s_sleep 1
 buffer_load_dwordx4 v[128:131], v15, s[24:27], s52 offen offset:0 sc1
 buffer_load_dwordx4 v[132:135], v15, s[24:27], s52 offen offset:1024 sc1
 buffer_load_dwordx4 v[136:139], v15, s[24:27], s52 offen offset:2048 sc1
 buffer_load_dwordx4 v[140:143], v15, s[24:27], s52 offen offset:3072 sc1
 s_add_u32 s53, s53, 1
 s_waitcnt vmcnt(0)
 v_xor_b32 v16, v51, v131
 v_xor_b32 v17, v51, v135
 v_xor_b32 v18, v51, v139
 v_xor_b32 v19, v51, v143
 v_or3_b32 v16, v16, v17, v18
 v_or_b32 v16, v16, v19
 v_cmp_eq_u32 vcc, 0, v16
 s_cmp_ge_u32 s53, 0x40000
 s_cbranch_scc1 XOK7
 s_nop 1
 s_cmp_eq_u64 vcc, -1
 s_cbranch_scc0 XSP7
XOK7:
    v_lshlrev_b32 v16, 16, v128
    v_and_b32 v17, 0xffff0000, v128
    v_add_f32 v184, v184, v16
    v_add_f32 v185, v185, v17
    v_lshlrev_b32 v18, 16, v129
    v_and_b32 v19, 0xffff0000, v129
    v_add_f32 v186, v186, v18
    v_add_f32 v187, v187, v19
    v_lshlrev_b32 v20, 16, v130
    v_and_b32 v21, 0xffff0000, v130
    v_add_f32 v188, v188, v20
    v_add_f32 v189, v189, v21
    v_lshlrev_b32 v22, 16, v132
    v_and_b32 v23, 0xffff0000, v132
    v_add_f32 v190, v190, v22
    v_add_f32 v191, v191, v23
    v_cvt_pk_bf16_f32 v32, v184, v185
    v_cvt_pk_bf16_f32 v33, v186, v187
    v_cvt_pk_bf16_f32 v34, v188, v189
    v_cvt_pk_bf16_f32 v35, v190, v191
    s_nop 0
    v_permlane16_swap_b32 v32, v34
    v_permlane16_swap_b32 v33, v35
    buffer_store_dwordx4 v[32:35], v7, s[20:23], s48 offen offset:0
    v_lshlrev_b32 v16, 16, v133
    v_and_b32 v17, 0xffff0000, v133
    v_add_f32 v192, v192, v16
    v_add_f32 v193, v193, v17
    v_lshlrev_b32 v18, 16, v134
    v_and_b32 v19, 0xffff0000, v134
    v_add_f32 v194, v194, v18
    v_add_f32 v195, v195, v19
    v_lshlrev_b32 v20, 16, v136
    v_and_b32 v21, 0xffff0000, v136
    v_add_f32 v196, v196, v20
    v_add_f32 v197, v197, v21
    v_lshlrev_b32 v22, 16, v137
    v_and_b32 v23, 0xffff0000, v137
    v_add_f32 v198, v198, v22
    v_add_f32 v199, v199, v23
    v_cvt_pk_bf16_f32 v36, v192, v193
    v_cvt_pk_bf16_f32 v37, v194, v195
    v_cvt_pk_bf16_f32 v38, v196, v197
    v_cvt_pk_bf16_f32 v39, v198, v199
    s_nop 0
    v_permlane16_swap_b32 v36, v38
    v_permlane16_swap_b32 v37, v39
    buffer_store_dwordx4 v[36:39], v7, s[20:23], s48 offen offset:64
    v_lshlrev_b32 v16, 16, v138
    v_and_b32 v17, 0xffff0000, v138
    v_add_f32 v200, v200, v16
    v_add_f32 v201, v201, v17
    v_lshlrev_b32 v18, 16, v140
    v_and_b32 v19, 0xffff0000, v140
    v_add_f32 v202, v202, v18
    v_add_f32 v203, v203, v19
    v_lshlrev_b32 v20, 16, v141
    v_and_b32 v21, 0xffff0000, v141
    v_add_f32 v204, v204, v20
    v_add_f32 v205, v205, v21
    v_lshlrev_b32 v22, 16, v142
    v_and_b32 v23, 0xffff0000, v142
    v_add_f32 v206, v206, v22
    v_add_f32 v207, v207, v23
    v_cvt_pk_bf16_f32 v40, v200, v201
    v_cvt_pk_bf16_f32 v41, v202, v203
    v_cvt_pk_bf16_f32 v42, v204, v205
    v_cvt_pk_bf16_f32 v43, v206, v207
    s_nop 0
    v_permlane16_swap_b32 v40, v42
    v_permlane16_swap_b32 v41, v43
    buffer_store_dwordx4 v[40:43], v7, s[20:23], s48 offen offset:128
    s_endpgm
XV2:
    s_add_u32 s42, s45, 0
    v_cvt_pk_bf16_f32 v48, v160, v161
    v_cvt_pk_bf16_f32 v49, v162, v163
    v_cvt_pk_bf16_f32 v50, v164, v165
    buffer_store_dwordx4 v[48:51], v15, s[24:27], s42 offen offset:0 sc1
    v_cvt_pk_bf16_f32 v52, v166, v167
    v_cvt_pk_bf16_f32 v53, v168, v169
    v_cvt_pk_bf16_f32 v54, v170, v171
    buffer_store_dwordx4 v[52:55], v15, s[24:27], s42 offen offset:1024 sc1
    v_cvt_pk_bf16_f32 v56, v172, v173
    v_cvt_pk_bf16_f32 v57, v174, v175
    v_cvt_pk_bf16_f32 v58, v176, v177
    buffer_store_dwordx4 v[56:59], v15, s[24:27], s42 offen offset:2048 sc1
    v_cvt_pk_bf16_f32 v60, v178, v179
    v_cvt_pk_bf16_f32 v61, v180, v181
    v_cvt_pk_bf16_f32 v62, v182, v183
    buffer_store_dwordx4 v[60:63], v15, s[24:27], s42 offen offset:3072 sc1
    s_add_u32 s42, s45, 65536
    v_cvt_pk_bf16_f32 v64, v184, v185
    v_cvt_pk_bf16_f32 v65, v186, v187
    v_cvt_pk_bf16_f32 v66, v188, v189
    buffer_store_dwordx4 v[64:67], v15, s[24:27], s42 offen offset:0 sc1
    v_cvt_pk_bf16_f32 v68, v190, v191
    v_cvt_pk_bf16_f32 v69, v192, v193
    v_cvt_pk_bf16_f32 v70, v194, v195
    buffer_store_dwordx4 v[68:71], v15, s[24:27], s42 offen offset:1024 sc1
    v_cvt_pk_bf16_f32 v72, v196, v197
    v_cvt_pk_bf16_f32 v73, v198, v199
    v_cvt_pk_bf16_f32 v74, v200, v201
    buffer_store_dwordx4 v[72:75], v15, s[24:27], s42 offen offset:2048 sc1
    v_cvt_pk_bf16_f32 v76, v202, v203
    v_cvt_pk_bf16_f32 v77, v204, v205
    v_cvt_pk_bf16_f32 v78, v206, v207
    buffer_store_dwordx4 v[76:79], v15, s[24:27], s42 offen offset:3072 sc1
    s_add_u32 s42, s45, 196608
    v_cvt_pk_bf16_f32 v80, v232, v233
    v_cvt_pk_bf16_f32 v81, v234, v235
    v_cvt_pk_bf16_f32 v82, v236, v237
    buffer_store_dwordx4 v[80:83], v15, s[24:27], s42 offen offset:0 sc1
    v_cvt_pk_bf16_f32 v84, v238, v239
    v_cvt_pk_bf16_f32 v85, v240, v241
    v_cvt_pk_bf16_f32 v86, v242, v243
    buffer_store_dwordx4 v[84:87], v15, s[24:27], s42 offen offset:1024 sc1
    v_cvt_pk_bf16_f32 v88, v244, v245
    v_cvt_pk_bf16_f32 v89, v246, v247
    v_cvt_pk_bf16_f32 v90, v248, v249
    buffer_store_dwordx4 v[88:91], v15, s[24:27], s42 offen offset:2048 sc1
    v_cvt_pk_bf16_f32 v92, v250, v251
    v_cvt_pk_bf16_f32 v93, v252, v253
    v_cvt_pk_bf16_f32 v94, v254, v255
    buffer_store_dwordx4 v[92:95], v15, s[24:27], s42 offen offset:3072 sc1
    s_add_u32 s50, s46, 0
    buffer_load_dwordx4 v[96:99], v15, s[24:27], s50 offen offset:0 sc1
    buffer_load_dwordx4 v[100:103], v15, s[24:27], s50 offen offset:1024 sc1
    buffer_load_dwordx4 v[104:107], v15, s[24:27], s50 offen offset:2048 sc1
    buffer_load_dwordx4 v[108:111], v15, s[24:27], s50 offen offset:3072 sc1
    s_add_u32 s51, s46, 16384
    buffer_load_dwordx4 v[112:115], v15, s[24:27], s51 offen offset:0 sc1
    buffer_load_dwordx4 v[116:119], v15, s[24:27], s51 offen offset:1024 sc1
    buffer_load_dwordx4 v[120:123], v15, s[24:27], s51 offen offset:2048 sc1
    buffer_load_dwordx4 v[124:127], v15, s[24:27], s51 offen offset:3072 sc1
    s_add_u32 s52, s46, 49152
    buffer_load_dwordx4 v[128:131], v15, s[24:27], s52 offen offset:0 sc1
    buffer_load_dwordx4 v[132:135], v15, s[24:27], s52 offen offset:1024 sc1
    buffer_load_dwordx4 v[136:139], v15, s[24:27], s52 offen offset:2048 sc1
    buffer_load_dwordx4 v[140:143], v15, s[24:27], s52 offen offset:3072 sc1
    s_waitcnt vmcnt(8)
    v_xor_b32 v16, v51, v99
    v_xor_b32 v17, v51, v103
    v_xor_b32 v18, v51, v107
    v_xor_b32 v19, v51, v111
    v_or3_b32 v16, v16, v17, v18
    v_or_b32 v16, v16, v19
    v_cmp_eq_u32 vcc, 0, v16
    s_nop 0
    s_cmp_eq_u64 vcc, -1
    s_cbranch_scc1 XOK8
s_mov_b32 s53, 0
XSP8:
 s_sleep 1
 buffer_load_dwordx4 v[96:99], v15, s[24:27], s50 offen offset:0 sc1
 buffer_load_dwordx4 v[100:103], v15, s[24:27], s50 offen offset:1024 sc1
 buffer_load_dwordx4 v[104:107], v15, s[24:27], s50 offen offset:2048 sc1
 buffer_load_dwordx4 v[108:111], v15, s[24:27], s50 offen offset:3072 sc1
 s_add_u32 s53, s53, 1
 s_waitcnt vmcnt(0)
 v_xor_b32 v16, v51, v99
 v_xor_b32 v17, v51, v103
 v_xor_b32 v18, v51, v107
 v_xor_b32 v19, v51, v111
 v_or3_b32 v16, v16, v17, v18
 v_or_b32 v16, v16, v19
 v_cmp_eq_u32 vcc, 0, v16
 s_cmp_ge_u32 s53, 0x40000
 s_cbranch_scc1 XOK8
 s_nop 1
 s_cmp_eq_u64 vcc, -1
 s_cbranch_scc0 XSP8
XOK8:
    v_lshlrev_b32 v16, 16, v96
    v_and_b32 v17, 0xffff0000, v96
    v_add_f32 v208, v208, v16
    v_add_f32 v209, v209, v17
    v_lshlrev_b32 v18, 16, v97
    v_and_b32 v19, 0xffff0000, v97
    v_add_f32 v210, v210, v18
    v_add_f32 v211, v211, v19
    v_lshlrev_b32 v20, 16, v98
    v_and_b32 v21, 0xffff0000, v98
    v_add_f32 v212, v212, v20
    v_add_f32 v213, v213, v21
    v_lshlrev_b32 v22, 16, v100
    v_and_b32 v23, 0xffff0000, v100
    v_add_f32 v214, v214, v22
    v_add_f32 v215, v215, v23
    v_lshlrev_b32 v16, 16, v101
    v_and_b32 v17, 0xffff0000, v101
    v_add_f32 v216, v216, v16
    v_add_f32 v217, v217, v17
    v_lshlrev_b32 v18, 16, v102
    v_and_b32 v19, 0xffff0000, v102
    v_add_f32 v218, v218, v18
    v_add_f32 v219, v219, v19
    v_lshlrev_b32 v20, 16, v104
    v_and_b32 v21, 0xffff0000, v104
    v_add_f32 v220, v220, v20
    v_add_f32 v221, v221, v21
    v_lshlrev_b32 v22, 16, v105
    v_and_b32 v23, 0xffff0000, v105
    v_add_f32 v222, v222, v22
    v_add_f32 v223, v223, v23
    v_lshlrev_b32 v16, 16, v106
    v_and_b32 v17, 0xffff0000, v106
    v_add_f32 v224, v224, v16
    v_add_f32 v225, v225, v17
    v_lshlrev_b32 v18, 16, v108
    v_and_b32 v19, 0xffff0000, v108
    v_add_f32 v226, v226, v18
    v_add_f32 v227, v227, v19
    v_lshlrev_b32 v20, 16, v109
    v_and_b32 v21, 0xffff0000, v109
    v_add_f32 v228, v228, v20
    v_add_f32 v229, v229, v21
    v_lshlrev_b32 v22, 16, v110
    v_and_b32 v23, 0xffff0000, v110
    v_add_f32 v230, v230, v22
    v_add_f32 v231, v231, v23
    s_waitcnt vmcnt(4)
    v_xor_b32 v16, v51, v115
    v_xor_b32 v17, v51, v119
    v_xor_b32 v18, v51, v123
    v_xor_b32 v19, v51, v127
    v_or3_b32 v16, v16, v17, v18
    v_or_b32 v16, v16, v19
    v_cmp_eq_u32 vcc, 0, v16
    s_nop 0
    s_cmp_eq_u64 vcc, -1
    s_cbranch_scc1 XOK9
s_mov_b32 s53, 0
XSP9:
 s_sleep 1
 buffer_load_dwordx4 v[112:115], v15, s[24:27], s51 offen offset:0 sc1
 buffer_load_dwordx4 v[116:119], v15, s[24:27], s51 offen offset:1024 sc1
 buffer_load_dwordx4 v[120:123], v15, s[24:27], s51 offen offset:2048 sc1
 buffer_load_dwordx4 v[124:127], v15, s[24:27], s51 offen offset:3072 sc1
 s_add_u32 s53, s53, 1
 s_waitcnt vmcnt(0)
 v_xor_b32 v16, v51, v115
 v_xor_b32 v17, v51, v119
 v_xor_b32 v18, v51, v123
 v_xor_b32 v19, v51, v127
 v_or3_b32 v16, v16, v17, v18
 v_or_b32 v16, v16, v19
 v_cmp_eq_u32 vcc, 0, v16
 s_cmp_ge_u32 s53, 0x40000
 s_cbranch_scc1 XOK9
 s_nop 1
 s_cmp_eq_u64 vcc, -1
 s_cbranch_scc0 XSP9
XOK9:
    v_lshlrev_b32 v16, 16, v112
    v_and_b32 v17, 0xffff0000, v112
    v_add_f32 v208, v208, v16
    v_add_f32 v209, v209, v17
    v_lshlrev_b32 v18, 16, v113
    v_and_b32 v19, 0xffff0000, v113
    v_add_f32 v210, v210, v18
    v_add_f32 v211, v211, v19
    v_lshlrev_b32 v20, 16, v114
    v_and_b32 v21, 0xffff0000, v114
    v_add_f32 v212, v212, v20
    v_add_f32 v213, v213, v21
    v_lshlrev_b32 v22, 16, v116
    v_and_b32 v23, 0xffff0000, v116
    v_add_f32 v214, v214, v22
    v_add_f32 v215, v215, v23
    v_lshlrev_b32 v16, 16, v117
    v_and_b32 v17, 0xffff0000, v117
    v_add_f32 v216, v216, v16
    v_add_f32 v217, v217, v17
    v_lshlrev_b32 v18, 16, v118
    v_and_b32 v19, 0xffff0000, v118
    v_add_f32 v218, v218, v18
    v_add_f32 v219, v219, v19
    v_lshlrev_b32 v20, 16, v120
    v_and_b32 v21, 0xffff0000, v120
    v_add_f32 v220, v220, v20
    v_add_f32 v221, v221, v21
    v_lshlrev_b32 v22, 16, v121
    v_and_b32 v23, 0xffff0000, v121
    v_add_f32 v222, v222, v22
    v_add_f32 v223, v223, v23
    v_lshlrev_b32 v16, 16, v122
    v_and_b32 v17, 0xffff0000, v122
    v_add_f32 v224, v224, v16
    v_add_f32 v225, v225, v17
    v_lshlrev_b32 v18, 16, v124
    v_and_b32 v19, 0xffff0000, v124
    v_add_f32 v226, v226, v18
    v_add_f32 v227, v227, v19
    v_lshlrev_b32 v20, 16, v125
    v_and_b32 v21, 0xffff0000, v125
    v_add_f32 v228, v228, v20
    v_add_f32 v229, v229, v21
    v_lshlrev_b32 v22, 16, v126
    v_and_b32 v23, 0xffff0000, v126
    v_add_f32 v230, v230, v22
    v_add_f32 v231, v231, v23
    s_waitcnt vmcnt(0)
    v_xor_b32 v16, v51, v131
    v_xor_b32 v17, v51, v135
    v_xor_b32 v18, v51, v139
    v_xor_b32 v19, v51, v143
    v_or3_b32 v16, v16, v17, v18
    v_or_b32 v16, v16, v19
    v_cmp_eq_u32 vcc, 0, v16
    s_nop 0
    s_cmp_eq_u64 vcc, -1
    s_cbranch_scc1 XOK10
s_mov_b32 s53, 0
XSP10:
 s_sleep 1
 buffer_load_dwordx4 v[128:131], v15, s[24:27], s52 offen offset:0 sc1
 buffer_load_dwordx4 v[132:135], v15, s[24:27], s52 offen offset:1024 sc1
 buffer_load_dwordx4 v[136:139], v15, s[24:27], s52 offen offset:2048 sc1
 buffer_load_dwordx4 v[140:143], v15, s[24:27], s52 offen offset:3072 sc1
 s_add_u32 s53, s53, 1
 s_waitcnt vmcnt(0)
 v_xor_b32 v16, v51, v131
 v_xor_b32 v17, v51, v135
 v_xor_b32 v18, v51, v139
 v_xor_b32 v19, v51, v143
 v_or3_b32 v16, v16, v17, v18
 v_or_b32 v16, v16, v19
 v_cmp_eq_u32 vcc, 0, v16
 s_cmp_ge_u32 s53, 0x40000
 s_cbranch_scc1 XOK10
 s_nop 1
 s_cmp_eq_u64 vcc, -1
 s_cbranch_scc0 XSP10
XOK10:
    v_lshlrev_b32 v16, 16, v128
    v_and_b32 v17, 0xffff0000, v128
    v_add_f32 v208, v208, v16
    v_add_f32 v209, v209, v17
    v_lshlrev_b32 v18, 16, v129
    v_and_b32 v19, 0xffff0000, v129
    v_add_f32 v210, v210, v18
    v_add_f32 v211, v211, v19
    v_lshlrev_b32 v20, 16, v130
    v_and_b32 v21, 0xffff0000, v130
    v_add_f32 v212, v212, v20
    v_add_f32 v213, v213, v21
    v_lshlrev_b32 v22, 16, v132
    v_and_b32 v23, 0xffff0000, v132
    v_add_f32 v214, v214, v22
    v_add_f32 v215, v215, v23
    v_cvt_pk_bf16_f32 v32, v208, v209
    v_cvt_pk_bf16_f32 v33, v210, v211
    v_cvt_pk_bf16_f32 v34, v212, v213
    v_cvt_pk_bf16_f32 v35, v214, v215
    s_nop 0
    v_permlane16_swap_b32 v32, v34
    v_permlane16_swap_b32 v33, v35
    buffer_store_dwordx4 v[32:35], v7, s[20:23], s48 offen offset:0
    v_lshlrev_b32 v16, 16, v133
    v_and_b32 v17, 0xffff0000, v133
    v_add_f32 v216, v216, v16
    v_add_f32 v217, v217, v17
    v_lshlrev_b32 v18, 16, v134
    v_and_b32 v19, 0xffff0000, v134
    v_add_f32 v218, v218, v18
    v_add_f32 v219, v219, v19
    v_lshlrev_b32 v20, 16, v136
    v_and_b32 v21, 0xffff0000, v136
    v_add_f32 v220, v220, v20
    v_add_f32 v221, v221, v21
    v_lshlrev_b32 v22, 16, v137
    v_and_b32 v23, 0xffff0000, v137
    v_add_f32 v222, v222, v22
    v_add_f32 v223, v223, v23
    v_cvt_pk_bf16_f32 v36, v216, v217
    v_cvt_pk_bf16_f32 v37, v218, v219
    v_cvt_pk_bf16_f32 v38, v220, v221
    v_cvt_pk_bf16_f32 v39, v222, v223
    s_nop 0
    v_permlane16_swap_b32 v36, v38
    v_permlane16_swap_b32 v37, v39
    buffer_store_dwordx4 v[36:39], v7, s[20:23], s48 offen offset:64
    v_lshlrev_b32 v16, 16, v138
    v_and_b32 v17, 0xffff0000, v138
    v_add_f32 v224, v224, v16
    v_add_f32 v225, v225, v17
    v_lshlrev_b32 v18, 16, v140
    v_and_b32 v19, 0xffff0000, v140
    v_add_f32 v226, v226, v18
    v_add_f32 v227, v227, v19
    v_lshlrev_b32 v20, 16, v141
    v_and_b32 v21, 0xffff0000, v141
    v_add_f32 v228, v228, v20
    v_add_f32 v229, v229, v21
    v_lshlrev_b32 v22, 16, v142
    v_and_b32 v23, 0xffff0000, v142
    v_add_f32 v230, v230, v22
    v_add_f32 v231, v231, v23
    v_cvt_pk_bf16_f32 v40, v224, v225
    v_cvt_pk_bf16_f32 v41, v226, v227
    v_cvt_pk_bf16_f32 v42, v228, v229
    v_cvt_pk_bf16_f32 v43, v230, v231
    s_nop 0
    v_permlane16_swap_b32 v40, v42
    v_permlane16_swap_b32 v41, v43
    buffer_store_dwordx4 v[40:43], v7, s[20:23], s48 offen offset:128
    s_endpgm
XV3:
    s_add_u32 s42, s45, 0
    v_cvt_pk_bf16_f32 v48, v160, v161
    v_cvt_pk_bf16_f32 v49, v162, v163
    v_cvt_pk_bf16_f32 v50, v164, v165
    buffer_store_dwordx4 v[48:51], v15, s[24:27], s42 offen offset:0 sc1
    v_cvt_pk_bf16_f32 v52, v166, v167
    v_cvt_pk_bf16_f32 v53, v168, v169
    v_cvt_pk_bf16_f32 v54, v170, v171
    buffer_store_dwordx4 v[52:55], v15, s[24:27], s42 offen offset:1024 sc1
    v_cvt_pk_bf16_f32 v56, v172, v173
    v_cvt_pk_bf16_f32 v57, v174, v175
    v_cvt_pk_bf16_f32 v58, v176, v177
    buffer_store_dwordx4 v[56:59], v15, s[24:27], s42 offen offset:2048 sc1
    v_cvt_pk_bf16_f32 v60, v178, v179
    v_cvt_pk_bf16_f32 v61, v180, v181
    v_cvt_pk_bf16_f32 v62, v182, v183
    buffer_store_dwordx4 v[60:63], v15, s[24:27], s42 offen offset:3072 sc1
    s_add_u32 s42, s45, 65536
    v_cvt_pk_bf16_f32 v64, v184, v185
    v_cvt_pk_bf16_f32 v65, v186, v187
    v_cvt_pk_bf16_f32 v66, v188, v189
    buffer_store_dwordx4 v[64:67], v15, s[24:27], s42 offen offset:0 sc1
    v_cvt_pk_bf16_f32 v68, v190, v191
    v_cvt_pk_bf16_f32 v69, v192, v193
    v_cvt_pk_bf16_f32 v70, v194, v195
    buffer_store_dwordx4 v[68:71], v15, s[24:27], s42 offen offset:1024 sc1
    v_cvt_pk_bf16_f32 v72, v196, v197
    v_cvt_pk_bf16_f32 v73, v198, v199
    v_cvt_pk_bf16_f32 v74, v200, v201
    buffer_store_dwordx4 v[72:75], v15, s[24:27], s42 offen offset:2048 sc1
    v_cvt_pk_bf16_f32 v76, v202, v203
    v_cvt_pk_bf16_f32 v77, v204, v205
    v_cvt_pk_bf16_f32 v78, v206, v207
    buffer_store_dwordx4 v[76:79], v15, s[24:27], s42 offen offset:3072 sc1
    s_add_u32 s42, s45, 131072
    v_cvt_pk_bf16_f32 v80, v208, v209
    v_cvt_pk_bf16_f32 v81, v210, v211
    v_cvt_pk_bf16_f32 v82, v212, v213
    buffer_store_dwordx4 v[80:83], v15, s[24:27], s42 offen offset:0 sc1
    v_cvt_pk_bf16_f32 v84, v214, v215
    v_cvt_pk_bf16_f32 v85, v216, v217
    v_cvt_pk_bf16_f32 v86, v218, v219
    buffer_store_dwordx4 v[84:87], v15, s[24:27], s42 offen offset:1024 sc1
    v_cvt_pk_bf16_f32 v88, v220, v221
    v_cvt_pk_bf16_f32 v89, v222, v223
    v_cvt_pk_bf16_f32 v90, v224, v225
    buffer_store_dwordx4 v[88:91], v15, s[24:27], s42 offen offset:2048 sc1
    v_cvt_pk_bf16_f32 v92, v226, v227
    v_cvt_pk_bf16_f32 v93, v228, v229
    v_cvt_pk_bf16_f32 v94, v230, v231
    buffer_store_dwordx4 v[92:95], v15, s[24:27], s42 offen offset:3072 sc1
    s_add_u32 s50, s46, 0
    buffer_load_dwordx4 v[96:99], v15, s[24:27], s50 offen offset:0 sc1
    buffer_load_dwordx4 v[100:103], v15, s[24:27], s50 offen offset:1024 sc1
    buffer_load_dwordx4 v[104:107], v15, s[24:27], s50 offen offset:2048 sc1
    buffer_load_dwordx4 v[108:111], v15, s[24:27], s50 offen offset:3072 sc1
    s_add_u32 s51, s46, 16384
    buffer_load_dwordx4 v[112:115], v15, s[24:27], s51 offen offset:0 sc1
    buffer_load_dwordx4 v[116:119], v15, s[24:27], s51 offen offset:1024 sc1
    buffer_load_dwordx4 v[120:123], v15, s[24:27], s51 offen offset:2048 sc1
    buffer_load_dwordx4 v[124:127], v15, s[24:27], s51 offen offset:3072 sc1
    s_add_u32 s52, s46, 32768
    buffer_load_dwordx4 v[128:131], v15, s[24:27], s52 offen offset:0 sc1
    buffer_load_dwordx4 v[132:135], v15, s[24:27], s52 offen offset:1024 sc1
    buffer_load_dwordx4 v[136:139], v15, s[24:27], s52 offen offset:2048 sc1
    buffer_load_dwordx4 v[140:143], v15, s[24:27], s52 offen offset:3072 sc1
    s_waitcnt vmcnt(8)
    v_xor_b32 v16, v51, v99
    v_xor_b32 v17, v51, v103
    v_xor_b32 v18, v51, v107
    v_xor_b32 v19, v51, v111
    v_or3_b32 v16, v16, v17, v18
    v_or_b32 v16, v16, v19
    v_cmp_eq_u32 vcc, 0, v16
    s_nop 0
    s_cmp_eq_u64 vcc, -1
    s_cbranch_scc1 XOK11
s_mov_b32 s53, 0
XSP11:
 s_sleep 1
 buffer_load_dwordx4 v[96:99], v15, s[24:27], s50 offen offset:0 sc1
 buffer_load_dwordx4 v[100:103], v15, s[24:27], s50 offen offset:1024 sc1
 buffer_load_dwordx4 v[104:107], v15, s[24:27], s50 offen offset:2048 sc1
 buffer_load_dwordx4 v[108:111], v15, s[24:27], s50 offen offset:3072 sc1
 s_add_u32 s53, s53, 1
 s_waitcnt vmcnt(0)
 v_xor_b32 v16, v51, v99
 v_xor_b32 v17, v51, v103
 v_xor_b32 v18, v51, v107
 v_xor_b32 v19, v51, v111
 v_or3_b32 v16, v16, v17, v18
 v_or_b32 v16, v16, v19
 v_cmp_eq_u32 vcc, 0, v16
 s_cmp_ge_u32 s53, 0x40000
 s_cbranch_scc1 XOK11
 s_nop 1
 s_cmp_eq_u64 vcc, -1
 s_cbranch_scc0 XSP11
XOK11:
    v_lshlrev_b32 v16, 16, v96
    v_and_b32 v17, 0xffff0000, v96
    v_add_f32 v232, v232, v16
    v_add_f32 v233, v233, v17
    v_lshlrev_b32 v18, 16, v97
    v_and_b32 v19, 0xffff0000, v97
    v_add_f32 v234, v234, v18
    v_add_f32 v235, v235, v19
    v_lshlrev_b32 v20, 16, v98
    v_and_b32 v21, 0xffff0000, v98
    v_add_f32 v236, v236, v20
    v_add_f32 v237, v237, v21
    v_lshlrev_b32 v22, 16, v100
    v_and_b32 v23, 0xffff0000, v100
    v_add_f32 v238, v238, v22
    v_add_f32 v239, v239, v23
    v_lshlrev_b32 v16, 16, v101
    v_and_b32 v17, 0xffff0000, v101
    v_add_f32 v240, v240, v16
    v_add_f32 v241, v241, v17
    v_lshlrev_b32 v18, 16, v102
    v_and_b32 v19, 0xffff0000, v102
    v_add_f32 v242, v242, v18
    v_add_f32 v243, v243, v19
    v_lshlrev_b32 v20, 16, v104
    v_and_b32 v21, 0xffff0000, v104
    v_add_f32 v244, v244, v20
    v_add_f32 v245, v245, v21
    v_lshlrev_b32 v22, 16, v105
    v_and_b32 v23, 0xffff0000, v105
    v_add_f32 v246, v246, v22
    v_add_f32 v247, v247, v23
    v_lshlrev_b32 v16, 16, v106
    v_and_b32 v17, 0xffff0000, v106
    v_add_f32 v248, v248, v16
    v_add_f32 v249, v249, v17
    v_lshlrev_b32 v18, 16, v108
    v_and_b32 v19, 0xffff0000, v108
    v_add_f32 v250, v250, v18
    v_add_f32 v251, v251, v19
    v_lshlrev_b32 v20, 16, v109
    v_and_b32 v21, 0xffff0000, v109
    v_add_f32 v252, v252, v20
    v_add_f32 v253, v253, v21
    v_lshlrev_b32 v22, 16, v110
    v_and_b32 v23, 0xffff0000, v110
    v_add_f32 v254, v254, v22
    v_add_f32 v255, v255, v23
    s_waitcnt vmcnt(4)
    v_xor_b32 v16, v51, v115
    v_xor_b32 v17, v51, v119
    v_xor_b32 v18, v51, v123
    v_xor_b32 v19, v51, v127
    v_or3_b32 v16, v16, v17, v18
    v_or_b32 v16, v16, v19
    v_cmp_eq_u32 vcc, 0, v16
    s_nop 0
    s_cmp_eq_u64 vcc, -1
    s_cbranch_scc1 XOK12
s_mov_b32 s53, 0
XSP12:
 s_sleep 1
 buffer_load_dwordx4 v[112:115], v15, s[24:27], s51 offen offset:0 sc1
 buffer_load_dwordx4 v[116:119], v15, s[24:27], s51 offen offset:1024 sc1
 buffer_load_dwordx4 v[120:123], v15, s[24:27], s51 offen offset:2048 sc1
 buffer_load_dwordx4 v[124:127], v15, s[24:27], s51 offen offset:3072 sc1
 s_add_u32 s53, s53, 1
 s_waitcnt vmcnt(0)
 v_xor_b32 v16, v51, v115
 v_xor_b32 v17, v51, v119
 v_xor_b32 v18, v51, v123
 v_xor_b32 v19, v51, v127
 v_or3_b32 v16, v16, v17, v18
 v_or_b32 v16, v16, v19
 v_cmp_eq_u32 vcc, 0, v16
 s_cmp_ge_u32 s53, 0x40000
 s_cbranch_scc1 XOK12
 s_nop 1
 s_cmp_eq_u64 vcc, -1
 s_cbranch_scc0 XSP12
XOK12:
    v_lshlrev_b32 v16, 16, v112
    v_and_b32 v17, 0xffff0000, v112
    v_add_f32 v232, v232, v16
    v_add_f32 v233, v233, v17
    v_lshlrev_b32 v18, 16, v113
    v_and_b32 v19, 0xffff0000, v113
    v_add_f32 v234, v234, v18
    v_add_f32 v235, v235, v19
    v_lshlrev_b32 v20, 16, v114
    v_and_b32 v21, 0xffff0000, v114
    v_add_f32 v236, v236, v20
    v_add_f32 v237, v237, v21
    v_lshlrev_b32 v22, 16, v116
    v_and_b32 v23, 0xffff0000, v116
    v_add_f32 v238, v238, v22
    v_add_f32 v239, v239, v23
    v_lshlrev_b32 v16, 16, v117
    v_and_b32 v17, 0xffff0000, v117
    v_add_f32 v240, v240, v16
    v_add_f32 v241, v241, v17
    v_lshlrev_b32 v18, 16, v118
    v_and_b32 v19, 0xffff0000, v118
    v_add_f32 v242, v242, v18
    v_add_f32 v243, v243, v19
    v_lshlrev_b32 v20, 16, v120
    v_and_b32 v21, 0xffff0000, v120
    v_add_f32 v244, v244, v20
    v_add_f32 v245, v245, v21
    v_lshlrev_b32 v22, 16, v121
    v_and_b32 v23, 0xffff0000, v121
    v_add_f32 v246, v246, v22
    v_add_f32 v247, v247, v23
    v_lshlrev_b32 v16, 16, v122
    v_and_b32 v17, 0xffff0000, v122
    v_add_f32 v248, v248, v16
    v_add_f32 v249, v249, v17
    v_lshlrev_b32 v18, 16, v124
    v_and_b32 v19, 0xffff0000, v124
    v_add_f32 v250, v250, v18
    v_add_f32 v251, v251, v19
    v_lshlrev_b32 v20, 16, v125
    v_and_b32 v21, 0xffff0000, v125
    v_add_f32 v252, v252, v20
    v_add_f32 v253, v253, v21
    v_lshlrev_b32 v22, 16, v126
    v_and_b32 v23, 0xffff0000, v126
    v_add_f32 v254, v254, v22
    v_add_f32 v255, v255, v23
    s_waitcnt vmcnt(0)
    v_xor_b32 v16, v51, v131
    v_xor_b32 v17, v51, v135
    v_xor_b32 v18, v51, v139
    v_xor_b32 v19, v51, v143
    v_or3_b32 v16, v16, v17, v18
    v_or_b32 v16, v16, v19
    v_cmp_eq_u32 vcc, 0, v16
    s_nop 0
    s_cmp_eq_u64 vcc, -1
    s_cbranch_scc1 XOK13
s_mov_b32 s53, 0
XSP13:
 s_sleep 1
 buffer_load_dwordx4 v[128:131], v15, s[24:27], s52 offen offset:0 sc1
 buffer_load_dwordx4 v[132:135], v15, s[24:27], s52 offen offset:1024 sc1
 buffer_load_dwordx4 v[136:139], v15, s[24:27], s52 offen offset:2048 sc1
 buffer_load_dwordx4 v[140:143], v15, s[24:27], s52 offen offset:3072 sc1
 s_add_u32 s53, s53, 1
 s_waitcnt vmcnt(0)
 v_xor_b32 v16, v51, v131
 v_xor_b32 v17, v51, v135
 v_xor_b32 v18, v51, v139
 v_xor_b32 v19, v51, v143
 v_or3_b32 v16, v16, v17, v18
 v_or_b32 v16, v16, v19
 v_cmp_eq_u32 vcc, 0, v16
 s_cmp_ge_u32 s53, 0x40000
 s_cbranch_scc1 XOK13
 s_nop 1
 s_cmp_eq_u64 vcc, -1
 s_cbranch_scc0 XSP13
XOK13:
    v_lshlrev_b32 v16, 16, v128
    v_and_b32 v17, 0xffff0000, v128
    v_add_f32 v232, v232, v16
    v_add_f32 v233, v233, v17
    v_lshlrev_b32 v18, 16, v129
    v_and_b32 v19, 0xffff0000, v129
    v_add_f32 v234, v234, v18
    v_add_f32 v235, v235, v19
    v_lshlrev_b32 v20, 16, v130
    v_and_b32 v21, 0xffff0000, v130
    v_add_f32 v236, v236, v20
    v_add_f32 v237, v237, v21
    v_lshlrev_b32 v22, 16, v132
    v_and_b32 v23, 0xffff0000, v132
    v_add_f32 v238, v238, v22
    v_add_f32 v239, v239, v23
    v_cvt_pk_bf16_f32 v32, v232, v233
    v_cvt_pk_bf16_f32 v33, v234, v235
    v_cvt_pk_bf16_f32 v34, v236, v237
    v_cvt_pk_bf16_f32 v35, v238, v239
    s_nop 0
    v_permlane16_swap_b32 v32, v34
    v_permlane16_swap_b32 v33, v35
    buffer_store_dwordx4 v[32:35], v7, s[20:23], s48 offen offset:0
    v_lshlrev_b32 v16, 16, v133
    v_and_b32 v17, 0xffff0000, v133
    v_add_f32 v240, v240, v16
    v_add_f32 v241, v241, v17
    v_lshlrev_b32 v18, 16, v134
    v_and_b32 v19, 0xffff0000, v134
    v_add_f32 v242, v242, v18
    v_add_f32 v243, v243, v19
    v_lshlrev_b32 v20, 16, v136
    v_and_b32 v21, 0xffff0000, v136
    v_add_f32 v244, v244, v20
    v_add_f32 v245, v245, v21
    v_lshlrev_b32 v22, 16, v137
    v_and_b32 v23, 0xffff0000, v137
    v_add_f32 v246, v246, v22
    v_add_f32 v247, v247, v23
    v_cvt_pk_bf16_f32 v36, v240, v241
    v_cvt_pk_bf16_f32 v37, v242, v243
    v_cvt_pk_bf16_f32 v38, v244, v245
    v_cvt_pk_bf16_f32 v39, v246, v247
    s_nop 0
    v_permlane16_swap_b32 v36, v38
    v_permlane16_swap_b32 v37, v39
    buffer_store_dwordx4 v[36:39], v7, s[20:23], s48 offen offset:64
    v_lshlrev_b32 v16, 16, v138
    v_and_b32 v17, 0xffff0000, v138
    v_add_f32 v248, v248, v16
    v_add_f32 v249, v249, v17
    v_lshlrev_b32 v18, 16, v140
    v_and_b32 v19, 0xffff0000, v140
    v_add_f32 v250, v250, v18
    v_add_f32 v251, v251, v19
    v_lshlrev_b32 v20, 16, v141
    v_and_b32 v21, 0xffff0000, v141
    v_add_f32 v252, v252, v20
    v_add_f32 v253, v253, v21
    v_lshlrev_b32 v22, 16, v142
    v_and_b32 v23, 0xffff0000, v142
    v_add_f32 v254, v254, v22
    v_add_f32 v255, v255, v23
    v_cvt_pk_bf16_f32 v40, v248, v249
    v_cvt_pk_bf16_f32 v41, v250, v251
    v_cvt_pk_bf16_f32 v42, v252, v253
    v_cvt_pk_bf16_f32 v43, v254, v255
    s_nop 0
    v_permlane16_swap_b32 v40, v42
    v_permlane16_swap_b32 v41, v43
    buffer_store_dwordx4 v[40:43], v7, s[20:23], s48 offen offset:128
    s_endpgm
G2_LOAD:
    ds_read_b64_tr_b16 v[44:45], v13 offset:6144
    ds_read_b64_tr_b16 v[46:47], v13 offset:6656
    s_waitcnt lgkmcnt(6)
    v_mfma_f32_32x32x16_bf16 v[64:79], v[32:35], v[112:115], 0
    v_exp_f32 v31, v31
    v_fma_f32 v28, v28, v6, v6
    v_fma_f32 v29, v29, v6, v6
    v_fma_f32 v30, v30, v6, v6
    s_and_b32 s29, s3, 1
    s_lshl_b32 s29, s29, 3
    s_and_b32 s42, s54, 7
    s_add_u32 s29, s29, s42
    s_lshr_b32 s30, s54, 3
    s_sub_u32 s32, s28, 4
    v_lshrrev_b32 v5, 2, v1
    v_and_b32 v0, 3, v1
    v_lshlrev_b32 v0, 4, v0
    v_mul_u32_u24 v4, 1152, v5
    v_add_u32 v4, v4, v0
    v_and_b32 v0, 1, v1
    v_lshlrev_b32 v0, 10, v0
    s_waitcnt vmcnt(2)
    v_lshl_add_u32 v7, v5, 12, v0
    v_bfe_u32 v0, v1, 1, 1
    v_lshl_add_u32 v7, v0, 4, v7
    v_lshrrev_b32 v5, 3, v1
    v_mul_u32_u24 v4, 1152, v5
    v_bfe_u32 v5, v1, 4, 1
    v_lshlrev_b32 v5, 2, v5
    v_and_b32 v0, 7, v1
    v_xor_b32 v0, v0, v5
    v_lshrrev_b32 v5, 5, v1
    v_lshlrev_b32 v5, 1, v5
    v_xor_b32 v0, v0, v5
    v_lshl_add_u32 v4, v0, 4, v4
    v_min_u32 v0, 5, v1
    v_lshlrev_b32 v0, 3, v0
    v_min_u32 v5, 36, v1
    v_lshlrev_b32 v5, 3, v5
    s_lshl_b32 s33, s29, 2
    s_add_u32 s33, s33, s32
    s_lshl_b32 s39, s33, 2
    s_add_u32 s39, s39, s55
    s_lshl_b32 s39, s39, 9
    s_add_u32 s39, s39, 41943040
    s_and_b32 s40, s33, 31
    s_lshl_b32 s40, s40, 5
    s_lshr_b32 s42, s33, 5
    s_lshl_b32 s42, s42, 11
    s_add_u32 s40, s40, s42
    s_mul_i32 s42, s55, 589824
    s_add_u32 s40, s40, s42
    s_add_u32 s40, s40, 28311552
    s_mul_i32 s33, s33, 294912
    s_mul_i32 s42, s55, 73728
    s_add_u32 s33, s33, s42
    s_lshl_b32 s34, s32, 12
    s_add_u32 s34, s34, 24576
    s_lshl_b32 s36, s32, 11
    s_lshr_b32 s42, s32, 1
    s_mul_i32 s35, s42, 221184
    s_and_b32 s42, s32, 1
    s_mul_i32 s42, s42, 18432
    s_add_u32 s35, s35, s42
    s_mul_i32 s42, s55, 1327104
    s_add_u32 s35, s35, s42
    s_mul_i32 s43, s30, 384
    s_add_u32 s35, s35, s43
    s_mul_i32 s44, s55, 165888
    s_add_u32 s44, s44, s43
    s_mul_i32 s42, s32, 18432
    s_add_u32 s43, s44, s42
    s_mov_b32 s47, 42075136
    ds_read_b64_tr_b16 v[32:33], v13 offset:8192
    ds_read_b64_tr_b16 v[34:35], v13 offset:8704
    s_waitcnt lgkmcnt(6)
    v_mfma_f32_32x32x16_bf16 v[64:79], v[36:39], v[116:119], v[64:79]
    v_fma_f32 v31, v31, v6, v6
    v_rcp_f32 v28, v28
    v_rcp_f32 v29, v29
    v_rcp_f32 v30, v30
    v_rcp_f32 v31, v31
    s_add_u32 s37, s35, 0
    s_add_u32 m0, s36, 0
    s_nop 0
    buffer_load_dwordx4 v4, s[12:15], s37 offen offset:0 lds
    ds_read_b64_tr_b16 v[36:37], v13 offset:10240
    ds_read_b64_tr_b16 v[38:39], v13 offset:10752
    s_waitcnt lgkmcnt(6)
    v_mfma_f32_32x32x16_bf16 v[64:79], v[40:43], v[120:123], v[64:79]
    v_mul_f32 v28, v100, v28
    v_mul_f32 v29, v101, v29
    v_mul_f32 v30, v102, v30
    v_mul_f32 v31, v103, v31
    s_add_u32 m0, s36, 8064
    s_nop 0
    buffer_load_dwordx4 v4, s[12:15], s37 offen offset:128 lds
    ds_read_b64_tr_b16 v[40:41], v13 offset:12288
    ds_read_b64_tr_b16 v[42:43], v13 offset:12800
    s_waitcnt lgkmcnt(6)
    v_mfma_f32_32x32x16_bf16 v[64:79], v[44:47], v[124:127], v[64:79]
    v_cvt_pk_bf16_f32 v18, v28, v29
    v_cvt_pk_bf16_f32 v19, v30, v31
    s_add_u32 s51, s45, 36864
    buffer_store_dwordx4 v[16:19], v15, s[24:27], s51 offen offset:0 sc1
    v_mul_f32 v24, s46, v104
    s_add_u32 m0, s36, 16128
    s_nop 0
    buffer_load_dwordx4 v4, s[12:15], s37 offen offset:256 lds
    ds_read_b64_tr_b16 v[44:45], v13 offset:14336
    ds_read_b64_tr_b16 v[46:47], v13 offset:14848
    s_waitcnt lgkmcnt(6)
    v_mfma_f32_32x32x16_bf16 v[64:79], v[32:35], v[128:131], v[64:79]
    v_mul_f32 v25, s46, v105
    v_mul_f32 v26, s46, v106
    v_mul_f32 v27, s46, v107
    v_exp_f32 v24, v24
    s_add_u32 s37, s35, 9216
    s_add_u32 m0, s36, 1024
    s_nop 0
    buffer_load_dwordx4 v4, s[12:15], s37 offen offset:0 lds
    ds_read_b64_tr_b16 v[32:33], v13 offset:16384
    ds_read_b64_tr_b16 v[34:35], v13 offset:16896
    s_waitcnt lgkmcnt(6)
    v_mfma_f32_32x32x16_bf16 v[64:79], v[36:39], v[132:135], v[64:79]
    v_exp_f32 v25, v25
    v_exp_f32 v26, v26
    v_exp_f32 v27, v27
    v_fma_f32 v24, v24, v6, v6
    s_add_u32 m0, s36, 9088
    s_nop 0
    buffer_load_dwordx4 v4, s[12:15], s37 offen offset:128 lds
    ds_read_b64_tr_b16 v[36:37], v13 offset:18432
    ds_read_b64_tr_b16 v[38:39], v13 offset:18944
    s_waitcnt lgkmcnt(6)
    v_mfma_f32_32x32x16_bf16 v[64:79], v[40:43], v[136:139], v[64:79]
    v_fma_f32 v25, v25, v6, v6
    v_fma_f32 v26, v26, v6, v6
    v_fma_f32 v27, v27, v6, v6
    v_rcp_f32 v24, v24
    v_rcp_f32 v25, v25
    s_add_u32 m0, s36, 17152
    s_nop 0
    buffer_load_dwordx4 v4, s[12:15], s37 offen offset:256 lds
    ds_read_b64_tr_b16 v[40:41], v13 offset:20480
    ds_read_b64_tr_b16 v[42:43], v13 offset:20992
    s_waitcnt lgkmcnt(6)
    v_mfma_f32_32x32x16_bf16 v[64:79], v[44:47], v[140:143], v[64:79]
    v_rcp_f32 v26, v26
    v_rcp_f32 v27, v27
    v_mul_f32 v24, v104, v24
    v_mul_f32 v25, v105, v25
    s_add_u32 s37, s35, 442368
    s_add_u32 m0, s36, 40960
    s_nop 0
    buffer_load_dwordx4 v4, s[12:15], s37 offen offset:0 lds
    ds_read_b64_tr_b16 v[44:45], v13 offset:22528
    ds_read_b64_tr_b16 v[46:47], v13 offset:23040
    s_waitcnt lgkmcnt(6)
    v_mfma_f32_32x32x16_bf16 v[64:79], v[32:35], v[144:147], v[64:79]
    v_mul_f32 v26, v106, v26
    v_mul_f32 v27, v107, v27
    v_cvt_pk_bf16_f32 v20, v24, v25
    v_cvt_pk_bf16_f32 v21, v26, v27
    s_add_u32 m0, s36, 49024
    s_nop 0
    buffer_load_dwordx4 v4, s[12:15], s37 offen offset:128 lds
    ds_read_b64_tr_b16 v[32:33], v13 offset:24576
    ds_read_b64_tr_b16 v[34:35], v13 offset:25088
    s_waitcnt lgkmcnt(6)
    v_mfma_f32_32x32x16_bf16 v[64:79], v[36:39], v[148:151], v[64:79]
    v_mul_f32 v28, s46, v108
    v_mul_f32 v29, s46, v109
    v_mul_f32 v30, s46, v110
    v_mul_f32 v31, s46, v111
    s_add_u32 m0, s36, 57088
    s_nop 0
    buffer_load_dwordx4 v4, s[12:15], s37 offen offset:256 lds
    ds_read_b64_tr_b16 v[36:37], v13 offset:26624
    ds_read_b64_tr_b16 v[38:39], v13 offset:27136
    s_waitcnt lgkmcnt(6)
    v_mfma_f32_32x32x16_bf16 v[64:79], v[40:43], v[152:155], v[64:79]
    v_exp_f32 v28, v28
    v_exp_f32 v29, v29
    v_exp_f32 v30, v30
    v_exp_f32 v31, v31
    s_add_u32 s37, s35, 451584
    s_add_u32 m0, s36, 41984
    s_nop 0
    buffer_load_dwordx4 v4, s[12:15], s37 offen offset:0 lds
    buffer_load_dwordx2 v[10:11], v0, s[24:27], s39 offen offset:0 sc1
    ds_read_b64_tr_b16 v[40:41], v13 offset:28672
    ds_read_b64_tr_b16 v[42:43], v13 offset:29184
    s_waitcnt lgkmcnt(6)
    v_mfma_f32_32x32x16_bf16 v[64:79], v[44:47], v[156:159], v[64:79]
    v_fma_f32 v28, v28, v6, v6
    v_fma_f32 v29, v29, v6, v6
    v_fma_f32 v30, v30, v6, v6
    v_fma_f32 v31, v31, v6, v6
    v_rcp_f32 v28, v28
    s_add_u32 m0, s36, 50048
    s_nop 0
    buffer_load_dwordx4 v4, s[12:15], s37 offen offset:128 lds
    ds_read_b64_tr_b16 v[44:45], v13 offset:30720
    ds_read_b64_tr_b16 v[46:47], v13 offset:31232
    s_waitcnt lgkmcnt(6)
    v_mfma_f32_32x32x16_bf16 v[64:79], v[32:35], v[160:163], v[64:79]
    v_rcp_f32 v29, v29
    v_rcp_f32 v30, v30
    v_rcp_f32 v31, v31
    v_mul_f32 v28, v108, v28
    s_waitcnt vmcnt(13)
    buffer_store_dwordx2 v[2:3], v8, s[24:27], s52 offen offset:96 sc1
    s_add_u32 m0, s36, 58112
    s_nop 0
    buffer_load_dwordx4 v4, s[12:15], s37 offen offset:256 lds
    ds_read_b64_tr_b16 v[32:33], v13 offset:32768
    ds_read_b64_tr_b16 v[34:35], v13 offset:33280
    s_waitcnt lgkmcnt(6)
    v_mfma_f32_32x32x16_bf16 v[64:79], v[36:39], v[164:167], v[64:79]
    v_mul_f32 v29, v109, v29
    v_mul_f32 v30, v110, v30
    v_mul_f32 v31, v111, v31
    v_cvt_pk_bf16_f32 v22, v28, v29
    ds_read_b64_tr_b16 v[36:37], v13 offset:34816
    ds_read_b64_tr_b16 v[38:39], v13 offset:35328
    s_waitcnt lgkmcnt(6)
    v_mfma_f32_32x32x16_bf16 v[64:79], v[40:43], v[168:171], v[64:79]
    v_cvt_pk_bf16_f32 v23, v30, v31
    buffer_store_dwordx4 v[20:23], v15, s[24:27], s51 offen offset:1024 sc1
    v_mul_f32 v24, s46, v48
    v_mul_f32 v25, s46, v49
    ds_read_b64_tr_b16 v[40:41], v13 offset:36864
    ds_read_b64_tr_b16 v[42:43], v13 offset:37376
    s_waitcnt lgkmcnt(6)
    v_mfma_f32_32x32x16_bf16 v[64:79], v[44:47], v[172:175], v[64:79]
    v_mul_f32 v26, s46, v50
    v_mul_f32 v27, s46, v51
    v_exp_f32 v24, v24
    v_exp_f32 v25, v25
    ds_read_b64_tr_b16 v[44:45], v13 offset:38912
    ds_read_b64_tr_b16 v[46:47], v13 offset:39424
    s_waitcnt lgkmcnt(6)
    v_mfma_f32_32x32x16_bf16 v[64:79], v[32:35], v[176:179], v[64:79]
    v_exp_f32 v26, v26
    v_exp_f32 v27, v27
    v_fma_f32 v24, v24, v6, v6
    v_fma_f32 v25, v25, v6, v6
    v_fma_f32 v26, v26, v6, v6
    ds_read_b64_tr_b16 v[32:33], v13 offset:40960
    ds_read_b64_tr_b16 v[34:35], v13 offset:41472
    s_waitcnt lgkmcnt(6)
    v_mfma_f32_32x32x16_bf16 v[64:79], v[36:39], v[180:183], v[64:79]
    v_fma_f32 v27, v27, v6, v6
    v_rcp_f32 v24, v24
    v_rcp_f32 v25, v25
    v_rcp_f32 v26, v26
    ds_read_b64_tr_b16 v[36:37], v13 offset:43008
    ds_read_b64_tr_b16 v[38:39], v13 offset:43520
    s_waitcnt lgkmcnt(6)
    v_mfma_f32_32x32x16_bf16 v[64:79], v[40:43], v[184:187], v[64:79]
    v_rcp_f32 v27, v27
    v_mul_f32 v24, v48, v24
    v_mul_f32 v25, v49, v25
    v_mul_f32 v26, v50, v26
    ds_read_b64_tr_b16 v[40:41], v13 offset:45056
    ds_read_b64_tr_b16 v[42:43], v13 offset:45568
    s_waitcnt lgkmcnt(6)
    v_mfma_f32_32x32x16_bf16 v[64:79], v[44:47], v[188:191], v[64:79]
    v_mul_f32 v27, v51, v27
    v_cvt_pk_bf16_f32 v16, v24, v25
    v_cvt_pk_bf16_f32 v17, v26, v27
    v_mul_f32 v28, s46, v52
    ds_read_b64_tr_b16 v[44:45], v13 offset:47104
    ds_read_b64_tr_b16 v[46:47], v13 offset:47616
    s_waitcnt lgkmcnt(6)
    v_mfma_f32_32x32x16_bf16 v[64:79], v[32:35], v[192:195], v[64:79]
    v_mul_f32 v29, s46, v53
    v_mul_f32 v30, s46, v54
    v_mul_f32 v31, s46, v55
    v_exp_f32 v28, v28
    s_waitcnt vmcnt(4)
    v_cmp_eq_u64 vcc, v[10:11], v[2:3]
    s_nop 0
    s_cmp_eq_u64 vcc, -1
    s_cbranch_scc1 POK14
s_mov_b32 s53, 0
PSP14:
 s_sleep 2
 buffer_load_dwordx2 v[10:11], v0, s[24:27], s39 offen offset:0 sc1
 s_add_u32 s53, s53, 1
 s_waitcnt vmcnt(0)
 v_cmp_eq_u64 vcc, v[10:11], v[2:3]
 s_cmp_ge_u32 s53, 0x40000
 s_cbranch_scc1 POK14
 s_nop 1
 s_cmp_eq_u64 vcc, -1
 s_cbranch_scc0 PSP14
POK14:
    s_add_u32 s38, s33, 0
    s_add_u32 m0, s34, 0
    s_nop 0
    buffer_load_dwordx4 v15, s[24:27], s38 offen offset:0  lds
    buffer_load_dwordx4 v15, s[24:27], s38 offen offset:1024  lds
    buffer_load_dwordx4 v15, s[24:27], s38 offen offset:2048  lds
    buffer_load_dwordx4 v15, s[24:27], s38 offen offset:3072  lds
    ds_read_b64_tr_b16 v[32:33], v13 offset:49152
    ds_read_b64_tr_b16 v[34:35], v13 offset:49664
    s_waitcnt lgkmcnt(6)
    v_mfma_f32_32x32x16_bf16 v[64:79], v[36:39], v[196:199], v[64:79]
    v_exp_f32 v29, v29
    v_exp_f32 v30, v30
    v_exp_f32 v31, v31
    v_fma_f32 v28, v28, v6, v6
    v_fma_f32 v29, v29, v6, v6
    ds_read_b64_tr_b16 v[36:37], v13 offset:51200
    ds_read_b64_tr_b16 v[38:39], v13 offset:51712
    s_waitcnt lgkmcnt(6)
    v_mfma_f32_32x32x16_bf16 v[64:79], v[40:43], v[200:203], v[64:79]
    v_fma_f32 v30, v30, v6, v6
    v_fma_f32 v31, v31, v6, v6
    v_rcp_f32 v28, v28
    v_rcp_f32 v29, v29
    s_add_u32 s38, s33, 4096
    s_add_u32 m0, s34, 40960
    s_nop 0
    buffer_load_dwordx4 v15, s[24:27], s38 offen offset:0  lds
    buffer_load_dwordx4 v15, s[24:27], s38 offen offset:1024  lds
    buffer_load_dwordx4 v15, s[24:27], s38 offen offset:2048  lds
    buffer_load_dwordx4 v15, s[24:27], s38 offen offset:3072  lds
    ds_read_b64_tr_b16 v[40:41], v13 offset:53248
    ds_read_b64_tr_b16 v[42:43], v13 offset:53760
    s_waitcnt lgkmcnt(6)
    v_mfma_f32_32x32x16_bf16 v[64:79], v[44:47], v[204:207], v[64:79]
    v_rcp_f32 v30, v30
    v_rcp_f32 v31, v31
    v_mul_f32 v28, v52, v28
    v_mul_f32 v29, v53, v29
    ds_read_b64_tr_b16 v[44:45], v13 offset:55296
    ds_read_b64_tr_b16 v[46:47], v13 offset:55808
    s_waitcnt lgkmcnt(6)
    v_mfma_f32_32x32x16_bf16 v[64:79], v[32:35], v[208:211], v[64:79]
    v_mul_f32 v30, v54, v30
    v_mul_f32 v31, v55, v31
    v_cvt_pk_bf16_f32 v18, v28, v29
    v_cvt_pk_bf16_f32 v19, v30, v31
    ds_read_b64_tr_b16 v[32:33], v13 offset:57344
    ds_read_b64_tr_b16 v[34:35], v13 offset:57856
    s_waitcnt lgkmcnt(6)
    v_mfma_f32_32x32x16_bf16 v[64:79], v[36:39], v[212:215], v[64:79]
    s_add_u32 s51, s45, 49152
    buffer_store_dwordx4 v[16:19], v15, s[24:27], s51 offen offset:0 sc1
    v_mul_f32 v24, s46, v56
    v_mul_f32 v25, s46, v57
    v_mul_f32 v26, s46, v58
    ds_read_b64_tr_b16 v[36:37], v13 offset:59392
    ds_read_b64_tr_b16 v[38:39], v13 offset:59904
    s_waitcnt lgkmcnt(6)
    v_mfma_f32_32x32x16_bf16 v[64:79], v[40:43], v[216:219], v[64:79]
    v_mul_f32 v27, s46, v59
    v_exp_f32 v24, v24
    v_exp_f32 v25, v25
    v_exp_f32 v26, v26
    v_exp_f32 v27, v27
    ds_read_b64_tr_b16 v[40:41], v13 offset:61440
    ds_read_b64_tr_b16 v[42:43], v13 offset:61952
    s_waitcnt lgkmcnt(6)
    v_mfma_f32_32x32x16_bf16 v[64:79], v[44:47], v[220:223], v[64:79]
    v_fma_f32 v24, v24, v6, v6
    v_fma_f32 v25, v25, v6, v6
    v_fma_f32 v26, v26, v6, v6
    v_fma_f32 v27, v27, v6, v6
    ds_read_b64_tr_b16 v[44:45], v13 offset:63488
    ds_read_b64_tr_b16 v[46:47], v13 offset:64000
    s_waitcnt lgkmcnt(6)
    v_mfma_f32_32x32x16_bf16 v[64:79], v[32:35], v[224:227], v[64:79]
    v_rcp_f32 v24, v24
    v_rcp_f32 v25, v25
    v_rcp_f32 v26, v26
    v_rcp_f32 v27, v27
    v_add_u32 v13, 65536, v13
    ds_read_b64_tr_b16 v[32:33], v13 offset:0
    ds_read_b64_tr_b16 v[34:35], v13 offset:512
    s_waitcnt lgkmcnt(6)
    v_mfma_f32_32x32x16_bf16 v[64:79], v[36:39], v[228:231], v[64:79]
    v_mul_f32 v24, v56, v24
    v_mul_f32 v25, v57, v25
    v_mul_f32 v26, v58, v26
    v_mul_f32 v27, v59, v27
    ds_read_b64_tr_b16 v[36:37], v13 offset:2048
    ds_read_b64_tr_b16 v[38:39], v13 offset:2560
    s_waitcnt lgkmcnt(6)
    v_mfma_f32_32x32x16_bf16 v[64:79], v[40:43], v[232:235], v[64:79]
    v_cvt_pk_bf16_f32 v20, v24, v25
    v_cvt_pk_bf16_f32 v21, v26, v27
    v_mul_f32 v28, s46, v60
    v_mul_f32 v29, s46, v61
    ds_read_b64_tr_b16 v[40:41], v13 offset:4096
    ds_read_b64_tr_b16 v[42:43], v13 offset:4608
    s_waitcnt lgkmcnt(6)
    v_mfma_f32_32x32x16_bf16 v[64:79], v[44:47], v[236:239], v[64:79]
    v_mul_f32 v30, s46, v62
    v_mul_f32 v31, s46, v63
    v_exp_f32 v28, v28
    v_exp_f32 v29, v29
    v_exp_f32 v30, v30
    ds_read_b64_tr_b16 v[44:45], v13 offset:6144
    ds_read_b64_tr_b16 v[46:47], v13 offset:6656
    s_waitcnt lgkmcnt(6)
    v_mfma_f32_32x32x16_bf16 v[64:79], v[32:35], v[240:243], v[64:79]
    v_exp_f32 v31, v31
    v_fma_f32 v28, v28, v6, v6
    v_fma_f32 v29, v29, v6, v6
    v_fma_f32 v30, v30, v6, v6
    s_waitcnt lgkmcnt(4)
    v_mfma_f32_32x32x16_bf16 v[64:79], v[36:39], v[244:247], v[64:79]
    v_fma_f32 v31, v31, v6, v6
    v_rcp_f32 v28, v28
    v_rcp_f32 v29, v29
    v_rcp_f32 v30, v30
    s_waitcnt lgkmcnt(2)
    v_mfma_f32_32x32x16_bf16 v[64:79], v[40:43], v[248:251], v[64:79]
    v_rcp_f32 v31, v31
    v_mul_f32 v28, v60, v28
    v_mul_f32 v29, v61, v29
    v_mul_f32 v30, v62, v30
    s_waitcnt vmcnt(9)
    buffer_store_dwordx2 v[2:3], v8, s[24:27], s52 offen offset:144 sc1
    s_waitcnt lgkmcnt(0)
    v_mfma_f32_32x32x16_bf16 v[64:79], v[44:47], v[252:255], v[64:79]
    v_mul_f32 v31, v63, v31
    v_cvt_pk_bf16_f32 v22, v28, v29
    v_cvt_pk_bf16_f32 v23, v30, v31
    buffer_store_dwordx4 v[20:23], v15, s[24:27], s51 offen offset:1024 sc1
    buffer_load_dwordx2 v[10:11], v0, s[24:27], s39 offen offset:48 sc1
    s_waitcnt vmcnt(8)
    s_barrier
    s_add_u32 s37, s35, 884736
    s_add_u32 m0, s36, 81920
    s_nop 0
    buffer_load_dwordx4 v4, s[12:15], s37 offen offset:0 lds
    s_add_u32 m0, s36, 89984
    s_nop 0
    buffer_load_dwordx4 v4, s[12:15], s37 offen offset:128 lds
    s_add_u32 m0, s36, 98048
    s_nop 0
    buffer_load_dwordx4 v4, s[12:15], s37 offen offset:256 lds
    s_add_u32 s37, s35, 893952
    s_add_u32 m0, s36, 82944
    s_nop 0
    buffer_load_dwordx4 v4, s[12:15], s37 offen offset:0 lds
    s_add_u32 m0, s36, 91008
    s_nop 0
    buffer_load_dwordx4 v4, s[12:15], s37 offen offset:128 lds
    s_add_u32 m0, s36, 99072
    s_nop 0
    buffer_load_dwordx4 v4, s[12:15], s37 offen offset:256 lds
    s_add_u32 s38, s33, 8192
    s_add_u32 m0, s34, 81920
    s_nop 0
    buffer_load_dwordx4 v15, s[24:27], s38 offen offset:0  lds
    buffer_load_dwordx4 v15, s[24:27], s38 offen offset:1024  lds
    buffer_load_dwordx4 v15, s[24:27], s38 offen offset:2048  lds
    buffer_load_dwordx4 v15, s[24:27], s38 offen offset:3072  lds
    s_setprio 0
    v_mul_f32 v24, s46, v64
    v_mul_f32 v25, s46, v65
    v_mul_f32 v26, s46, v66
    v_mul_f32 v27, s46, v67
    v_exp_f32 v24, v24
    v_exp_f32 v25, v25
    v_exp_f32 v26, v26
    v_exp_f32 v27, v27
    v_fma_f32 v24, v24, v6, v6
    v_fma_f32 v25, v25, v6, v6
    v_fma_f32 v26, v26, v6, v6
    v_fma_f32 v27, v27, v6, v6
    v_rcp_f32 v24, v24
    v_rcp_f32 v25, v25
    v_rcp_f32 v26, v26
    v_rcp_f32 v27, v27
    v_mul_f32 v24, v64, v24
    v_mul_f32 v25, v65, v25
    v_mul_f32 v26, v66, v26
    v_mul_f32 v27, v67, v27
    v_cvt_pk_bf16_f32 v16, v24, v25
    v_cvt_pk_bf16_f32 v17, v26, v27
    v_mul_f32 v28, s46, v68
    v_mul_f32 v29, s46, v69
    v_mul_f32 v30, s46, v70
    v_mul_f32 v31, s46, v71
    v_exp_f32 v28, v28
    v_exp_f32 v29, v29
    v_exp_f32 v30, v30
    v_exp_f32 v31, v31
    v_fma_f32 v28, v28, v6, v6
    v_fma_f32 v29, v29, v6, v6
    v_fma_f32 v30, v30, v6, v6
    v_fma_f32 v31, v31, v6, v6
    v_rcp_f32 v28, v28
    v_rcp_f32 v29, v29
    v_rcp_f32 v30, v30
    v_rcp_f32 v31, v31
    v_mul_f32 v28, v68, v28
    v_mul_f32 v29, v69, v29
    v_mul_f32 v30, v70, v30
    v_mul_f32 v31, v71, v31
    v_cvt_pk_bf16_f32 v18, v28, v29
    v_cvt_pk_bf16_f32 v19, v30, v31
    s_add_u32 s51, s45, 61440
    buffer_store_dwordx4 v[16:19], v15, s[24:27], s51 offen offset:0 sc1
    s_waitcnt vmcnt(15)
    s_barrier
    s_waitcnt vmcnt(11)
    v_cmp_eq_u64 vcc, v[10:11], v[2:3]
    s_nop 0
    s_cmp_eq_u64 vcc, -1
    s_cbranch_scc1 POK15
s_mov_b32 s53, 0
PSP15:
 s_sleep 2
 buffer_load_dwordx2 v[10:11], v0, s[24:27], s39 offen offset:48 sc1
 s_add_u32 s53, s53, 1
 s_waitcnt vmcnt(0)
 v_cmp_eq_u64 vcc, v[10:11], v[2:3]
 s_cmp_ge_u32 s53, 0x40000
 s_cbranch_scc1 POK15
 s_nop 1
 s_cmp_eq_u64 vcc, -1
 s_cbranch_scc0 PSP15
POK15:
    s_add_u32 s37, s35, 36864
    s_add_u32 m0, s36, 122880
    s_nop 0
    buffer_load_dwordx4 v4, s[12:15], s37 offen offset:0 lds
    s_add_u32 m0, s36, 130944
    s_nop 0
    buffer_load_dwordx4 v4, s[12:15], s37 offen offset:128 lds
    s_add_u32 m0, s36, 139008
    s_nop 0
    buffer_load_dwordx4 v4, s[12:15], s37 offen offset:256 lds
    s_add_u32 s37, s35, 46080
    s_add_u32 m0, s36, 123904
    s_nop 0
    buffer_load_dwordx4 v4, s[12:15], s37 offen offset:0 lds
    s_add_u32 m0, s36, 131968
    s_nop 0
    buffer_load_dwordx4 v4, s[12:15], s37 offen offset:128 lds
    s_add_u32 m0, s36, 140032
    s_nop 0
    buffer_load_dwordx4 v4, s[12:15], s37 offen offset:256 lds
    s_add_u32 s38, s33, 12288
    s_add_u32 m0, s34, 122880
    s_nop 0
    buffer_load_dwordx4 v15, s[24:27], s38 offen offset:0  lds
    buffer_load_dwordx4 v15, s[24:27], s38 offen offset:1024  lds
    buffer_load_dwordx4 v15, s[24:27], s38 offen offset:2048  lds
    buffer_load_dwordx4 v15, s[24:27], s38 offen offset:3072  lds
    v_mul_f32 v24, s46, v72
    v_mul_f32 v25, s46, v73
    v_mul_f32 v26, s46, v74
    v_mul_f32 v27, s46, v75
    v_exp_f32 v24, v24
    v_exp_f32 v25, v25
    v_exp_f32 v26, v26
    v_exp_f32 v27, v27
    v_fma_f32 v24, v24, v6, v6
    v_fma_f32 v25, v25, v6, v6
    v_fma_f32 v26, v26, v6, v6
    v_fma_f32 v27, v27, v6, v6
    v_rcp_f32 v24, v24
    v_rcp_f32 v25, v25
    v_rcp_f32 v26, v26
    v_rcp_f32 v27, v27
    v_mul_f32 v24, v72, v24
    v_mul_f32 v25, v73, v25
    v_mul_f32 v26, v74, v26
    v_mul_f32 v27, v75, v27
    v_cvt_pk_bf16_f32 v20, v24, v25
    v_cvt_pk_bf16_f32 v21, v26, v27
    v_mul_f32 v28, s46, v76
    v_mul_f32 v29, s46, v77
    v_mul_f32 v30, s46, v78
    v_mul_f32 v31, s46, v79
    v_exp_f32 v28, v28
    v_exp_f32 v29, v29
    v_exp_f32 v30, v30
    v_exp_f32 v31, v31
    v_fma_f32 v28, v28, v6, v6
    v_fma_f32 v29, v29, v6, v6
    v_fma_f32 v30, v30, v6, v6
    v_fma_f32 v31, v31, v6, v6
    v_rcp_f32 v28, v28
    v_rcp_f32 v29, v29
    v_rcp_f32 v30, v30
    v_rcp_f32 v31, v31
    v_mul_f32 v28, v76, v28
    v_mul_f32 v29, v77, v29
    v_mul_f32 v30, v78, v30
    v_mul_f32 v31, v79, v31
    v_cvt_pk_bf16_f32 v22, v28, v29
    v_cvt_pk_bf16_f32 v23, v30, v31
    buffer_store_dwordx4 v[20:23], v15, s[24:27], s51 offen offset:1024 sc1
    s_waitcnt vmcnt(12)
    s_barrier
    s_add_u32 s37, s35, 479232
    s_add_u32 m0, s36, 0
    s_nop 0
    buffer_load_dwordx4 v4, s[12:15], s37 offen offset:0 lds
    s_add_u32 m0, s36, 8064
    s_nop 0
    buffer_load_dwordx4 v4, s[12:15], s37 offen offset:128 lds
    s_add_u32 m0, s36, 16128
    s_nop 0
    buffer_load_dwordx4 v4, s[12:15], s37 offen offset:256 lds
    s_add_u32 s37, s35, 488448
    s_add_u32 m0, s36, 1024
    s_nop 0
    buffer_load_dwordx4 v4, s[12:15], s37 offen offset:0 lds
    s_add_u32 m0, s36, 9088
    s_nop 0
    buffer_load_dwordx4 v4, s[12:15], s37 offen offset:128 lds
    s_add_u32 m0, s36, 17152
    s_nop 0
    buffer_load_dwordx4 v4, s[12:15], s37 offen offset:256 lds
    s_add_u32 s38, s33, 16384
    s_add_u32 m0, s34, 0
    s_nop 0
    buffer_load_dwordx4 v15, s[24:27], s38 offen offset:0  lds
    buffer_load_dwordx4 v15, s[24:27], s38 offen offset:1024  lds
    buffer_load_dwordx4 v15, s[24:27], s38 offen offset:2048  lds
    buffer_load_dwordx4 v15, s[24:27], s38 offen offset:3072  lds
    s_waitcnt vmcnt(11)
    s_barrier
    buffer_load_dwordx2 v[10:11], v0, s[24:27], s39 offen offset:96 sc1
    s_add_u32 s37, s35, 921600
    s_add_u32 m0, s36, 40960
    s_nop 0
    buffer_load_dwordx4 v4, s[12:15], s37 offen offset:0 lds
    s_add_u32 m0, s36, 49024
    s_nop 0
    buffer_load_dwordx4 v4, s[12:15], s37 offen offset:128 lds
    s_add_u32 m0, s36, 57088
    s_nop 0
    buffer_load_dwordx4 v4, s[12:15], s37 offen offset:256 lds
    s_add_u32 s37, s35, 930816
    s_add_u32 m0, s36, 41984
    s_nop 0
    buffer_load_dwordx4 v4, s[12:15], s37 offen offset:0 lds
    s_add_u32 m0, s36, 50048
    s_nop 0
    buffer_load_dwordx4 v4, s[12:15], s37 offen offset:128 lds
    s_add_u32 m0, s36, 58112
    s_nop 0
    buffer_load_dwordx4 v4, s[12:15], s37 offen offset:256 lds
    s_add_u32 s38, s33, 20480
    s_add_u32 m0, s34, 40960
    s_nop 0
    buffer_load_dwordx4 v15, s[24:27], s38 offen offset:0  lds
    buffer_load_dwordx4 v15, s[24:27], s38 offen offset:1024  lds
    buffer_load_dwordx4 v15, s[24:27], s38 offen offset:2048  lds
    buffer_load_dwordx4 v15, s[24:27], s38 offen offset:3072  lds
    s_waitcnt vmcnt(11)
    s_barrier
    s_waitcnt vmcnt(10)
    v_cmp_eq_u64 vcc, v[10:11], v[2:3]
    s_nop 0
    s_cmp_eq_u64 vcc, -1
    s_cbranch_scc1 POK16
s_mov_b32 s53, 0
PSP16:
 s_sleep 2
 buffer_load_dwordx2 v[10:11], v0, s[24:27], s39 offen offset:96 sc1
 s_add_u32 s53, s53, 1
 s_waitcnt vmcnt(0)
 v_cmp_eq_u64 vcc, v[10:11], v[2:3]
 s_cmp_ge_u32 s53, 0x40000
 s_cbranch_scc1 POK16
 s_nop 1
 s_cmp_eq_u64 vcc, -1
 s_cbranch_scc0 PSP16
POK16:
    s_add_u32 s37, s35, 73728
    s_add_u32 m0, s36, 81920
    s_nop 0
    buffer_load_dwordx4 v4, s[12:15], s37 offen offset:0 lds
    s_add_u32 m0, s36, 89984
    s_nop 0
    buffer_load_dwordx4 v4, s[12:15], s37 offen offset:128 lds
    s_add_u32 m0, s36, 98048
    s_nop 0
    buffer_load_dwordx4 v4, s[12:15], s37 offen offset:256 lds
    s_add_u32 s37, s35, 82944
    s_add_u32 m0, s36, 82944
    s_nop 0
    buffer_load_dwordx4 v4, s[12:15], s37 offen offset:0 lds
    s_add_u32 m0, s36, 91008
    s_nop 0
    buffer_load_dwordx4 v4, s[12:15], s37 offen offset:128 lds
    s_add_u32 m0, s36, 99072
    s_nop 0
    buffer_load_dwordx4 v4, s[12:15], s37 offen offset:256 lds
    s_add_u32 s38, s33, 24576
    s_add_u32 m0, s34, 81920
    s_nop 0
    buffer_load_dwordx4 v15, s[24:27], s38 offen offset:0  lds
    buffer_load_dwordx4 v15, s[24:27], s38 offen offset:1024  lds
    buffer_load_dwordx4 v15, s[24:27], s38 offen offset:2048  lds
    buffer_load_dwordx4 v15, s[24:27], s38 offen offset:3072  lds
    buffer_store_dwordx2 v[2:3], v8, s[24:27], s52 offen offset:192 sc1
    s_waitcnt vmcnt(11)
    s_barrier
    s_add_u32 s37, s35, 516096
    s_add_u32 m0, s36, 122880
    s_nop 0
    buffer_load_dwordx4 v4, s[12:15], s37 offen offset:0 lds
    s_add_u32 m0, s36, 130944
    s_nop 0
    buffer_load_dwordx4 v4, s[12:15], s37 offen offset:128 lds
    s_add_u32 m0, s36, 139008
    s_nop 0
    buffer_load_dwordx4 v4, s[12:15], s37 offen offset:256 lds
    s_add_u32 s37, s35, 525312
    s_add_u32 m0, s36, 123904
    s_nop 0
    buffer_load_dwordx4 v4, s[12:15], s37 offen offset:0 lds
    s_add_u32 m0, s36, 131968
    s_nop 0
    buffer_load_dwordx4 v4, s[12:15], s37 offen offset:128 lds
    s_add_u32 m0, s36, 140032
    s_nop 0
    buffer_load_dwordx4 v4, s[12:15], s37 offen offset:256 lds
    s_add_u32 s38, s33, 28672
    s_add_u32 m0, s34, 122880
    s_nop 0
    buffer_load_dwordx4 v15, s[24:27], s38 offen offset:0  lds
    buffer_load_dwordx4 v15, s[24:27], s38 offen offset:1024  lds
    buffer_load_dwordx4 v15, s[24:27], s38 offen offset:2048  lds
    buffer_load_dwordx4 v15, s[24:27], s38 offen offset:3072  lds
    s_waitcnt vmcnt(11)
    s_barrier
    buffer_load_dwordx2 v[10:11], v0, s[24:27], s39 offen offset:144 sc1
    s_add_u32 s37, s35, 958464
    s_add_u32 m0, s36, 0
    s_nop 0
    buffer_load_dwordx4 v4, s[12:15], s37 offen offset:0 lds
    s_add_u32 m0, s36, 8064
    s_nop 0
    buffer_load_dwordx4 v4, s[12:15], s37 offen offset:128 lds
    s_add_u32 m0, s36, 16128
    s_nop 0
    buffer_load_dwordx4 v4, s[12:15], s37 offen offset:256 lds
    s_add_u32 s37, s35, 967680
    s_add_u32 m0, s36, 1024
    s_nop 0
    buffer_load_dwordx4 v4, s[12:15], s37 offen offset:0 lds
    s_add_u32 m0, s36, 9088
    s_nop 0
    buffer_load_dwordx4 v4, s[12:15], s37 offen offset:128 lds
    s_add_u32 m0, s36, 17152
    s_nop 0
    buffer_load_dwordx4 v4, s[12:15], s37 offen offset:256 lds
    s_add_u32 s38, s33, 32768
    s_add_u32 m0, s34, 0
    s_nop 0
    buffer_load_dwordx4 v15, s[24:27], s38 offen offset:0  lds
    buffer_load_dwordx4 v15, s[24:27], s38 offen offset:1024  lds
    buffer_load_dwordx4 v15, s[24:27], s38 offen offset:2048  lds
    buffer_load_dwordx4 v15, s[24:27], s38 offen offset:3072  lds
    s_waitcnt vmcnt(11)
    s_barrier
    s_waitcnt vmcnt(10)
    v_cmp_eq_u64 vcc, v[10:11], v[2:3]
    s_nop 0
    s_cmp_eq_u64 vcc, -1
    s_cbranch_scc1 POK17
s_mov_b32 s53, 0
PSP17:
 s_sleep 2
 buffer_load_dwordx2 v[10:11], v0, s[24:27], s39 offen offset:144 sc1
 s_add_u32 s53, s53, 1
 s_waitcnt vmcnt(0)
 v_cmp_eq_u64 vcc, v[10:11], v[2:3]
 s_cmp_ge_u32 s53, 0x40000
 s_cbranch_scc1 POK17
 s_nop 1
 s_cmp_eq_u64 vcc, -1
 s_cbranch_scc0 PSP17
POK17:
    s_add_u32 s37, s35, 110592
    s_add_u32 m0, s36, 40960
    s_nop 0
    buffer_load_dwordx4 v4, s[12:15], s37 offen offset:0 lds
    s_add_u32 m0, s36, 49024
    s_nop 0
    buffer_load_dwordx4 v4, s[12:15], s37 offen offset:128 lds
    s_add_u32 m0, s36, 57088
    s_nop 0
    buffer_load_dwordx4 v4, s[12:15], s37 offen offset:256 lds
    s_add_u32 s37, s35, 119808
    s_add_u32 m0, s36, 41984
    s_nop 0
    buffer_load_dwordx4 v4, s[12:15], s37 offen offset:0 lds
    s_add_u32 m0, s36, 50048
    s_nop 0
    buffer_load_dwordx4 v4, s[12:15], s37 offen offset:128 lds
    s_add_u32 m0, s36, 58112
    s_nop 0
    buffer_load_dwordx4 v4, s[12:15], s37 offen offset:256 lds
    s_add_u32 s38, s33, 36864
    s_add_u32 m0, s34, 40960
    s_nop 0
    buffer_load_dwordx4 v15, s[24:27], s38 offen offset:0  lds
    buffer_load_dwordx4 v15, s[24:27], s38 offen offset:1024  lds
    buffer_load_dwordx4 v15, s[24:27], s38 offen offset:2048  lds
    buffer_load_dwordx4 v15, s[24:27], s38 offen offset:3072  lds
    buffer_store_dwordx2 v[2:3], v8, s[24:27], s52 offen offset:240 sc1
    s_waitcnt vmcnt(11)
    s_barrier
    s_add_u32 s37, s35, 552960
    s_add_u32 m0, s36, 81920
    s_nop 0
    buffer_load_dwordx4 v4, s[12:15], s37 offen offset:0 lds
    s_add_u32 m0, s36, 89984
    s_nop 0
    buffer_load_dwordx4 v4, s[12:15], s37 offen offset:128 lds
    s_add_u32 m0, s36, 98048
    s_nop 0
    buffer_load_dwordx4 v4, s[12:15], s37 offen offset:256 lds
    s_add_u32 s37, s35, 562176
    s_add_u32 m0, s36, 82944
    s_nop 0
    buffer_load_dwordx4 v4, s[12:15], s37 offen offset:0 lds
    s_add_u32 m0, s36, 91008
    s_nop 0
    buffer_load_dwordx4 v4, s[12:15], s37 offen offset:128 lds
    s_add_u32 m0, s36, 99072
    s_nop 0
    buffer_load_dwordx4 v4, s[12:15], s37 offen offset:256 lds
    s_add_u32 s38, s33, 40960
    s_add_u32 m0, s34, 81920
    s_nop 0
    buffer_load_dwordx4 v15, s[24:27], s38 offen offset:0  lds
    buffer_load_dwordx4 v15, s[24:27], s38 offen offset:1024  lds
    buffer_load_dwordx4 v15, s[24:27], s38 offen offset:2048  lds
    buffer_load_dwordx4 v15, s[24:27], s38 offen offset:3072  lds
    s_waitcnt vmcnt(11)
    s_barrier
    buffer_load_dwordx2 v[10:11], v0, s[24:27], s39 offen offset:192 sc1
    s_add_u32 s37, s35, 995328
    s_add_u32 m0, s36, 122880
    s_nop 0
    buffer_load_dwordx4 v4, s[12:15], s37 offen offset:0 lds
    s_add_u32 m0, s36, 130944
    s_nop 0
    buffer_load_dwordx4 v4, s[12:15], s37 offen offset:128 lds
    s_add_u32 m0, s36, 139008
    s_nop 0
    buffer_load_dwordx4 v4, s[12:15], s37 offen offset:256 lds
    s_add_u32 s37, s35, 1004544
    s_add_u32 m0, s36, 123904
    s_nop 0
    buffer_load_dwordx4 v4, s[12:15], s37 offen offset:0 lds
    s_add_u32 m0, s36, 131968
    s_nop 0
    buffer_load_dwordx4 v4, s[12:15], s37 offen offset:128 lds
    s_add_u32 m0, s36, 140032
    s_nop 0
    buffer_load_dwordx4 v4, s[12:15], s37 offen offset:256 lds
    s_add_u32 s38, s33, 45056
    s_add_u32 m0, s34, 122880
    s_nop 0
    buffer_load_dwordx4 v15, s[24:27], s38 offen offset:0  lds
    buffer_load_dwordx4 v15, s[24:27], s38 offen offset:1024  lds
    buffer_load_dwordx4 v15, s[24:27], s38 offen offset:2048  lds
    buffer_load_dwordx4 v15, s[24:27], s38 offen offset:3072  lds
    s_waitcnt vmcnt(11)
    s_barrier
    s_waitcnt vmcnt(10)
    v_cmp_eq_u64 vcc, v[10:11], v[2:3]
    s_nop 0
    s_cmp_eq_u64 vcc, -1
    s_cbranch_scc1 POK18
s_mov_b32 s53, 0
PSP18:
 s_sleep 2
 buffer_load_dwordx2 v[10:11], v0, s[24:27], s39 offen offset:192 sc1
 s_add_u32 s53, s53, 1
 s_waitcnt vmcnt(0)
 v_cmp_eq_u64 vcc, v[10:11], v[2:3]
 s_cmp_ge_u32 s53, 0x40000
 s_cbranch_scc1 POK18
 s_nop 1
 s_cmp_eq_u64 vcc, -1
 s_cbranch_scc0 PSP18
POK18:
    s_add_u32 s37, s35, 147456
    s_add_u32 m0, s36, 0
    s_nop 0
    buffer_load_dwordx4 v4, s[12:15], s37 offen offset:0 lds
    s_add_u32 m0, s36, 8064
    s_nop 0
    buffer_load_dwordx4 v4, s[12:15], s37 offen offset:128 lds
    s_add_u32 m0, s36, 16128
    s_nop 0
    buffer_load_dwordx4 v4, s[12:15], s37 offen offset:256 lds
    s_add_u32 s37, s35, 156672
    s_add_u32 m0, s36, 1024
    s_nop 0
    buffer_load_dwordx4 v4, s[12:15], s37 offen offset:0 lds
    s_add_u32 m0, s36, 9088
    s_nop 0
    buffer_load_dwordx4 v4, s[12:15], s37 offen offset:128 lds
    s_add_u32 m0, s36, 17152
    s_nop 0
    buffer_load_dwordx4 v4, s[12:15], s37 offen offset:256 lds
    s_add_u32 s38, s33, 49152
    s_add_u32 m0, s34, 0
    s_nop 0
    buffer_load_dwordx4 v15, s[24:27], s38 offen offset:0  lds
    buffer_load_dwordx4 v15, s[24:27], s38 offen offset:1024  lds
    buffer_load_dwordx4 v15, s[24:27], s38 offen offset:2048  lds
    buffer_load_dwordx4 v15, s[24:27], s38 offen offset:3072  lds
    s_waitcnt vmcnt(10)
    s_barrier
    s_add_u32 s37, s35, 589824
    s_add_u32 m0, s36, 40960
    s_nop 0
    buffer_load_dwordx4 v4, s[12:15], s37 offen offset:0 lds
    s_add_u32 m0, s36, 49024
    s_nop 0
    buffer_load_dwordx4 v4, s[12:15], s37 offen offset:128 lds
    s_add_u32 m0, s36, 57088
    s_nop 0
    buffer_load_dwordx4 v4, s[12:15], s37 offen offset:256 lds
    s_add_u32 s37, s35, 599040
    s_add_u32 m0, s36, 41984
    s_nop 0
    buffer_load_dwordx4 v4, s[12:15], s37 offen offset:0 lds
    s_add_u32 m0, s36, 50048
    s_nop 0
    buffer_load_dwordx4 v4, s[12:15], s37 offen offset:128 lds
    s_add_u32 m0, s36, 58112
    s_nop 0
    buffer_load_dwordx4 v4, s[12:15], s37 offen offset:256 lds
    s_add_u32 s38, s33, 53248
    s_add_u32 m0, s34, 40960
    s_nop 0
    buffer_load_dwordx4 v15, s[24:27], s38 offen offset:0  lds
    buffer_load_dwordx4 v15, s[24:27], s38 offen offset:1024  lds
    buffer_load_dwordx4 v15, s[24:27], s38 offen offset:2048  lds
    buffer_load_dwordx4 v15, s[24:27], s38 offen offset:3072  lds
    s_waitcnt vmcnt(10)
    s_barrier
    buffer_load_dwordx2 v[10:11], v0, s[24:27], s39 offen offset:240 sc1
    s_add_u32 s37, s35, 1032192
    s_add_u32 m0, s36, 81920
    s_nop 0
    buffer_load_dwordx4 v4, s[12:15], s37 offen offset:0 lds
    s_add_u32 m0, s36, 89984
    s_nop 0
    buffer_load_dwordx4 v4, s[12:15], s37 offen offset:128 lds
    s_add_u32 m0, s36, 98048
    s_nop 0
    buffer_load_dwordx4 v4, s[12:15], s37 offen offset:256 lds
    s_add_u32 s37, s35, 1041408
    s_add_u32 m0, s36, 82944
    s_nop 0
    buffer_load_dwordx4 v4, s[12:15], s37 offen offset:0 lds
    s_add_u32 m0, s36, 91008
    s_nop 0
    buffer_load_dwordx4 v4, s[12:15], s37 offen offset:128 lds
    s_add_u32 m0, s36, 99072
    s_nop 0
    buffer_load_dwordx4 v4, s[12:15], s37 offen offset:256 lds
    s_add_u32 s38, s33, 57344
    s_add_u32 m0, s34, 81920
    s_nop 0
    buffer_load_dwordx4 v15, s[24:27], s38 offen offset:0  lds
    buffer_load_dwordx4 v15, s[24:27], s38 offen offset:1024  lds
    buffer_load_dwordx4 v15, s[24:27], s38 offen offset:2048  lds
    buffer_load_dwordx4 v15, s[24:27], s38 offen offset:3072  lds
    s_waitcnt vmcnt(11)
    s_barrier
    s_waitcnt vmcnt(10)
    v_cmp_eq_u64 vcc, v[10:11], v[2:3]
    s_nop 0
    s_cmp_eq_u64 vcc, -1
    s_cbranch_scc1 POK19
s_mov_b32 s53, 0
PSP19:
 s_sleep 2
 buffer_load_dwordx2 v[10:11], v0, s[24:27], s39 offen offset:240 sc1
 s_add_u32 s53, s53, 1
 s_waitcnt vmcnt(0)
 v_cmp_eq_u64 vcc, v[10:11], v[2:3]
 s_cmp_ge_u32 s53, 0x40000
 s_cbranch_scc1 POK19
 s_nop 1
 s_cmp_eq_u64 vcc, -1
 s_cbranch_scc0 PSP19
POK19:
    s_add_u32 s37, s35, 184320
    s_add_u32 m0, s36, 122880
    s_nop 0
    buffer_load_dwordx4 v4, s[12:15], s37 offen offset:0 lds
    s_add_u32 m0, s36, 130944
    s_nop 0
    buffer_load_dwordx4 v4, s[12:15], s37 offen offset:128 lds
    s_add_u32 m0, s36, 139008
    s_nop 0
    buffer_load_dwordx4 v4, s[12:15], s37 offen offset:256 lds
    s_add_u32 s37, s35, 193536
    s_add_u32 m0, s36, 123904
    s_nop 0
    buffer_load_dwordx4 v4, s[12:15], s37 offen offset:0 lds
    s_add_u32 m0, s36, 131968
    s_nop 0
    buffer_load_dwordx4 v4, s[12:15], s37 offen offset:128 lds
    s_add_u32 m0, s36, 140032
    s_nop 0
    buffer_load_dwordx4 v4, s[12:15], s37 offen offset:256 lds
    s_add_u32 s38, s33, 61440
    s_add_u32 m0, s34, 122880
    s_nop 0
    buffer_load_dwordx4 v15, s[24:27], s38 offen offset:0  lds
    buffer_load_dwordx4 v15, s[24:27], s38 offen offset:1024  lds
    buffer_load_dwordx4 v15, s[24:27], s38 offen offset:2048  lds
    buffer_load_dwordx4 v15, s[24:27], s38 offen offset:3072  lds
    s_waitcnt vmcnt(10)
    s_barrier
    s_add_u32 s37, s35, 626688
    s_add_u32 m0, s36, 0
    s_nop 0
    buffer_load_dwordx4 v4, s[12:15], s37 offen offset:0 lds
    s_add_u32 m0, s36, 8064
    s_nop 0
    buffer_load_dwordx4 v4, s[12:15], s37 offen offset:128 lds
    s_add_u32 m0, s36, 16128
    s_nop 0
    buffer_load_dwordx4 v4, s[12:15], s37 offen offset:256 lds
    s_add_u32 s37, s35, 635904
    s_add_u32 m0, s36, 1024
    s_nop 0
    buffer_load_dwordx4 v4, s[12:15], s37 offen offset:0 lds
    s_add_u32 m0, s36, 9088
    s_nop 0
    buffer_load_dwordx4 v4, s[12:15], s37 offen offset:128 lds
    s_add_u32 m0, s36, 17152
    s_nop 0
    buffer_load_dwordx4 v4, s[12:15], s37 offen offset:256 lds
    s_add_u32 s38, s33, 65536
    s_add_u32 m0, s34, 0
    s_nop 0
    buffer_load_dwordx4 v15, s[24:27], s38 offen offset:0  lds
    buffer_load_dwordx4 v15, s[24:27], s38 offen offset:1024  lds
    buffer_load_dwordx4 v15, s[24:27], s38 offen offset:2048  lds
    buffer_load_dwordx4 v15, s[24:27], s38 offen offset:3072  lds
    s_waitcnt vmcnt(10)
    s_barrier
    buffer_load_dwordx2 v[10:11], v5, s[24:27], s47 offen offset:0 sc1
    s_add_u32 s37, s35, 1069056
    s_add_u32 m0, s36, 40960
    s_nop 0
    buffer_load_dwordx4 v4, s[12:15], s37 offen offset:0 lds
    s_add_u32 m0, s36, 49024
    s_nop 0
    buffer_load_dwordx4 v4, s[12:15], s37 offen offset:128 lds
    s_add_u32 m0, s36, 57088
    s_nop 0
    buffer_load_dwordx4 v4, s[12:15], s37 offen offset:256 lds
    s_add_u32 s37, s35, 1078272
    s_add_u32 m0, s36, 41984
    s_nop 0
    buffer_load_dwordx4 v4, s[12:15], s37 offen offset:0 lds
    s_add_u32 m0, s36, 50048
    s_nop 0
    buffer_load_dwordx4 v4, s[12:15], s37 offen offset:128 lds
    s_add_u32 m0, s36, 58112
    s_nop 0
    buffer_load_dwordx4 v4, s[12:15], s37 offen offset:256 lds
    s_add_u32 s38, s33, 69632
    s_add_u32 m0, s34, 40960
    s_nop 0
    buffer_load_dwordx4 v15, s[24:27], s38 offen offset:0  lds
    buffer_load_dwordx4 v15, s[24:27], s38 offen offset:1024  lds
    buffer_load_dwordx4 v15, s[24:27], s38 offen offset:2048  lds
    buffer_load_dwordx4 v15, s[24:27], s38 offen offset:3072  lds
    s_waitcnt vmcnt(11)
    s_barrier
    s_waitcnt vmcnt(10)
    v_cmp_eq_u64 vcc, v[10:11], v[2:3]
    s_nop 0
    s_cmp_eq_u64 vcc, -1
    s_cbranch_scc1 POK20
s_mov_b32 s53, 0
PSP20:
 s_sleep 2
 buffer_load_dwordx2 v[10:11], v5, s[24:27], s47 offen offset:0 sc1
 s_add_u32 s53, s53, 1
 s_waitcnt vmcnt(0)
 v_cmp_eq_u64 vcc, v[10:11], v[2:3]
 s_cmp_ge_u32 s53, 0x40000
 s_cbranch_scc1 POK20
 s_nop 1
 s_cmp_eq_u64 vcc, -1
 s_cbranch_scc0 PSP20
POK20:
    s_add_u32 s37, s43, 0
    s_add_u32 m0, s36, 81920
    s_nop 0
    buffer_load_dwordx4 v4, s[16:19], s37 offen offset:0 lds
    s_add_u32 m0, s36, 89984
    s_nop 0
    buffer_load_dwordx4 v4, s[16:19], s37 offen offset:128 lds
    s_add_u32 m0, s36, 98048
    s_nop 0
    buffer_load_dwordx4 v4, s[16:19], s37 offen offset:256 lds
    s_add_u32 s37, s43, 9216
    s_add_u32 m0, s36, 82944
    s_nop 0
    buffer_load_dwordx4 v4, s[16:19], s37 offen offset:0 lds
    s_add_u32 m0, s36, 91008
    s_nop 0
    buffer_load_dwordx4 v4, s[16:19], s37 offen offset:128 lds
    s_add_u32 m0, s36, 99072
    s_nop 0
    buffer_load_dwordx4 v4, s[16:19], s37 offen offset:256 lds
    s_add_u32 s38, s40, 0
    s_add_u32 m0, s34, 81920
    s_nop 0
    buffer_load_dwordx4 v7, s[24:27], s38 offen  lds
    s_add_u32 s38, s40, 65536
    s_add_u32 m0, s34, 82944
    s_nop 0
    buffer_load_dwordx4 v7, s[24:27], s38 offen  lds
    s_add_u32 s38, s40, 131072
    s_add_u32 m0, s34, 83968
    s_nop 0
    buffer_load_dwordx4 v7, s[24:27], s38 offen  lds
    s_add_u32 s38, s40, 196608
    s_add_u32 m0, s34, 84992
    s_nop 0
    buffer_load_dwordx4 v7, s[24:27], s38 offen  lds
    s_waitcnt vmcnt(10)
    s_barrier
    s_add_u32 s37, s43, 73728
    s_add_u32 m0, s36, 122880
    s_nop 0
    buffer_load_dwordx4 v4, s[16:19], s37 offen offset:0 lds
    s_add_u32 m0, s36, 130944
    s_nop 0
    buffer_load_dwordx4 v4, s[16:19], s37 offen offset:128 lds
    s_add_u32 m0, s36, 139008
    s_nop 0
    buffer_load_dwordx4 v4, s[16:19], s37 offen offset:256 lds
    s_add_u32 s37, s43, 82944
    s_add_u32 m0, s36, 123904
    s_nop 0
    buffer_load_dwordx4 v4, s[16:19], s37 offen offset:0 lds
    s_add_u32 m0, s36, 131968
    s_nop 0
    buffer_load_dwordx4 v4, s[16:19], s37 offen offset:128 lds
    s_add_u32 m0, s36, 140032
    s_nop 0
    buffer_load_dwordx4 v4, s[16:19], s37 offen offset:256 lds
    s_add_u32 s38, s40, 262144
    s_add_u32 m0, s34, 122880
    s_nop 0
    buffer_load_dwordx4 v7, s[24:27], s38 offen  lds
    s_add_u32 s38, s40, 327680
    s_add_u32 m0, s34, 123904
    s_nop 0
    buffer_load_dwordx4 v7, s[24:27], s38 offen  lds
    s_add_u32 s38, s40, 393216
    s_add_u32 m0, s34, 124928
    s_nop 0
    buffer_load_dwordx4 v7, s[24:27], s38 offen  lds
    s_add_u32 s38, s40, 458752
    s_add_u32 m0, s34, 125952
    s_nop 0
    buffer_load_dwordx4 v7, s[24:27], s38 offen  lds
    s_waitcnt vmcnt(10)
    s_barrier
    s_mov_b32 s42, s32
    s_and_b32 s38, s42, 1
    s_lshr_b32 s42, s42, 1
    s_mul_i32 s37, s38, 9216
    s_add_u32 s37, s37, s44
    s_add_u32 s37, s37, 147456
    s_lshl_b32 s38, s38, 10
    s_lshl_b32 s48, s42, 7
    s_add_u32 s37, s37, s48
    s_lshl_b32 s42, s42, 13
    s_add_u32 s42, s42, s38
    s_add_u32 m0, s42, 0
    s_nop 0
    buffer_load_dwordx4 v4, s[16:19], s37 offen lds
    s_add_u32 s42, s32, 4
    s_min_u32 s42, s42, 5
    s_and_b32 s38, s42, 1
    s_lshr_b32 s42, s42, 1
    s_mul_i32 s37, s38, 9216
    s_add_u32 s37, s37, s44
    s_add_u32 s37, s37, 147456
    s_lshl_b32 s38, s38, 10
    s_lshl_b32 s48, s42, 7
    s_add_u32 s37, s37, s48
    s_lshl_b32 s42, s42, 13
    s_add_u32 s42, s42, s38
    s_add_u32 m0, s42, 0
    s_nop 0
    buffer_load_dwordx4 v4, s[16:19], s37 offen lds
    s_add_u32 s38, s40, 524288
    s_add_u32 m0, s34, 0
    s_nop 0
    buffer_load_dwordx4 v7, s[24:27], s38 offen  lds
    s_waitcnt vmcnt(3)
    s_barrier
    s_waitcnt vmcnt(0)
    s_barrier
    s_endpgm
M_U:
    s_getpc_b64 s[20:21]
    s_add_u32 s20, s20, FTAB@rel32@lo+4
    s_addc_u32 s21, s21, FTAB@rel32@hi+12
    s_mov_b32 s22, 663552
    s_mov_b32 s23, 0x20000
    s_sub_u32 s30, s54, 24
    s_mov_b32 s55, s30
    s_and_b32 s29, s3, 1
    s_lshl_b32 s29, s29, 2
    s_lshr_b32 s42, s3, 1
    s_add_u32 s29, s29, s42
    s_lshl_b32 s31, s29, 3
    s_add_u32 s31, s31, s28
    s_mul_i32 s32, s31, 1152
    s_add_u32 s33, s32, 589824
    s_add_u32 s34, s32, 1179648
    s_add_u32 s35, s32, 1769472
    s_lshl_b32 s36, s28, 13
    s_add_u32 s36, s36, 98304
    s_mul_i32 s43, s30, 384
    s_and_b32 s41, s28, 3
    s_mul_i32 s37, s41, 18432
    s_lshr_b32 s42, s28, 2
    s_lshl_b32 s44, s42, 7
    s_add_u32 s37, s37, s44
    s_add_u32 s37, s37, s43
    s_lshl_b32 s41, s41, 11
    s_cmp_eq_u32 s42, 0
    s_cselect_b32 s38, 81920, 0
    s_cselect_b32 s40, 24576, 0
    s_add_u32 s38, s38, s41
    s_add_u32 s41, s55, s3
    s_mul_i32 s42, s41, 43
    s_lshr_b32 s42, s42, 7
    s_mul_i32 s42, s42, 3
    s_sub_u32 s59, s41, s42
    s_mul_i32 s57, s59, 384
    s_mul_i32 s58, s59, 221184
    s_add_u32 s37, s37, s58
    s_add_u32 s32, s32, s57
    s_add_u32 s33, s33, s57
    s_add_u32 s34, s34, s57
    s_add_u32 s35, s35, s57
    s_cmp_eq_u32 s59, 2
    s_cselect_b32 s60, 1152, 0
    s_cselect_b32 s62, 663552, 0
    s_cmp_eq_u32 s59, 1
    s_cselect_b32 s61, 1152, 0
    s_cselect_b32 s63, 663552, 0
    s_sub_u32 s60, s60, 384
    s_sub_u32 s61, s61, 384
    s_sub_u32 s62, s62, 221184
    s_sub_u32 s63, s63, 221184
    v_and_b32 v1, 63, v0
    v_lshrrev_b32 v4, 3, v1
    v_and_b32 v5, 7, v1
    v_lshrrev_b32 v6, 1, v4
    v_xor_b32 v5, v5, v6
    v_lshlrev_b32 v5, 4, v5
    s_mov_b32 s41, 73728
    v_mul_lo_u32 v4, v4, s41
    v_add_u32 v2, v4, v5
    v_xor_b32 v3, 64, v2
    v_lshrrev_b32 v5, 3, v1
    v_mul_u32_u24 v4, 1152, v5
    v_bfe_u32 v5, v1, 4, 1
    v_lshlrev_b32 v5, 2, v5
    v_and_b32 v6, 7, v1
    v_xor_b32 v6, v6, v5
    v_lshl_add_u32 v4, v6, 4, v4
    v_lshrrev_b32 v5, 2, v1
    v_lshrrev_b32 v6, 4, v1
    v_xor_b32 v5, v5, v6
    v_and_b32 v5, 1, v5
    v_and_b32 v6, 3, v1
    v_lshlrev_b32 v6, 5, v6
    v_lshrrev_b32 v7, 5, v1
    v_lshl_add_u32 v7, v7, 4, v6
    v_lshl_add_u32 v7, v5, 30, v7
    s_waitcnt lgkmcnt(0)
    s_mov_b32 s16, s4
    s_mov_b32 s17, s5
    s_mov_b32 s18, 0x240000
    s_mov_b32 s19, 0x20000
    s_mov_b32 s12, s10
    s_mov_b32 s13, s11
    s_mov_b32 s14, 0x480
    s_mov_b32 s15, 0x20000
    s_mov_b32 s24, s8
    s_mov_b32 s25, s9
    s_mov_b32 s26, 0x4000000
    s_mov_b32 s27, 0x20000
    s_add_u32 m0, s36, 0
    s_nop 0
    buffer_load_dwordx4 v2, s[16:19], s32 offen offset:0 lds
    s_add_u32 m0, s36, 1024
    s_nop 0
    buffer_load_dwordx4 v3, s[16:19], s33 offen offset:0 lds
    s_add_u32 m0, s36, 2048
    s_nop 0
    buffer_load_dwordx4 v2, s[16:19], s34 offen offset:0 lds
    s_add_u32 m0, s36, 3072
    s_nop 0
    buffer_load_dwordx4 v3, s[16:19], s35 offen offset:0 lds
    buffer_load_dwordx4 v[16:19], v7, s[12:15], s57 offen offset:0
    s_add_u32 s41, s37, 0
    s_add_u32 m0, s38, 0
    s_nop 0
    buffer_load_dwordx4 v4, s[20:23], s41 offen lds
    s_add_u32 s41, s37, 9216
    s_add_u32 m0, s38, 1024
    s_nop 0
    buffer_load_dwordx4 v4, s[20:23], s41 offen lds
    s_add_u32 m0, s36, 3968
    s_nop 0
    buffer_load_dwordx4 v2, s[16:19], s32 offen offset:128 lds
    s_add_u32 m0, s36, 4992
    s_nop 0
    buffer_load_dwordx4 v3, s[16:19], s33 offen offset:128 lds
    s_add_u32 m0, s36, 6016
    s_nop 0
    buffer_load_dwordx4 v2, s[16:19], s34 offen offset:128 lds
    s_add_u32 m0, s36, 7040
    s_nop 0
    buffer_load_dwordx4 v3, s[16:19], s35 offen offset:128 lds
    buffer_load_dwordx4 v[20:23], v7, s[12:15], s57 offen offset:128
    s_add_u32 s38, s38, 8192
    s_add_u32 s41, s37, 73728
    s_add_u32 m0, s38, 0
    s_nop 0
    buffer_load_dwordx4 v4, s[20:23], s41 offen lds
    s_add_u32 s41, s37, 82944
    s_add_u32 m0, s38, 1024
    s_nop 0
    buffer_load_dwordx4 v4, s[20:23], s41 offen lds
    v_lshlrev_b32 v15, 4, v1
    v_and_b32 v0, 31, v1
    v_lshrrev_b32 v6, 5, v1
    v_lshrrev_b32 v13, 1, v0
    v_and_b32 v13, 7, v13
    v_xor_b32 v13, v13, v6
    v_lshlrev_b32 v13, 4, v13
    v_lshlrev_b32 v0, 7, v0
    v_add_u32 v0, s36, v0
    v_xor_b32 v8, 0, v13
    v_add_u32 v8, v8, v0
    v_xor_b32 v9, 32, v13
    v_add_u32 v9, v9, v0
    v_xor_b32 v10, 64, v13
    v_add_u32 v10, v10, v0
    v_xor_b32 v11, 96, v13
    v_add_u32 v11, v11, v0
    v_lshrrev_b32 v0, 5, v1
    v_lshlrev_b32 v0, 10, v0
    v_bfe_u32 v6, v1, 2, 2
    v_lshl_add_u32 v0, v6, 7, v0
    v_bfe_u32 v6, v1, 3, 1
    v_lshl_add_u32 v0, v6, 6, v0
    v_bfe_u32 v6, v1, 4, 1
    v_lshl_add_u32 v0, v6, 5, v0
    v_and_b32 v6, 3, v1
    v_lshl_add_u32 v14, v6, 3, v0
    v_add_u32 v12, 73728, v14
    v_xor_b32 v13, 64, v12
    v_mov_b32 v0, 0
    s_mul_i32 s45, s30, 12288
    s_mul_i32 s41, s31, 36864
    s_add_u32 s45, s45, s41
    s_add_u32 s45, s45, 20971520
    s_mul_i32 s47, s28, 9216
    s_add_u32 s47, s47, s43
    s_add_u32 s47, s47, 256
    s_lshl_b32 s48, s28, 10
    s_add_u32 s47, s47, s58
    s_waitcnt vmcnt(7)
    s_barrier
    ds_read_b128 v[112:115], v8 offset:0
    ds_read_b128 v[116:119], v9 offset:0
    ds_read_b128 v[120:123], v10 offset:0
    ds_read_b128 v[124:127], v11 offset:0
    ds_read_b64_tr_b16 v[32:33], v12 offset:8192
    ds_read_b64_tr_b16 v[34:35], v12 offset:8704
    ds_read_b64_tr_b16 v[36:37], v13 offset:8192
    ds_read_b64_tr_b16 v[38:39], v13 offset:8704
    ds_read_b64_tr_b16 v[40:41], v14 offset:0
    ds_read_b64_tr_b16 v[42:43], v14 offset:512
    ds_read_b64_tr_b16 v[44:45], v12 offset:10240
    ds_read_b64_tr_b16 v[46:47], v12 offset:10752
    s_waitcnt lgkmcnt(6)
    v_mfma_f32_32x32x16_bf16 v[48:63], v[112:115], v[32:35], 0
    s_add_u32 s38, s38, 8192
    s_sub_u32 s38, s38, s40
    s_add_u32 s41, s37, 147456
    s_add_u32 m0, s38, 0
    s_nop 0
    buffer_load_dwordx4 v4, s[20:23], s41 offen lds
    s_add_u32 s41, s37, 156672
    s_add_u32 m0, s38, 1024
    s_nop 0
    buffer_load_dwordx4 v4, s[20:23], s41 offen lds
    s_add_u32 m0, s36, 4294967040
    s_nop 0
    buffer_load_dwordx4 v2, s[16:19], s32 offen offset:256 lds
    s_add_u32 m0, s36, 768
    s_nop 0
    buffer_load_dwordx4 v3, s[16:19], s33 offen offset:256 lds
    s_add_u32 m0, s36, 1792
    s_nop 0
    buffer_load_dwordx4 v2, s[16:19], s34 offen offset:256 lds
    s_add_u32 m0, s36, 2816
    s_nop 0
    buffer_load_dwordx4 v3, s[16:19], s35 offen offset:256 lds
    ds_read_b64_tr_b16 v[32:33], v13 offset:10240
    ds_read_b64_tr_b16 v[34:35], v13 offset:10752
    s_waitcnt lgkmcnt(6)
    v_mfma_f32_32x32x16_bf16 v[64:79], v[112:115], v[36:39], 0
    buffer_load_dwordx4 v[24:27], v7, s[12:15], s57 offen offset:256
    ds_read_b64_tr_b16 v[36:37], v14 offset:2048
    ds_read_b64_tr_b16 v[38:39], v14 offset:2560
    s_waitcnt lgkmcnt(6)
    v_mfma_f32_32x32x16_bf16 v[80:95], v[112:115], v[40:43], 0
    v_mfma_f32_16x16x32_bf16 v[96:99], v[16:19], v[112:115], 0
    ds_read_b64_tr_b16 v[40:41], v12 offset:12288
    ds_read_b64_tr_b16 v[42:43], v12 offset:12800
    s_waitcnt lgkmcnt(6)
    v_mfma_f32_32x32x16_bf16 v[48:63], v[116:119], v[44:47], v[48:63]
    ds_read_b64_tr_b16 v[44:45], v13 offset:12288
    ds_read_b64_tr_b16 v[46:47], v13 offset:12800
    s_waitcnt lgkmcnt(6)
    v_mfma_f32_32x32x16_bf16 v[64:79], v[116:119], v[32:35], v[64:79]
    v_mfma_f32_16x16x32_bf16 v[100:103], v[16:19], v[116:119], 0
    ds_read_b64_tr_b16 v[32:33], v14 offset:4096
    ds_read_b64_tr_b16 v[34:35], v14 offset:4608
    s_waitcnt lgkmcnt(6)
    v_mfma_f32_32x32x16_bf16 v[80:95], v[116:119], v[36:39], v[80:95]
    ds_read_b64_tr_b16 v[36:37], v12 offset:14336
    ds_read_b64_tr_b16 v[38:39], v12 offset:14848
    s_waitcnt lgkmcnt(6)
    v_mfma_f32_32x32x16_bf16 v[48:63], v[120:123], v[40:43], v[48:63]
    v_mfma_f32_16x16x32_bf16 v[104:107], v[16:19], v[120:123], 0
    ds_read_b64_tr_b16 v[40:41], v13 offset:14336
    ds_read_b64_tr_b16 v[42:43], v13 offset:14848
    s_waitcnt lgkmcnt(6)
    v_mfma_f32_32x32x16_bf16 v[64:79], v[120:123], v[44:47], v[64:79]
    ds_read_b64_tr_b16 v[44:45], v14 offset:6144
    ds_read_b64_tr_b16 v[46:47], v14 offset:6656
    s_waitcnt lgkmcnt(6)
    v_mfma_f32_32x32x16_bf16 v[80:95], v[120:123], v[32:35], v[80:95]
    v_mfma_f32_16x16x32_bf16 v[108:111], v[16:19], v[124:127], 0
    s_waitcnt vmcnt(7)
    s_waitcnt lgkmcnt(2)
    s_barrier
    ds_read_b128 v[128:131], v8 offset:4096
    ds_read_b128 v[132:135], v9 offset:4096
    ds_read_b128 v[136:139], v10 offset:4096
    ds_read_b128 v[140:143], v11 offset:4096
    ds_read_b64_tr_b16 v[32:33], v12 offset:16384
    ds_read_b64_tr_b16 v[34:35], v12 offset:16896
    v_mfma_f32_32x32x16_bf16 v[48:63], v[124:127], v[36:39], v[48:63]
    ds_read_b64_tr_b16 v[36:37], v13 offset:16384
    ds_read_b64_tr_b16 v[38:39], v13 offset:16896
    v_mfma_f32_32x32x16_bf16 v[64:79], v[124:127], v[40:43], v[64:79]
    s_sub_u32 s37, s37, s62
    s_add_u32 s38, s38, 8192
    s_add_u32 s41, s37, 0
    s_add_u32 m0, s38, 0
    s_nop 0
    buffer_load_dwordx4 v4, s[20:23], s41 offen lds
    s_add_u32 s41, s37, 9216
    s_add_u32 m0, s38, 1024
    s_nop 0
    buffer_load_dwordx4 v4, s[20:23], s41 offen lds
    ds_read_b64_tr_b16 v[40:41], v14 offset:8192
    ds_read_b64_tr_b16 v[42:43], v14 offset:8704
    s_waitcnt lgkmcnt(10)
    v_mfma_f32_32x32x16_bf16 v[80:95], v[124:127], v[44:47], v[80:95]
    s_waitcnt lgkmcnt(6)
    s_sub_u32 s32, s32, s60
    s_add_u32 m0, s36, 4096
    s_nop 0
    buffer_load_dwordx4 v2, s[16:19], s32 offen offset:0 lds
    s_sub_u32 s33, s33, s60
    s_add_u32 m0, s36, 5120
    s_nop 0
    buffer_load_dwordx4 v3, s[16:19], s33 offen offset:0 lds
    ds_read_b64_tr_b16 v[44:45], v12 offset:18432
    ds_read_b64_tr_b16 v[46:47], v12 offset:18944
    s_waitcnt lgkmcnt(6)
    v_mfma_f32_32x32x16_bf16 v[48:63], v[128:131], v[32:35], v[48:63]
    s_sub_u32 s34, s34, s60
    s_add_u32 m0, s36, 6144
    s_nop 0
    buffer_load_dwordx4 v2, s[16:19], s34 offen offset:0 lds
    s_sub_u32 s35, s35, s60
    s_add_u32 m0, s36, 7168
    s_nop 0
    buffer_load_dwordx4 v3, s[16:19], s35 offen offset:0 lds
    ds_read_b64_tr_b16 v[32:33], v13 offset:18432
    ds_read_b64_tr_b16 v[34:35], v13 offset:18944
    s_waitcnt lgkmcnt(6)
    v_mfma_f32_32x32x16_bf16 v[64:79], v[128:131], v[36:39], v[64:79]
    s_sub_u32 s57, s57, s60
    buffer_load_dwordx4 v[16:19], v7, s[12:15], s57 offen offset:0
    ds_read_b64_tr_b16 v[36:37], v14 offset:10240
    ds_read_b64_tr_b16 v[38:39], v14 offset:10752
    s_waitcnt lgkmcnt(6)
    v_mfma_f32_32x32x16_bf16 v[80:95], v[128:131], v[40:43], v[80:95]
    v_mfma_f32_16x16x32_bf16 v[96:99], v[20:23], v[128:131], v[96:99]
    ds_read_b64_tr_b16 v[40:41], v12 offset:20480
    ds_read_b64_tr_b16 v[42:43], v12 offset:20992
    s_waitcnt lgkmcnt(6)
    v_mfma_f32_32x32x16_bf16 v[48:63], v[132:135], v[44:47], v[48:63]
    ds_read_b64_tr_b16 v[44:45], v13 offset:20480
    ds_read_b64_tr_b16 v[46:47], v13 offset:20992
    s_waitcnt lgkmcnt(6)
    v_mfma_f32_32x32x16_bf16 v[64:79], v[132:135], v[32:35], v[64:79]
    v_mfma_f32_16x16x32_bf16 v[100:103], v[20:23], v[132:135], v[100:103]
    ds_read_b64_tr_b16 v[32:33], v14 offset:12288
    ds_read_b64_tr_b16 v[34:35], v14 offset:12800
    s_waitcnt lgkmcnt(6)
    v_mfma_f32_32x32x16_bf16 v[80:95], v[132:135], v[36:39], v[80:95]
    ds_read_b64_tr_b16 v[36:37], v12 offset:22528
    ds_read_b64_tr_b16 v[38:39], v12 offset:23040
    s_waitcnt lgkmcnt(6)
    v_mfma_f32_32x32x16_bf16 v[48:63], v[136:139], v[40:43], v[48:63]
    v_mfma_f32_16x16x32_bf16 v[104:107], v[20:23], v[136:139], v[104:107]
    ds_read_b64_tr_b16 v[40:41], v13 offset:22528
    ds_read_b64_tr_b16 v[42:43], v13 offset:23040
    s_waitcnt lgkmcnt(6)
    v_mfma_f32_32x32x16_bf16 v[64:79], v[136:139], v[44:47], v[64:79]
    ds_read_b64_tr_b16 v[44:45], v14 offset:14336
    ds_read_b64_tr_b16 v[46:47], v14 offset:14848
    s_waitcnt lgkmcnt(6)
    v_mfma_f32_32x32x16_bf16 v[80:95], v[136:139], v[32:35], v[80:95]
    v_mfma_f32_16x16x32_bf16 v[108:111], v[20:23], v[140:143], v[108:111]
    global_load_dwordx2 v[28:29], v0, s[100:101] sc1
    s_waitcnt vmcnt(8)
    s_waitcnt lgkmcnt(2)
    s_barrier
    ds_read_b128 v[144:147], v8 offset:0
    ds_read_b128 v[148:151], v9 offset:0
    ds_read_b128 v[152:155], v10 offset:0
    ds_read_b128 v[156:159], v11 offset:0
    ds_read_b64_tr_b16 v[32:33], v12 offset:0
    ds_read_b64_tr_b16 v[34:35], v12 offset:512
    v_mfma_f32_32x32x16_bf16 v[48:63], v[140:143], v[36:39], v[48:63]
    s_or_b32 s41, s28, s55
    s_cmp_eq_u32 s41, 0
    s_cselect_b32 s41, 0, 0x7f000000
    v_mov_b32 v31, 0x7f000000
    v_mov_b32 v30, s41
    v_cmp_eq_u32 vcc, 0, v1
    s_nop 1
    v_cndmask_b32 v30, v31, v30, vcc
    s_lshl_b32 s49, s3, 8
    s_add_u32 s49, s49, 42090496
    ds_read_b64_tr_b16 v[36:37], v13 offset:0
    ds_read_b64_tr_b16 v[38:39], v13 offset:512
    v_mfma_f32_32x32x16_bf16 v[64:79], v[140:143], v[40:43], v[64:79]
    s_add_u32 s38, s38, 8192
    s_add_u32 s41, s37, 73728
    s_add_u32 m0, s38, 0
    s_nop 0
    buffer_load_dwordx4 v4, s[20:23], s41 offen lds
    s_add_u32 s41, s37, 82944
    s_add_u32 m0, s38, 1024
    s_nop 0
    buffer_load_dwordx4 v4, s[20:23], s41 offen lds
    ds_read_b64_tr_b16 v[40:41], v14 offset:16384
    ds_read_b64_tr_b16 v[42:43], v14 offset:16896
    s_waitcnt lgkmcnt(10)
    v_mfma_f32_32x32x16_bf16 v[80:95], v[140:143], v[44:47], v[80:95]
    s_waitcnt lgkmcnt(6)
    s_add_u32 m0, s36, 4294967168
    s_nop 0
    buffer_load_dwordx4 v2, s[16:19], s32 offen offset:128 lds
    s_add_u32 m0, s36, 896
    s_nop 0
    buffer_load_dwordx4 v3, s[16:19], s33 offen offset:128 lds
    ds_read_b64_tr_b16 v[44:45], v12 offset:2048
    ds_read_b64_tr_b16 v[46:47], v12 offset:2560
    s_waitcnt lgkmcnt(6)
    v_mfma_f32_32x32x16_bf16 v[48:63], v[144:147], v[32:35], v[48:63]
    s_add_u32 m0, s36, 1920
    s_nop 0
    buffer_load_dwordx4 v2, s[16:19], s34 offen offset:128 lds
    s_add_u32 m0, s36, 2944
    s_nop 0
    buffer_load_dwordx4 v3, s[16:19], s35 offen offset:128 lds
    ds_read_b64_tr_b16 v[32:33], v13 offset:2048
    ds_read_b64_tr_b16 v[34:35], v13 offset:2560
    s_waitcnt lgkmcnt(6)
    v_mfma_f32_32x32x16_bf16 v[64:79], v[144:147], v[36:39], v[64:79]
    buffer_load_dwordx4 v[20:23], v7, s[12:15], s57 offen offset:128
    ds_read_b64_tr_b16 v[36:37], v14 offset:18432
    ds_read_b64_tr_b16 v[38:39], v14 offset:18944
    s_waitcnt lgkmcnt(6)
    v_mfma_f32_32x32x16_bf16 v[80:95], v[144:147], v[40:43], v[80:95]
    v_mfma_f32_16x16x32_bf16 v[96:99], v[24:27], v[144:147], v[96:99]
    ds_read_b64_tr_b16 v[40:41], v12 offset:4096
    ds_read_b64_tr_b16 v[42:43], v12 offset:4608
    s_waitcnt lgkmcnt(6)
    v_mfma_f32_32x32x16_bf16 v[48:63], v[148:151], v[44:47], v[48:63]
    ds_read_b64_tr_b16 v[44:45], v13 offset:4096
    ds_read_b64_tr_b16 v[46:47], v13 offset:4608
    s_waitcnt lgkmcnt(6)
    v_mfma_f32_32x32x16_bf16 v[64:79], v[148:151], v[32:35], v[64:79]
    v_mfma_f32_16x16x32_bf16 v[100:103], v[24:27], v[148:151], v[100:103]
    ds_read_b64_tr_b16 v[32:33], v14 offset:20480
    ds_read_b64_tr_b16 v[34:35], v14 offset:20992
    s_waitcnt lgkmcnt(6)
    v_mfma_f32_32x32x16_bf16 v[80:95], v[148:151], v[36:39], v[80:95]
    ds_read_b64_tr_b16 v[36:37], v12 offset:6144
    ds_read_b64_tr_b16 v[38:39], v12 offset:6656
    s_waitcnt lgkmcnt(6)
    v_mfma_f32_32x32x16_bf16 v[48:63], v[152:155], v[40:43], v[48:63]
    v_mfma_f32_16x16x32_bf16 v[104:107], v[24:27], v[152:155], v[104:107]
    ds_read_b64_tr_b16 v[40:41], v13 offset:6144
    ds_read_b64_tr_b16 v[42:43], v13 offset:6656
    s_waitcnt lgkmcnt(6)
    v_mfma_f32_32x32x16_bf16 v[64:79], v[152:155], v[44:47], v[64:79]
    ds_read_b64_tr_b16 v[44:45], v14 offset:22528
    ds_read_b64_tr_b16 v[46:47], v14 offset:23040
    s_waitcnt lgkmcnt(6)
    v_mfma_f32_32x32x16_bf16 v[80:95], v[152:155], v[32:35], v[80:95]
    v_mfma_f32_16x16x32_bf16 v[108:111], v[24:27], v[156:159], v[108:111]
    s_waitcnt vmcnt(8)
    s_waitcnt lgkmcnt(2)
    s_barrier
    ds_read_b128 v[160:163], v8 offset:4096
    ds_read_b128 v[164:167], v9 offset:4096
    ds_read_b128 v[168:171], v10 offset:4096
    ds_read_b128 v[172:175], v11 offset:4096
    ds_read_b64_tr_b16 v[32:33], v12 offset:8192
    ds_read_b64_tr_b16 v[34:35], v12 offset:8704
    v_mfma_f32_32x32x16_bf16 v[48:63], v[156:159], v[36:39], v[48:63]
    ds_read_b64_tr_b16 v[36:37], v13 offset:8192
    ds_read_b64_tr_b16 v[38:39], v13 offset:8704
    v_mfma_f32_32x32x16_bf16 v[64:79], v[156:159], v[40:43], v[64:79]
    s_add_u32 s38, s38, 8192
    s_sub_u32 s38, s38, s40
    s_add_u32 s41, s37, 147456
    s_add_u32 m0, s38, 0
    s_nop 0
    buffer_load_dwordx4 v4, s[20:23], s41 offen lds
    s_add_u32 s41, s37, 156672
    s_add_u32 m0, s38, 1024
    s_nop 0
    buffer_load_dwordx4 v4, s[20:23], s41 offen lds
    ds_read_b64_tr_b16 v[40:41], v14 offset:24576
    ds_read_b64_tr_b16 v[42:43], v14 offset:25088
    s_waitcnt lgkmcnt(10)
    v_mfma_f32_32x32x16_bf16 v[80:95], v[156:159], v[44:47], v[80:95]
    s_waitcnt lgkmcnt(6)
    s_add_u32 m0, s36, 3840
    s_nop 0
    buffer_load_dwordx4 v2, s[16:19], s32 offen offset:256 lds
    s_add_u32 m0, s36, 4864
    s_nop 0
    buffer_load_dwordx4 v3, s[16:19], s33 offen offset:256 lds
    ds_read_b64_tr_b16 v[44:45], v12 offset:10240
    ds_read_b64_tr_b16 v[46:47], v12 offset:10752
    s_waitcnt lgkmcnt(6)
    v_mfma_f32_32x32x16_bf16 v[48:63], v[160:163], v[32:35], v[48:63]
    s_add_u32 m0, s36, 5888
    s_nop 0
    buffer_load_dwordx4 v2, s[16:19], s34 offen offset:256 lds
    s_add_u32 m0, s36, 6912
    s_nop 0
    buffer_load_dwordx4 v3, s[16:19], s35 offen offset:256 lds
    ds_read_b64_tr_b16 v[32:33], v13 offset:10240
    ds_read_b64_tr_b16 v[34:35], v13 offset:10752
    s_waitcnt lgkmcnt(6)
    v_mfma_f32_32x32x16_bf16 v[64:79], v[160:163], v[36:39], v[64:79]
    buffer_load_dwordx4 v[24:27], v7, s[12:15], s57 offen offset:256
    ds_read_b64_tr_b16 v[36:37], v14 offset:26624
    ds_read_b64_tr_b16 v[38:39], v14 offset:27136
    s_waitcnt lgkmcnt(6)
    v_mfma_f32_32x32x16_bf16 v[80:95], v[160:163], v[40:43], v[80:95]
    v_mfma_f32_16x16x32_bf16 v[96:99], v[16:19], v[160:163], v[96:99]
    ds_read_b64_tr_b16 v[40:41], v12 offset:12288
    ds_read_b64_tr_b16 v[42:43], v12 offset:12800
    s_waitcnt lgkmcnt(6)
    v_mfma_f32_32x32x16_bf16 v[48:63], v[164:167], v[44:47], v[48:63]
    ds_read_b64_tr_b16 v[44:45], v13 offset:12288
    ds_read_b64_tr_b16 v[46:47], v13 offset:12800
    s_waitcnt lgkmcnt(6)
    v_mfma_f32_32x32x16_bf16 v[64:79], v[164:167], v[32:35], v[64:79]
    v_mfma_f32_16x16x32_bf16 v[100:103], v[16:19], v[164:167], v[100:103]
    ds_read_b64_tr_b16 v[32:33], v14 offset:28672
    ds_read_b64_tr_b16 v[34:35], v14 offset:29184
    s_waitcnt lgkmcnt(6)
    v_mfma_f32_32x32x16_bf16 v[80:95], v[164:167], v[36:39], v[80:95]
    ds_read_b64_tr_b16 v[36:37], v12 offset:14336
    ds_read_b64_tr_b16 v[38:39], v12 offset:14848
    s_waitcnt lgkmcnt(6)
    v_mfma_f32_32x32x16_bf16 v[48:63], v[168:171], v[40:43], v[48:63]
    v_mfma_f32_16x16x32_bf16 v[104:107], v[16:19], v[168:171], v[104:107]
    ds_read_b64_tr_b16 v[40:41], v13 offset:14336
    ds_read_b64_tr_b16 v[42:43], v13 offset:14848
    s_waitcnt lgkmcnt(6)
    v_mfma_f32_32x32x16_bf16 v[64:79], v[168:171], v[44:47], v[64:79]
    ds_read_b64_tr_b16 v[44:45], v14 offset:30720
    ds_read_b64_tr_b16 v[46:47], v14 offset:31232
    s_waitcnt lgkmcnt(6)
    v_mfma_f32_32x32x16_bf16 v[80:95], v[168:171], v[32:35], v[80:95]
    v_mfma_f32_16x16x32_bf16 v[108:111], v[16:19], v[172:175], v[108:111]
    s_waitcnt vmcnt(7)
    s_waitcnt lgkmcnt(2)
    s_barrier
    ds_read_b128 v[176:179], v8 offset:0
    ds_read_b128 v[180:183], v9 offset:0
    ds_read_b128 v[184:187], v10 offset:0
    ds_read_b128 v[188:191], v11 offset:0
    ds_read_b64_tr_b16 v[32:33], v12 offset:16384
    ds_read_b64_tr_b16 v[34:35], v12 offset:16896
    v_mfma_f32_32x32x16_bf16 v[48:63], v[172:175], v[36:39], v[48:63]
    ds_read_b64_tr_b16 v[36:37], v13 offset:16384
    ds_read_b64_tr_b16 v[38:39], v13 offset:16896
    v_mfma_f32_32x32x16_bf16 v[64:79], v[172:175], v[40:43], v[64:79]
    s_sub_u32 s37, s37, s63
    s_add_u32 s38, s38, 8192
    s_add_u32 s41, s37, 0
    s_add_u32 m0, s38, 0
    s_nop 0
    buffer_load_dwordx4 v4, s[20:23], s41 offen lds
    s_add_u32 s41, s37, 9216
    s_add_u32 m0, s38, 1024
    s_nop 0
    buffer_load_dwordx4 v4, s[20:23], s41 offen lds
    ds_read_b64_tr_b16 v[40:41], v14 offset:32768
    ds_read_b64_tr_b16 v[42:43], v14 offset:33280
    s_waitcnt lgkmcnt(10)
    v_mfma_f32_32x32x16_bf16 v[80:95], v[172:175], v[44:47], v[80:95]
    s_waitcnt lgkmcnt(6)
    s_sub_u32 s32, s32, s61
    s_add_u32 m0, s36, 0
    s_nop 0
    buffer_load_dwordx4 v2, s[16:19], s32 offen offset:0 lds
    s_sub_u32 s33, s33, s61
    s_add_u32 m0, s36, 1024
    s_nop 0
    buffer_load_dwordx4 v3, s[16:19], s33 offen offset:0 lds
    ds_read_b64_tr_b16 v[44:45], v12 offset:18432
    ds_read_b64_tr_b16 v[46:47], v12 offset:18944
    s_waitcnt lgkmcnt(6)
    v_mfma_f32_32x32x16_bf16 v[48:63], v[176:179], v[32:35], v[48:63]
    s_sub_u32 s34, s34, s61
    s_add_u32 m0, s36, 2048
    s_nop 0
    buffer_load_dwordx4 v2, s[16:19], s34 offen offset:0 lds
    s_sub_u32 s35, s35, s61
    s_add_u32 m0, s36, 3072
    s_nop 0
    buffer_load_dwordx4 v3, s[16:19], s35 offen offset:0 lds
    ds_read_b64_tr_b16 v[32:33], v13 offset:18432
    ds_read_b64_tr_b16 v[34:35], v13 offset:18944
    s_waitcnt lgkmcnt(6)
    v_mfma_f32_32x32x16_bf16 v[64:79], v[176:179], v[36:39], v[64:79]
    s_sub_u32 s57, s57, s61
    buffer_load_dwordx4 v[16:19], v7, s[12:15], s57 offen offset:0
    ds_read_b64_tr_b16 v[36:37], v14 offset:34816
    ds_read_b64_tr_b16 v[38:39], v14 offset:35328
    s_waitcnt lgkmcnt(6)
    v_mfma_f32_32x32x16_bf16 v[80:95], v[176:179], v[40:43], v[80:95]
    v_mfma_f32_16x16x32_bf16 v[96:99], v[20:23], v[176:179], v[96:99]
    ds_read_b64_tr_b16 v[40:41], v12 offset:20480
    ds_read_b64_tr_b16 v[42:43], v12 offset:20992
    s_waitcnt lgkmcnt(6)
    v_mfma_f32_32x32x16_bf16 v[48:63], v[180:183], v[44:47], v[48:63]
    ds_read_b64_tr_b16 v[44:45], v13 offset:20480
    ds_read_b64_tr_b16 v[46:47], v13 offset:20992
    s_waitcnt lgkmcnt(6)
    v_mfma_f32_32x32x16_bf16 v[64:79], v[180:183], v[32:35], v[64:79]
    v_mfma_f32_16x16x32_bf16 v[100:103], v[20:23], v[180:183], v[100:103]
    ds_read_b64_tr_b16 v[32:33], v14 offset:36864
    ds_read_b64_tr_b16 v[34:35], v14 offset:37376
    s_waitcnt lgkmcnt(6)
    v_mfma_f32_32x32x16_bf16 v[80:95], v[180:183], v[36:39], v[80:95]
    ds_read_b64_tr_b16 v[36:37], v12 offset:22528
    ds_read_b64_tr_b16 v[38:39], v12 offset:23040
    s_waitcnt lgkmcnt(6)
    v_mfma_f32_32x32x16_bf16 v[48:63], v[184:187], v[40:43], v[48:63]
    v_mfma_f32_16x16x32_bf16 v[104:107], v[20:23], v[184:187], v[104:107]
    ds_read_b64_tr_b16 v[40:41], v13 offset:22528
    ds_read_b64_tr_b16 v[42:43], v13 offset:23040
    s_waitcnt lgkmcnt(6)
    v_mfma_f32_32x32x16_bf16 v[64:79], v[184:187], v[44:47], v[64:79]
    ds_read_b64_tr_b16 v[44:45], v14 offset:38912
    ds_read_b64_tr_b16 v[46:47], v14 offset:39424
    s_waitcnt lgkmcnt(6)
    v_mfma_f32_32x32x16_bf16 v[80:95], v[184:187], v[32:35], v[80:95]
    v_mfma_f32_16x16x32_bf16 v[108:111], v[20:23], v[188:191], v[108:111]
    s_waitcnt vmcnt(7)
    s_waitcnt lgkmcnt(2)
    s_barrier
    ds_read_b128 v[192:195], v8 offset:4096
    ds_read_b128 v[196:199], v9 offset:4096
    ds_read_b128 v[200:203], v10 offset:4096
    ds_read_b128 v[204:207], v11 offset:4096
    ds_read_b64_tr_b16 v[32:33], v12 offset:0
    ds_read_b64_tr_b16 v[34:35], v12 offset:512
    v_mfma_f32_32x32x16_bf16 v[48:63], v[188:191], v[36:39], v[48:63]
    ds_read_b64_tr_b16 v[36:37], v13 offset:0
    ds_read_b64_tr_b16 v[38:39], v13 offset:512
    v_mfma_f32_32x32x16_bf16 v[64:79], v[188:191], v[40:43], v[64:79]
    s_add_u32 s38, s38, 8192
    s_add_u32 s41, s37, 73728
    s_add_u32 m0, s38, 0
    s_nop 0
    buffer_load_dwordx4 v4, s[20:23], s41 offen lds
    s_add_u32 s41, s37, 82944
    s_add_u32 m0, s38, 1024
    s_nop 0
    buffer_load_dwordx4 v4, s[20:23], s41 offen lds
    ds_read_b64_tr_b16 v[40:41], v14 offset:40960
    ds_read_b64_tr_b16 v[42:43], v14 offset:41472
    s_waitcnt lgkmcnt(10)
    v_mfma_f32_32x32x16_bf16 v[80:95], v[188:191], v[44:47], v[80:95]
    s_waitcnt lgkmcnt(6)
    s_add_u32 m0, s36, 3968
    s_nop 0
    buffer_load_dwordx4 v2, s[16:19], s32 offen offset:128 lds
    s_add_u32 m0, s36, 4992
    s_nop 0
    buffer_load_dwordx4 v3, s[16:19], s33 offen offset:128 lds
    ds_read_b64_tr_b16 v[44:45], v12 offset:2048
    ds_read_b64_tr_b16 v[46:47], v12 offset:2560
    s_waitcnt lgkmcnt(6)
    v_mfma_f32_32x32x16_bf16 v[48:63], v[192:195], v[32:35], v[48:63]
    s_add_u32 m0, s36, 6016
    s_nop 0
    buffer_load_dwordx4 v2, s[16:19], s34 offen offset:128 lds
    s_add_u32 m0, s36, 7040
    s_nop 0
    buffer_load_dwordx4 v3, s[16:19], s35 offen offset:128 lds
    ds_read_b64_tr_b16 v[32:33], v13 offset:2048
    ds_read_b64_tr_b16 v[34:35], v13 offset:2560
    s_waitcnt lgkmcnt(6)
    v_mfma_f32_32x32x16_bf16 v[64:79], v[192:195], v[36:39], v[64:79]
    buffer_load_dwordx4 v[20:23], v7, s[12:15], s57 offen offset:128
    ds_read_b64_tr_b16 v[36:37], v14 offset:43008
    ds_read_b64_tr_b16 v[38:39], v14 offset:43520
    s_waitcnt lgkmcnt(6)
    v_mfma_f32_32x32x16_bf16 v[80:95], v[192:195], v[40:43], v[80:95]
    v_mfma_f32_16x16x32_bf16 v[96:99], v[24:27], v[192:195], v[96:99]
    ds_read_b64_tr_b16 v[40:41], v12 offset:4096
    ds_read_b64_tr_b16 v[42:43], v12 offset:4608
    s_waitcnt lgkmcnt(6)
    v_mfma_f32_32x32x16_bf16 v[48:63], v[196:199], v[44:47], v[48:63]
    ds_read_b64_tr_b16 v[44:45], v13 offset:4096
    ds_read_b64_tr_b16 v[46:47], v13 offset:4608
    s_waitcnt lgkmcnt(6)
    v_mfma_f32_32x32x16_bf16 v[64:79], v[196:199], v[32:35], v[64:79]
    v_mfma_f32_16x16x32_bf16 v[100:103], v[24:27], v[196:199], v[100:103]
    ds_read_b64_tr_b16 v[32:33], v14 offset:45056
    ds_read_b64_tr_b16 v[34:35], v14 offset:45568
    s_waitcnt lgkmcnt(6)
    v_mfma_f32_32x32x16_bf16 v[80:95], v[196:199], v[36:39], v[80:95]
    ds_read_b64_tr_b16 v[36:37], v12 offset:6144
    ds_read_b64_tr_b16 v[38:39], v12 offset:6656
    s_waitcnt lgkmcnt(6)
    v_mfma_f32_32x32x16_bf16 v[48:63], v[200:203], v[40:43], v[48:63]
    v_mfma_f32_16x16x32_bf16 v[104:107], v[24:27], v[200:203], v[104:107]
    ds_read_b64_tr_b16 v[40:41], v13 offset:6144
    ds_read_b64_tr_b16 v[42:43], v13 offset:6656
    s_waitcnt lgkmcnt(6)
    v_mfma_f32_32x32x16_bf16 v[64:79], v[200:203], v[44:47], v[64:79]
    ds_read_b64_tr_b16 v[44:45], v14 offset:47104
    ds_read_b64_tr_b16 v[46:47], v14 offset:47616
    s_waitcnt lgkmcnt(6)
    v_mfma_f32_32x32x16_bf16 v[80:95], v[200:203], v[32:35], v[80:95]
    v_mfma_f32_16x16x32_bf16 v[108:111], v[24:27], v[204:207], v[108:111]
    s_waitcnt vmcnt(7)
    s_waitcnt lgkmcnt(2)
    s_barrier
    ds_read_b128 v[208:211], v8 offset:0
    ds_read_b128 v[212:215], v9 offset:0
    ds_read_b128 v[216:219], v10 offset:0
    ds_read_b128 v[220:223], v11 offset:0
    ds_read_b64_tr_b16 v[32:33], v12 offset:8192
    ds_read_b64_tr_b16 v[34:35], v12 offset:8704
    v_mfma_f32_32x32x16_bf16 v[48:63], v[204:207], v[36:39], v[48:63]
    ds_read_b64_tr_b16 v[36:37], v13 offset:8192
    ds_read_b64_tr_b16 v[38:39], v13 offset:8704
    v_mfma_f32_32x32x16_bf16 v[64:79], v[204:207], v[40:43], v[64:79]
    s_add_u32 s38, s38, 8192
    s_sub_u32 s38, s38, s40
    s_add_u32 s41, s37, 147456
    s_add_u32 m0, s38, 0
    s_nop 0
    buffer_load_dwordx4 v4, s[20:23], s41 offen lds
    s_add_u32 s41, s37, 156672
    s_add_u32 m0, s38, 1024
    s_nop 0
    buffer_load_dwordx4 v4, s[20:23], s41 offen lds
    ds_read_b64_tr_b16 v[40:41], v14 offset:49152
    ds_read_b64_tr_b16 v[42:43], v14 offset:49664
    s_waitcnt lgkmcnt(10)
    v_mfma_f32_32x32x16_bf16 v[80:95], v[204:207], v[44:47], v[80:95]
    s_waitcnt lgkmcnt(6)
    s_add_u32 m0, s36, 4294967040
    s_nop 0
    buffer_load_dwordx4 v2, s[16:19], s32 offen offset:256 lds
    s_add_u32 m0, s36, 768
    s_nop 0
    buffer_load_dwordx4 v3, s[16:19], s33 offen offset:256 lds
    ds_read_b64_tr_b16 v[44:45], v12 offset:10240
    ds_read_b64_tr_b16 v[46:47], v12 offset:10752
    s_waitcnt lgkmcnt(6)
    v_mfma_f32_32x32x16_bf16 v[48:63], v[208:211], v[32:35], v[48:63]
    s_add_u32 m0, s36, 1792
    s_nop 0
    buffer_load_dwordx4 v2, s[16:19], s34 offen offset:256 lds
    s_add_u32 m0, s36, 2816
    s_nop 0
    buffer_load_dwordx4 v3, s[16:19], s35 offen offset:256 lds
    v_cmp_ne_u64 vcc, 0, v[28:29]
    s_nop 0
    s_cmp_eq_u64 vcc, -1
    s_cbranch_scc1 NOK21
s_mov_b32 s53, 0
NSP21:
 s_sleep 2
 global_load_dwordx2 v[28:29], v0, s[100:101] sc1
 s_add_u32 s53, s53, 1
 s_waitcnt vmcnt(0)
 v_cmp_ne_u64 vcc, 0, v[28:29]
 s_cmp_ge_u32 s53, 0x40000
 s_cbranch_scc1 NOK21
 s_nop 1
 s_cmp_eq_u64 vcc, -1
 s_cbranch_scc0 NSP21
NOK21:
    buffer_store_dwordx2 v[28:29], v30, s[24:27], s49 offen sc1
    ds_read_b64_tr_b16 v[32:33], v13 offset:10240
    ds_read_b64_tr_b16 v[34:35], v13 offset:10752
    s_waitcnt lgkmcnt(6)
    v_mfma_f32_32x32x16_bf16 v[64:79], v[208:211], v[36:39], v[64:79]
    buffer_load_dwordx4 v[24:27], v7, s[12:15], s57 offen offset:256
    ds_read_b64_tr_b16 v[36:37], v14 offset:51200
    ds_read_b64_tr_b16 v[38:39], v14 offset:51712
    s_waitcnt lgkmcnt(6)
    v_mfma_f32_32x32x16_bf16 v[80:95], v[208:211], v[40:43], v[80:95]
    v_mfma_f32_16x16x32_bf16 v[96:99], v[16:19], v[208:211], v[96:99]
    global_load_dwordx2 v[2:3], v0, s[100:101] sc1
    ds_read_b64_tr_b16 v[40:41], v12 offset:12288
    ds_read_b64_tr_b16 v[42:43], v12 offset:12800
    s_waitcnt lgkmcnt(6)
    v_mfma_f32_32x32x16_bf16 v[48:63], v[212:215], v[44:47], v[48:63]
    ds_read_b64_tr_b16 v[44:45], v13 offset:12288
    ds_read_b64_tr_b16 v[46:47], v13 offset:12800
    s_waitcnt lgkmcnt(6)
    v_mfma_f32_32x32x16_bf16 v[64:79], v[212:215], v[32:35], v[64:79]
    v_mfma_f32_16x16x32_bf16 v[100:103], v[16:19], v[212:215], v[100:103]
    ds_read_b64_tr_b16 v[32:33], v14 offset:53248
    ds_read_b64_tr_b16 v[34:35], v14 offset:53760
    s_waitcnt lgkmcnt(6)
    v_mfma_f32_32x32x16_bf16 v[80:95], v[212:215], v[36:39], v[80:95]
    ds_read_b64_tr_b16 v[36:37], v12 offset:14336
    ds_read_b64_tr_b16 v[38:39], v12 offset:14848
    s_waitcnt lgkmcnt(6)
    v_mfma_f32_32x32x16_bf16 v[48:63], v[216:219], v[40:43], v[48:63]
    v_mfma_f32_16x16x32_bf16 v[104:107], v[16:19], v[216:219], v[104:107]
    ds_read_b64_tr_b16 v[40:41], v13 offset:14336
    ds_read_b64_tr_b16 v[42:43], v13 offset:14848
    s_waitcnt lgkmcnt(6)
    v_mfma_f32_32x32x16_bf16 v[64:79], v[216:219], v[44:47], v[64:79]
    ds_read_b64_tr_b16 v[44:45], v14 offset:55296
    ds_read_b64_tr_b16 v[46:47], v14 offset:55808
    s_waitcnt lgkmcnt(6)
    v_mfma_f32_32x32x16_bf16 v[80:95], v[216:219], v[32:35], v[80:95]
    v_mfma_f32_16x16x32_bf16 v[108:111], v[16:19], v[220:223], v[108:111]
    s_waitcnt vmcnt(9)
    s_waitcnt lgkmcnt(2)
    s_barrier
    ds_read_b128 v[224:227], v8 offset:4096
    ds_read_b128 v[228:231], v9 offset:4096
    ds_read_b128 v[232:235], v10 offset:4096
    ds_read_b128 v[236:239], v11 offset:4096
    ds_read_b64_tr_b16 v[32:33], v12 offset:16384
    ds_read_b64_tr_b16 v[34:35], v12 offset:16896
    v_mfma_f32_32x32x16_bf16 v[48:63], v[220:223], v[36:39], v[48:63]
    ds_read_b64_tr_b16 v[36:37], v13 offset:16384
    ds_read_b64_tr_b16 v[38:39], v13 offset:16896
    v_mfma_f32_32x32x16_bf16 v[64:79], v[220:223], v[40:43], v[64:79]
    ds_read_b64_tr_b16 v[40:41], v14 offset:57344
    ds_read_b64_tr_b16 v[42:43], v14 offset:57856
    s_waitcnt lgkmcnt(10)
    v_mfma_f32_32x32x16_bf16 v[80:95], v[220:223], v[44:47], v[80:95]
    ds_read_b64_tr_b16 v[44:45], v12 offset:18432
    ds_read_b64_tr_b16 v[46:47], v12 offset:18944
    s_waitcnt lgkmcnt(6)
    v_mfma_f32_32x32x16_bf16 v[48:63], v[224:227], v[32:35], v[48:63]
    ds_read_b64_tr_b16 v[32:33], v13 offset:18432
    ds_read_b64_tr_b16 v[34:35], v13 offset:18944
    s_waitcnt lgkmcnt(6)
    v_mfma_f32_32x32x16_bf16 v[64:79], v[224:227], v[36:39], v[64:79]
    ds_read_b64_tr_b16 v[36:37], v14 offset:59392
    ds_read_b64_tr_b16 v[38:39], v14 offset:59904
    s_waitcnt lgkmcnt(6)
    v_mfma_f32_32x32x16_bf16 v[80:95], v[224:227], v[40:43], v[80:95]
    v_mfma_f32_16x16x32_bf16 v[96:99], v[20:23], v[224:227], v[96:99]
    ds_read_b64_tr_b16 v[40:41], v12 offset:20480
    ds_read_b64_tr_b16 v[42:43], v12 offset:20992
    s_waitcnt lgkmcnt(6)
    v_mfma_f32_32x32x16_bf16 v[48:63], v[228:231], v[44:47], v[48:63]
    ds_read_b64_tr_b16 v[44:45], v13 offset:20480
    ds_read_b64_tr_b16 v[46:47], v13 offset:20992
    s_waitcnt lgkmcnt(6)
    v_mfma_f32_32x32x16_bf16 v[64:79], v[228:231], v[32:35], v[64:79]
    v_mfma_f32_16x16x32_bf16 v[100:103], v[20:23], v[228:231], v[100:103]
    ds_read_b64_tr_b16 v[32:33], v14 offset:61440
    ds_read_b64_tr_b16 v[34:35], v14 offset:61952
    s_waitcnt lgkmcnt(6)
    v_mfma_f32_32x32x16_bf16 v[80:95], v[228:231], v[36:39], v[80:95]
    ds_read_b64_tr_b16 v[36:37], v12 offset:22528
    ds_read_b64_tr_b16 v[38:39], v12 offset:23040
    s_waitcnt lgkmcnt(6)
    v_mfma_f32_32x32x16_bf16 v[48:63], v[232:235], v[40:43], v[48:63]
    v_mfma_f32_16x16x32_bf16 v[104:107], v[20:23], v[232:235], v[104:107]
    ds_read_b64_tr_b16 v[40:41], v13 offset:22528
    ds_read_b64_tr_b16 v[42:43], v13 offset:23040
    s_waitcnt lgkmcnt(6)
    v_mfma_f32_32x32x16_bf16 v[64:79], v[232:235], v[44:47], v[64:79]
    ds_read_b64_tr_b16 v[44:45], v14 offset:63488
    ds_read_b64_tr_b16 v[46:47], v14 offset:64000
    s_waitcnt lgkmcnt(6)
    v_mfma_f32_32x32x16_bf16 v[80:95], v[232:235], v[32:35], v[80:95]
    v_mfma_f32_16x16x32_bf16 v[108:111], v[20:23], v[236:239], v[108:111]
    s_waitcnt vmcnt(1)
    s_waitcnt lgkmcnt(2)
    s_barrier
    ds_read_b128 v[240:243], v8 offset:0
    ds_read_b128 v[244:247], v9 offset:0
    ds_read_b128 v[248:251], v10 offset:0
    ds_read_b128 v[252:255], v11 offset:0
    ds_read_b64_tr_b16 v[32:33], v12 offset:0
    ds_read_b64_tr_b16 v[34:35], v12 offset:512
    v_mfma_f32_32x32x16_bf16 v[48:63], v[236:239], v[36:39], v[48:63]
    ds_read_b64_tr_b16 v[36:37], v13 offset:0
    ds_read_b64_tr_b16 v[38:39], v13 offset:512
    v_mfma_f32_32x32x16_bf16 v[64:79], v[236:239], v[40:43], v[64:79]
    v_add_u32 v14, 65536, v14
    ds_read_b64_tr_b16 v[40:41], v14 offset:0
    ds_read_b64_tr_b16 v[42:43], v14 offset:512
    s_waitcnt lgkmcnt(10)
    v_mfma_f32_32x32x16_bf16 v[80:95], v[236:239], v[44:47], v[80:95]
    ds_read_b64_tr_b16 v[44:45], v12 offset:2048
    ds_read_b64_tr_b16 v[46:47], v12 offset:2560
    s_waitcnt lgkmcnt(6)
    v_mfma_f32_32x32x16_bf16 v[48:63], v[240:243], v[32:35], v[48:63]
    v_cmp_eq_u32 vcc, 0, v1
    v_mov_b32 v9, 0x7f000000
    s_nop 0
    v_cndmask_b32 v8, v9, v0, vcc
    s_barrier
    ds_read_b64_tr_b16 v[32:33], v13 offset:2048
    ds_read_b64_tr_b16 v[34:35], v13 offset:2560
    s_waitcnt lgkmcnt(6)
    v_mfma_f32_32x32x16_bf16 v[64:79], v[240:243], v[36:39], v[64:79]
    ds_read_b64_tr_b16 v[36:37], v14 offset:2048
    ds_read_b64_tr_b16 v[38:39], v14 offset:2560
    s_waitcnt lgkmcnt(6)
    v_mfma_f32_32x32x16_bf16 v[80:95], v[240:243], v[40:43], v[80:95]
    s_add_u32 s41, s47, 0
    s_add_u32 m0, s48, 90112
    s_nop 0
    buffer_load_dwordx4 v4, s[20:23], s41 offen lds
    v_mfma_f32_16x16x32_bf16 v[96:99], v[24:27], v[240:243], v[96:99]
    ds_read_b64_tr_b16 v[40:41], v12 offset:4096
    ds_read_b64_tr_b16 v[42:43], v12 offset:4608
    s_waitcnt lgkmcnt(6)
    v_mfma_f32_32x32x16_bf16 v[48:63], v[244:247], v[44:47], v[48:63]
    ds_read_b64_tr_b16 v[44:45], v13 offset:4096
    ds_read_b64_tr_b16 v[46:47], v13 offset:4608
    s_waitcnt lgkmcnt(6)
    v_mfma_f32_32x32x16_bf16 v[64:79], v[244:247], v[32:35], v[64:79]
    s_add_u32 s41, s47, 73728
    s_add_u32 m0, s48, 98304
    s_nop 0
    buffer_load_dwordx4 v4, s[20:23], s41 offen lds
    v_mfma_f32_16x16x32_bf16 v[100:103], v[24:27], v[244:247], v[100:103]
    ds_read_b64_tr_b16 v[32:33], v14 offset:4096
    ds_read_b64_tr_b16 v[34:35], v14 offset:4608
    s_waitcnt lgkmcnt(6)
    v_mfma_f32_32x32x16_bf16 v[80:95], v[244:247], v[36:39], v[80:95]
    ds_read_b64_tr_b16 v[36:37], v12 offset:6144
    ds_read_b64_tr_b16 v[38:39], v12 offset:6656
    s_waitcnt lgkmcnt(6)
    v_mfma_f32_32x32x16_bf16 v[48:63], v[248:251], v[40:43], v[48:63]
    s_add_u32 s41, s47, 147456
    s_add_u32 m0, s48, 106496
    s_nop 0
    buffer_load_dwordx4 v4, s[20:23], s41 offen lds
    v_mfma_f32_16x16x32_bf16 v[104:107], v[24:27], v[248:251], v[104:107]
    ds_read_b64_tr_b16 v[40:41], v13 offset:6144
    ds_read_b64_tr_b16 v[42:43], v13 offset:6656
    s_waitcnt lgkmcnt(6)
    v_mfma_f32_32x32x16_bf16 v[64:79], v[248:251], v[44:47], v[64:79]
    ds_read_b64_tr_b16 v[44:45], v14 offset:6144
    ds_read_b64_tr_b16 v[46:47], v14 offset:6656
    s_waitcnt lgkmcnt(6)
    v_mfma_f32_32x32x16_bf16 v[80:95], v[248:251], v[32:35], v[80:95]
    s_sub_u32 s47, s47, s62
    s_add_u32 s41, s47, 0
    s_add_u32 m0, s48, 114688
    s_nop 0
    buffer_load_dwordx4 v4, s[20:23], s41 offen lds
    v_mfma_f32_16x16x32_bf16 v[108:111], v[24:27], v[252:255], v[108:111]
    v_subrev_u32 v14, 73728, v13
    ds_read_b64_tr_b16 v[32:33], v14 offset:0
    ds_read_b64_tr_b16 v[34:35], v14 offset:512
    s_waitcnt lgkmcnt(6)
    v_mfma_f32_32x32x16_bf16 v[48:63], v[252:255], v[36:39], v[48:63]
    ds_read_b64_tr_b16 v[36:37], v14 offset:2048
    ds_read_b64_tr_b16 v[38:39], v14 offset:2560
    s_waitcnt lgkmcnt(6)
    v_mfma_f32_32x32x16_bf16 v[64:79], v[252:255], v[40:43], v[64:79]
    s_add_u32 s41, s47, 73728
    s_add_u32 m0, s48, 122880
    s_nop 0
    buffer_load_dwordx4 v4, s[20:23], s41 offen lds
    ds_read_b64_tr_b16 v[40:41], v14 offset:4096
    ds_read_b64_tr_b16 v[42:43], v14 offset:4608
    s_waitcnt lgkmcnt(6)
    v_mfma_f32_32x32x16_bf16 v[80:95], v[252:255], v[44:47], v[80:95]
    v_add_f32 v5, v96, v101
    v_add_f32 v6, v106, v111
    v_add_f32 v5, v5, v6
    ds_read_b64_tr_b16 v[44:45], v14 offset:6144
    ds_read_b64_tr_b16 v[46:47], v14 offset:6656
    s_waitcnt lgkmcnt(6)
    v_mfma_f32_32x32x16_bf16 v[96:111], v[112:115], v[32:35], 0
    s_add_u32 s41, s47, 147456
    s_add_u32 m0, s48, 131072
    s_nop 0
    buffer_load_dwordx4 v4, s[20:23], s41 offen lds
    v_mul_f32 v5, 0xbfb8aa3b, v5
    v_exp_f32 v5, v5
    s_nop 0
    v_add_f32 v5, 1.0, v5
    v_rcp_f32 v6, v5
    v_bfe_u32 v10, v1, 2, 1
    v_lshlrev_b32 v10, 6, v10
    v_bfe_u32 v11, v1, 3, 2
    v_lshl_add_u32 v10, v11, 4, v10
    v_and_b32 v11, 3, v1
    v_lshl_add_u32 v10, v11, 2, v10
    v_lshrrev_b32 v11, 5, v1
    v_lshl_add_u32 v10, v11, 30, v10
    s_lshl_b32 s41, s31, 7
    s_add_u32 s41, s41, 27262976
    buffer_store_dword v6, v10, s[24:27], s41 offen sc1
    s_waitcnt vmcnt(7)
    v_cmp_ne_u64 vcc, 0, v[2:3]
    s_nop 0
    s_cmp_eq_u64 vcc, -1
    s_cbranch_scc1 NOK22
s_mov_b32 s53, 0
NSP22:
 s_sleep 2
 global_load_dwordx2 v[2:3], v0, s[100:101] sc1
 s_add_u32 s53, s53, 1
 s_waitcnt vmcnt(0)
 v_cmp_ne_u64 vcc, 0, v[2:3]
 s_cmp_ge_u32 s53, 0x40000
 s_cbranch_scc1 NOK22
 s_nop 1
 s_cmp_eq_u64 vcc, -1
 s_cbranch_scc0 NSP22
NOK22:
    ds_read_b64_tr_b16 v[32:33], v14 offset:8192
    ds_read_b64_tr_b16 v[34:35], v14 offset:8704
    s_waitcnt lgkmcnt(6)
    v_mfma_f32_32x32x16_bf16 v[96:111], v[116:119], v[36:39], v[96:111]
    v_cvt_pk_bf16_f32 v16, v48, v49
    ds_read_b64_tr_b16 v[36:37], v14 offset:10240
    ds_read_b64_tr_b16 v[38:39], v14 offset:10752
    s_waitcnt lgkmcnt(6)
    v_mfma_f32_32x32x16_bf16 v[96:111], v[120:123], v[40:43], v[96:111]
    s_sub_u32 s47, s47, s63
    s_add_u32 s41, s47, 0
    s_add_u32 m0, s48, 139264
    s_nop 0
    buffer_load_dwordx4 v4, s[20:23], s41 offen lds
    ds_read_b64_tr_b16 v[40:41], v14 offset:12288
    ds_read_b64_tr_b16 v[42:43], v14 offset:12800
    s_waitcnt lgkmcnt(6)
    v_mfma_f32_32x32x16_bf16 v[96:111], v[124:127], v[44:47], v[96:111]
    v_cvt_pk_bf16_f32 v17, v50, v51
    ds_read_b64_tr_b16 v[44:45], v14 offset:14336
    ds_read_b64_tr_b16 v[46:47], v14 offset:14848
    s_waitcnt lgkmcnt(6)
    v_mfma_f32_32x32x16_bf16 v[96:111], v[128:131], v[32:35], v[96:111]
    s_add_u32 s41, s47, 73728
    s_add_u32 m0, s48, 147456
    s_nop 0
    buffer_load_dwordx4 v4, s[20:23], s41 offen lds
    ds_read_b64_tr_b16 v[32:33], v14 offset:16384
    ds_read_b64_tr_b16 v[34:35], v14 offset:16896
    s_waitcnt lgkmcnt(6)
    v_mfma_f32_32x32x16_bf16 v[96:111], v[132:135], v[36:39], v[96:111]
    v_cvt_pk_bf16_f32 v18, v52, v53
    ds_read_b64_tr_b16 v[36:37], v14 offset:18432
    ds_read_b64_tr_b16 v[38:39], v14 offset:18944
    s_waitcnt lgkmcnt(6)
    v_mfma_f32_32x32x16_bf16 v[96:111], v[136:139], v[40:43], v[96:111]
    s_add_u32 s41, s47, 147456
    s_add_u32 m0, s48, 155648
    s_nop 0
    buffer_load_dwordx4 v4, s[20:23], s41 offen lds
    ds_read_b64_tr_b16 v[40:41], v14 offset:20480
    ds_read_b64_tr_b16 v[42:43], v14 offset:20992
    s_waitcnt lgkmcnt(6)
    v_mfma_f32_32x32x16_bf16 v[96:111], v[140:143], v[44:47], v[96:111]
    v_cvt_pk_bf16_f32 v19, v54, v55
    ds_read_b64_tr_b16 v[44:45], v14 offset:22528
    ds_read_b64_tr_b16 v[46:47], v14 offset:23040
    s_waitcnt lgkmcnt(6)
    v_mfma_f32_32x32x16_bf16 v[96:111], v[144:147], v[32:35], v[96:111]
    ds_read_b64_tr_b16 v[32:33], v14 offset:24576
    ds_read_b64_tr_b16 v[34:35], v14 offset:25088
    s_waitcnt lgkmcnt(6)
    v_mfma_f32_32x32x16_bf16 v[96:111], v[148:151], v[36:39], v[96:111]
    s_add_u32 s51, s45, 0
    buffer_store_dwordx4 v[16:19], v15, s[24:27], s51 offen offset:0 sc1
    ds_read_b64_tr_b16 v[36:37], v14 offset:26624
    ds_read_b64_tr_b16 v[38:39], v14 offset:27136
    s_waitcnt lgkmcnt(6)
    v_mfma_f32_32x32x16_bf16 v[96:111], v[152:155], v[40:43], v[96:111]
    ds_read_b64_tr_b16 v[40:41], v14 offset:28672
    ds_read_b64_tr_b16 v[42:43], v14 offset:29184
    s_waitcnt lgkmcnt(6)
    v_mfma_f32_32x32x16_bf16 v[96:111], v[156:159], v[44:47], v[96:111]
    v_cvt_pk_bf16_f32 v20, v56, v57
    ds_read_b64_tr_b16 v[44:45], v14 offset:30720
    ds_read_b64_tr_b16 v[46:47], v14 offset:31232
    s_waitcnt lgkmcnt(6)
    v_mfma_f32_32x32x16_bf16 v[96:111], v[160:163], v[32:35], v[96:111]
    ds_read_b64_tr_b16 v[32:33], v14 offset:32768
    ds_read_b64_tr_b16 v[34:35], v14 offset:33280
    s_waitcnt lgkmcnt(6)
    v_mfma_f32_32x32x16_bf16 v[96:111], v[164:167], v[36:39], v[96:111]
    v_cvt_pk_bf16_f32 v21, v58, v59
    ds_read_b64_tr_b16 v[36:37], v14 offset:34816
    ds_read_b64_tr_b16 v[38:39], v14 offset:35328
    s_waitcnt lgkmcnt(6)
    v_mfma_f32_32x32x16_bf16 v[96:111], v[168:171], v[40:43], v[96:111]
    ds_read_b64_tr_b16 v[40:41], v14 offset:36864
    ds_read_b64_tr_b16 v[42:43], v14 offset:37376
    s_waitcnt lgkmcnt(6)
    v_mfma_f32_32x32x16_bf16 v[96:111], v[172:175], v[44:47], v[96:111]
    v_cvt_pk_bf16_f32 v22, v60, v61
    ds_read_b64_tr_b16 v[44:45], v14 offset:38912
    ds_read_b64_tr_b16 v[46:47], v14 offset:39424
    s_waitcnt lgkmcnt(6)
    v_mfma_f32_32x32x16_bf16 v[96:111], v[176:179], v[32:35], v[96:111]
    ds_read_b64_tr_b16 v[32:33], v14 offset:40960
    ds_read_b64_tr_b16 v[34:35], v14 offset:41472
    s_waitcnt lgkmcnt(6)
    v_mfma_f32_32x32x16_bf16 v[96:111], v[180:183], v[36:39], v[96:111]
    ds_read_b64_tr_b16 v[36:37], v14 offset:43008
    ds_read_b64_tr_b16 v[38:39], v14 offset:43520
    s_waitcnt lgkmcnt(6)
    v_mfma_f32_32x32x16_bf16 v[96:111], v[184:187], v[40:43], v[96:111]
    v_cvt_pk_bf16_f32 v23, v62, v63
    ds_read_b64_tr_b16 v[40:41], v14 offset:45056
    ds_read_b64_tr_b16 v[42:43], v14 offset:45568
    s_waitcnt lgkmcnt(6)
    v_mfma_f32_32x32x16_bf16 v[96:111], v[188:191], v[44:47], v[96:111]
    ds_read_b64_tr_b16 v[44:45], v14 offset:47104
    ds_read_b64_tr_b16 v[46:47], v14 offset:47616
    s_waitcnt lgkmcnt(6)
    v_mfma_f32_32x32x16_bf16 v[96:111], v[192:195], v[32:35], v[96:111]
    s_add_u32 s51, s45, 0
    buffer_store_dwordx4 v[20:23], v15, s[24:27], s51 offen offset:1024 sc1
    ds_read_b64_tr_b16 v[32:33], v14 offset:49152
    ds_read_b64_tr_b16 v[34:35], v14 offset:49664
    s_waitcnt lgkmcnt(6)
    v_mfma_f32_32x32x16_bf16 v[96:111], v[196:199], v[36:39], v[96:111]
    ds_read_b64_tr_b16 v[36:37], v14 offset:51200
    ds_read_b64_tr_b16 v[38:39], v14 offset:51712
    s_waitcnt lgkmcnt(6)
    v_mfma_f32_32x32x16_bf16 v[96:111], v[200:203], v[40:43], v[96:111]
    v_cvt_pk_bf16_f32 v16, v64, v65
    ds_read_b64_tr_b16 v[40:41], v14 offset:53248
    ds_read_b64_tr_b16 v[42:43], v14 offset:53760
    s_waitcnt lgkmcnt(6)
    v_mfma_f32_32x32x16_bf16 v[96:111], v[204:207], v[44:47], v[96:111]
    ds_read_b64_tr_b16 v[44:45], v14 offset:55296
    ds_read_b64_tr_b16 v[46:47], v14 offset:55808
    s_waitcnt lgkmcnt(6)
    v_mfma_f32_32x32x16_bf16 v[96:111], v[208:211], v[32:35], v[96:111]
    v_cvt_pk_bf16_f32 v17, v66, v67
    ds_read_b64_tr_b16 v[32:33], v14 offset:57344
    ds_read_b64_tr_b16 v[34:35], v14 offset:57856
    s_waitcnt lgkmcnt(6)
    v_mfma_f32_32x32x16_bf16 v[96:111], v[212:215], v[36:39], v[96:111]
    ds_read_b64_tr_b16 v[36:37], v14 offset:59392
    ds_read_b64_tr_b16 v[38:39], v14 offset:59904
    s_waitcnt lgkmcnt(6)
    v_mfma_f32_32x32x16_bf16 v[96:111], v[216:219], v[40:43], v[96:111]
    v_cvt_pk_bf16_f32 v18, v68, v69
    ds_read_b64_tr_b16 v[40:41], v14 offset:61440
    ds_read_b64_tr_b16 v[42:43], v14 offset:61952
    s_waitcnt lgkmcnt(6)
    v_mfma_f32_32x32x16_bf16 v[96:111], v[220:223], v[44:47], v[96:111]
    ds_read_b64_tr_b16 v[44:45], v14 offset:63488
    ds_read_b64_tr_b16 v[46:47], v14 offset:64000
    s_waitcnt lgkmcnt(6)
    v_mfma_f32_32x32x16_bf16 v[96:111], v[224:227], v[32:35], v[96:111]
    v_cvt_pk_bf16_f32 v19, v70, v71
    v_add_u32 v14, 65536, v14
    ds_read_b64_tr_b16 v[32:33], v14 offset:0
    ds_read_b64_tr_b16 v[34:35], v14 offset:512
    s_waitcnt lgkmcnt(6)
    v_mfma_f32_32x32x16_bf16 v[96:111], v[228:231], v[36:39], v[96:111]
    ds_read_b64_tr_b16 v[36:37], v14 offset:2048
    ds_read_b64_tr_b16 v[38:39], v14 offset:2560
    s_waitcnt lgkmcnt(6)
    v_mfma_f32_32x32x16_bf16 v[96:111], v[232:235], v[40:43], v[96:111]
    s_add_u32 s51, s45, 2048
    buffer_store_dwordx4 v[16:19], v15, s[24:27], s51 offen offset:0 sc1
    ds_read_b64_tr_b16 v[40:41], v14 offset:4096
    ds_read_b64_tr_b16 v[42:43], v14 offset:4608
    s_waitcnt lgkmcnt(6)
    v_mfma_f32_32x32x16_bf16 v[96:111], v[236:239], v[44:47], v[96:111]
    ds_read_b64_tr_b16 v[44:45], v14 offset:6144
    ds_read_b64_tr_b16 v[46:47], v14 offset:6656
    s_waitcnt lgkmcnt(6)
    v_mfma_f32_32x32x16_bf16 v[96:111], v[240:243], v[32:35], v[96:111]
    s_waitcnt vmcnt(3)
    s_waitcnt lgkmcnt(0)
    s_barrier
    v_add_u32 v12, 16384, v12
    ds_read_b64_tr_b16 v[32:33], v12 offset:0
    ds_read_b64_tr_b16 v[34:35], v12 offset:512
    v_mfma_f32_32x32x16_bf16 v[96:111], v[244:247], v[36:39], v[96:111]
    v_cvt_pk_bf16_f32 v20, v72, v73
    ds_read_b64_tr_b16 v[36:37], v12 offset:2048
    ds_read_b64_tr_b16 v[38:39], v12 offset:2560
    v_mfma_f32_32x32x16_bf16 v[96:111], v[248:251], v[40:43], v[96:111]
    ds_read_b64_tr_b16 v[40:41], v12 offset:4096
    ds_read_b64_tr_b16 v[42:43], v12 offset:4608
    v_mfma_f32_32x32x16_bf16 v[96:111], v[252:255], v[44:47], v[96:111]
    v_cvt_pk_bf16_f32 v21, v74, v75
    ds_read_b64_tr_b16 v[44:45], v12 offset:6144
    ds_read_b64_tr_b16 v[46:47], v12 offset:6656
    s_waitcnt lgkmcnt(6)
    v_mfma_f32_32x32x16_bf16 v[48:63], v[112:115], v[32:35], 0
    ds_read_b64_tr_b16 v[32:33], v12 offset:8192
    ds_read_b64_tr_b16 v[34:35], v12 offset:8704
    s_waitcnt lgkmcnt(6)
    v_mfma_f32_32x32x16_bf16 v[48:63], v[116:119], v[36:39], v[48:63]
    v_cvt_pk_bf16_f32 v22, v76, v77
    ds_read_b64_tr_b16 v[36:37], v12 offset:10240
    ds_read_b64_tr_b16 v[38:39], v12 offset:10752
    s_waitcnt lgkmcnt(6)
    v_mfma_f32_32x32x16_bf16 v[48:63], v[120:123], v[40:43], v[48:63]
    ds_read_b64_tr_b16 v[40:41], v12 offset:12288
    ds_read_b64_tr_b16 v[42:43], v12 offset:12800
    s_waitcnt lgkmcnt(6)
    v_mfma_f32_32x32x16_bf16 v[48:63], v[124:127], v[44:47], v[48:63]
    v_cvt_pk_bf16_f32 v23, v78, v79
    ds_read_b64_tr_b16 v[44:45], v12 offset:14336
    ds_read_b64_tr_b16 v[46:47], v12 offset:14848
    s_waitcnt lgkmcnt(6)
    v_mfma_f32_32x32x16_bf16 v[48:63], v[128:131], v[32:35], v[48:63]
    ds_read_b64_tr_b16 v[32:33], v12 offset:16384
    ds_read_b64_tr_b16 v[34:35], v12 offset:16896
    s_waitcnt lgkmcnt(6)
    v_mfma_f32_32x32x16_bf16 v[48:63], v[132:135], v[36:39], v[48:63]
    s_add_u32 s51, s45, 2048
    buffer_store_dwordx4 v[20:23], v15, s[24:27], s51 offen offset:1024 sc1
    ds_read_b64_tr_b16 v[36:37], v12 offset:18432
    ds_read_b64_tr_b16 v[38:39], v12 offset:18944
    s_waitcnt lgkmcnt(6)
    v_mfma_f32_32x32x16_bf16 v[48:63], v[136:139], v[40:43], v[48:63]
    ds_read_b64_tr_b16 v[40:41], v12 offset:20480
    ds_read_b64_tr_b16 v[42:43], v12 offset:20992
    s_waitcnt lgkmcnt(6)
    v_mfma_f32_32x32x16_bf16 v[48:63], v[140:143], v[44:47], v[48:63]
    v_cvt_pk_bf16_f32 v16, v80, v81
    ds_read_b64_tr_b16 v[44:45], v12 offset:22528
    ds_read_b64_tr_b16 v[46:47], v12 offset:23040
    s_waitcnt lgkmcnt(6)
    v_mfma_f32_32x32x16_bf16 v[48:63], v[144:147], v[32:35], v[48:63]
    ds_read_b64_tr_b16 v[32:33], v12 offset:24576
    ds_read_b64_tr_b16 v[34:35], v12 offset:25088
    s_waitcnt lgkmcnt(6)
    v_mfma_f32_32x32x16_bf16 v[48:63], v[148:151], v[36:39], v[48:63]
    v_cvt_pk_bf16_f32 v17, v82, v83
    ds_read_b64_tr_b16 v[36:37], v12 offset:26624
    ds_read_b64_tr_b16 v[38:39], v12 offset:27136
    s_waitcnt lgkmcnt(6)
    v_mfma_f32_32x32x16_bf16 v[48:63], v[152:155], v[40:43], v[48:63]
    ds_read_b64_tr_b16 v[40:41], v12 offset:28672
    ds_read_b64_tr_b16 v[42:43], v12 offset:29184
    s_waitcnt lgkmcnt(6)
    v_mfma_f32_32x32x16_bf16 v[48:63], v[156:159], v[44:47], v[48:63]
    ds_read_b64_tr_b16 v[44:45], v12 offset:30720
    ds_read_b64_tr_b16 v[46:47], v12 offset:31232
    s_waitcnt lgkmcnt(6)
    v_mfma_f32_32x32x16_bf16 v[48:63], v[160:163], v[32:35], v[48:63]
    v_cvt_pk_bf16_f32 v18, v84, v85
    ds_read_b64_tr_b16 v[32:33], v12 offset:32768
    ds_read_b64_tr_b16 v[34:35], v12 offset:33280
    s_waitcnt lgkmcnt(6)
    v_mfma_f32_32x32x16_bf16 v[48:63], v[164:167], v[36:39], v[48:63]
    ds_read_b64_tr_b16 v[36:37], v12 offset:34816
    ds_read_b64_tr_b16 v[38:39], v12 offset:35328
    s_waitcnt lgkmcnt(6)
    v_mfma_f32_32x32x16_bf16 v[48:63], v[168:171], v[40:43], v[48:63]
    v_cvt_pk_bf16_f32 v19, v86, v87
    ds_read_b64_tr_b16 v[40:41], v12 offset:36864
    ds_read_b64_tr_b16 v[42:43], v12 offset:37376
    s_waitcnt lgkmcnt(6)
    v_mfma_f32_32x32x16_bf16 v[48:63], v[172:175], v[44:47], v[48:63]
    ds_read_b64_tr_b16 v[44:45], v12 offset:38912
    ds_read_b64_tr_b16 v[46:47], v12 offset:39424
    s_waitcnt lgkmcnt(6)
    v_mfma_f32_32x32x16_bf16 v[48:63], v[176:179], v[32:35], v[48:63]
    s_add_u32 s51, s45, 4096
    buffer_store_dwordx4 v[16:19], v15, s[24:27], s51 offen offset:0 sc1
    ds_read_b64_tr_b16 v[32:33], v12 offset:40960
    ds_read_b64_tr_b16 v[34:35], v12 offset:41472
    s_waitcnt lgkmcnt(6)
    v_mfma_f32_32x32x16_bf16 v[48:63], v[180:183], v[36:39], v[48:63]
    ds_read_b64_tr_b16 v[36:37], v12 offset:43008
    ds_read_b64_tr_b16 v[38:39], v12 offset:43520
    s_waitcnt lgkmcnt(6)
    v_mfma_f32_32x32x16_bf16 v[48:63], v[184:187], v[40:43], v[48:63]
    v_cvt_pk_bf16_f32 v20, v88, v89
    ds_read_b64_tr_b16 v[40:41], v12 offset:45056
    ds_read_b64_tr_b16 v[42:43], v12 offset:45568
    s_waitcnt lgkmcnt(6)
    v_mfma_f32_32x32x16_bf16 v[48:63], v[188:191], v[44:47], v[48:63]
    ds_read_b64_tr_b16 v[44:45], v12 offset:47104
    ds_read_b64_tr_b16 v[46:47], v12 offset:47616
    s_waitcnt lgkmcnt(6)
    v_mfma_f32_32x32x16_bf16 v[48:63], v[192:195], v[32:35], v[48:63]
    v_cvt_pk_bf16_f32 v21, v90, v91
    ds_read_b64_tr_b16 v[32:33], v12 offset:49152
    ds_read_b64_tr_b16 v[34:35], v12 offset:49664
    s_waitcnt lgkmcnt(6)
    v_mfma_f32_32x32x16_bf16 v[48:63], v[196:199], v[36:39], v[48:63]
    ds_read_b64_tr_b16 v[36:37], v12 offset:51200
    ds_read_b64_tr_b16 v[38:39], v12 offset:51712
    s_waitcnt lgkmcnt(6)
    v_mfma_f32_32x32x16_bf16 v[48:63], v[200:203], v[40:43], v[48:63]
    v_cvt_pk_bf16_f32 v22, v92, v93
    ds_read_b64_tr_b16 v[40:41], v12 offset:53248
    ds_read_b64_tr_b16 v[42:43], v12 offset:53760
    s_waitcnt lgkmcnt(6)
    v_mfma_f32_32x32x16_bf16 v[48:63], v[204:207], v[44:47], v[48:63]
    ds_read_b64_tr_b16 v[44:45], v12 offset:55296
    ds_read_b64_tr_b16 v[46:47], v12 offset:55808
    s_waitcnt lgkmcnt(6)
    v_mfma_f32_32x32x16_bf16 v[48:63], v[208:211], v[32:35], v[48:63]
    v_cvt_pk_bf16_f32 v23, v94, v95
    ds_read_b64_tr_b16 v[32:33], v12 offset:57344
    ds_read_b64_tr_b16 v[34:35], v12 offset:57856
    s_waitcnt lgkmcnt(6)
    v_mfma_f32_32x32x16_bf16 v[48:63], v[212:215], v[36:39], v[48:63]
    ds_read_b64_tr_b16 v[36:37], v12 offset:59392
    ds_read_b64_tr_b16 v[38:39], v12 offset:59904
    s_waitcnt lgkmcnt(6)
    v_mfma_f32_32x32x16_bf16 v[48:63], v[216:219], v[40:43], v[48:63]
    ds_read_b64_tr_b16 v[40:41], v12 offset:61440
    ds_read_b64_tr_b16 v[42:43], v12 offset:61952
    s_waitcnt lgkmcnt(6)
    v_mfma_f32_32x32x16_bf16 v[48:63], v[220:223], v[44:47], v[48:63]
    s_add_u32 s51, s45, 4096
    buffer_store_dwordx4 v[20:23], v15, s[24:27], s51 offen offset:1024 sc1
    ds_read_b64_tr_b16 v[44:45], v12 offset:63488
    ds_read_b64_tr_b16 v[46:47], v12 offset:64000
    s_waitcnt lgkmcnt(6)
    v_mfma_f32_32x32x16_bf16 v[48:63], v[224:227], v[32:35], v[48:63]
    v_add_u32 v12, 65536, v12
    ds_read_b64_tr_b16 v[32:33], v12 offset:0
    ds_read_b64_tr_b16 v[34:35], v12 offset:512
    s_waitcnt lgkmcnt(6)
    v_mfma_f32_32x32x16_bf16 v[48:63], v[228:231], v[36:39], v[48:63]
    v_cvt_pk_bf16_f32 v16, v96, v97
    ds_read_b64_tr_b16 v[36:37], v12 offset:2048
    ds_read_b64_tr_b16 v[38:39], v12 offset:2560
    s_waitcnt lgkmcnt(6)
    v_mfma_f32_32x32x16_bf16 v[48:63], v[232:235], v[40:43], v[48:63]
    ds_read_b64_tr_b16 v[40:41], v12 offset:4096
    ds_read_b64_tr_b16 v[42:43], v12 offset:4608
    s_waitcnt lgkmcnt(6)
    v_mfma_f32_32x32x16_bf16 v[48:63], v[236:239], v[44:47], v[48:63]
    v_cvt_pk_bf16_f32 v17, v98, v99
    ds_read_b64_tr_b16 v[44:45], v12 offset:6144
    ds_read_b64_tr_b16 v[46:47], v12 offset:6656
    s_waitcnt lgkmcnt(6)
    v_mfma_f32_32x32x16_bf16 v[48:63], v[240:243], v[32:35], v[48:63]
    v_add_u32 v13, 16384, v13
    ds_read_b64_tr_b16 v[32:33], v13 offset:0
    ds_read_b64_tr_b16 v[34:35], v13 offset:512
    s_waitcnt lgkmcnt(6)
    v_mfma_f32_32x32x16_bf16 v[48:63], v[244:247], v[36:39], v[48:63]
    v_cvt_pk_bf16_f32 v18, v100, v101
    ds_read_b64_tr_b16 v[36:37], v13 offset:2048
    ds_read_b64_tr_b16 v[38:39], v13 offset:2560
    s_waitcnt lgkmcnt(6)
    v_mfma_f32_32x32x16_bf16 v[48:63], v[248:251], v[40:43], v[48:63]
    ds_read_b64_tr_b16 v[40:41], v13 offset:4096
    ds_read_b64_tr_b16 v[42:43], v13 offset:4608
    s_waitcnt lgkmcnt(6)
    v_mfma_f32_32x32x16_bf16 v[48:63], v[252:255], v[44:47], v[48:63]
    v_cvt_pk_bf16_f32 v19, v102, v103
    ds_read_b64_tr_b16 v[44:45], v13 offset:6144
    ds_read_b64_tr_b16 v[46:47], v13 offset:6656
    s_waitcnt lgkmcnt(6)
    v_mfma_f32_32x32x16_bf16 v[64:79], v[112:115], v[32:35], 0
    ds_read_b64_tr_b16 v[32:33], v13 offset:8192
    ds_read_b64_tr_b16 v[34:35], v13 offset:8704
    s_waitcnt lgkmcnt(6)
    v_mfma_f32_32x32x16_bf16 v[64:79], v[116:119], v[36:39], v[64:79]
    s_add_u32 s51, s45, 6144
    buffer_store_dwordx4 v[16:19], v15, s[24:27], s51 offen offset:0 sc1
    ds_read_b64_tr_b16 v[36:37], v13 offset:10240
    ds_read_b64_tr_b16 v[38:39], v13 offset:10752
    s_waitcnt lgkmcnt(6)
    v_mfma_f32_32x32x16_bf16 v[64:79], v[120:123], v[40:43], v[64:79]
    ds_read_b64_tr_b16 v[40:41], v13 offset:12288
    ds_read_b64_tr_b16 v[42:43], v13 offset:12800
    s_waitcnt lgkmcnt(6)
    v_mfma_f32_32x32x16_bf16 v[64:79], v[124:127], v[44:47], v[64:79]
    v_cvt_pk_bf16_f32 v20, v104, v105
    ds_read_b64_tr_b16 v[44:45], v13 offset:14336
    ds_read_b64_tr_b16 v[46:47], v13 offset:14848
    s_waitcnt lgkmcnt(6)
    v_mfma_f32_32x32x16_bf16 v[64:79], v[128:131], v[32:35], v[64:79]
    ds_read_b64_tr_b16 v[32:33], v13 offset:16384
    ds_read_b64_tr_b16 v[34:35], v13 offset:16896
    s_waitcnt lgkmcnt(6)
    v_mfma_f32_32x32x16_bf16 v[64:79], v[132:135], v[36:39], v[64:79]
    ds_read_b64_tr_b16 v[36:37], v13 offset:18432
    ds_read_b64_tr_b16 v[38:39], v13 offset:18944
    s_waitcnt lgkmcnt(6)
    v_mfma_f32_32x32x16_bf16 v[64:79], v[136:139], v[40:43], v[64:79]
    v_cvt_pk_bf16_f32 v21, v106, v107
    ds_read_b64_tr_b16 v[40:41], v13 offset:20480
    ds_read_b64_tr_b16 v[42:43], v13 offset:20992
    s_waitcnt lgkmcnt(6)
    v_mfma_f32_32x32x16_bf16 v[64:79], v[140:143], v[44:47], v[64:79]
    ds_read_b64_tr_b16 v[44:45], v13 offset:22528
    ds_read_b64_tr_b16 v[46:47], v13 offset:23040
    s_waitcnt lgkmcnt(6)
    v_mfma_f32_32x32x16_bf16 v[64:79], v[144:147], v[32:35], v[64:79]
    v_cvt_pk_bf16_f32 v22, v108, v109
    ds_read_b64_tr_b16 v[32:33], v13 offset:24576
    ds_read_b64_tr_b16 v[34:35], v13 offset:25088
    s_waitcnt lgkmcnt(6)
    v_mfma_f32_32x32x16_bf16 v[64:79], v[148:151], v[36:39], v[64:79]
    ds_read_b64_tr_b16 v[36:37], v13 offset:26624
    ds_read_b64_tr_b16 v[38:39], v13 offset:27136
    s_waitcnt lgkmcnt(6)
    v_mfma_f32_32x32x16_bf16 v[64:79], v[152:155], v[40:43], v[64:79]
    v_cvt_pk_bf16_f32 v23, v110, v111
    ds_read_b64_tr_b16 v[40:41], v13 offset:28672
    ds_read_b64_tr_b16 v[42:43], v13 offset:29184
    s_waitcnt lgkmcnt(6)
    v_mfma_f32_32x32x16_bf16 v[64:79], v[156:159], v[44:47], v[64:79]
    ds_read_b64_tr_b16 v[44:45], v13 offset:30720
    ds_read_b64_tr_b16 v[46:47], v13 offset:31232
    s_waitcnt lgkmcnt(6)
    v_mfma_f32_32x32x16_bf16 v[64:79], v[160:163], v[32:35], v[64:79]
    s_add_u32 s51, s45, 6144
    buffer_store_dwordx4 v[20:23], v15, s[24:27], s51 offen offset:1024 sc1
    ds_read_b64_tr_b16 v[32:33], v13 offset:32768
    ds_read_b64_tr_b16 v[34:35], v13 offset:33280
    s_waitcnt lgkmcnt(6)
    v_mfma_f32_32x32x16_bf16 v[64:79], v[164:167], v[36:39], v[64:79]
    ds_read_b64_tr_b16 v[36:37], v13 offset:34816
    ds_read_b64_tr_b16 v[38:39], v13 offset:35328
    s_waitcnt lgkmcnt(6)
    v_mfma_f32_32x32x16_bf16 v[64:79], v[168:171], v[40:43], v[64:79]
    v_cvt_pk_bf16_f32 v16, v48, v49
    ds_read_b64_tr_b16 v[40:41], v13 offset:36864
    ds_read_b64_tr_b16 v[42:43], v13 offset:37376
    s_waitcnt lgkmcnt(6)
    v_mfma_f32_32x32x16_bf16 v[64:79], v[172:175], v[44:47], v[64:79]
    ds_read_b64_tr_b16 v[44:45], v13 offset:38912
    ds_read_b64_tr_b16 v[46:47], v13 offset:39424
    s_waitcnt lgkmcnt(6)
    v_mfma_f32_32x32x16_bf16 v[64:79], v[176:179], v[32:35], v[64:79]
    v_cvt_pk_bf16_f32 v17, v50, v51
    ds_read_b64_tr_b16 v[32:33], v13 offset:40960
    ds_read_b64_tr_b16 v[34:35], v13 offset:41472
    s_waitcnt lgkmcnt(6)
    v_mfma_f32_32x32x16_bf16 v[64:79], v[180:183], v[36:39], v[64:79]
    ds_read_b64_tr_b16 v[36:37], v13 offset:43008
    ds_read_b64_tr_b16 v[38:39], v13 offset:43520
    s_waitcnt lgkmcnt(6)
    v_mfma_f32_32x32x16_bf16 v[64:79], v[184:187], v[40:43], v[64:79]
    v_cvt_pk_bf16_f32 v18, v52, v53
    ds_read_b64_tr_b16 v[40:41], v13 offset:45056
    ds_read_b64_tr_b16 v[42:43], v13 offset:45568
    s_waitcnt lgkmcnt(6)
    v_mfma_f32_32x32x16_bf16 v[64:79], v[188:191], v[44:47], v[64:79]
    ds_read_b64_tr_b16 v[44:45], v13 offset:47104
    ds_read_b64_tr_b16 v[46:47], v13 offset:47616
    s_waitcnt lgkmcnt(6)
    v_mfma_f32_32x32x16_bf16 v[64:79], v[192:195], v[32:35], v[64:79]
    ds_read_b64_tr_b16 v[32:33], v13 offset:49152
    ds_read_b64_tr_b16 v[34:35], v13 offset:49664
    s_waitcnt lgkmcnt(6)
    v_mfma_f32_32x32x16_bf16 v[64:79], v[196:199], v[36:39], v[64:79]
    v_cvt_pk_bf16_f32 v19, v54, v55
    ds_read_b64_tr_b16 v[36:37], v13 offset:51200
    ds_read_b64_tr_b16 v[38:39], v13 offset:51712
    s_waitcnt lgkmcnt(6)
    v_mfma_f32_32x32x16_bf16 v[64:79], v[200:203], v[40:43], v[64:79]
    ds_read_b64_tr_b16 v[40:41], v13 offset:53248
    ds_read_b64_tr_b16 v[42:43], v13 offset:53760
    s_waitcnt lgkmcnt(6)
    v_mfma_f32_32x32x16_bf16 v[64:79], v[204:207], v[44:47], v[64:79]
    s_add_u32 s51, s45, 8192
    buffer_store_dwordx4 v[16:19], v15, s[24:27], s51 offen offset:0 sc1
    ds_read_b64_tr_b16 v[44:45], v13 offset:55296
    ds_read_b64_tr_b16 v[46:47], v13 offset:55808
    s_waitcnt lgkmcnt(6)
    v_mfma_f32_32x32x16_bf16 v[64:79], v[208:211], v[32:35], v[64:79]
    ds_read_b64_tr_b16 v[32:33], v13 offset:57344
    ds_read_b64_tr_b16 v[34:35], v13 offset:57856
    s_waitcnt lgkmcnt(6)
    v_mfma_f32_32x32x16_bf16 v[64:79], v[212:215], v[36:39], v[64:79]
    v_cvt_pk_bf16_f32 v20, v56, v57
    ds_read_b64_tr_b16 v[36:37], v13 offset:59392
    ds_read_b64_tr_b16 v[38:39], v13 offset:59904
    s_waitcnt lgkmcnt(6)
    v_mfma_f32_32x32x16_bf16 v[64:79], v[216:219], v[40:43], v[64:79]
    ds_read_b64_tr_b16 v[40:41], v13 offset:61440
    ds_read_b64_tr_b16 v[42:43], v13 offset:61952
    s_waitcnt lgkmcnt(6)
    v_mfma_f32_32x32x16_bf16 v[64:79], v[220:223], v[44:47], v[64:79]
    v_cvt_pk_bf16_f32 v21, v58, v59
    ds_read_b64_tr_b16 v[44:45], v13 offset:63488
    ds_read_b64_tr_b16 v[46:47], v13 offset:64000
    s_waitcnt lgkmcnt(6)
    v_mfma_f32_32x32x16_bf16 v[64:79], v[224:227], v[32:35], v[64:79]
    v_add_u32 v13, 65536, v13
    ds_read_b64_tr_b16 v[32:33], v13 offset:0
    ds_read_b64_tr_b16 v[34:35], v13 offset:512
    s_waitcnt lgkmcnt(6)
    v_mfma_f32_32x32x16_bf16 v[64:79], v[228:231], v[36:39], v[64:79]
    v_cvt_pk_bf16_f32 v22, v60, v61
    ds_read_b64_tr_b16 v[36:37], v13 offset:2048
    ds_read_b64_tr_b16 v[38:39], v13 offset:2560
    s_waitcnt lgkmcnt(6)
    v_mfma_f32_32x32x16_bf16 v[64:79], v[232:235], v[40:43], v[64:79]
    ds_read_b64_tr_b16 v[40:41], v13 offset:4096
    ds_read_b64_tr_b16 v[42:43], v13 offset:4608
    s_waitcnt lgkmcnt(6)
    v_mfma_f32_32x32x16_bf16 v[64:79], v[236:239], v[44:47], v[64:79]
    v_cvt_pk_bf16_f32 v23, v62, v63
    ds_read_b64_tr_b16 v[44:45], v13 offset:6144
    ds_read_b64_tr_b16 v[46:47], v13 offset:6656
    s_waitcnt lgkmcnt(6)
    v_mfma_f32_32x32x16_bf16 v[64:79], v[240:243], v[32:35], v[64:79]
    s_waitcnt lgkmcnt(4)
    v_mfma_f32_32x32x16_bf16 v[64:79], v[244:247], v[36:39], v[64:79]
    s_add_u32 s51, s45, 8192
    buffer_store_dwordx4 v[20:23], v15, s[24:27], s51 offen offset:1024 sc1
    s_waitcnt lgkmcnt(2)
    v_mfma_f32_32x32x16_bf16 v[64:79], v[248:251], v[40:43], v[64:79]
    s_waitcnt lgkmcnt(0)
    v_mfma_f32_32x32x16_bf16 v[64:79], v[252:255], v[44:47], v[64:79]
    s_nop 11
    v_cvt_pk_bf16_f32 v16, v64, v65
    v_cvt_pk_bf16_f32 v17, v66, v67
    v_cvt_pk_bf16_f32 v18, v68, v69
    v_cvt_pk_bf16_f32 v19, v70, v71
    s_add_u32 s51, s45, 10240
    buffer_store_dwordx4 v[16:19], v15, s[24:27], s51 offen offset:0 sc1
    v_cvt_pk_bf16_f32 v20, v72, v73
    v_cvt_pk_bf16_f32 v21, v74, v75
    v_cvt_pk_bf16_f32 v22, v76, v77
    v_cvt_pk_bf16_f32 v23, v78, v79
    s_add_u32 s51, s45, 10240
    buffer_store_dwordx4 v[20:23], v15, s[24:27], s51 offen offset:1024 sc1
    s_waitcnt vmcnt(0)
    s_barrier
    s_lshl_b32 s41, s30, 11
    s_lshl_b32 s42, s29, 8
    s_add_u32 s41, s41, s42
    s_add_u32 s41, s41, 42082304
    s_cmp_lg_u32 s28, 0
    s_cbranch_scc1 U_NOFLAG
    buffer_store_dwordx2 v[2:3], v8, s[24:27], s41 offen sc1
U_NOFLAG:
    s_getpc_b64 s[16:17]
    s_add_u32 s16, s16, GTR@rel32@lo+4
    s_addc_u32 s17, s17, GTR@rel32@hi+12
    s_mov_b32 s18, 663552
    s_lshr_b32 s41, s3, 1
    s_mul_i32 s41, s41, 165888
    s_lshl_b32 s42, s55, 3
    s_add_u32 s42, s42, s28
    s_mul_i32 s42, s42, 6912
    s_add_u32 s41, s41, s42
    v_min_u32 v7, 53, v1
    v_lshlrev_b32 v7, 7, v7
    buffer_load_dword v7, v7, s[16:19], s41 offen
    s_waitcnt vmcnt(0)
    s_endpgm
M_FFT:
    s_waitcnt lgkmcnt(0)
    s_mov_b32 s24, s8
    s_mov_b32 s25, s9
    s_mov_b32 s26, 0x4000000
    s_mov_b32 s27, 0x20000
    s_mul_i32 s29, s3, 5
    s_add_u32 s29, s29, s54
    s_sub_u32 s29, s29, 27
    s_sub_u32 s30, s54, 27
    s_lshl_b32 s30, s30, 3
    s_add_u32 s30, s30, s28
    v_and_b32 v1, 63, v0
    s_getpc_b64 s[16:17]
    s_add_u32 s16, s16, FTAB@rel32@lo+4
    s_addc_u32 s17, s17, FTAB@rel32@hi+12
    s_mov_b32 s18, 663552
    s_mov_b32 s19, 0x20000
    s_lshl_b32 s31, s30, 6
    v_add_u32 v4, s31, v1
    v_lshlrev_b32 v5, 7, v4
    s_mov_b32 s35, 73728
    buffer_load_dword v16, v5, s[16:19], s35 offen
    v_add_u32 v5, 401408, v5
    buffer_load_dword v17, v5, s[16:19], 0 offen
    s_cmp_ge_u32 s29, 37
    s_cbranch_scc1 M_IDLE
    s_load_dwordx4 s[44:47], s[0:1], 8
    s_getpc_b64 s[12:13]
    s_add_u32 s12, s12, FFTTAB@rel32@lo+4
    s_addc_u32 s13, s13, FFTTAB@rel32@hi+12
    s_mov_b32 s14, 65536
    s_mov_b32 s15, 0x20000
    v_and_b32 v1, 63, v0
    v_lshlrev_b32 v9, 4, v1
    s_lshl_b32 s42, s28, 13
    v_add_u32 v7, s42, v9
    v_mov_b32 v0, 0
    s_lshl_b32 m0, s28, 13
    s_nop 0
    buffer_load_dwordx4 v7, s[12:15], 0 offen offset:0 lds
    buffer_load_dwordx4 v7, s[12:15], 0 offen offset:1024 lds
    buffer_load_dwordx4 v7, s[12:15], 0 offen offset:2048 lds
    buffer_load_dwordx4 v7, s[12:15], 0 offen offset:3072 lds
    s_movk_i32 s42, 0x1000
    s_add_u32 m0, m0, s42
    s_nop 0
    buffer_load_dwordx4 v7, s[12:15], s42 offen offset:0 lds
    buffer_load_dwordx4 v7, s[12:15], s42 offen offset:1024 lds
    buffer_load_dwordx4 v7, s[12:15], s42 offen offset:2048 lds
    buffer_load_dwordx4 v7, s[12:15], s42 offen offset:3072 lds
    global_load_dwordx2 v[2:3], v0, s[100:101] sc1
    s_waitcnt lgkmcnt(0)
    s_mov_b32 s16, s44
    s_mov_b32 s17, s45
    s_mov_b32 s18, 0x121000
    s_mov_b32 s19, 0x20000
    s_mov_b32 s20, s46
    s_mov_b32 s21, s47
    s_mov_b32 s22, 0x121000
    s_mov_b32 s23, 0x20000
    s_lshl_b32 s30, s29, 3
    s_add_u32 s30, s30, s28
    v_and_b32 v5, 31, v1
    v_lshrrev_b32 v6, 5, v1
    s_cmp_ge_u32 s29, 32
    s_cbranch_scc1 F_NOPROD
    s_waitcnt vmcnt(0)
    v_cmp_ne_u64 vcc, 0, v[2:3]
    s_nop 0
    s_cmp_eq_u64 vcc, -1
    s_cbranch_scc1 NOK23
s_mov_b32 s53, 0
NSP23:
 s_sleep 2
 global_load_dwordx2 v[2:3], v0, s[100:101] sc1
 s_add_u32 s53, s53, 1
 s_waitcnt vmcnt(0)
 v_cmp_ne_u64 vcc, 0, v[2:3]
 s_cmp_ge_u32 s53, 0x40000
 s_cbranch_scc1 NOK23
 s_nop 1
 s_cmp_eq_u64 vcc, -1
 s_cbranch_scc0 NSP23
NOK23:
    s_lshl_b32 s47, s3, 8
    s_add_u32 s47, s47, 42090496
    s_cmp_lg_u32 s28, 0
    s_cbranch_scc1 F_NOSP
    buffer_load_dwordx2 v[10:11], v0, s[24:27], s47 offen offset:0 sc1
    s_waitcnt vmcnt(0)
    v_cmp_eq_u64 vcc, v[10:11], v[2:3]
    s_nop 0
    s_cmp_eq_u64 vcc, -1
    s_cbranch_scc1 POK24
s_mov_b32 s53, 0
PSP24:
 s_sleep 16
 buffer_load_dwordx2 v[10:11], v0, s[24:27], s47 offen offset:0 sc1
 s_add_u32 s53, s53, 1
 s_waitcnt vmcnt(0)
 v_cmp_eq_u64 vcc, v[10:11], v[2:3]
 s_cmp_ge_u32 s53, 0x40000
 s_cbranch_scc1 POK24
 s_nop 1
 s_cmp_eq_u64 vcc, -1
 s_cbranch_scc0 PSP24
POK24:
F_NOSP:
    s_barrier
    s_lshr_b32 s31, s29, 3
    s_lshl_b32 s31, s31, 9
    s_bfe_u32 s42, s29, 0x10002
    s_lshl_b32 s42, s42, 7
    s_add_u32 s31, s31, s42
    s_and_b32 s42, s29, 3
    s_lshl_b32 s42, s42, 3
    s_add_u32 s31, s31, s42
    s_and_b32 s42, s28, 3
    s_lshl_b32 s42, s42, 5
    s_add_u32 s31, s31, s42
    s_lshr_b32 s42, s28, 2
    s_lshl_b32 s42, s42, 8
    s_add_u32 s31, s31, s42
    s_mul_i32 s31, s31, 578
    v_add_u32 v7, s31, v9
    s_mul_i32 s32, s28, 5120
    s_add_u32 s32, s32, 65536
    s_movk_i32 s42, 0x1000
    s_add_u32 m0, s32, 0
    s_nop 0
    buffer_load_dwordx4 v7, s[16:19], 0 offen offset:0 lds
    buffer_load_dwordx4 v7, s[16:19], 0 offen offset:1024 lds
    buffer_load_dwordx4 v7, s[16:19], 0 offen offset:2048 lds
    buffer_load_dwordx4 v7, s[16:19], 0 offen offset:3072 lds
    s_add_u32 m0, s32, 4096
    v_add_u32 v8, s42, v7
    buffer_load_dwordx4 v8, s[16:19], 0 offen lds
    s_add_u32 m0, s32, 40960
    s_nop 0
    buffer_load_dwordx4 v7, s[20:23], 0 offen offset:0 lds
    buffer_load_dwordx4 v7, s[20:23], 0 offen offset:1024 lds
    buffer_load_dwordx4 v7, s[20:23], 0 offen offset:2048 lds
    buffer_load_dwordx4 v7, s[20:23], 0 offen offset:3072 lds
    s_add_u32 m0, s32, 45056
    v_add_u32 v8, s42, v7
    buffer_load_dwordx4 v8, s[20:23], 0 offen lds
    v_cmp_ne_u64 vcc, 0, v[2:3]
    s_nop 0
    s_cmp_eq_u64 vcc, -1
    s_cbranch_scc1 NOK25
s_mov_b32 s53, 0
NSP25:
 s_sleep 2
 global_load_dwordx2 v[2:3], v0, s[100:101] sc1
 s_add_u32 s53, s53, 1
 s_waitcnt vmcnt(0)
 v_cmp_ne_u64 vcc, 0, v[2:3]
 s_cmp_ge_u32 s53, 0x40000
 s_cbranch_scc1 NOK25
 s_nop 1
 s_cmp_eq_u64 vcc, -1
 s_cbranch_scc0 NSP25
NOK25:
    v_and_b32 v10, 7, v1
    v_lshrrev_b32 v11, 3, v1
    s_lshl_b32 s42, s28, 3
    v_add_u32 v11, s42, v11
    v_mul_u32_u24 v7, 578, v10
    v_lshl_add_u32 v7, v11, 1, v7
    v_add_u32 v7, 65536, v7
    v_add_u32 v13, 40960, v7
    v_lshlrev_b32 v8, 13, v11
    v_lshl_add_u32 v8, v10, 4, v8
    v_cmp_gt_u32 vcc, 33, v11
    v_mov_b32 v12, 0x7f000000
    s_nop 0
    v_cndmask_b32 v12, v12, v8, vcc
    s_lshr_b32 s33, s29, 3
    s_lshl_b32 s33, s33, 10
    s_and_b32 s42, s29, 7
    s_lshl_b32 s42, s42, 7
    s_add_u32 s33, s33, s42
    s_add_u32 s33, s33, 24117248
    s_waitcnt vmcnt(0)
    s_waitcnt lgkmcnt(0)
    s_barrier
    ds_read_u16 v128, v7 offset:0
    ds_read_u16_d16_hi v129, v7 offset:5120
    ds_read_u16 v130, v7 offset:10240
    ds_read_u16_d16_hi v131, v7 offset:15360
    ds_read_u16 v132, v7 offset:20480
    ds_read_u16_d16_hi v133, v7 offset:25600
    ds_read_u16 v134, v7 offset:30720
    ds_read_u16_d16_hi v135, v7 offset:35840
    ds_read_u16 v136, v7 offset:128
    ds_read_u16_d16_hi v137, v7 offset:5248
    ds_read_u16 v138, v7 offset:10368
    ds_read_u16_d16_hi v139, v7 offset:15488
    ds_read_u16 v140, v7 offset:20608
    ds_read_u16_d16_hi v141, v7 offset:25728
    ds_read_u16 v142, v7 offset:30848
    ds_read_u16_d16_hi v143, v7 offset:35968
    ds_read_u16 v144, v7 offset:256
    ds_read_u16_d16_hi v145, v7 offset:5376
    ds_read_u16 v146, v7 offset:10496
    ds_read_u16_d16_hi v147, v7 offset:15616
    ds_read_u16 v148, v7 offset:20736
    ds_read_u16_d16_hi v149, v7 offset:25856
    ds_read_u16 v150, v7 offset:30976
    ds_read_u16_d16_hi v151, v7 offset:36096
    s_waitcnt lgkmcnt(15)
    v_or_b32 v32, v128, v129
    v_or_b32 v33, v130, v131
    v_or_b32 v34, v132, v133
    v_or_b32 v35, v134, v135
    s_add_u32 s42, s33, 0
    buffer_store_dwordx4 v[32:35], v8, s[24:27], s42 offen sc1
    ds_read_u16 v152, v7 offset:384
    ds_read_u16_d16_hi v153, v7 offset:5504
    ds_read_u16 v154, v7 offset:10624
    ds_read_u16_d16_hi v155, v7 offset:15744
    ds_read_u16 v156, v7 offset:20864
    ds_read_u16_d16_hi v157, v7 offset:25984
    ds_read_u16 v158, v7 offset:31104
    ds_read_u16_d16_hi v159, v7 offset:36224
    s_waitcnt lgkmcnt(15)
    v_or_b32 v36, v136, v137
    v_or_b32 v37, v138, v139
    v_or_b32 v38, v140, v141
    v_or_b32 v39, v142, v143
    s_add_u32 s42, s33, 524288
    buffer_store_dwordx4 v[36:39], v8, s[24:27], s42 offen sc1
    ds_read_u16 v160, v7 offset:512
    ds_read_u16_d16_hi v161, v7 offset:5632
    ds_read_u16 v162, v7 offset:10752
    ds_read_u16_d16_hi v163, v7 offset:15872
    ds_read_u16 v164, v7 offset:20992
    ds_read_u16_d16_hi v165, v7 offset:26112
    ds_read_u16 v166, v7 offset:31232
    ds_read_u16_d16_hi v167, v7 offset:36352
    s_waitcnt lgkmcnt(15)
    v_or_b32 v40, v144, v145
    v_or_b32 v41, v146, v147
    v_or_b32 v42, v148, v149
    v_or_b32 v43, v150, v151
    s_add_u32 s42, s33, 1048576
    buffer_store_dwordx4 v[40:43], v8, s[24:27], s42 offen sc1
    ds_read_u16 v168, v13 offset:0
    ds_read_u16_d16_hi v169, v13 offset:5120
    ds_read_u16 v170, v13 offset:10240
    ds_read_u16_d16_hi v171, v13 offset:15360
    ds_read_u16 v172, v13 offset:20480
    ds_read_u16_d16_hi v173, v13 offset:25600
    ds_read_u16 v174, v13 offset:30720
    ds_read_u16_d16_hi v175, v13 offset:35840
    s_waitcnt lgkmcnt(15)
    v_or_b32 v44, v152, v153
    v_or_b32 v45, v154, v155
    v_or_b32 v46, v156, v157
    v_or_b32 v47, v158, v159
    s_add_u32 s42, s33, 1572864
    buffer_store_dwordx4 v[44:47], v8, s[24:27], s42 offen sc1
    ds_read_u16 v176, v13 offset:128
    ds_read_u16_d16_hi v177, v13 offset:5248
    ds_read_u16 v178, v13 offset:10368
    ds_read_u16_d16_hi v179, v13 offset:15488
    ds_read_u16 v180, v13 offset:20608
    ds_read_u16_d16_hi v181, v13 offset:25728
    ds_read_u16 v182, v13 offset:30848
    ds_read_u16_d16_hi v183, v13 offset:35968
    s_waitcnt lgkmcnt(15)
    v_or_b32 v48, v160, v161
    v_or_b32 v49, v162, v163
    v_or_b32 v50, v164, v165
    v_or_b32 v51, v166, v167
    s_add_u32 s42, s33, 2097152
    buffer_store_dwordx4 v[48:51], v12, s[24:27], s42 offen sc1
    ds_read_u16 v184, v13 offset:256
    ds_read_u16_d16_hi v185, v13 offset:5376
    ds_read_u16 v186, v13 offset:10496
    ds_read_u16_d16_hi v187, v13 offset:15616
    ds_read_u16 v188, v13 offset:20736
    ds_read_u16_d16_hi v189, v13 offset:25856
    ds_read_u16 v190, v13 offset:30976
    ds_read_u16_d16_hi v191, v13 offset:36096
    s_waitcnt lgkmcnt(15)
    v_or_b32 v52, v168, v169
    v_or_b32 v53, v170, v171
    v_or_b32 v54, v172, v173
    v_or_b32 v55, v174, v175
    s_add_u32 s42, s33, 4096
    buffer_store_dwordx4 v[52:55], v8, s[24:27], s42 offen sc1
    ds_read_u16 v192, v13 offset:384
    ds_read_u16_d16_hi v193, v13 offset:5504
    ds_read_u16 v194, v13 offset:10624
    ds_read_u16_d16_hi v195, v13 offset:15744
    ds_read_u16 v196, v13 offset:20864
    ds_read_u16_d16_hi v197, v13 offset:25984
    ds_read_u16 v198, v13 offset:31104
    ds_read_u16_d16_hi v199, v13 offset:36224
    s_waitcnt lgkmcnt(15)
    v_or_b32 v56, v176, v177
    v_or_b32 v57, v178, v179
    v_or_b32 v58, v180, v181
    v_or_b32 v59, v182, v183
    s_add_u32 s42, s33, 528384
    buffer_store_dwordx4 v[56:59], v8, s[24:27], s42 offen sc1
    ds_read_u16 v200, v13 offset:512
    ds_read_u16_d16_hi v201, v13 offset:5632
    ds_read_u16 v202, v13 offset:10752
    ds_read_u16_d16_hi v203, v13 offset:15872
    ds_read_u16 v204, v13 offset:20992
    ds_read_u16_d16_hi v205, v13 offset:26112
    ds_read_u16 v206, v13 offset:31232
    ds_read_u16_d16_hi v207, v13 offset:36352
    s_waitcnt lgkmcnt(15)
    v_or_b32 v60, v184, v185
    v_or_b32 v61, v186, v187
    v_or_b32 v62, v188, v189
    v_or_b32 v63, v190, v191
    s_add_u32 s42, s33, 1052672
    buffer_store_dwordx4 v[60:63], v8, s[24:27], s42 offen sc1
    s_waitcnt lgkmcnt(14)
    v_or_b32 v64, v192, v193
    s_waitcnt lgkmcnt(12)
    v_or_b32 v65, v194, v195
    s_waitcnt lgkmcnt(10)
    v_or_b32 v66, v196, v197
    s_waitcnt lgkmcnt(8)
    v_or_b32 v67, v198, v199
    s_add_u32 s42, s33, 1576960
    buffer_store_dwordx4 v[64:67], v8, s[24:27], s42 offen sc1
    s_waitcnt lgkmcnt(6)
    v_or_b32 v68, v200, v201
    s_waitcnt lgkmcnt(4)
    v_or_b32 v69, v202, v203
    s_waitcnt lgkmcnt(2)
    v_or_b32 v70, v204, v205
    s_waitcnt lgkmcnt(0)
    v_or_b32 v71, v206, v207
    s_add_u32 s42, s33, 2101248
    buffer_store_dwordx4 v[68:71], v12, s[24:27], s42 offen sc1
    v_cmp_eq_u32 vcc, 0, v1
    v_mov_b32 v10, 0x7f000000
    s_nop 0
    v_cndmask_b32 v10, v10, v1, vcc
    s_lshl_b32 s41, s29, 3
    s_add_u32 s41, s41, 42078208
    s_waitcnt vmcnt(0)
    s_barrier
    s_cmp_lg_u32 s28, 0
    s_cbranch_scc1 F_PJOIN
    buffer_store_dwordx2 v[2:3], v10, s[24:27], s41 offen sc1
    s_branch F_PJOIN
F_NOPROD:
    s_waitcnt vmcnt(0)
    v_cmp_ne_u64 vcc, 0, v[2:3]
    s_nop 0
    s_cmp_eq_u64 vcc, -1
    s_cbranch_scc1 NOK26
s_mov_b32 s53, 0
NSP26:
 s_sleep 2
 global_load_dwordx2 v[2:3], v0, s[100:101] sc1
 s_add_u32 s53, s53, 1
 s_waitcnt vmcnt(0)
 v_cmp_ne_u64 vcc, 0, v[2:3]
 s_cmp_ge_u32 s53, 0x40000
 s_cbranch_scc1 NOK26
 s_nop 1
 s_cmp_eq_u64 vcc, -1
 s_cbranch_scc0 NSP26
NOK26:
    s_waitcnt vmcnt(0) lgkmcnt(0)
F_PJOIN:
s_nop 4
    v_lshrrev_b32 v8, 3, v1
    v_lshrrev_b32 v10, 1, v8
    s_and_b32 s42, s28, 1
    s_lshl_b32 s42, s42, 2
    v_add_u32 v10, s42, v10
    v_and_b32 v11, 7, v1
    v_xor_b32 v10, v10, v11
    v_lshlrev_b32 v10, 4, v10
    v_lshl_add_u32 v12, v8, 7, v10
    v_mul_u32_u24 v8, 36864, v8
    v_add_u32 v8, v8, v10
    s_lshr_b32 s42, s29, 2
    s_lshl_b32 s42, s42, 11
    s_and_b32 s35, s29, 3
    s_lshl_b32 s35, s35, 7
    s_add_u32 s35, s35, s42
    s_mul_i32 s42, s28, 294912
    s_add_u32 s35, s35, s42
    s_add_u32 s35, s35, 20971520
    s_add_u32 s36, s35, 18432
    s_lshl_b32 s32, s28, 10
    s_add_u32 s39, s32, 27262976
    v_bfe_u32 v15, v1, 1, 3
    v_xor_b32 v13, s28, v15
    v_lshlrev_b32 v13, 4, v13
    v_lshl_add_u32 v13, v5, 7, v13
    v_lshl_add_u32 v13, v6, 13, v13
    v_add_u32 v13, 65536, v13
    v_lshlrev_b32 v4, 2, v6
    v_xor_b32 v4, v4, v15
    v_lshlrev_b32 v4, 4, v4
    v_lshl_add_u32 v4, v5, 7, v4
    v_add_u32 v4, 131072, v4
    s_lshl_b32 s31, s30, 12
    s_add_u32 s33, s31, 1179648
    s_cmp_eq_u32 s30, 0
    s_cselect_b32 s33, 0x7f000000, s33
    s_cmp_eq_u32 s30, 288
    s_cselect_b32 s33, 0x7f000000, s33
    s_add_u32 s37, s31, 28311552
    s_mov_b32 s38, 28311552
    v_lshlrev_b32 v5, 5, v5
    v_lshl_add_u32 v5, v6, 4, v5
    v_add_u32 v6, s33, v5
    v_mov_b32 v0, v9
    s_lshr_b32 s42, s29, 2
    s_cmp_ge_u32 s42, 6
    s_cselect_b32 s43, 2048, 0
    s_cmp_ge_u32 s42, 3
    s_cselect_b32 s42, 2, 1
    s_lshl_b32 s42, s42, 11
    s_sub_u32 s42, s42, s43
    v_min_u32 v7, 1, v1
    v_mul_u32_u24 v7, s42, v7
    s_lshl_b32 s47, s28, 8
    s_add_u32 s47, s47, s43
    s_add_u32 s47, s47, 42082304
    s_waitcnt vmcnt(0) lgkmcnt(0)
    s_barrier
    buffer_load_dwordx2 v[10:11], v7, s[24:27], s47 offen offset:0 sc1
    s_waitcnt vmcnt(0)
    v_cmp_eq_u64 vcc, v[10:11], v[2:3]
    s_nop 0
    s_cmp_eq_u64 vcc, -1
    s_cbranch_scc1 POK27
s_mov_b32 s53, 0
PSP27:
 s_sleep 4
 buffer_load_dwordx2 v[10:11], v7, s[24:27], s47 offen offset:0 sc1
 s_add_u32 s53, s53, 1
 s_waitcnt vmcnt(0)
 v_cmp_eq_u64 vcc, v[10:11], v[2:3]
 s_cmp_ge_u32 s53, 0x40000
 s_cbranch_scc1 POK27
 s_nop 1
 s_cmp_eq_u64 vcc, -1
 s_cbranch_scc0 PSP27
POK27:
    s_add_u32 m0, s32, 65536
    s_nop 0
    buffer_load_dwordx4 v8, s[24:27], s35 offen offset:0 sc1 lds
    s_add_u32 m0, s32, 73216
    s_nop 0
    buffer_load_dwordx4 v8, s[24:27], s35 offen offset:512 sc1 lds
    s_add_u32 m0, s32, 80896
    s_nop 0
    buffer_load_dwordx4 v8, s[24:27], s35 offen offset:1024 sc1 lds
    s_add_u32 m0, s32, 88576
    s_nop 0
    buffer_load_dwordx4 v8, s[24:27], s35 offen offset:1536 sc1 lds
    s_add_u32 m0, s32, 98304
    s_nop 0
    buffer_load_dwordx4 v8, s[24:27], s36 offen offset:0 sc1 lds
    s_add_u32 m0, s32, 105984
    s_nop 0
    buffer_load_dwordx4 v8, s[24:27], s36 offen offset:512 sc1 lds
    s_add_u32 m0, s32, 113664
    s_nop 0
    buffer_load_dwordx4 v8, s[24:27], s36 offen offset:1024 sc1 lds
    s_add_u32 m0, s32, 121344
    s_nop 0
    buffer_load_dwordx4 v8, s[24:27], s36 offen offset:1536 sc1 lds
    s_add_u32 m0, s32, 131072
    s_nop 0
    buffer_load_dwordx4 v12, s[24:27], s39 offen sc1 lds
    v_min_u32 v14, 31, v1
    v_lshlrev_b32 v14, 3, v14
    s_mov_b32 s47, 42078208
    buffer_load_dwordx2 v[10:11], v14, s[24:27], s47 offen offset:0 sc1
    s_waitcnt vmcnt(0)
    v_cmp_eq_u64 vcc, v[10:11], v[2:3]
    s_nop 0
    s_cmp_eq_u64 vcc, -1
    s_cbranch_scc1 POK28
s_mov_b32 s53, 0
PSP28:
 s_sleep 8
 buffer_load_dwordx2 v[10:11], v14, s[24:27], s47 offen offset:0 sc1
 s_add_u32 s53, s53, 1
 s_waitcnt vmcnt(0)
 v_cmp_eq_u64 vcc, v[10:11], v[2:3]
 s_cmp_ge_u32 s53, 0x40000
 s_cbranch_scc1 POK28
 s_nop 1
 s_cmp_eq_u64 vcc, -1
 s_cbranch_scc0 PSP28
POK28:
    s_min_u32 s42, s30, 288
    s_lshl_b32 s42, s42, 13
    s_add_u32 s42, s42, 24117248
    s_add_u32 s43, s42, 4096
    buffer_load_dwordx4 v[32:35], v0, s[24:27], s42 offen offset:0 sc1
    buffer_load_dwordx4 v[36:39], v0, s[24:27], s42 offen offset:1024 sc1
    buffer_load_dwordx4 v[48:51], v0, s[24:27], s42 offen offset:2048 sc1
    buffer_load_dwordx4 v[52:55], v0, s[24:27], s42 offen offset:3072 sc1
    buffer_load_dwordx4 v[40:43], v0, s[24:27], s43 offen offset:0 sc1
    buffer_load_dwordx4 v[44:47], v0, s[24:27], s43 offen offset:1024 sc1
    buffer_load_dwordx4 v[56:59], v0, s[24:27], s43 offen offset:2048 sc1
    buffer_load_dwordx4 v[60:63], v0, s[24:27], s43 offen offset:3072 sc1
    s_waitcnt lgkmcnt(0)
    s_barrier
    s_cmp_gt_u32 s30, 288
    s_cbranch_scc1 M_END
s_cmp_ge_u32 s28, 4
 s_cbranch_scc1 F_LOP
 s_setprio 1
F_LOP:
    ds_read_b128 v[64:67], v13 offset:0
    ds_read_b128 v[72:75], v13 offset:32768
    ds_read_b128 v[68:71], v13 offset:16384
    ds_read_b128 v[76:79], v13 offset:49152
    ds_read_b128 v[80:83], v13 offset:4096
    ds_read_b128 v[88:91], v13 offset:36864
    ds_read_b128 v[84:87], v13 offset:20480
    ds_read_b128 v[92:95], v13 offset:53248
    s_cmp_lg_u32 s33, 0x7f000000
    s_cbranch_scc1 F_NOZ
s_waitcnt lgkmcnt(0)
 v_mov_b32 v72, 0
 v_mov_b32 v73, 0
 v_mov_b32 v74, 0
 v_mov_b32 v75, 0
 v_mov_b32 v76, 0
 v_mov_b32 v77, 0
 v_mov_b32 v78, 0
 v_mov_b32 v79, 0
 v_mov_b32 v88, 0
 v_mov_b32 v89, 0
 v_mov_b32 v90, 0
 v_mov_b32 v91, 0
 v_mov_b32 v92, 0
 v_mov_b32 v93, 0
 v_mov_b32 v94, 0
 v_mov_b32 v95, 0
s_nop 1
F_NOZ:
    ds_read_b128 v[8:11], v0 offset:0
    ds_read_b128 v[12:15], v0 offset:1024
    ds_read_b128 v[16:19], v0 offset:2048
    ds_read_b128 v[20:23], v0 offset:3072
    ds_read_b128 v[24:27], v0 offset:4096
    ds_read_b128 v[28:31], v0 offset:5120
    s_waitcnt lgkmcnt(5)
    v_mfma_f32_32x32x16_bf16 v[128:143], v[64:67], v[8:11], 0
    v_mfma_f32_32x32x16_bf16 v[144:159], v[72:75], v[8:11], 0
    s_waitcnt lgkmcnt(3)
    v_mfma_f32_32x32x16_bf16 v[128:143], v[72:75], v[16:19], v[128:143]
    s_waitcnt lgkmcnt(1)
    v_mfma_f32_32x32x16_bf16 v[144:159], v[64:67], v[24:27], v[144:159]
    v_mfma_f32_32x32x16_bf16 v[128:143], v[68:71], v[12:15], v[128:143]
    v_mfma_f32_32x32x16_bf16 v[144:159], v[76:79], v[12:15], v[144:159]
    v_mfma_f32_32x32x16_bf16 v[128:143], v[76:79], v[20:23], v[128:143]
    s_waitcnt lgkmcnt(0)
    v_mfma_f32_32x32x16_bf16 v[144:159], v[68:71], v[28:31], v[144:159]
    v_mfma_f32_32x32x16_bf16 v[160:175], v[80:83], v[8:11], 0
    v_mfma_f32_32x32x16_bf16 v[176:191], v[88:91], v[8:11], 0
    v_mfma_f32_32x32x16_bf16 v[160:175], v[88:91], v[16:19], v[160:175]
    v_mfma_f32_32x32x16_bf16 v[176:191], v[80:83], v[24:27], v[176:191]
    v_mfma_f32_32x32x16_bf16 v[160:175], v[84:87], v[12:15], v[160:175]
    v_mfma_f32_32x32x16_bf16 v[176:191], v[92:95], v[12:15], v[176:191]
    v_mfma_f32_32x32x16_bf16 v[160:175], v[92:95], v[20:23], v[160:175]
    v_mfma_f32_32x32x16_bf16 v[176:191], v[84:87], v[28:31], v[176:191]
    ds_read_b128 v[8:11], v0 offset:30720
    ds_read_b128 v[12:15], v0 offset:31744
    ds_read_b128 v[16:19], v0 offset:32768
    ds_read_b128 v[20:23], v0 offset:33792
    ds_read_b128 v[24:27], v0 offset:34816
    ds_read_b128 v[28:31], v0 offset:35840
    s_waitcnt lgkmcnt(5)
    v_mul_f32 v192, v128, v8
    v_mul_f32 v194, v144, v8
    v_mul_f32 v193, v129, v10
    v_mul_f32 v195, v145, v10
    v_fma_f32 v192, -v144, v9, v192
    v_fma_f32 v194, v128, v9, v194
    v_fma_f32 v193, -v145, v11, v193
    v_fma_f32 v195, v129, v11, v195
    v_cvt_pk_bf16_f32 v96, v192, v193
    v_cvt_pk_bf16_f32 v104, v194, v195
    ds_read_b128 v[8:11], v0 offset:36864
    s_waitcnt lgkmcnt(5)
    v_mul_f32 v196, v130, v12
    v_mul_f32 v198, v146, v12
    v_mul_f32 v197, v131, v14
    v_mul_f32 v199, v147, v14
    v_fma_f32 v196, -v146, v13, v196
    v_fma_f32 v198, v130, v13, v198
    v_fma_f32 v197, -v147, v15, v197
    v_fma_f32 v199, v131, v15, v199
    v_cvt_pk_bf16_f32 v97, v196, v197
    v_cvt_pk_bf16_f32 v105, v198, v199
    ds_read_b128 v[12:15], v0 offset:37888
    s_waitcnt lgkmcnt(5)
    v_mul_f32 v192, v132, v16
    v_mul_f32 v194, v148, v16
    v_mul_f32 v193, v133, v18
    v_mul_f32 v195, v149, v18
    v_fma_f32 v192, -v148, v17, v192
    v_fma_f32 v194, v132, v17, v194
    v_fma_f32 v193, -v149, v19, v193
    v_fma_f32 v195, v133, v19, v195
    v_cvt_pk_bf16_f32 v98, v192, v193
    v_cvt_pk_bf16_f32 v106, v194, v195
    ds_read_b128 v[16:19], v0 offset:38912
    s_waitcnt lgkmcnt(5)
    v_mul_f32 v196, v134, v20
    v_mul_f32 v198, v150, v20
    v_mul_f32 v197, v135, v22
    v_mul_f32 v199, v151, v22
    v_fma_f32 v196, -v150, v21, v196
    v_fma_f32 v198, v134, v21, v198
    v_fma_f32 v197, -v151, v23, v197
    v_fma_f32 v199, v135, v23, v199
    v_cvt_pk_bf16_f32 v99, v196, v197
    v_cvt_pk_bf16_f32 v107, v198, v199
    ds_read_b128 v[20:23], v0 offset:39936
    s_waitcnt lgkmcnt(5)
    v_mul_f32 v192, v136, v24
    v_mul_f32 v194, v152, v24
    v_mul_f32 v193, v137, v26
    v_mul_f32 v195, v153, v26
    v_fma_f32 v192, -v152, v25, v192
    v_fma_f32 v194, v136, v25, v194
    v_fma_f32 v193, -v153, v27, v193
    v_fma_f32 v195, v137, v27, v195
    v_cvt_pk_bf16_f32 v100, v192, v193
    v_cvt_pk_bf16_f32 v108, v194, v195
    ds_read_b128 v[24:27], v0 offset:40960
    s_waitcnt lgkmcnt(5)
    v_mul_f32 v196, v138, v28
    v_mul_f32 v198, v154, v28
    v_mul_f32 v197, v139, v30
    v_mul_f32 v199, v155, v30
    v_fma_f32 v196, -v154, v29, v196
    v_fma_f32 v198, v138, v29, v198
    v_fma_f32 v197, -v155, v31, v197
    v_fma_f32 v199, v139, v31, v199
    v_cvt_pk_bf16_f32 v101, v196, v197
    v_cvt_pk_bf16_f32 v109, v198, v199
    ds_read_b128 v[28:31], v0 offset:41984
    s_waitcnt lgkmcnt(5)
    v_mul_f32 v192, v140, v8
    v_mul_f32 v194, v156, v8
    v_mul_f32 v193, v141, v10
    v_mul_f32 v195, v157, v10
    v_fma_f32 v192, -v156, v9, v192
    v_fma_f32 v194, v140, v9, v194
    v_fma_f32 v193, -v157, v11, v193
    v_fma_f32 v195, v141, v11, v195
    v_cvt_pk_bf16_f32 v102, v192, v193
    v_cvt_pk_bf16_f32 v110, v194, v195
    ds_read_b128 v[8:11], v0 offset:43008
    s_waitcnt lgkmcnt(5)
    v_mul_f32 v196, v142, v12
    v_mul_f32 v198, v158, v12
    v_mul_f32 v197, v143, v14
    v_mul_f32 v199, v159, v14
    v_fma_f32 v196, -v158, v13, v196
    v_fma_f32 v198, v142, v13, v198
    v_fma_f32 v197, -v159, v15, v197
    v_fma_f32 v199, v143, v15, v199
    v_cvt_pk_bf16_f32 v103, v196, v197
    v_cvt_pk_bf16_f32 v111, v198, v199
    ds_read_b128 v[12:15], v0 offset:44032
    s_waitcnt lgkmcnt(5)
    v_mul_f32 v192, v160, v16
    v_mul_f32 v194, v176, v16
    v_mul_f32 v193, v161, v18
    v_mul_f32 v195, v177, v18
    v_fma_f32 v192, -v176, v17, v192
    v_fma_f32 v194, v160, v17, v194
    v_fma_f32 v193, -v177, v19, v193
    v_fma_f32 v195, v161, v19, v195
    v_cvt_pk_bf16_f32 v112, v192, v193
    v_cvt_pk_bf16_f32 v120, v194, v195
    ds_read_b128 v[16:19], v0 offset:45056
    s_waitcnt lgkmcnt(5)
    v_mul_f32 v196, v162, v20
    v_mul_f32 v198, v178, v20
    v_mul_f32 v197, v163, v22
    v_mul_f32 v199, v179, v22
    v_fma_f32 v196, -v178, v21, v196
    v_fma_f32 v198, v162, v21, v198
    v_fma_f32 v197, -v179, v23, v197
    v_fma_f32 v199, v163, v23, v199
    v_cvt_pk_bf16_f32 v113, v196, v197
    v_cvt_pk_bf16_f32 v121, v198, v199
    ds_read_b128 v[20:23], v0 offset:46080
    s_waitcnt lgkmcnt(5)
    v_mul_f32 v192, v164, v24
    v_mul_f32 v194, v180, v24
    v_mul_f32 v193, v165, v26
    v_mul_f32 v195, v181, v26
    v_fma_f32 v192, -v180, v25, v192
    v_fma_f32 v194, v164, v25, v194
    v_fma_f32 v193, -v181, v27, v193
    v_fma_f32 v195, v165, v27, v195
    v_cvt_pk_bf16_f32 v114, v192, v193
    v_cvt_pk_bf16_f32 v122, v194, v195
    s_waitcnt lgkmcnt(4)
    v_mul_f32 v196, v166, v28
    v_mul_f32 v198, v182, v28
    v_mul_f32 v197, v167, v30
    v_mul_f32 v199, v183, v30
    v_fma_f32 v196, -v182, v29, v196
    v_fma_f32 v198, v166, v29, v198
    v_fma_f32 v197, -v183, v31, v197
    v_fma_f32 v199, v167, v31, v199
    v_cvt_pk_bf16_f32 v115, v196, v197
    v_cvt_pk_bf16_f32 v123, v198, v199
    s_waitcnt lgkmcnt(3)
    v_mul_f32 v192, v168, v8
    v_mul_f32 v194, v184, v8
    v_mul_f32 v193, v169, v10
    v_mul_f32 v195, v185, v10
    v_fma_f32 v192, -v184, v9, v192
    v_fma_f32 v194, v168, v9, v194
    v_fma_f32 v193, -v185, v11, v193
    v_fma_f32 v195, v169, v11, v195
    v_cvt_pk_bf16_f32 v116, v192, v193
    v_cvt_pk_bf16_f32 v124, v194, v195
    s_waitcnt lgkmcnt(2)
    v_mul_f32 v196, v170, v12
    v_mul_f32 v198, v186, v12
    v_mul_f32 v197, v171, v14
    v_mul_f32 v199, v187, v14
    v_fma_f32 v196, -v186, v13, v196
    v_fma_f32 v198, v170, v13, v198
    v_fma_f32 v197, -v187, v15, v197
    v_fma_f32 v199, v171, v15, v199
    v_cvt_pk_bf16_f32 v117, v196, v197
    v_cvt_pk_bf16_f32 v125, v198, v199
    s_waitcnt lgkmcnt(1)
    v_mul_f32 v192, v172, v16
    v_mul_f32 v194, v188, v16
    v_mul_f32 v193, v173, v18
    v_mul_f32 v195, v189, v18
    v_fma_f32 v192, -v188, v17, v192
    v_fma_f32 v194, v172, v17, v194
    v_fma_f32 v193, -v189, v19, v193
    v_fma_f32 v195, v173, v19, v195
    v_cvt_pk_bf16_f32 v118, v192, v193
    v_cvt_pk_bf16_f32 v126, v194, v195
    s_waitcnt lgkmcnt(0)
    v_mul_f32 v196, v174, v20
    v_mul_f32 v198, v190, v20
    v_mul_f32 v197, v175, v22
    v_mul_f32 v199, v191, v22
    v_fma_f32 v196, -v190, v21, v196
    v_fma_f32 v198, v174, v21, v198
    v_fma_f32 v197, -v191, v23, v197
    v_fma_f32 v199, v175, v23, v199
    v_cvt_pk_bf16_f32 v119, v196, v197
    v_cvt_pk_bf16_f32 v127, v198, v199
    ds_read_b128 v[8:11], v0 offset:6144
    ds_read_b128 v[12:15], v0 offset:14336
    ds_read_b128 v[16:19], v0 offset:22528
    s_waitcnt lgkmcnt(2)
    v_mfma_f32_32x32x16_bf16 v[192:207], v[8:11], v[96:99], 0
    ds_read_b128 v[20:23], v0 offset:7168
    ds_read_b128 v[24:27], v0 offset:15360
    ds_read_b128 v[28:31], v0 offset:23552
    v_mfma_f32_32x32x16_bf16 v[208:223], v[8:11], v[104:107], 0
    s_waitcnt lgkmcnt(4)
    v_mfma_f32_32x32x16_bf16 v[192:207], v[12:15], v[104:107], v[192:207]
    s_waitcnt lgkmcnt(3)
    v_mfma_f32_32x32x16_bf16 v[208:223], v[16:19], v[96:99], v[208:223]
    s_waitcnt lgkmcnt(2)
    v_mfma_f32_32x32x16_bf16 v[192:207], v[20:23], v[100:103], v[192:207]
    ds_read_b128 v[8:11], v0 offset:8192
    ds_read_b128 v[12:15], v0 offset:16384
    ds_read_b128 v[16:19], v0 offset:24576
    v_mfma_f32_32x32x16_bf16 v[208:223], v[20:23], v[108:111], v[208:223]
    s_waitcnt lgkmcnt(4)
    v_mfma_f32_32x32x16_bf16 v[192:207], v[24:27], v[108:111], v[192:207]
    s_waitcnt lgkmcnt(3)
    v_mfma_f32_32x32x16_bf16 v[208:223], v[28:31], v[100:103], v[208:223]
    s_waitcnt lgkmcnt(2)
    v_mfma_f32_32x32x16_bf16 v[192:207], v[8:11], v[112:115], v[192:207]
    ds_read_b128 v[20:23], v0 offset:9216
    ds_read_b128 v[24:27], v0 offset:17408
    ds_read_b128 v[28:31], v0 offset:25600
    v_mfma_f32_32x32x16_bf16 v[208:223], v[8:11], v[120:123], v[208:223]
    s_waitcnt lgkmcnt(4)
    v_mfma_f32_32x32x16_bf16 v[192:207], v[12:15], v[120:123], v[192:207]
    s_waitcnt lgkmcnt(3)
    v_mfma_f32_32x32x16_bf16 v[208:223], v[16:19], v[112:115], v[208:223]
    s_waitcnt lgkmcnt(2)
    v_mfma_f32_32x32x16_bf16 v[192:207], v[20:23], v[116:119], v[192:207]
    ds_read_b128 v[8:11], v0 offset:10240
    ds_read_b128 v[12:15], v0 offset:18432
    ds_read_b128 v[16:19], v0 offset:26624
    v_mfma_f32_32x32x16_bf16 v[208:223], v[20:23], v[124:127], v[208:223]
    s_waitcnt lgkmcnt(4)
    v_mfma_f32_32x32x16_bf16 v[192:207], v[24:27], v[124:127], v[192:207]
    s_waitcnt lgkmcnt(3)
    v_mfma_f32_32x32x16_bf16 v[208:223], v[28:31], v[116:119], v[208:223]
    s_waitcnt lgkmcnt(2)
    v_mfma_f32_32x32x16_bf16 v[224:239], v[8:11], v[96:99], 0
    ds_read_b128 v[20:23], v0 offset:11264
    ds_read_b128 v[24:27], v0 offset:19456
    ds_read_b128 v[28:31], v0 offset:27648
    v_mfma_f32_32x32x16_bf16 v[240:255], v[8:11], v[104:107], 0
    s_waitcnt lgkmcnt(4)
    v_mfma_f32_32x32x16_bf16 v[224:239], v[12:15], v[104:107], v[224:239]
    s_waitcnt lgkmcnt(3)
    v_mfma_f32_32x32x16_bf16 v[240:255], v[16:19], v[96:99], v[240:255]
    s_waitcnt lgkmcnt(2)
    v_mfma_f32_32x32x16_bf16 v[224:239], v[20:23], v[100:103], v[224:239]
    ds_read_b128 v[8:11], v0 offset:12288
    ds_read_b128 v[12:15], v0 offset:20480
    ds_read_b128 v[16:19], v0 offset:28672
    v_mfma_f32_32x32x16_bf16 v[240:255], v[20:23], v[108:111], v[240:255]
    s_waitcnt lgkmcnt(4)
    v_mfma_f32_32x32x16_bf16 v[224:239], v[24:27], v[108:111], v[224:239]
    s_waitcnt lgkmcnt(3)
    v_mfma_f32_32x32x16_bf16 v[240:255], v[28:31], v[100:103], v[240:255]
    s_waitcnt lgkmcnt(2)
    v_mfma_f32_32x32x16_bf16 v[224:239], v[8:11], v[112:115], v[224:239]
    ds_read_b128 v[20:23], v0 offset:13312
    ds_read_b128 v[24:27], v0 offset:21504
    ds_read_b128 v[28:31], v0 offset:29696
    v_mfma_f32_32x32x16_bf16 v[240:255], v[8:11], v[120:123], v[240:255]
    s_waitcnt lgkmcnt(4)
    v_mfma_f32_32x32x16_bf16 v[224:239], v[12:15], v[120:123], v[224:239]
    s_waitcnt lgkmcnt(3)
    v_mfma_f32_32x32x16_bf16 v[240:255], v[16:19], v[112:115], v[240:255]
    s_waitcnt lgkmcnt(2)
    v_mfma_f32_32x32x16_bf16 v[224:239], v[20:23], v[116:119], v[224:239]
    v_mfma_f32_32x32x16_bf16 v[240:255], v[20:23], v[124:127], v[240:255]
    s_waitcnt lgkmcnt(1)
    v_mfma_f32_32x32x16_bf16 v[224:239], v[24:27], v[124:127], v[224:239]
    s_waitcnt lgkmcnt(0)
    v_mfma_f32_32x32x16_bf16 v[240:255], v[28:31], v[116:119], v[240:255]
    s_waitcnt vmcnt(7)
    v_lshlrev_b32 v132, 16, v32
    v_and_b32 v133, 0xffff0000, v32
    s_waitcnt vmcnt(3)
    v_lshlrev_b32 v134, 16, v40
    v_and_b32 v135, 0xffff0000, v40
    v_mul_f32 v128, v192, v132
    v_mul_f32 v130, v208, v132
    v_mul_f32 v129, v193, v133
    v_mul_f32 v131, v209, v133
    v_fma_f32 v128, -v208, v134, v128
    v_fma_f32 v130, v192, v134, v130
    v_fma_f32 v129, -v209, v135, v129
    v_fma_f32 v131, v193, v135, v131
    v_cvt_pk_bf16_f32 v64, v128, v129
    v_cvt_pk_bf16_f32 v72, v130, v131
    v_lshlrev_b32 v140, 16, v33
    v_and_b32 v141, 0xffff0000, v33
    v_lshlrev_b32 v142, 16, v41
    v_and_b32 v143, 0xffff0000, v41
    v_mul_f32 v136, v194, v140
    v_mul_f32 v138, v210, v140
    v_mul_f32 v137, v195, v141
    v_mul_f32 v139, v211, v141
    v_fma_f32 v136, -v210, v142, v136
    v_fma_f32 v138, v194, v142, v138
    v_fma_f32 v137, -v211, v143, v137
    v_fma_f32 v139, v195, v143, v139
    v_cvt_pk_bf16_f32 v65, v136, v137
    v_cvt_pk_bf16_f32 v73, v138, v139
    v_lshlrev_b32 v132, 16, v34
    v_and_b32 v133, 0xffff0000, v34
    v_lshlrev_b32 v134, 16, v42
    v_and_b32 v135, 0xffff0000, v42
    v_mul_f32 v128, v196, v132
    v_mul_f32 v130, v212, v132
    v_mul_f32 v129, v197, v133
    v_mul_f32 v131, v213, v133
    v_fma_f32 v128, -v212, v134, v128
    v_fma_f32 v130, v196, v134, v130
    v_fma_f32 v129, -v213, v135, v129
    v_fma_f32 v131, v197, v135, v131
    v_cvt_pk_bf16_f32 v66, v128, v129
    v_cvt_pk_bf16_f32 v74, v130, v131
    v_lshlrev_b32 v140, 16, v35
    v_and_b32 v141, 0xffff0000, v35
    v_lshlrev_b32 v142, 16, v43
    v_and_b32 v143, 0xffff0000, v43
    v_mul_f32 v136, v198, v140
    v_mul_f32 v138, v214, v140
    v_mul_f32 v137, v199, v141
    v_mul_f32 v139, v215, v141
    v_fma_f32 v136, -v214, v142, v136
    v_fma_f32 v138, v198, v142, v138
    v_fma_f32 v137, -v215, v143, v137
    v_fma_f32 v139, v199, v143, v139
    v_cvt_pk_bf16_f32 v67, v136, v137
    v_cvt_pk_bf16_f32 v75, v138, v139
    v_lshlrev_b32 v132, 16, v36
    v_and_b32 v133, 0xffff0000, v36
    s_waitcnt vmcnt(2)
    v_lshlrev_b32 v134, 16, v44
    v_and_b32 v135, 0xffff0000, v44
    v_mul_f32 v128, v200, v132
    v_mul_f32 v130, v216, v132
    v_mul_f32 v129, v201, v133
    v_mul_f32 v131, v217, v133
    v_fma_f32 v128, -v216, v134, v128
    v_fma_f32 v130, v200, v134, v130
    v_fma_f32 v129, -v217, v135, v129
    v_fma_f32 v131, v201, v135, v131
    v_cvt_pk_bf16_f32 v68, v128, v129
    v_cvt_pk_bf16_f32 v76, v130, v131
    v_lshlrev_b32 v140, 16, v37
    v_and_b32 v141, 0xffff0000, v37
    v_lshlrev_b32 v142, 16, v45
    v_and_b32 v143, 0xffff0000, v45
    v_mul_f32 v136, v202, v140
    v_mul_f32 v138, v218, v140
    v_mul_f32 v137, v203, v141
    v_mul_f32 v139, v219, v141
    v_fma_f32 v136, -v218, v142, v136
    v_fma_f32 v138, v202, v142, v138
    v_fma_f32 v137, -v219, v143, v137
    v_fma_f32 v139, v203, v143, v139
    v_cvt_pk_bf16_f32 v69, v136, v137
    v_cvt_pk_bf16_f32 v77, v138, v139
    v_lshlrev_b32 v132, 16, v38
    v_and_b32 v133, 0xffff0000, v38
    v_lshlrev_b32 v134, 16, v46
    v_and_b32 v135, 0xffff0000, v46
    v_mul_f32 v128, v204, v132
    v_mul_f32 v130, v220, v132
    v_mul_f32 v129, v205, v133
    v_mul_f32 v131, v221, v133
    v_fma_f32 v128, -v220, v134, v128
    v_fma_f32 v130, v204, v134, v130
    v_fma_f32 v129, -v221, v135, v129
    v_fma_f32 v131, v205, v135, v131
    v_cvt_pk_bf16_f32 v70, v128, v129
    v_cvt_pk_bf16_f32 v78, v130, v131
    v_lshlrev_b32 v140, 16, v39
    v_and_b32 v141, 0xffff0000, v39
    v_lshlrev_b32 v142, 16, v47
    v_and_b32 v143, 0xffff0000, v47
    v_mul_f32 v136, v206, v140
    v_mul_f32 v138, v222, v140
    v_mul_f32 v137, v207, v141
    v_mul_f32 v139, v223, v141
    v_fma_f32 v136, -v222, v142, v136
    v_fma_f32 v138, v206, v142, v138
    v_fma_f32 v137, -v223, v143, v137
    v_fma_f32 v139, v207, v143, v139
    v_cvt_pk_bf16_f32 v71, v136, v137
    v_cvt_pk_bf16_f32 v79, v138, v139
    v_lshlrev_b32 v132, 16, v48
    v_and_b32 v133, 0xffff0000, v48
    s_waitcnt vmcnt(1)
    v_lshlrev_b32 v134, 16, v56
    v_and_b32 v135, 0xffff0000, v56
    v_mul_f32 v128, v224, v132
    v_mul_f32 v130, v240, v132
    v_mul_f32 v129, v225, v133
    v_mul_f32 v131, v241, v133
    v_fma_f32 v128, -v240, v134, v128
    v_fma_f32 v130, v224, v134, v130
    v_fma_f32 v129, -v241, v135, v129
    v_fma_f32 v131, v225, v135, v131
    v_cvt_pk_bf16_f32 v80, v128, v129
    v_cvt_pk_bf16_f32 v88, v130, v131
    v_lshlrev_b32 v140, 16, v49
    v_and_b32 v141, 0xffff0000, v49
    v_lshlrev_b32 v142, 16, v57
    v_and_b32 v143, 0xffff0000, v57
    v_mul_f32 v136, v226, v140
    v_mul_f32 v138, v242, v140
    v_mul_f32 v137, v227, v141
    v_mul_f32 v139, v243, v141
    v_fma_f32 v136, -v242, v142, v136
    v_fma_f32 v138, v226, v142, v138
    v_fma_f32 v137, -v243, v143, v137
    v_fma_f32 v139, v227, v143, v139
    v_cvt_pk_bf16_f32 v81, v136, v137
    v_cvt_pk_bf16_f32 v89, v138, v139
    v_lshlrev_b32 v132, 16, v50
    v_and_b32 v133, 0xffff0000, v50
    v_lshlrev_b32 v134, 16, v58
    v_and_b32 v135, 0xffff0000, v58
    v_mul_f32 v128, v228, v132
    v_mul_f32 v130, v244, v132
    v_mul_f32 v129, v229, v133
    v_mul_f32 v131, v245, v133
    v_fma_f32 v128, -v244, v134, v128
    v_fma_f32 v130, v228, v134, v130
    v_fma_f32 v129, -v245, v135, v129
    v_fma_f32 v131, v229, v135, v131
    v_cvt_pk_bf16_f32 v82, v128, v129
    v_cvt_pk_bf16_f32 v90, v130, v131
    v_lshlrev_b32 v140, 16, v51
    v_and_b32 v141, 0xffff0000, v51
    v_lshlrev_b32 v142, 16, v59
    v_and_b32 v143, 0xffff0000, v59
    v_mul_f32 v136, v230, v140
    v_mul_f32 v138, v246, v140
    v_mul_f32 v137, v231, v141
    v_mul_f32 v139, v247, v141
    v_fma_f32 v136, -v246, v142, v136
    v_fma_f32 v138, v230, v142, v138
    v_fma_f32 v137, -v247, v143, v137
    v_fma_f32 v139, v231, v143, v139
    v_cvt_pk_bf16_f32 v83, v136, v137
    v_cvt_pk_bf16_f32 v91, v138, v139
    v_lshlrev_b32 v132, 16, v52
    v_and_b32 v133, 0xffff0000, v52
    s_waitcnt vmcnt(0)
    v_lshlrev_b32 v134, 16, v60
    v_and_b32 v135, 0xffff0000, v60
    v_mul_f32 v128, v232, v132
    v_mul_f32 v130, v248, v132
    v_mul_f32 v129, v233, v133
    v_mul_f32 v131, v249, v133
    v_fma_f32 v128, -v248, v134, v128
    v_fma_f32 v130, v232, v134, v130
    v_fma_f32 v129, -v249, v135, v129
    v_fma_f32 v131, v233, v135, v131
    v_cvt_pk_bf16_f32 v84, v128, v129
    v_cvt_pk_bf16_f32 v92, v130, v131
    v_lshlrev_b32 v140, 16, v53
    v_and_b32 v141, 0xffff0000, v53
    v_lshlrev_b32 v142, 16, v61
    v_and_b32 v143, 0xffff0000, v61
    v_mul_f32 v136, v234, v140
    v_mul_f32 v138, v250, v140
    v_mul_f32 v137, v235, v141
    v_mul_f32 v139, v251, v141
    v_fma_f32 v136, -v250, v142, v136
    v_fma_f32 v138, v234, v142, v138
    v_fma_f32 v137, -v251, v143, v137
    v_fma_f32 v139, v235, v143, v139
    v_cvt_pk_bf16_f32 v85, v136, v137
    v_cvt_pk_bf16_f32 v93, v138, v139
    v_lshlrev_b32 v132, 16, v54
    v_and_b32 v133, 0xffff0000, v54
    v_lshlrev_b32 v134, 16, v62
    v_and_b32 v135, 0xffff0000, v62
    v_mul_f32 v128, v236, v132
    v_mul_f32 v130, v252, v132
    v_mul_f32 v129, v237, v133
    v_mul_f32 v131, v253, v133
    v_fma_f32 v128, -v252, v134, v128
    v_fma_f32 v130, v236, v134, v130
    v_fma_f32 v129, -v253, v135, v129
    v_fma_f32 v131, v237, v135, v131
    v_cvt_pk_bf16_f32 v86, v128, v129
    v_cvt_pk_bf16_f32 v94, v130, v131
    v_lshlrev_b32 v140, 16, v55
    v_and_b32 v141, 0xffff0000, v55
    v_lshlrev_b32 v142, 16, v63
    v_and_b32 v143, 0xffff0000, v63
    v_mul_f32 v136, v238, v140
    v_mul_f32 v138, v254, v140
    v_mul_f32 v137, v239, v141
    v_mul_f32 v139, v255, v141
    v_fma_f32 v136, -v254, v142, v136
    v_fma_f32 v138, v238, v142, v138
    v_fma_f32 v137, -v255, v143, v137
    v_fma_f32 v139, v239, v143, v139
    v_cvt_pk_bf16_f32 v87, v136, v137
    v_cvt_pk_bf16_f32 v95, v138, v139
    ds_read_b128 v[32:35], v4 offset:0
    ds_read_b128 v[48:51], v4 offset:4096
    v_xor_b32 v7, 16, v4
    ds_read_b128 v[36:39], v7 offset:0
    ds_read_b128 v[52:55], v7 offset:4096
    v_xor_b32 v7, 32, v4
    ds_read_b128 v[40:43], v7 offset:0
    ds_read_b128 v[56:59], v7 offset:4096
    v_xor_b32 v7, 48, v4
    ds_read_b128 v[44:47], v7 offset:0
    ds_read_b128 v[60:63], v7 offset:4096
    ds_read_b128 v[8:11], v0 offset:6144
    ds_read_b128 v[12:15], v0 offset:14336
    ds_read_b128 v[16:19], v0 offset:22528
    s_waitcnt lgkmcnt(2)
    v_mfma_f32_32x32x16_bf16 v[128:143], v[64:67], v[8:11], 0
    ds_read_b128 v[20:23], v0 offset:7168
    ds_read_b128 v[24:27], v0 offset:15360
    ds_read_b128 v[28:31], v0 offset:23552
    v_mfma_f32_32x32x16_bf16 v[144:159], v[72:75], v[8:11], 0
    s_waitcnt lgkmcnt(3)
    v_mfma_f32_32x32x16_bf16 v[128:143], v[72:75], v[16:19], v[128:143]
    v_mfma_f32_32x32x16_bf16 v[144:159], v[64:67], v[12:15], v[144:159]
    s_waitcnt lgkmcnt(2)
    v_mfma_f32_32x32x16_bf16 v[128:143], v[68:71], v[20:23], v[128:143]
    ds_read_b128 v[8:11], v0 offset:8192
    ds_read_b128 v[12:15], v0 offset:16384
    ds_read_b128 v[16:19], v0 offset:24576
    v_mfma_f32_32x32x16_bf16 v[144:159], v[76:79], v[20:23], v[144:159]
    s_waitcnt lgkmcnt(3)
    v_mfma_f32_32x32x16_bf16 v[128:143], v[76:79], v[28:31], v[128:143]
    v_mfma_f32_32x32x16_bf16 v[144:159], v[68:71], v[24:27], v[144:159]
    s_waitcnt lgkmcnt(2)
    v_mfma_f32_32x32x16_bf16 v[128:143], v[80:83], v[8:11], v[128:143]
    ds_read_b128 v[20:23], v0 offset:9216
    ds_read_b128 v[24:27], v0 offset:17408
    ds_read_b128 v[28:31], v0 offset:25600
    v_mfma_f32_32x32x16_bf16 v[144:159], v[88:91], v[8:11], v[144:159]
    s_waitcnt lgkmcnt(3)
    v_mfma_f32_32x32x16_bf16 v[128:143], v[88:91], v[16:19], v[128:143]
    v_mfma_f32_32x32x16_bf16 v[144:159], v[80:83], v[12:15], v[144:159]
    s_waitcnt lgkmcnt(2)
    v_mfma_f32_32x32x16_bf16 v[128:143], v[84:87], v[20:23], v[128:143]
    ds_read_b128 v[8:11], v0 offset:10240
    ds_read_b128 v[12:15], v0 offset:18432
    ds_read_b128 v[16:19], v0 offset:26624
    v_mfma_f32_32x32x16_bf16 v[144:159], v[92:95], v[20:23], v[144:159]
    s_waitcnt lgkmcnt(3)
    v_mfma_f32_32x32x16_bf16 v[128:143], v[92:95], v[28:31], v[128:143]
    v_mfma_f32_32x32x16_bf16 v[144:159], v[84:87], v[24:27], v[144:159]
    s_waitcnt lgkmcnt(2)
    v_mfma_f32_32x32x16_bf16 v[160:175], v[64:67], v[8:11], 0
    ds_read_b128 v[20:23], v0 offset:11264
    ds_read_b128 v[24:27], v0 offset:19456
    ds_read_b128 v[28:31], v0 offset:27648
    v_mfma_f32_32x32x16_bf16 v[176:191], v[72:75], v[8:11], 0
    s_waitcnt lgkmcnt(3)
    v_mfma_f32_32x32x16_bf16 v[160:175], v[72:75], v[16:19], v[160:175]
    v_mfma_f32_32x32x16_bf16 v[176:191], v[64:67], v[12:15], v[176:191]
    s_waitcnt lgkmcnt(2)
    v_mfma_f32_32x32x16_bf16 v[160:175], v[68:71], v[20:23], v[160:175]
    ds_read_b128 v[8:11], v0 offset:12288
    ds_read_b128 v[12:15], v0 offset:20480
    ds_read_b128 v[16:19], v0 offset:28672
    v_mfma_f32_32x32x16_bf16 v[176:191], v[76:79], v[20:23], v[176:191]
    s_waitcnt lgkmcnt(3)
    v_mfma_f32_32x32x16_bf16 v[160:175], v[76:79], v[28:31], v[160:175]
    v_mfma_f32_32x32x16_bf16 v[176:191], v[68:71], v[24:27], v[176:191]
    s_waitcnt lgkmcnt(2)
    v_mfma_f32_32x32x16_bf16 v[160:175], v[80:83], v[8:11], v[160:175]
    ds_read_b128 v[20:23], v0 offset:13312
    ds_read_b128 v[24:27], v0 offset:21504
    ds_read_b128 v[28:31], v0 offset:29696
    v_mfma_f32_32x32x16_bf16 v[176:191], v[88:91], v[8:11], v[176:191]
    s_waitcnt lgkmcnt(3)
    v_mfma_f32_32x32x16_bf16 v[160:175], v[88:91], v[16:19], v[160:175]
    v_mfma_f32_32x32x16_bf16 v[176:191], v[80:83], v[12:15], v[176:191]
    s_waitcnt lgkmcnt(2)
    v_mfma_f32_32x32x16_bf16 v[160:175], v[84:87], v[20:23], v[160:175]
    v_mfma_f32_32x32x16_bf16 v[176:191], v[92:95], v[20:23], v[176:191]
    s_waitcnt lgkmcnt(0)
    v_mfma_f32_32x32x16_bf16 v[160:175], v[92:95], v[28:31], v[160:175]
    v_mfma_f32_32x32x16_bf16 v[176:191], v[84:87], v[24:27], v[176:191]
    ds_read_b128 v[8:11], v0 offset:47104
    ds_read_b128 v[12:15], v0 offset:48128
    ds_read_b128 v[16:19], v0 offset:49152
    ds_read_b128 v[20:23], v0 offset:50176
    ds_read_b128 v[24:27], v0 offset:51200
    ds_read_b128 v[28:31], v0 offset:52224
    s_waitcnt lgkmcnt(5)
    v_mul_f32 v192, v128, v8
    v_mul_f32 v194, v144, v8
    v_mul_f32 v193, v129, v10
    v_mul_f32 v195, v145, v10
    v_fma_f32 v192, -v144, v9, v192
    v_fma_f32 v194, v128, v9, v194
    v_fma_f32 v193, -v145, v11, v193
    v_fma_f32 v195, v129, v11, v195
    v_cvt_pk_bf16_f32 v96, v192, v193
    v_cvt_pk_bf16_f32 v104, v194, v195
    ds_read_b128 v[8:11], v0 offset:53248
    s_waitcnt lgkmcnt(5)
    v_mul_f32 v196, v130, v12
    v_mul_f32 v198, v146, v12
    v_mul_f32 v197, v131, v14
    v_mul_f32 v199, v147, v14
    v_fma_f32 v196, -v146, v13, v196
    v_fma_f32 v198, v130, v13, v198
    v_fma_f32 v197, -v147, v15, v197
    v_fma_f32 v199, v131, v15, v199
    v_cvt_pk_bf16_f32 v97, v196, v197
    v_cvt_pk_bf16_f32 v105, v198, v199
    ds_read_b128 v[12:15], v0 offset:54272
    s_waitcnt lgkmcnt(5)
    v_mul_f32 v192, v132, v16
    v_mul_f32 v194, v148, v16
    v_mul_f32 v193, v133, v18
    v_mul_f32 v195, v149, v18
    v_fma_f32 v192, -v148, v17, v192
    v_fma_f32 v194, v132, v17, v194
    v_fma_f32 v193, -v149, v19, v193
    v_fma_f32 v195, v133, v19, v195
    v_cvt_pk_bf16_f32 v98, v192, v193
    v_cvt_pk_bf16_f32 v106, v194, v195
    ds_read_b128 v[16:19], v0 offset:55296
    s_waitcnt lgkmcnt(5)
    v_mul_f32 v196, v134, v20
    v_mul_f32 v198, v150, v20
    v_mul_f32 v197, v135, v22
    v_mul_f32 v199, v151, v22
    v_fma_f32 v196, -v150, v21, v196
    v_fma_f32 v198, v134, v21, v198
    v_fma_f32 v197, -v151, v23, v197
    v_fma_f32 v199, v135, v23, v199
    v_cvt_pk_bf16_f32 v99, v196, v197
    v_cvt_pk_bf16_f32 v107, v198, v199
    ds_read_b128 v[20:23], v0 offset:56320
    s_waitcnt lgkmcnt(5)
    v_mul_f32 v192, v136, v24
    v_mul_f32 v194, v152, v24
    v_mul_f32 v193, v137, v26
    v_mul_f32 v195, v153, v26
    v_fma_f32 v192, -v152, v25, v192
    v_fma_f32 v194, v136, v25, v194
    v_fma_f32 v193, -v153, v27, v193
    v_fma_f32 v195, v137, v27, v195
    v_cvt_pk_bf16_f32 v100, v192, v193
    v_cvt_pk_bf16_f32 v108, v194, v195
    ds_read_b128 v[24:27], v0 offset:57344
    s_waitcnt lgkmcnt(5)
    v_mul_f32 v196, v138, v28
    v_mul_f32 v198, v154, v28
    v_mul_f32 v197, v139, v30
    v_mul_f32 v199, v155, v30
    v_fma_f32 v196, -v154, v29, v196
    v_fma_f32 v198, v138, v29, v198
    v_fma_f32 v197, -v155, v31, v197
    v_fma_f32 v199, v139, v31, v199
    v_cvt_pk_bf16_f32 v101, v196, v197
    v_cvt_pk_bf16_f32 v109, v198, v199
    ds_read_b128 v[28:31], v0 offset:58368
    s_waitcnt lgkmcnt(5)
    v_mul_f32 v192, v140, v8
    v_mul_f32 v194, v156, v8
    v_mul_f32 v193, v141, v10
    v_mul_f32 v195, v157, v10
    v_fma_f32 v192, -v156, v9, v192
    v_fma_f32 v194, v140, v9, v194
    v_fma_f32 v193, -v157, v11, v193
    v_fma_f32 v195, v141, v11, v195
    v_cvt_pk_bf16_f32 v102, v192, v193
    v_cvt_pk_bf16_f32 v110, v194, v195
    ds_read_b128 v[8:11], v0 offset:59392
    s_waitcnt lgkmcnt(5)
    v_mul_f32 v196, v142, v12
    v_mul_f32 v198, v158, v12
    v_mul_f32 v197, v143, v14
    v_mul_f32 v199, v159, v14
    v_fma_f32 v196, -v158, v13, v196
    v_fma_f32 v198, v142, v13, v198
    v_fma_f32 v197, -v159, v15, v197
    v_fma_f32 v199, v143, v15, v199
    v_cvt_pk_bf16_f32 v103, v196, v197
    v_cvt_pk_bf16_f32 v111, v198, v199
    ds_read_b128 v[12:15], v0 offset:60416
    s_waitcnt lgkmcnt(5)
    v_mul_f32 v192, v160, v16
    v_mul_f32 v194, v176, v16
    v_mul_f32 v193, v161, v18
    v_mul_f32 v195, v177, v18
    v_fma_f32 v192, -v176, v17, v192
    v_fma_f32 v194, v160, v17, v194
    v_fma_f32 v193, -v177, v19, v193
    v_fma_f32 v195, v161, v19, v195
    v_cvt_pk_bf16_f32 v112, v192, v193
    v_cvt_pk_bf16_f32 v120, v194, v195
    ds_read_b128 v[16:19], v0 offset:61440
    s_waitcnt lgkmcnt(5)
    v_mul_f32 v196, v162, v20
    v_mul_f32 v198, v178, v20
    v_mul_f32 v197, v163, v22
    v_mul_f32 v199, v179, v22
    v_fma_f32 v196, -v178, v21, v196
    v_fma_f32 v198, v162, v21, v198
    v_fma_f32 v197, -v179, v23, v197
    v_fma_f32 v199, v163, v23, v199
    v_cvt_pk_bf16_f32 v113, v196, v197
    v_cvt_pk_bf16_f32 v121, v198, v199
    ds_read_b128 v[20:23], v0 offset:62464
    s_waitcnt lgkmcnt(5)
    v_mul_f32 v192, v164, v24
    v_mul_f32 v194, v180, v24
    v_mul_f32 v193, v165, v26
    v_mul_f32 v195, v181, v26
    v_fma_f32 v192, -v180, v25, v192
    v_fma_f32 v194, v164, v25, v194
    v_fma_f32 v193, -v181, v27, v193
    v_fma_f32 v195, v165, v27, v195
    v_cvt_pk_bf16_f32 v114, v192, v193
    v_cvt_pk_bf16_f32 v122, v194, v195
    s_waitcnt lgkmcnt(4)
    v_mul_f32 v196, v166, v28
    v_mul_f32 v198, v182, v28
    v_mul_f32 v197, v167, v30
    v_mul_f32 v199, v183, v30
    v_fma_f32 v196, -v182, v29, v196
    v_fma_f32 v198, v166, v29, v198
    v_fma_f32 v197, -v183, v31, v197
    v_fma_f32 v199, v167, v31, v199
    v_cvt_pk_bf16_f32 v115, v196, v197
    v_cvt_pk_bf16_f32 v123, v198, v199
    s_waitcnt lgkmcnt(3)
    v_mul_f32 v192, v168, v8
    v_mul_f32 v194, v184, v8
    v_mul_f32 v193, v169, v10
    v_mul_f32 v195, v185, v10
    v_fma_f32 v192, -v184, v9, v192
    v_fma_f32 v194, v168, v9, v194
    v_fma_f32 v193, -v185, v11, v193
    v_fma_f32 v195, v169, v11, v195
    v_cvt_pk_bf16_f32 v116, v192, v193
    v_cvt_pk_bf16_f32 v124, v194, v195
    s_waitcnt lgkmcnt(2)
    v_mul_f32 v196, v170, v12
    v_mul_f32 v198, v186, v12
    v_mul_f32 v197, v171, v14
    v_mul_f32 v199, v187, v14
    v_fma_f32 v196, -v186, v13, v196
    v_fma_f32 v198, v170, v13, v198
    v_fma_f32 v197, -v187, v15, v197
    v_fma_f32 v199, v171, v15, v199
    v_cvt_pk_bf16_f32 v117, v196, v197
    v_cvt_pk_bf16_f32 v125, v198, v199
    s_waitcnt lgkmcnt(1)
    v_mul_f32 v192, v172, v16
    v_mul_f32 v194, v188, v16
    v_mul_f32 v193, v173, v18
    v_mul_f32 v195, v189, v18
    v_fma_f32 v192, -v188, v17, v192
    v_fma_f32 v194, v172, v17, v194
    v_fma_f32 v193, -v189, v19, v193
    v_fma_f32 v195, v173, v19, v195
    v_cvt_pk_bf16_f32 v118, v192, v193
    v_cvt_pk_bf16_f32 v126, v194, v195
    s_waitcnt lgkmcnt(0)
    v_mul_f32 v196, v174, v20
    v_mul_f32 v198, v190, v20
    v_mul_f32 v197, v175, v22
    v_mul_f32 v199, v191, v22
    v_fma_f32 v196, -v190, v21, v196
    v_fma_f32 v198, v174, v21, v198
    v_fma_f32 v197, -v191, v23, v197
    v_fma_f32 v199, v175, v23, v199
    v_cvt_pk_bf16_f32 v119, v196, v197
    v_cvt_pk_bf16_f32 v127, v198, v199
    ds_read_b128 v[8:11], v0 offset:0
    ds_read_b128 v[12:15], v0 offset:1024
    ds_read_b128 v[16:19], v0 offset:2048
    ds_read_b128 v[20:23], v0 offset:3072
    ds_read_b128 v[24:27], v0 offset:4096
    ds_read_b128 v[28:31], v0 offset:5120
    s_waitcnt lgkmcnt(5)
    v_mfma_f32_32x32x16_bf16 v[192:207], v[8:11], v[96:99], 0
    v_mfma_f32_32x32x16_bf16 v[208:223], v[8:11], v[104:107], 0
    s_waitcnt lgkmcnt(1)
    v_mfma_f32_32x32x16_bf16 v[192:207], v[24:27], v[104:107], v[192:207]
    v_mfma_f32_32x32x16_bf16 v[208:223], v[16:19], v[96:99], v[208:223]
    v_mfma_f32_32x32x16_bf16 v[192:207], v[12:15], v[100:103], v[192:207]
    v_mfma_f32_32x32x16_bf16 v[208:223], v[12:15], v[108:111], v[208:223]
    s_waitcnt lgkmcnt(0)
    v_mfma_f32_32x32x16_bf16 v[192:207], v[28:31], v[108:111], v[192:207]
    v_mfma_f32_32x32x16_bf16 v[208:223], v[20:23], v[100:103], v[208:223]
    v_mfma_f32_32x32x16_bf16 v[224:239], v[8:11], v[112:115], 0
    v_mfma_f32_32x32x16_bf16 v[240:255], v[8:11], v[120:123], 0
    v_mfma_f32_32x32x16_bf16 v[224:239], v[24:27], v[120:123], v[224:239]
    v_mfma_f32_32x32x16_bf16 v[240:255], v[16:19], v[112:115], v[240:255]
    v_mfma_f32_32x32x16_bf16 v[224:239], v[12:15], v[116:119], v[224:239]
    v_mfma_f32_32x32x16_bf16 v[240:255], v[12:15], v[124:127], v[240:255]
    v_mfma_f32_32x32x16_bf16 v[224:239], v[28:31], v[124:127], v[224:239]
    v_mfma_f32_32x32x16_bf16 v[240:255], v[20:23], v[116:119], v[240:255]
    s_nop 2
    v_mul_f32 v192, v192, v32
    v_mul_f32 v193, v193, v33
    v_mul_f32 v194, v194, v34
    v_mul_f32 v195, v195, v35
    v_mul_f32 v196, v196, v36
    v_mul_f32 v197, v197, v37
    v_mul_f32 v198, v198, v38
    v_mul_f32 v199, v199, v39
    v_cvt_pk_bf16_f32 v64, v192, v193
    v_cvt_pk_bf16_f32 v65, v194, v195
    v_cvt_pk_bf16_f32 v66, v196, v197
    v_cvt_pk_bf16_f32 v67, v198, v199
    buffer_store_dwordx4 v[64:67], v5, s[24:27], s37 offen offset:0 sc1
    v_mul_f32 v200, v200, v40
    v_mul_f32 v201, v201, v41
    v_mul_f32 v202, v202, v42
    v_mul_f32 v203, v203, v43
    v_mul_f32 v204, v204, v44
    v_mul_f32 v205, v205, v45
    v_mul_f32 v206, v206, v46
    v_mul_f32 v207, v207, v47
    v_cvt_pk_bf16_f32 v68, v200, v201
    v_cvt_pk_bf16_f32 v69, v202, v203
    v_cvt_pk_bf16_f32 v70, v204, v205
    v_cvt_pk_bf16_f32 v71, v206, v207
    buffer_store_dwordx4 v[68:71], v5, s[24:27], s37 offen offset:1024 sc1
    v_mul_f32 v208, v208, v32
    v_mul_f32 v209, v209, v33
    v_mul_f32 v210, v210, v34
    v_mul_f32 v211, v211, v35
    v_mul_f32 v212, v212, v36
    v_mul_f32 v213, v213, v37
    v_mul_f32 v214, v214, v38
    v_mul_f32 v215, v215, v39
    v_cvt_pk_bf16_f32 v72, v208, v209
    v_cvt_pk_bf16_f32 v73, v210, v211
    v_cvt_pk_bf16_f32 v74, v212, v213
    v_cvt_pk_bf16_f32 v75, v214, v215
    buffer_store_dwordx4 v[72:75], v6, s[24:27], s38 offen offset:0 sc1
    v_mul_f32 v216, v216, v40
    v_mul_f32 v217, v217, v41
    v_mul_f32 v218, v218, v42
    v_mul_f32 v219, v219, v43
    v_mul_f32 v220, v220, v44
    v_mul_f32 v221, v221, v45
    v_mul_f32 v222, v222, v46
    v_mul_f32 v223, v223, v47
    v_cvt_pk_bf16_f32 v76, v216, v217
    v_cvt_pk_bf16_f32 v77, v218, v219
    v_cvt_pk_bf16_f32 v78, v220, v221
    v_cvt_pk_bf16_f32 v79, v222, v223
    buffer_store_dwordx4 v[76:79], v6, s[24:27], s38 offen offset:1024 sc1
    v_mul_f32 v224, v224, v48
    v_mul_f32 v225, v225, v49
    v_mul_f32 v226, v226, v50
    v_mul_f32 v227, v227, v51
    v_mul_f32 v228, v228, v52
    v_mul_f32 v229, v229, v53
    v_mul_f32 v230, v230, v54
    v_mul_f32 v231, v231, v55
    v_cvt_pk_bf16_f32 v80, v224, v225
    v_cvt_pk_bf16_f32 v81, v226, v227
    v_cvt_pk_bf16_f32 v82, v228, v229
    v_cvt_pk_bf16_f32 v83, v230, v231
    buffer_store_dwordx4 v[80:83], v5, s[24:27], s37 offen offset:2048 sc1
    v_mul_f32 v232, v232, v56
    v_mul_f32 v233, v233, v57
    v_mul_f32 v234, v234, v58
    v_mul_f32 v235, v235, v59
    v_mul_f32 v236, v236, v60
    v_mul_f32 v237, v237, v61
    v_mul_f32 v238, v238, v62
    v_mul_f32 v239, v239, v63
    v_cvt_pk_bf16_f32 v84, v232, v233
    v_cvt_pk_bf16_f32 v85, v234, v235
    v_cvt_pk_bf16_f32 v86, v236, v237
    v_cvt_pk_bf16_f32 v87, v238, v239
    buffer_store_dwordx4 v[84:87], v5, s[24:27], s37 offen offset:3072 sc1
    v_mul_f32 v240, v240, v48
    v_mul_f32 v241, v241, v49
    v_mul_f32 v242, v242, v50
    v_mul_f32 v243, v243, v51
    v_mul_f32 v244, v244, v52
    v_mul_f32 v245, v245, v53
    v_mul_f32 v246, v246, v54
    v_mul_f32 v247, v247, v55
    v_cvt_pk_bf16_f32 v88, v240, v241
    v_cvt_pk_bf16_f32 v89, v242, v243
    v_cvt_pk_bf16_f32 v90, v244, v245
    v_cvt_pk_bf16_f32 v91, v246, v247
    buffer_store_dwordx4 v[88:91], v6, s[24:27], s38 offen offset:2048 sc1
    v_mul_f32 v248, v248, v56
    v_mul_f32 v249, v249, v57
    v_mul_f32 v250, v250, v58
    v_mul_f32 v251, v251, v59
    v_mul_f32 v252, v252, v60
    v_mul_f32 v253, v253, v61
    v_mul_f32 v254, v254, v62
    v_mul_f32 v255, v255, v63
    v_cvt_pk_bf16_f32 v92, v248, v249
    v_cvt_pk_bf16_f32 v93, v250, v251
    v_cvt_pk_bf16_f32 v94, v252, v253
    v_cvt_pk_bf16_f32 v95, v254, v255
    buffer_store_dwordx4 v[92:95], v6, s[24:27], s38 offen offset:3072 sc1
    v_cmp_eq_u32 vcc, 0, v1
    v_mov_b32 v9, 0x7f000000
    s_nop 0
    v_cndmask_b32 v8, v9, v1, vcc
    s_lshl_b32 s41, s29, 3
    s_add_u32 s41, s41, 42075136
    s_waitcnt vmcnt(0)
    s_barrier
    s_cmp_lg_u32 s28, 0
    s_cbranch_scc1 F_NOFLAG
    buffer_store_dwordx2 v[2:3], v8, s[24:27], s41 offen sc1
F_NOFLAG:
    s_endpgm
M_IDLE:
    v_and_b32 v1, 63, v0
M_END:
s_waitcnt vmcnt(0)
s_endpgm
.section .rodata,"a"
.p2align 6
.amdhsa_kernel gated_mix__spectral_gfnet__dense_activation_silu__prompt_kernel
  .amdhsa_next_free_vgpr 256
  .amdhsa_next_free_sgpr 102
  .amdhsa_accum_offset 256
  .amdhsa_group_segment_fixed_size 0
  .amdhsa_kernarg_size 80
  .amdhsa_user_sgpr_count 2
  .amdhsa_user_sgpr_kernarg_segment_ptr 1
  .amdhsa_system_sgpr_workgroup_id_x 1
.end_amdhsa_kernel
.p2align 8
FFTTAB:
.long 0x3f803f80,0x3f803f80,0x3f803f80,0x3f803f80,0x3f7b3f80,0x3f553f6d,0xbe480000,0xbf0ebec4
.long 0x3f6d3f80,0x3ec43f35,0xbf6dbf80,0xbec4bf35,0x3f553f80,0xbe483ec4,0x3f0e0000,0x3f7b3f6d
.long 0x3f353f80,0xbf350000,0x3f353f80,0xbf350000,0x3f0e3f80,0xbf7bbec4,0xbf550000,0xbe48bf6d
.long 0x3ec43f80,0xbf6dbf35,0xbec4bf80,0x3f6d3f35,0x3e483f80,0xbf0ebf6d,0x3f7b0000,0xbf553ec4
.long 0x3f80,0xbf80,0x3f80,0xbf80,0xbe483f80,0x3f0ebf6d,0xbf7b0000,0x3f553ec4
.long 0xbec43f80,0x3f6dbf35,0x3ec4bf80,0xbf6d3f35,0xbf0e3f80,0x3f7bbec4,0x3f550000,0x3e48bf6d
.long 0xbf353f80,0x3f350000,0xbf353f80,0x3f350000,0xbf553f80,0x3e483ec4,0xbf0e0000,0xbf7b3f6d
.long 0xbf6d3f80,0xbec43f35,0x3f6dbf80,0x3ec4bf35,0xbf7b3f80,0xbf553f6d,0x3e480000,0x3f0ebec4
.long 0xbf803f80,0xbf803f80,0xbf803f80,0xbf803f80,0xbf7b3f80,0xbf553f6d,0x3e480000,0x3f0ebec4
.long 0xbf6d3f80,0xbec43f35,0x3f6dbf80,0x3ec4bf35,0xbf553f80,0x3e483ec4,0xbf0e0000,0xbf7b3f6d
.long 0xbf353f80,0x3f350000,0xbf353f80,0x3f350000,0xbf0e3f80,0x3f7bbec4,0x3f550000,0x3e48bf6d
.long 0xbec43f80,0x3f6dbf35,0x3ec4bf80,0xbf6d3f35,0xbe483f80,0x3f0ebf6d,0xbf7b0000,0x3f553ec4
.long 0x3f80,0xbf80,0x3f80,0xbf80,0x3e483f80,0xbf0ebf6d,0x3f7b0000,0xbf553ec4
.long 0x3ec43f80,0xbf6dbf35,0xbec4bf80,0x3f6d3f35,0x3f0e3f80,0xbf7bbec4,0xbf550000,0xbe48bf6d
.long 0x3f353f80,0xbf350000,0x3f353f80,0xbf350000,0x3f553f80,0xbe483ec4,0x3f0e0000,0x3f7b3f6d
.long 0x3f6d3f80,0x3ec43f35,0xbf6dbf80,0xbec4bf35,0x3f7b3f80,0x3f553f6d,0xbe480000,0xbf0ebec4
.long 0x3f803f80,0x3f803f80,0x3f803f80,0x3f803f80,0x3f0e3f35,0x3e483ec4,0xbf55bf35,0xbf7bbf6d
.long 0xbec40000,0xbf6dbf35,0x3ec40000,0x3f6d3f35,0xbf7bbf35,0xbf0ebf6d,0x3e483f35,0xbf55bec4
.long 0xbf35bf80,0x3f350000,0xbf35bf80,0x3f350000,0x3e48bf35,0x3f553f6d,0x3f7b3f35,0xbf0e3ec4
.long 0x3f6d0000,0xbec43f35,0xbf6d0000,0x3ec4bf35,0x3f553f35,0xbf7bbec4,0x3f0ebf35,0xbe483f6d
.long 0x3f80,0xbf80,0x3f80,0xbf80,0xbf553f35,0x3f7bbec4,0xbf0ebf35,0x3e483f6d
.long 0xbf6d0000,0x3ec43f35,0x3f6d0000,0xbec4bf35,0xbe48bf35,0xbf553f6d,0xbf7b3f35,0x3f0e3ec4
.long 0x3f35bf80,0xbf350000,0x3f35bf80,0xbf350000,0x3f7bbf35,0x3f0ebf6d,0xbe483f35,0x3f55bec4
.long 0x3ec40000,0x3f6dbf35,0xbec40000,0xbf6d3f35,0xbf0e3f35,0xbe483ec4,0x3f55bf35,0x3f7bbf6d
.long 0xbf803f80,0xbf803f80,0xbf803f80,0xbf803f80,0xbf0e3f35,0xbe483ec4,0x3f55bf35,0x3f7bbf6d
.long 0x3ec40000,0x3f6dbf35,0xbec40000,0xbf6d3f35,0x3f7bbf35,0x3f0ebf6d,0xbe483f35,0x3f55bec4
.long 0x3f35bf80,0xbf350000,0x3f35bf80,0xbf350000,0xbe48bf35,0xbf553f6d,0xbf7b3f35,0x3f0e3ec4
.long 0xbf6d0000,0x3ec43f35,0x3f6d0000,0xbec4bf35,0xbf553f35,0x3f7bbec4,0xbf0ebf35,0x3e483f6d
.long 0x3f80,0xbf80,0x3f80,0xbf80,0x3f553f35,0xbf7bbec4,0x3f0ebf35,0xbe483f6d
.long 0x3f6d0000,0xbec43f35,0xbf6d0000,0x3ec4bf35,0x3e48bf35,0x3f553f6d,0x3f7b3f35,0xbf0e3ec4
.long 0xbf35bf80,0x3f350000,0xbf35bf80,0x3f350000,0xbf7bbf35,0xbf0ebf6d,0x3e483f35,0xbf55bec4
.long 0xbec40000,0xbf6dbf35,0x3ec40000,0x3f6d3f35,0x3f0e3f35,0x3e483ec4,0xbf55bf35,0xbf7bbf6d
.long 0x3f803f80,0x3f803f80,0x3f803f80,0x3f803f80,0xbf7bbf80,0xbf55bf6d,0x3e480000,0x3f0e3ec4
.long 0x3f6d3f80,0x3ec43f35,0xbf6dbf80,0xbec4bf35,0xbf55bf80,0x3e48bec4,0xbf0e0000,0xbf7bbf6d
.long 0x3f353f80,0xbf350000,0x3f353f80,0xbf350000,0xbf0ebf80,0x3f7b3ec4,0x3f550000,0x3e483f6d
.long 0x3ec43f80,0xbf6dbf35,0xbec4bf80,0x3f6d3f35,0xbe48bf80,0x3f0e3f6d,0xbf7b0000,0x3f55bec4
.long 0x3f80,0xbf80,0x3f80,0xbf80,0x3e48bf80,0xbf0e3f6d,0x3f7b0000,0xbf55bec4
.long 0xbec43f80,0x3f6dbf35,0x3ec4bf80,0xbf6d3f35,0x3f0ebf80,0xbf7b3ec4,0xbf550000,0xbe483f6d
.long 0xbf353f80,0x3f350000,0xbf353f80,0x3f350000,0x3f55bf80,0xbe48bec4,0x3f0e0000,0x3f7bbf6d
.long 0xbf6d3f80,0xbec43f35,0x3f6dbf80,0x3ec4bf35,0x3f7bbf80,0x3f55bf6d,0xbe480000,0xbf0e3ec4
.long 0xbf803f80,0xbf803f80,0xbf803f80,0xbf803f80,0x3f7bbf80,0x3f55bf6d,0xbe480000,0xbf0e3ec4
.long 0xbf6d3f80,0xbec43f35,0x3f6dbf80,0x3ec4bf35,0x3f55bf80,0xbe48bec4,0x3f0e0000,0x3f7bbf6d
.long 0xbf353f80,0x3f350000,0xbf353f80,0x3f350000,0x3f0ebf80,0xbf7b3ec4,0xbf550000,0xbe483f6d
.long 0xbec43f80,0x3f6dbf35,0x3ec4bf80,0xbf6d3f35,0x3e48bf80,0xbf0e3f6d,0x3f7b0000,0xbf55bec4
.long 0x3f80,0xbf80,0x3f80,0xbf80,0xbe48bf80,0x3f0e3f6d,0xbf7b0000,0x3f55bec4
.long 0x3ec43f80,0xbf6dbf35,0xbec4bf80,0x3f6d3f35,0xbf0ebf80,0x3f7b3ec4,0x3f550000,0x3e483f6d
.long 0x3f353f80,0xbf350000,0x3f353f80,0xbf350000,0xbf55bf80,0x3e48bec4,0xbf0e0000,0xbf7bbf6d
.long 0x3f6d3f80,0x3ec43f35,0xbf6dbf80,0xbec4bf35,0xbf7bbf80,0xbf55bf6d,0x3e480000,0x3f0e3ec4
.long 0x3f803f80,0x3f803f80,0x3f803f80,0x3f803f80,0xbf0ebf35,0xbe48bec4,0x3f553f35,0x3f7b3f6d
.long 0xbec40000,0xbf6dbf35,0x3ec40000,0x3f6d3f35,0x3f7b3f35,0x3f0e3f6d,0xbe48bf35,0x3f553ec4
.long 0xbf35bf80,0x3f350000,0xbf35bf80,0x3f350000,0xbe483f35,0xbf55bf6d,0xbf7bbf35,0x3f0ebec4
.long 0x3f6d0000,0xbec43f35,0xbf6d0000,0x3ec4bf35,0xbf55bf35,0x3f7b3ec4,0xbf0e3f35,0x3e48bf6d
.long 0x3f80,0xbf80,0x3f80,0xbf80,0x3f55bf35,0xbf7b3ec4,0x3f0e3f35,0xbe48bf6d
.long 0xbf6d0000,0x3ec43f35,0x3f6d0000,0xbec4bf35,0x3e483f35,0x3f55bf6d,0x3f7bbf35,0xbf0ebec4
.long 0x3f35bf80,0xbf350000,0x3f35bf80,0xbf350000,0xbf7b3f35,0xbf0e3f6d,0x3e48bf35,0xbf553ec4
.long 0x3ec40000,0x3f6dbf35,0xbec40000,0xbf6d3f35,0x3f0ebf35,0x3e48bec4,0xbf553f35,0xbf7b3f6d
.long 0xbf803f80,0xbf803f80,0xbf803f80,0xbf803f80,0x3f0ebf35,0x3e48bec4,0xbf553f35,0xbf7b3f6d
.long 0x3ec40000,0x3f6dbf35,0xbec40000,0xbf6d3f35,0xbf7b3f35,0xbf0e3f6d,0x3e48bf35,0xbf553ec4
.long 0x3f35bf80,0xbf350000,0x3f35bf80,0xbf350000,0x3e483f35,0x3f55bf6d,0x3f7bbf35,0xbf0ebec4
.long 0xbf6d0000,0x3ec43f35,0x3f6d0000,0xbec4bf35,0x3f55bf35,0xbf7b3ec4,0x3f0e3f35,0xbe48bf6d
.long 0x3f80,0xbf80,0x3f80,0xbf80,0xbf55bf35,0x3f7b3ec4,0xbf0e3f35,0x3e48bf6d
.long 0x3f6d0000,0xbec43f35,0xbf6d0000,0x3ec4bf35,0xbe483f35,0xbf55bf6d,0xbf7bbf35,0x3f0ebec4
.long 0xbf35bf80,0x3f350000,0xbf35bf80,0x3f350000,0x3f7b3f35,0x3f0e3f6d,0xbe48bf35,0x3f553ec4
.long 0xbec40000,0xbf6dbf35,0x3ec40000,0x3f6d3f35,0xbf0ebf35,0xbe48bec4,0x3f553f35,0x3f7b3f6d
.long 0x0,0x0,0x0,0x0,0x3e480000,0x3f0e3ec4,0x3f7b3f80,0x3f553f6d
.long 0x3ec40000,0x3f6d3f35,0xbec40000,0xbf6dbf35,0x3f0e0000,0x3f7b3f6d,0xbf55bf80,0x3e48bec4
.long 0x3f350000,0x3f353f80,0x3f350000,0x3f353f80,0x3f550000,0x3e483f6d,0x3f0e3f80,0xbf7bbec4
.long 0x3f6d0000,0xbec43f35,0xbf6d0000,0x3ec4bf35,0x3f7b0000,0xbf553ec4,0xbe48bf80,0x3f0e3f6d
.long 0x3f800000,0xbf800000,0x3f800000,0xbf800000,0x3f7b0000,0xbf55bec4,0xbe483f80,0x3f0ebf6d
.long 0x3f6d0000,0xbec4bf35,0xbf6d0000,0x3ec43f35,0x3f550000,0x3e48bf6d,0x3f0ebf80,0xbf7b3ec4
.long 0x3f350000,0x3f35bf80,0x3f350000,0x3f35bf80,0x3f0e0000,0x3f7bbf6d,0xbf553f80,0x3e483ec4
.long 0x3ec40000,0x3f6dbf35,0xbec40000,0xbf6d3f35,0x3e480000,0x3f0ebec4,0x3f7bbf80,0x3f55bf6d
.long 0x0,0x0,0x0,0x0,0xbe480000,0xbf0e3ec4,0xbf7b3f80,0xbf553f6d
.long 0xbec40000,0xbf6d3f35,0x3ec40000,0x3f6dbf35,0xbf0e0000,0xbf7b3f6d,0x3f55bf80,0xbe48bec4
.long 0xbf350000,0xbf353f80,0xbf350000,0xbf353f80,0xbf550000,0xbe483f6d,0xbf0e3f80,0x3f7bbec4
.long 0xbf6d0000,0x3ec43f35,0x3f6d0000,0xbec4bf35,0xbf7b0000,0x3f553ec4,0x3e48bf80,0xbf0e3f6d
.long 0xbf800000,0x3f800000,0xbf800000,0x3f800000,0xbf7b0000,0x3f55bec4,0x3e483f80,0xbf0ebf6d
.long 0xbf6d0000,0x3ec4bf35,0x3f6d0000,0xbec43f35,0xbf550000,0xbe48bf6d,0xbf0ebf80,0x3f7b3ec4
.long 0xbf350000,0xbf35bf80,0xbf350000,0xbf35bf80,0xbf0e0000,0xbf7bbf6d,0x3f553f80,0xbe483ec4
.long 0xbec40000,0xbf6dbf35,0x3ec40000,0x3f6d3f35,0xbe480000,0xbf0ebec4,0xbf7bbf80,0xbf55bf6d
.long 0x0,0x0,0x0,0x0,0x3f553f35,0x3f7b3f6d,0x3f0e3f35,0x3e483ec4
.long 0x3f6d3f80,0x3ec43f35,0xbf6dbf80,0xbec4bf35,0x3e483f35,0xbf55bec4,0x3f7b3f35,0x3f0e3f6d
.long 0xbf350000,0xbf35bf80,0xbf350000,0xbf35bf80,0xbf7bbf35,0x3f0ebec4,0x3e48bf35,0x3f553f6d
.long 0xbec4bf80,0x3f6d3f35,0x3ec43f80,0xbf6dbf35,0x3f0ebf35,0xbe483f6d,0xbf55bf35,0x3f7b3ec4
.long 0x3f800000,0xbf800000,0x3f800000,0xbf800000,0x3f0e3f35,0xbe48bf6d,0xbf553f35,0x3f7bbec4
.long 0xbec43f80,0x3f6dbf35,0x3ec4bf80,0xbf6d3f35,0xbf7b3f35,0x3f0e3ec4,0x3e483f35,0x3f55bf6d
.long 0xbf350000,0xbf353f80,0xbf350000,0xbf353f80,0x3e48bf35,0xbf553ec4,0x3f7bbf35,0x3f0ebf6d
.long 0x3f6dbf80,0x3ec4bf35,0xbf6d3f80,0xbec43f35,0x3f55bf35,0x3f7bbf6d,0x3f0ebf35,0x3e48bec4
.long 0x0,0x0,0x0,0x0,0xbf553f35,0xbf7b3f6d,0xbf0e3f35,0xbe483ec4
.long 0xbf6d3f80,0xbec43f35,0x3f6dbf80,0x3ec4bf35,0xbe483f35,0x3f55bec4,0xbf7b3f35,0xbf0e3f6d
.long 0x3f350000,0x3f35bf80,0x3f350000,0x3f35bf80,0x3f7bbf35,0xbf0ebec4,0xbe48bf35,0xbf553f6d
.long 0x3ec4bf80,0xbf6d3f35,0xbec43f80,0x3f6dbf35,0xbf0ebf35,0x3e483f6d,0x3f55bf35,0xbf7b3ec4
.long 0xbf800000,0x3f800000,0xbf800000,0x3f800000,0xbf0e3f35,0x3e48bf6d,0x3f553f35,0xbf7bbec4
.long 0x3ec43f80,0xbf6dbf35,0xbec4bf80,0x3f6d3f35,0x3f7b3f35,0xbf0e3ec4,0xbe483f35,0xbf55bf6d
.long 0x3f350000,0x3f353f80,0x3f350000,0x3f353f80,0xbe48bf35,0x3f553ec4,0xbf7bbf35,0xbf0ebf6d
.long 0xbf6dbf80,0xbec4bf35,0x3f6d3f80,0x3ec43f35,0xbf55bf35,0xbf7bbf6d,0xbf0ebf35,0xbe48bec4
.long 0x0,0x0,0x0,0x0,0xbe480000,0xbf0ebec4,0xbf7bbf80,0xbf55bf6d
.long 0x3ec40000,0x3f6d3f35,0xbec40000,0xbf6dbf35,0xbf0e0000,0xbf7bbf6d,0x3f553f80,0xbe483ec4
.long 0x3f350000,0x3f353f80,0x3f350000,0x3f353f80,0xbf550000,0xbe48bf6d,0xbf0ebf80,0x3f7b3ec4
.long 0x3f6d0000,0xbec43f35,0xbf6d0000,0x3ec4bf35,0xbf7b0000,0x3f55bec4,0x3e483f80,0xbf0ebf6d
.long 0x3f800000,0xbf800000,0x3f800000,0xbf800000,0xbf7b0000,0x3f553ec4,0x3e48bf80,0xbf0e3f6d
.long 0x3f6d0000,0xbec4bf35,0xbf6d0000,0x3ec43f35,0xbf550000,0xbe483f6d,0xbf0e3f80,0x3f7bbec4
.long 0x3f350000,0x3f35bf80,0x3f350000,0x3f35bf80,0xbf0e0000,0xbf7b3f6d,0x3f55bf80,0xbe48bec4
.long 0x3ec40000,0x3f6dbf35,0xbec40000,0xbf6d3f35,0xbe480000,0xbf0e3ec4,0xbf7b3f80,0xbf553f6d
.long 0x0,0x0,0x0,0x0,0x3e480000,0x3f0ebec4,0x3f7bbf80,0x3f55bf6d
.long 0xbec40000,0xbf6d3f35,0x3ec40000,0x3f6dbf35,0x3f0e0000,0x3f7bbf6d,0xbf553f80,0x3e483ec4
.long 0xbf350000,0xbf353f80,0xbf350000,0xbf353f80,0x3f550000,0x3e48bf6d,0x3f0ebf80,0xbf7b3ec4
.long 0xbf6d0000,0x3ec43f35,0x3f6d0000,0xbec4bf35,0x3f7b0000,0xbf55bec4,0xbe483f80,0x3f0ebf6d
.long 0xbf800000,0x3f800000,0xbf800000,0x3f800000,0x3f7b0000,0xbf553ec4,0xbe48bf80,0x3f0e3f6d
.long 0xbf6d0000,0x3ec4bf35,0x3f6d0000,0xbec43f35,0x3f550000,0x3e483f6d,0x3f0e3f80,0xbf7bbec4
.long 0xbf350000,0xbf35bf80,0xbf350000,0xbf35bf80,0x3f0e0000,0x3f7b3f6d,0xbf55bf80,0x3e48bec4
.long 0xbec40000,0xbf6dbf35,0x3ec40000,0x3f6d3f35,0x3e480000,0x3f0e3ec4,0x3f7b3f80,0x3f553f6d
.long 0x0,0x0,0x0,0x0,0xbf55bf35,0xbf7bbf6d,0xbf0ebf35,0xbe48bec4
.long 0x3f6d3f80,0x3ec43f35,0xbf6dbf80,0xbec4bf35,0xbe48bf35,0x3f553ec4,0xbf7bbf35,0xbf0ebf6d
.long 0xbf350000,0xbf35bf80,0xbf350000,0xbf35bf80,0x3f7b3f35,0xbf0e3ec4,0xbe483f35,0xbf55bf6d
.long 0xbec4bf80,0x3f6d3f35,0x3ec43f80,0xbf6dbf35,0xbf0e3f35,0x3e48bf6d,0x3f553f35,0xbf7bbec4
.long 0x3f800000,0xbf800000,0x3f800000,0xbf800000,0xbf0ebf35,0x3e483f6d,0x3f55bf35,0xbf7b3ec4
.long 0xbec43f80,0x3f6dbf35,0x3ec4bf80,0xbf6d3f35,0x3f7bbf35,0xbf0ebec4,0xbe48bf35,0xbf553f6d
.long 0xbf350000,0xbf353f80,0xbf350000,0xbf353f80,0xbe483f35,0x3f55bec4,0xbf7b3f35,0xbf0e3f6d
.long 0x3f6dbf80,0x3ec4bf35,0xbf6d3f80,0xbec43f35,0xbf553f35,0xbf7b3f6d,0xbf0e3f35,0xbe483ec4
.long 0x0,0x0,0x0,0x0,0x3f55bf35,0x3f7bbf6d,0x3f0ebf35,0x3e48bec4
.long 0xbf6d3f80,0xbec43f35,0x3f6dbf80,0x3ec4bf35,0x3e48bf35,0xbf553ec4,0x3f7bbf35,0x3f0ebf6d
.long 0x3f350000,0x3f35bf80,0x3f350000,0x3f35bf80,0xbf7b3f35,0x3f0e3ec4,0x3e483f35,0x3f55bf6d
.long 0x3ec4bf80,0xbf6d3f35,0xbec43f80,0x3f6dbf35,0x3f0e3f35,0xbe48bf6d,0xbf553f35,0x3f7bbec4
.long 0xbf800000,0x3f800000,0xbf800000,0x3f800000,0x3f0ebf35,0xbe483f6d,0xbf55bf35,0x3f7b3ec4
.long 0x3ec43f80,0xbf6dbf35,0xbec4bf80,0x3f6d3f35,0xbf7bbf35,0x3f0ebec4,0x3e48bf35,0x3f553f6d
.long 0x3f350000,0x3f353f80,0x3f350000,0x3f353f80,0x3e483f35,0xbf55bec4,0x3f7b3f35,0x3f0e3f6d
.long 0xbf6dbf80,0xbec4bf35,0x3f6d3f80,0x3ec43f35,0x3f553f35,0x3f7b3f6d,0x3f0e3f35,0x3e483ec4
.long 0x0,0x0,0x0,0x0,0xbe480000,0xbf0ebec4,0xbf7bbf80,0xbf55bf6d
.long 0xbec40000,0xbf6dbf35,0x3ec40000,0x3f6d3f35,0xbf0e0000,0xbf7bbf6d,0x3f553f80,0xbe483ec4
.long 0xbf350000,0xbf35bf80,0xbf350000,0xbf35bf80,0xbf550000,0xbe48bf6d,0xbf0ebf80,0x3f7b3ec4
.long 0xbf6d0000,0x3ec4bf35,0x3f6d0000,0xbec43f35,0xbf7b0000,0x3f55bec4,0x3e483f80,0xbf0ebf6d
.long 0xbf800000,0x3f800000,0xbf800000,0x3f800000,0xbf7b0000,0x3f553ec4,0x3e48bf80,0xbf0e3f6d
.long 0xbf6d0000,0x3ec43f35,0x3f6d0000,0xbec4bf35,0xbf550000,0xbe483f6d,0xbf0e3f80,0x3f7bbec4
.long 0xbf350000,0xbf353f80,0xbf350000,0xbf353f80,0xbf0e0000,0xbf7b3f6d,0x3f55bf80,0xbe48bec4
.long 0xbec40000,0xbf6d3f35,0x3ec40000,0x3f6dbf35,0xbe480000,0xbf0e3ec4,0xbf7b3f80,0xbf553f6d
.long 0x0,0x0,0x0,0x0,0x3e480000,0x3f0ebec4,0x3f7bbf80,0x3f55bf6d
.long 0x3ec40000,0x3f6dbf35,0xbec40000,0xbf6d3f35,0x3f0e0000,0x3f7bbf6d,0xbf553f80,0x3e483ec4
.long 0x3f350000,0x3f35bf80,0x3f350000,0x3f35bf80,0x3f550000,0x3e48bf6d,0x3f0ebf80,0xbf7b3ec4
.long 0x3f6d0000,0xbec4bf35,0xbf6d0000,0x3ec43f35,0x3f7b0000,0xbf55bec4,0xbe483f80,0x3f0ebf6d
.long 0x3f800000,0xbf800000,0x3f800000,0xbf800000,0x3f7b0000,0xbf553ec4,0xbe48bf80,0x3f0e3f6d
.long 0x3f6d0000,0xbec43f35,0xbf6d0000,0x3ec4bf35,0x3f550000,0x3e483f6d,0x3f0e3f80,0xbf7bbec4
.long 0x3f350000,0x3f353f80,0x3f350000,0x3f353f80,0x3f0e0000,0x3f7b3f6d,0xbf55bf80,0x3e48bec4
.long 0x3ec40000,0x3f6d3f35,0xbec40000,0xbf6dbf35,0x3e480000,0x3f0e3ec4,0x3f7b3f80,0x3f553f6d
.long 0x0,0x0,0x0,0x0,0xbf55bf35,0xbf7bbf6d,0xbf0ebf35,0xbe48bec4
.long 0xbf6dbf80,0xbec4bf35,0x3f6d3f80,0x3ec43f35,0xbe48bf35,0x3f553ec4,0xbf7bbf35,0xbf0ebf6d
.long 0x3f350000,0x3f353f80,0x3f350000,0x3f353f80,0x3f7b3f35,0xbf0e3ec4,0xbe483f35,0xbf55bf6d
.long 0x3ec43f80,0xbf6dbf35,0xbec4bf80,0x3f6d3f35,0xbf0e3f35,0x3e48bf6d,0x3f553f35,0xbf7bbec4
.long 0xbf800000,0x3f800000,0xbf800000,0x3f800000,0xbf0ebf35,0x3e483f6d,0x3f55bf35,0xbf7b3ec4
.long 0x3ec4bf80,0xbf6d3f35,0xbec43f80,0x3f6dbf35,0x3f7bbf35,0xbf0ebec4,0xbe48bf35,0xbf553f6d
.long 0x3f350000,0x3f35bf80,0x3f350000,0x3f35bf80,0xbe483f35,0x3f55bec4,0xbf7b3f35,0xbf0e3f6d
.long 0xbf6d3f80,0xbec43f35,0x3f6dbf80,0x3ec4bf35,0xbf553f35,0xbf7b3f6d,0xbf0e3f35,0xbe483ec4
.long 0x0,0x0,0x0,0x0,0x3f55bf35,0x3f7bbf6d,0x3f0ebf35,0x3e48bec4
.long 0x3f6dbf80,0x3ec4bf35,0xbf6d3f80,0xbec43f35,0x3e48bf35,0xbf553ec4,0x3f7bbf35,0x3f0ebf6d
.long 0xbf350000,0xbf353f80,0xbf350000,0xbf353f80,0xbf7b3f35,0x3f0e3ec4,0x3e483f35,0x3f55bf6d
.long 0xbec43f80,0x3f6dbf35,0x3ec4bf80,0xbf6d3f35,0x3f0e3f35,0xbe48bf6d,0xbf553f35,0x3f7bbec4
.long 0x3f800000,0xbf800000,0x3f800000,0xbf800000,0x3f0ebf35,0xbe483f6d,0xbf55bf35,0x3f7b3ec4
.long 0xbec4bf80,0x3f6d3f35,0x3ec43f80,0xbf6dbf35,0xbf7bbf35,0x3f0ebec4,0x3e48bf35,0x3f553f6d
.long 0xbf350000,0xbf35bf80,0xbf350000,0xbf35bf80,0x3e483f35,0xbf55bec4,0x3f7b3f35,0x3f0e3f6d
.long 0x3f6d3f80,0x3ec43f35,0xbf6dbf80,0xbec4bf35,0x3f553f35,0x3f7b3f6d,0x3f0e3f35,0x3e483ec4
.long 0x0,0x0,0x0,0x0,0x3e480000,0x3f0e3ec4,0x3f7b3f80,0x3f553f6d
.long 0xbec40000,0xbf6dbf35,0x3ec40000,0x3f6d3f35,0x3f0e0000,0x3f7b3f6d,0xbf55bf80,0x3e48bec4
.long 0xbf350000,0xbf35bf80,0xbf350000,0xbf35bf80,0x3f550000,0x3e483f6d,0x3f0e3f80,0xbf7bbec4
.long 0xbf6d0000,0x3ec4bf35,0x3f6d0000,0xbec43f35,0x3f7b0000,0xbf553ec4,0xbe48bf80,0x3f0e3f6d
.long 0xbf800000,0x3f800000,0xbf800000,0x3f800000,0x3f7b0000,0xbf55bec4,0xbe483f80,0x3f0ebf6d
.long 0xbf6d0000,0x3ec43f35,0x3f6d0000,0xbec4bf35,0x3f550000,0x3e48bf6d,0x3f0ebf80,0xbf7b3ec4
.long 0xbf350000,0xbf353f80,0xbf350000,0xbf353f80,0x3f0e0000,0x3f7bbf6d,0xbf553f80,0x3e483ec4
.long 0xbec40000,0xbf6d3f35,0x3ec40000,0x3f6dbf35,0x3e480000,0x3f0ebec4,0x3f7bbf80,0x3f55bf6d
.long 0x0,0x0,0x0,0x0,0xbe480000,0xbf0e3ec4,0xbf7b3f80,0xbf553f6d
.long 0x3ec40000,0x3f6dbf35,0xbec40000,0xbf6d3f35,0xbf0e0000,0xbf7b3f6d,0x3f55bf80,0xbe48bec4
.long 0x3f350000,0x3f35bf80,0x3f350000,0x3f35bf80,0xbf550000,0xbe483f6d,0xbf0e3f80,0x3f7bbec4
.long 0x3f6d0000,0xbec4bf35,0xbf6d0000,0x3ec43f35,0xbf7b0000,0x3f553ec4,0x3e48bf80,0xbf0e3f6d
.long 0x3f800000,0xbf800000,0x3f800000,0xbf800000,0xbf7b0000,0x3f55bec4,0x3e483f80,0xbf0ebf6d
.long 0x3f6d0000,0xbec43f35,0xbf6d0000,0x3ec4bf35,0xbf550000,0xbe48bf6d,0xbf0ebf80,0x3f7b3ec4
.long 0x3f350000,0x3f353f80,0x3f350000,0x3f353f80,0xbf0e0000,0xbf7bbf6d,0x3f553f80,0xbe483ec4
.long 0x3ec40000,0x3f6d3f35,0xbec40000,0xbf6dbf35,0xbe480000,0xbf0ebec4,0xbf7bbf80,0xbf55bf6d
.long 0x0,0x0,0x0,0x0,0x3f553f35,0x3f7b3f6d,0x3f0e3f35,0x3e483ec4
.long 0xbf6dbf80,0xbec4bf35,0x3f6d3f80,0x3ec43f35,0x3e483f35,0xbf55bec4,0x3f7b3f35,0x3f0e3f6d
.long 0x3f350000,0x3f353f80,0x3f350000,0x3f353f80,0xbf7bbf35,0x3f0ebec4,0x3e48bf35,0x3f553f6d
.long 0x3ec43f80,0xbf6dbf35,0xbec4bf80,0x3f6d3f35,0x3f0ebf35,0xbe483f6d,0xbf55bf35,0x3f7b3ec4
.long 0xbf800000,0x3f800000,0xbf800000,0x3f800000,0x3f0e3f35,0xbe48bf6d,0xbf553f35,0x3f7bbec4
.long 0x3ec4bf80,0xbf6d3f35,0xbec43f80,0x3f6dbf35,0xbf7b3f35,0x3f0e3ec4,0x3e483f35,0x3f55bf6d
.long 0x3f350000,0x3f35bf80,0x3f350000,0x3f35bf80,0x3e48bf35,0xbf553ec4,0x3f7bbf35,0x3f0ebf6d
.long 0xbf6d3f80,0xbec43f35,0x3f6dbf80,0x3ec4bf35,0x3f55bf35,0x3f7bbf6d,0x3f0ebf35,0x3e48bec4
.long 0x0,0x0,0x0,0x0,0xbf553f35,0xbf7b3f6d,0xbf0e3f35,0xbe483ec4
.long 0x3f6dbf80,0x3ec4bf35,0xbf6d3f80,0xbec43f35,0xbe483f35,0x3f55bec4,0xbf7b3f35,0xbf0e3f6d
.long 0xbf350000,0xbf353f80,0xbf350000,0xbf353f80,0x3f7bbf35,0xbf0ebec4,0xbe48bf35,0xbf553f6d
.long 0xbec43f80,0x3f6dbf35,0x3ec4bf80,0xbf6d3f35,0xbf0ebf35,0x3e483f6d,0x3f55bf35,0xbf7b3ec4
.long 0x3f800000,0xbf800000,0x3f800000,0xbf800000,0xbf0e3f35,0x3e48bf6d,0x3f553f35,0xbf7bbec4
.long 0xbec4bf80,0x3f6d3f35,0x3ec43f80,0xbf6dbf35,0x3f7b3f35,0xbf0e3ec4,0xbe483f35,0xbf55bf6d
.long 0xbf350000,0xbf35bf80,0xbf350000,0xbf35bf80,0xbe48bf35,0x3f553ec4,0xbf7bbf35,0xbf0ebf6d
.long 0x3f6d3f80,0x3ec43f35,0xbf6dbf80,0xbec4bf35,0xbf55bf35,0xbf7bbf6d,0xbf0ebf35,0xbe48bec4
.long 0x3f803f80,0x3f803f80,0x3f803f80,0x3f803f80,0x3f7f3f80,0x3f753f7b,0x3f223f35,0x3ef13f0e
.long 0x3f7b3f80,0x3f553f6d,0xbe480000,0xbf0ebec4,0x3f753f80,0x3f223f55,0xbf62bf35,0xbf7fbf7b
.long 0x3f6d3f80,0x3ec43f35,0xbf6dbf80,0xbec4bf35,0x3f623f80,0x3dc93f0e,0xbe95bf35,0x3f223e48
.long 0x3f553f80,0xbe483ec4,0x3f0e0000,0x3f7b3f6d,0x3f463f80,0xbef13e48,0x3f7f3f35,0x3e953f55
.long 0x3f353f80,0xbf350000,0x3f353f80,0xbf350000,0x3f223f80,0xbf62be48,0xbdc93f35,0xbf75bf55
.long 0x3f0e3f80,0xbf7bbec4,0xbf550000,0xbe48bf6d,0x3ef13f80,0xbf7fbf0e,0xbf75bf35,0x3f46be48
.long 0x3ec43f80,0xbf6dbf35,0xbec4bf80,0x3f6d3f35,0x3e953f80,0xbf46bf55,0x3ef1bf35,0x3dc93f7b
.long 0x3e483f80,0xbf0ebf6d,0x3f7b0000,0xbf553ec4,0x3dc93f80,0xbe95bf7b,0x3f463f35,0xbf62bf0e
.long 0x3f80,0xbf80,0x3f80,0xbf80,0xbdc93f80,0x3e95bf7b,0xbf463f35,0x3f62bf0e
.long 0xbe483f80,0x3f0ebf6d,0xbf7b0000,0x3f553ec4,0xbe953f80,0x3f46bf55,0xbef1bf35,0xbdc93f7b
.long 0xbec43f80,0x3f6dbf35,0x3ec4bf80,0xbf6d3f35,0xbef13f80,0x3f7fbf0e,0x3f75bf35,0xbf46be48
.long 0xbf0e3f80,0x3f7bbec4,0x3f550000,0x3e48bf6d,0xbf223f80,0x3f62be48,0x3dc93f35,0x3f75bf55
.long 0xbf353f80,0x3f350000,0xbf353f80,0x3f350000,0xbf463f80,0x3ef13e48,0xbf7f3f35,0xbe953f55
.long 0xbf553f80,0x3e483ec4,0xbf0e0000,0xbf7b3f6d,0xbf623f80,0xbdc93f0e,0x3e95bf35,0xbf223e48
.long 0xbf6d3f80,0xbec43f35,0x3f6dbf80,0x3ec4bf35,0xbf753f80,0xbf223f55,0x3f62bf35,0x3f7fbf7b
.long 0xbf7b3f80,0xbf553f6d,0x3e480000,0x3f0ebec4,0xbf7f3f80,0xbf753f7b,0xbf223f35,0xbef13f0e
.long 0x3f803f80,0x3f803f80,0x3f803f80,0x3f803f80,0x3f623f6d,0x3f463f55,0x3e953ec4,0x3dc93e48
.long 0x3f0e3f35,0x3e483ec4,0xbf55bf35,0xbf7bbf6d,0x3dc93ec4,0xbef1be48,0xbf46bf6d,0xbe95bf0e
.long 0xbec40000,0xbf6dbf35,0x3ec40000,0x3f6d3f35,0xbf46bec4,0xbf75bf7b,0x3f7f3f6d,0x3ef13f55
.long 0xbf7bbf35,0xbf0ebf6d,0x3e483f35,0xbf55bec4,0xbf75bf6d,0x3dc9bf0e,0xbf62bec4,0xbf22bf7b
.long 0xbf35bf80,0x3f350000,0xbf35bf80,0x3f350000,0xbe95bf6d,0x3f7f3f0e,0x3ef1bec4,0x3f463f7b
.long 0x3e48bf35,0x3f553f6d,0x3f7b3f35,0xbf0e3ec4,0x3f22bec4,0x3e953f7b,0x3dc93f6d,0xbf62bf55
.long 0x3f6d0000,0xbec43f35,0xbf6d0000,0x3ec4bf35,0x3f7f3ec4,0xbf623e48,0xbf22bf6d,0x3f753f0e
.long 0x3f553f35,0xbf7bbec4,0x3f0ebf35,0xbe483f6d,0x3ef13f6d,0xbf22bf55,0x3f753ec4,0xbf7fbe48
.long 0x3f80,0xbf80,0x3f80,0xbf80,0xbef13f6d,0x3f22bf55,0xbf753ec4,0x3f7fbe48
.long 0xbf553f35,0x3f7bbec4,0xbf0ebf35,0x3e483f6d,0xbf7f3ec4,0x3f623e48,0x3f22bf6d,0xbf753f0e
.long 0xbf6d0000,0x3ec43f35,0x3f6d0000,0xbec4bf35,0xbf22bec4,0xbe953f7b,0xbdc93f6d,0x3f62bf55
.long 0xbe48bf35,0xbf553f6d,0xbf7b3f35,0x3f0e3ec4,0x3e95bf6d,0xbf7f3f0e,0xbef1bec4,0xbf463f7b
.long 0x3f35bf80,0xbf350000,0x3f35bf80,0xbf350000,0x3f75bf6d,0xbdc9bf0e,0x3f62bec4,0x3f22bf7b
.long 0x3f7bbf35,0x3f0ebf6d,0xbe483f35,0x3f55bec4,0x3f46bec4,0x3f75bf7b,0xbf7f3f6d,0xbef13f55
.long 0x3ec40000,0x3f6dbf35,0xbec40000,0xbf6d3f35,0xbdc93ec4,0x3ef1be48,0x3f46bf6d,0x3e95bf0e
.long 0xbf0e3f35,0xbe483ec4,0x3f55bf35,0x3f7bbf6d,0xbf623f6d,0xbf463f55,0xbe953ec4,0xbdc93e48
.long 0x3f803f80,0x3f803f80,0x3f803f80,0x3f803f80,0xbdc90000,0xbe95be48,0xbf46bf35,0xbf62bf55
.long 0xbf7bbf80,0xbf55bf6d,0x3e480000,0x3f0e3ec4,0x3e950000,0x3f463f0e,0x3ef13f35,0xbdc93e48
.long 0x3f6d3f80,0x3ec43f35,0xbf6dbf80,0xbec4bf35,0xbef10000,0xbf7fbf55,0x3f753f35,0x3f463f7b
.long 0xbf55bf80,0x3e48bec4,0xbf0e0000,0xbf7bbf6d,0x3f220000,0x3f623f7b,0xbdc9bf35,0x3f753f0e
.long 0x3f353f80,0xbf350000,0x3f353f80,0xbf350000,0xbf460000,0xbef1bf7b,0xbf7fbf35,0x3e95bf0e
.long 0xbf0ebf80,0x3f7b3ec4,0x3f550000,0x3e483f6d,0x3f620000,0xbdc93f55,0xbe953f35,0xbf22bf7b
.long 0x3ec43f80,0xbf6dbf35,0xbec4bf80,0x3f6d3f35,0xbf750000,0x3f22bf0e,0x3f623f35,0xbf7fbe48
.long 0xbe48bf80,0x3f0e3f6d,0xbf7b0000,0x3f55bec4,0x3f7f0000,0xbf753e48,0x3f22bf35,0xbef13f55
.long 0x3f80,0xbf80,0x3f80,0xbf80,0xbf7f0000,0x3f753e48,0xbf22bf35,0x3ef13f55
.long 0x3e48bf80,0xbf0e3f6d,0x3f7b0000,0xbf55bec4,0x3f750000,0xbf22bf0e,0xbf623f35,0x3f7fbe48
.long 0xbec43f80,0x3f6dbf35,0x3ec4bf80,0xbf6d3f35,0xbf620000,0x3dc93f55,0x3e953f35,0x3f22bf7b
.long 0x3f0ebf80,0xbf7b3ec4,0xbf550000,0xbe483f6d,0x3f460000,0x3ef1bf7b,0x3f7fbf35,0xbe95bf0e
.long 0xbf353f80,0x3f350000,0xbf353f80,0x3f350000,0xbf220000,0xbf623f7b,0x3dc9bf35,0xbf753f0e
.long 0x3f55bf80,0xbe48bec4,0x3f0e0000,0x3f7bbf6d,0x3ef10000,0x3f7fbf55,0xbf753f35,0xbf463f7b
.long 0xbf6d3f80,0xbec43f35,0x3f6dbf80,0x3ec4bf35,0xbe950000,0xbf463f0e,0xbef13f35,0x3dc93e48
.long 0x3f7bbf80,0x3f55bf6d,0xbe480000,0xbf0e3ec4,0x3dc90000,0x3e95be48,0x3f46bf35,0x3f62bf55
.long 0x3f803f80,0x3f803f80,0x3f803f80,0x3f803f80,0xbef1bec4,0xbf22bf0e,0xbf75bf6d,0xbf7fbf7b
.long 0xbf0ebf35,0xbe48bec4,0x3f553f35,0x3f7b3f6d,0x3f7f3f6d,0x3f623f7b,0xbf22bec4,0xbf75bf55
.long 0xbec40000,0xbf6dbf35,0x3ec40000,0x3f6d3f35,0xbf22bf6d,0x3e95be48,0xbdc93ec4,0xbf62bf0e
.long 0x3f7b3f35,0x3f0e3f6d,0xbe48bf35,0x3f553ec4,0xbe953ec4,0xbf7fbf55,0x3ef13f6d,0xbf46be48
.long 0xbf35bf80,0x3f350000,0xbf35bf80,0x3f350000,0x3f753ec4,0x3dc93f55,0x3f623f6d,0xbf223e48
.long 0xbe483f35,0xbf55bf6d,0xbf7bbf35,0x3f0ebec4,0xbf46bf6d,0x3f753e48,0x3f7f3ec4,0xbef13f0e
.long 0x3f6d0000,0xbec43f35,0xbf6d0000,0x3ec4bf35,0xbdc93f6d,0xbef1bf7b,0x3f46bec4,0xbe953f55
.long 0xbf55bf35,0x3f7b3ec4,0xbf0e3f35,0x3e48bf6d,0x3f62bec4,0xbf463f0e,0x3e95bf6d,0xbdc93f7b
.long 0x3f80,0xbf80,0x3f80,0xbf80,0xbf62bec4,0x3f463f0e,0xbe95bf6d,0x3dc93f7b
.long 0x3f55bf35,0xbf7b3ec4,0x3f0e3f35,0xbe48bf6d,0x3dc93f6d,0x3ef1bf7b,0xbf46bec4,0x3e953f55
.long 0xbf6d0000,0x3ec43f35,0x3f6d0000,0xbec4bf35,0x3f46bf6d,0xbf753e48,0xbf7f3ec4,0x3ef13f0e
.long 0x3e483f35,0x3f55bf6d,0x3f7bbf35,0xbf0ebec4,0xbf753ec4,0xbdc93f55,0xbf623f6d,0x3f223e48
.long 0x3f35bf80,0xbf350000,0x3f35bf80,0xbf350000,0x3e953ec4,0x3f7fbf55,0xbef13f6d,0x3f46be48
.long 0xbf7b3f35,0xbf0e3f6d,0x3e48bf35,0xbf553ec4,0x3f22bf6d,0xbe95be48,0x3dc93ec4,0x3f62bf0e
.long 0x3ec40000,0x3f6dbf35,0xbec40000,0xbf6d3f35,0xbf7f3f6d,0xbf623f7b,0x3f22bec4,0x3f75bf55
.long 0x3f0ebf35,0x3e48bec4,0xbf553f35,0xbf7b3f6d,0x3ef1bec4,0x3f22bf0e,0x3f75bf6d,0x3f7fbf7b
.long 0x3f803f80,0x3f803f80,0x3f803f80,0x3f803f80,0xbf7fbf80,0xbf75bf7b,0xbf22bf35,0xbef1bf0e
.long 0x3f7b3f80,0x3f553f6d,0xbe480000,0xbf0ebec4,0xbf75bf80,0xbf22bf55,0x3f623f35,0x3f7f3f7b
.long 0x3f6d3f80,0x3ec43f35,0xbf6dbf80,0xbec4bf35,0xbf62bf80,0xbdc9bf0e,0x3e953f35,0xbf22be48
.long 0x3f553f80,0xbe483ec4,0x3f0e0000,0x3f7b3f6d,0xbf46bf80,0x3ef1be48,0xbf7fbf35,0xbe95bf55
.long 0x3f353f80,0xbf350000,0x3f353f80,0xbf350000,0xbf22bf80,0x3f623e48,0x3dc9bf35,0x3f753f55
.long 0x3f0e3f80,0xbf7bbec4,0xbf550000,0xbe48bf6d,0xbef1bf80,0x3f7f3f0e,0x3f753f35,0xbf463e48
.long 0x3ec43f80,0xbf6dbf35,0xbec4bf80,0x3f6d3f35,0xbe95bf80,0x3f463f55,0xbef13f35,0xbdc9bf7b
.long 0x3e483f80,0xbf0ebf6d,0x3f7b0000,0xbf553ec4,0xbdc9bf80,0x3e953f7b,0xbf46bf35,0x3f623f0e
.long 0x3f80,0xbf80,0x3f80,0xbf80,0x3dc9bf80,0xbe953f7b,0x3f46bf35,0xbf623f0e
.long 0xbe483f80,0x3f0ebf6d,0xbf7b0000,0x3f553ec4,0x3e95bf80,0xbf463f55,0x3ef13f35,0x3dc9bf7b
.long 0xbec43f80,0x3f6dbf35,0x3ec4bf80,0xbf6d3f35,0x3ef1bf80,0xbf7f3f0e,0xbf753f35,0x3f463e48
.long 0xbf0e3f80,0x3f7bbec4,0x3f550000,0x3e48bf6d,0x3f22bf80,0xbf623e48,0xbdc9bf35,0xbf753f55
.long 0xbf353f80,0x3f350000,0xbf353f80,0x3f350000,0x3f46bf80,0xbef1be48,0x3f7fbf35,0x3e95bf55
.long 0xbf553f80,0x3e483ec4,0xbf0e0000,0xbf7b3f6d,0x3f62bf80,0x3dc9bf0e,0xbe953f35,0x3f22be48
.long 0xbf6d3f80,0xbec43f35,0x3f6dbf80,0x3ec4bf35,0x3f75bf80,0x3f22bf55,0xbf623f35,0xbf7f3f7b
.long 0xbf7b3f80,0xbf553f6d,0x3e480000,0x3f0ebec4,0x3f7fbf80,0x3f75bf7b,0x3f22bf35,0x3ef1bf0e
.long 0x3f803f80,0x3f803f80,0x3f803f80,0x3f803f80,0xbf62bf6d,0xbf46bf55,0xbe95bec4,0xbdc9be48
.long 0x3f0e3f35,0x3e483ec4,0xbf55bf35,0xbf7bbf6d,0xbdc9bec4,0x3ef13e48,0x3f463f6d,0x3e953f0e
.long 0xbec40000,0xbf6dbf35,0x3ec40000,0x3f6d3f35,0x3f463ec4,0x3f753f7b,0xbf7fbf6d,0xbef1bf55
.long 0xbf7bbf35,0xbf0ebf6d,0x3e483f35,0xbf55bec4,0x3f753f6d,0xbdc93f0e,0x3f623ec4,0x3f223f7b
.long 0xbf35bf80,0x3f350000,0xbf35bf80,0x3f350000,0x3e953f6d,0xbf7fbf0e,0xbef13ec4,0xbf46bf7b
.long 0x3e48bf35,0x3f553f6d,0x3f7b3f35,0xbf0e3ec4,0xbf223ec4,0xbe95bf7b,0xbdc9bf6d,0x3f623f55
.long 0x3f6d0000,0xbec43f35,0xbf6d0000,0x3ec4bf35,0xbf7fbec4,0x3f62be48,0x3f223f6d,0xbf75bf0e
.long 0x3f553f35,0xbf7bbec4,0x3f0ebf35,0xbe483f6d,0xbef1bf6d,0x3f223f55,0xbf75bec4,0x3f7f3e48
.long 0x3f80,0xbf80,0x3f80,0xbf80,0x3ef1bf6d,0xbf223f55,0x3f75bec4,0xbf7f3e48
.long 0xbf553f35,0x3f7bbec4,0xbf0ebf35,0x3e483f6d,0x3f7fbec4,0xbf62be48,0xbf223f6d,0x3f75bf0e
.long 0xbf6d0000,0x3ec43f35,0x3f6d0000,0xbec4bf35,0x3f223ec4,0x3e95bf7b,0x3dc9bf6d,0xbf623f55
.long 0xbe48bf35,0xbf553f6d,0xbf7b3f35,0x3f0e3ec4,0xbe953f6d,0x3f7fbf0e,0x3ef13ec4,0x3f46bf7b
.long 0x3f35bf80,0xbf350000,0x3f35bf80,0xbf350000,0xbf753f6d,0x3dc93f0e,0xbf623ec4,0xbf223f7b
.long 0x3f7bbf35,0x3f0ebf6d,0xbe483f35,0x3f55bec4,0xbf463ec4,0xbf753f7b,0x3f7fbf6d,0x3ef1bf55
.long 0x3ec40000,0x3f6dbf35,0xbec40000,0xbf6d3f35,0x3dc9bec4,0xbef13e48,0xbf463f6d,0xbe953f0e
.long 0xbf0e3f35,0xbe483ec4,0x3f55bf35,0x3f7bbf6d,0x3f62bf6d,0x3f46bf55,0x3e95bec4,0x3dc9be48
.long 0x3f803f80,0x3f803f80,0x3f803f80,0x3f803f80,0x3dc90000,0x3e953e48,0x3f463f35,0x3f623f55
.long 0xbf7bbf80,0xbf55bf6d,0x3e480000,0x3f0e3ec4,0xbe950000,0xbf46bf0e,0xbef1bf35,0x3dc9be48
.long 0x3f6d3f80,0x3ec43f35,0xbf6dbf80,0xbec4bf35,0x3ef10000,0x3f7f3f55,0xbf75bf35,0xbf46bf7b
.long 0xbf55bf80,0x3e48bec4,0xbf0e0000,0xbf7bbf6d,0xbf220000,0xbf62bf7b,0x3dc93f35,0xbf75bf0e
.long 0x3f353f80,0xbf350000,0x3f353f80,0xbf350000,0x3f460000,0x3ef13f7b,0x3f7f3f35,0xbe953f0e
.long 0xbf0ebf80,0x3f7b3ec4,0x3f550000,0x3e483f6d,0xbf620000,0x3dc9bf55,0x3e95bf35,0x3f223f7b
.long 0x3ec43f80,0xbf6dbf35,0xbec4bf80,0x3f6d3f35,0x3f750000,0xbf223f0e,0xbf62bf35,0x3f7f3e48
.long 0xbe48bf80,0x3f0e3f6d,0xbf7b0000,0x3f55bec4,0xbf7f0000,0x3f75be48,0xbf223f35,0x3ef1bf55
.long 0x3f80,0xbf80,0x3f80,0xbf80,0x3f7f0000,0xbf75be48,0x3f223f35,0xbef1bf55
.long 0x3e48bf80,0xbf0e3f6d,0x3f7b0000,0xbf55bec4,0xbf750000,0x3f223f0e,0x3f62bf35,0xbf7f3e48
.long 0xbec43f80,0x3f6dbf35,0x3ec4bf80,0xbf6d3f35,0x3f620000,0xbdc9bf55,0xbe95bf35,0xbf223f7b
.long 0x3f0ebf80,0xbf7b3ec4,0xbf550000,0xbe483f6d,0xbf460000,0xbef13f7b,0xbf7f3f35,0x3e953f0e
.long 0xbf353f80,0x3f350000,0xbf353f80,0x3f350000,0x3f220000,0x3f62bf7b,0xbdc93f35,0x3f75bf0e
.long 0x3f55bf80,0xbe48bec4,0x3f0e0000,0x3f7bbf6d,0xbef10000,0xbf7f3f55,0x3f75bf35,0x3f46bf7b
.long 0xbf6d3f80,0xbec43f35,0x3f6dbf80,0x3ec4bf35,0x3e950000,0x3f46bf0e,0x3ef1bf35,0xbdc9be48
.long 0x3f7bbf80,0x3f55bf6d,0xbe480000,0xbf0e3ec4,0xbdc90000,0xbe953e48,0xbf463f35,0xbf623f55
.long 0x3f803f80,0x3f803f80,0x3f803f80,0x3f803f80,0x3ef13ec4,0x3f223f0e,0x3f753f6d,0x3f7f3f7b
.long 0xbf0ebf35,0xbe48bec4,0x3f553f35,0x3f7b3f6d,0xbf7fbf6d,0xbf62bf7b,0x3f223ec4,0x3f753f55
.long 0xbec40000,0xbf6dbf35,0x3ec40000,0x3f6d3f35,0x3f223f6d,0xbe953e48,0x3dc9bec4,0x3f623f0e
.long 0x3f7b3f35,0x3f0e3f6d,0xbe48bf35,0x3f553ec4,0x3e95bec4,0x3f7f3f55,0xbef1bf6d,0x3f463e48
.long 0xbf35bf80,0x3f350000,0xbf35bf80,0x3f350000,0xbf75bec4,0xbdc9bf55,0xbf62bf6d,0x3f22be48
.long 0xbe483f35,0xbf55bf6d,0xbf7bbf35,0x3f0ebec4,0x3f463f6d,0xbf75be48,0xbf7fbec4,0x3ef1bf0e
.long 0x3f6d0000,0xbec43f35,0xbf6d0000,0x3ec4bf35,0x3dc9bf6d,0x3ef13f7b,0xbf463ec4,0x3e95bf55
.long 0xbf55bf35,0x3f7b3ec4,0xbf0e3f35,0x3e48bf6d,0xbf623ec4,0x3f46bf0e,0xbe953f6d,0x3dc9bf7b
.long 0x3f80,0xbf80,0x3f80,0xbf80,0x3f623ec4,0xbf46bf0e,0x3e953f6d,0xbdc9bf7b
.long 0x3f55bf35,0xbf7b3ec4,0x3f0e3f35,0xbe48bf6d,0xbdc9bf6d,0xbef13f7b,0x3f463ec4,0xbe95bf55
.long 0xbf6d0000,0x3ec43f35,0x3f6d0000,0xbec4bf35,0xbf463f6d,0x3f75be48,0x3f7fbec4,0xbef1bf0e
.long 0x3e483f35,0x3f55bf6d,0x3f7bbf35,0xbf0ebec4,0x3f75bec4,0x3dc9bf55,0x3f62bf6d,0xbf22be48
.long 0x3f35bf80,0xbf350000,0x3f35bf80,0xbf350000,0xbe95bec4,0xbf7f3f55,0x3ef1bf6d,0xbf463e48
.long 0xbf7b3f35,0xbf0e3f6d,0x3e48bf35,0xbf553ec4,0xbf223f6d,0x3e953e48,0xbdc9bec4,0xbf623f0e
.long 0x3ec40000,0x3f6dbf35,0xbec40000,0xbf6d3f35,0x3f7fbf6d,0x3f62bf7b,0xbf223ec4,0xbf753f55
.long 0x3f0ebf35,0x3e48bec4,0xbf553f35,0xbf7b3f6d,0xbef13ec4,0xbf223f0e,0xbf753f6d,0xbf7f3f7b
.long 0xbf803f80,0xbf803f80,0xbf803f80,0xbf803f80,0xbf7f3f80,0xbf753f7b,0xbf223f35,0xbef13f0e
.long 0xbf7b3f80,0xbf553f6d,0x3e480000,0x3f0ebec4,0xbf753f80,0xbf223f55,0x3f62bf35,0x3f7fbf7b
.long 0xbf6d3f80,0xbec43f35,0x3f6dbf80,0x3ec4bf35,0xbf623f80,0xbdc93f0e,0x3e95bf35,0xbf223e48
.long 0xbf553f80,0x3e483ec4,0xbf0e0000,0xbf7b3f6d,0xbf463f80,0x3ef13e48,0xbf7f3f35,0xbe953f55
.long 0xbf353f80,0x3f350000,0xbf353f80,0x3f350000,0xbf223f80,0x3f62be48,0x3dc93f35,0x3f75bf55
.long 0xbf0e3f80,0x3f7bbec4,0x3f550000,0x3e48bf6d,0xbef13f80,0x3f7fbf0e,0x3f75bf35,0xbf46be48
.long 0xbec43f80,0x3f6dbf35,0x3ec4bf80,0xbf6d3f35,0xbe953f80,0x3f46bf55,0xbef1bf35,0xbdc93f7b
.long 0xbe483f80,0x3f0ebf6d,0xbf7b0000,0x3f553ec4,0xbdc93f80,0x3e95bf7b,0xbf463f35,0x3f62bf0e
.long 0x3f80,0xbf80,0x3f80,0xbf80,0x3dc93f80,0xbe95bf7b,0x3f463f35,0xbf62bf0e
.long 0x3e483f80,0xbf0ebf6d,0x3f7b0000,0xbf553ec4,0x3e953f80,0xbf46bf55,0x3ef1bf35,0x3dc93f7b
.long 0x3ec43f80,0xbf6dbf35,0xbec4bf80,0x3f6d3f35,0x3ef13f80,0xbf7fbf0e,0xbf75bf35,0x3f46be48
.long 0x3f0e3f80,0xbf7bbec4,0xbf550000,0xbe48bf6d,0x3f223f80,0xbf62be48,0xbdc93f35,0xbf75bf55
.long 0x3f353f80,0xbf350000,0x3f353f80,0xbf350000,0x3f463f80,0xbef13e48,0x3f7f3f35,0x3e953f55
.long 0x3f553f80,0xbe483ec4,0x3f0e0000,0x3f7b3f6d,0x3f623f80,0x3dc93f0e,0xbe95bf35,0x3f223e48
.long 0x3f6d3f80,0x3ec43f35,0xbf6dbf80,0xbec4bf35,0x3f753f80,0x3f223f55,0xbf62bf35,0xbf7fbf7b
.long 0x3f7b3f80,0x3f553f6d,0xbe480000,0xbf0ebec4,0x3f7f3f80,0x3f753f7b,0x3f223f35,0x3ef13f0e
.long 0xbf803f80,0xbf803f80,0xbf803f80,0xbf803f80,0xbf623f6d,0xbf463f55,0xbe953ec4,0xbdc93e48
.long 0xbf0e3f35,0xbe483ec4,0x3f55bf35,0x3f7bbf6d,0xbdc93ec4,0x3ef1be48,0x3f46bf6d,0x3e95bf0e
.long 0x3ec40000,0x3f6dbf35,0xbec40000,0xbf6d3f35,0x3f46bec4,0x3f75bf7b,0xbf7f3f6d,0xbef13f55
.long 0x3f7bbf35,0x3f0ebf6d,0xbe483f35,0x3f55bec4,0x3f75bf6d,0xbdc9bf0e,0x3f62bec4,0x3f22bf7b
.long 0x3f35bf80,0xbf350000,0x3f35bf80,0xbf350000,0x3e95bf6d,0xbf7f3f0e,0xbef1bec4,0xbf463f7b
.long 0xbe48bf35,0xbf553f6d,0xbf7b3f35,0x3f0e3ec4,0xbf22bec4,0xbe953f7b,0xbdc93f6d,0x3f62bf55
.long 0xbf6d0000,0x3ec43f35,0x3f6d0000,0xbec4bf35,0xbf7f3ec4,0x3f623e48,0x3f22bf6d,0xbf753f0e
.long 0xbf553f35,0x3f7bbec4,0xbf0ebf35,0x3e483f6d,0xbef13f6d,0x3f22bf55,0xbf753ec4,0x3f7fbe48
.long 0x3f80,0xbf80,0x3f80,0xbf80,0x3ef13f6d,0xbf22bf55,0x3f753ec4,0xbf7fbe48
.long 0x3f553f35,0xbf7bbec4,0x3f0ebf35,0xbe483f6d,0x3f7f3ec4,0xbf623e48,0xbf22bf6d,0x3f753f0e
.long 0x3f6d0000,0xbec43f35,0xbf6d0000,0x3ec4bf35,0x3f22bec4,0x3e953f7b,0x3dc93f6d,0xbf62bf55
.long 0x3e48bf35,0x3f553f6d,0x3f7b3f35,0xbf0e3ec4,0xbe95bf6d,0x3f7f3f0e,0x3ef1bec4,0x3f463f7b
.long 0xbf35bf80,0x3f350000,0xbf35bf80,0x3f350000,0xbf75bf6d,0x3dc9bf0e,0xbf62bec4,0xbf22bf7b
.long 0xbf7bbf35,0xbf0ebf6d,0x3e483f35,0xbf55bec4,0xbf46bec4,0xbf75bf7b,0x3f7f3f6d,0x3ef13f55
.long 0xbec40000,0xbf6dbf35,0x3ec40000,0x3f6d3f35,0x3dc93ec4,0xbef1be48,0xbf46bf6d,0xbe95bf0e
.long 0x3f0e3f35,0x3e483ec4,0xbf55bf35,0xbf7bbf6d,0x3f623f6d,0x3f463f55,0x3e953ec4,0x3dc93e48
.long 0xbf803f80,0xbf803f80,0xbf803f80,0xbf803f80,0x3dc90000,0x3e95be48,0x3f46bf35,0x3f62bf55
.long 0x3f7bbf80,0x3f55bf6d,0xbe480000,0xbf0e3ec4,0xbe950000,0xbf463f0e,0xbef13f35,0x3dc93e48
.long 0xbf6d3f80,0xbec43f35,0x3f6dbf80,0x3ec4bf35,0x3ef10000,0x3f7fbf55,0xbf753f35,0xbf463f7b
.long 0x3f55bf80,0xbe48bec4,0x3f0e0000,0x3f7bbf6d,0xbf220000,0xbf623f7b,0x3dc9bf35,0xbf753f0e
.long 0xbf353f80,0x3f350000,0xbf353f80,0x3f350000,0x3f460000,0x3ef1bf7b,0x3f7fbf35,0xbe95bf0e
.long 0x3f0ebf80,0xbf7b3ec4,0xbf550000,0xbe483f6d,0xbf620000,0x3dc93f55,0x3e953f35,0x3f22bf7b
.long 0xbec43f80,0x3f6dbf35,0x3ec4bf80,0xbf6d3f35,0x3f750000,0xbf22bf0e,0xbf623f35,0x3f7fbe48
.long 0x3e48bf80,0xbf0e3f6d,0x3f7b0000,0xbf55bec4,0xbf7f0000,0x3f753e48,0xbf22bf35,0x3ef13f55
.long 0x3f80,0xbf80,0x3f80,0xbf80,0x3f7f0000,0xbf753e48,0x3f22bf35,0xbef13f55
.long 0xbe48bf80,0x3f0e3f6d,0xbf7b0000,0x3f55bec4,0xbf750000,0x3f22bf0e,0x3f623f35,0xbf7fbe48
.long 0x3ec43f80,0xbf6dbf35,0xbec4bf80,0x3f6d3f35,0x3f620000,0xbdc93f55,0xbe953f35,0xbf22bf7b
.long 0xbf0ebf80,0x3f7b3ec4,0x3f550000,0x3e483f6d,0xbf460000,0xbef1bf7b,0xbf7fbf35,0x3e95bf0e
.long 0x3f353f80,0xbf350000,0x3f353f80,0xbf350000,0x3f220000,0x3f623f7b,0xbdc9bf35,0x3f753f0e
.long 0xbf55bf80,0x3e48bec4,0xbf0e0000,0xbf7bbf6d,0xbef10000,0xbf7fbf55,0x3f753f35,0x3f463f7b
.long 0x3f6d3f80,0x3ec43f35,0xbf6dbf80,0xbec4bf35,0x3e950000,0x3f463f0e,0x3ef13f35,0xbdc93e48
.long 0xbf7bbf80,0xbf55bf6d,0x3e480000,0x3f0e3ec4,0xbdc90000,0xbe95be48,0xbf46bf35,0xbf62bf55
.long 0xbf803f80,0xbf803f80,0xbf803f80,0xbf803f80,0x3ef1bec4,0x3f22bf0e,0x3f75bf6d,0x3f7fbf7b
.long 0x3f0ebf35,0x3e48bec4,0xbf553f35,0xbf7b3f6d,0xbf7f3f6d,0xbf623f7b,0x3f22bec4,0x3f75bf55
.long 0x3ec40000,0x3f6dbf35,0xbec40000,0xbf6d3f35,0x3f22bf6d,0xbe95be48,0x3dc93ec4,0x3f62bf0e
.long 0xbf7b3f35,0xbf0e3f6d,0x3e48bf35,0xbf553ec4,0x3e953ec4,0x3f7fbf55,0xbef13f6d,0x3f46be48
.long 0x3f35bf80,0xbf350000,0x3f35bf80,0xbf350000,0xbf753ec4,0xbdc93f55,0xbf623f6d,0x3f223e48
.long 0x3e483f35,0x3f55bf6d,0x3f7bbf35,0xbf0ebec4,0x3f46bf6d,0xbf753e48,0xbf7f3ec4,0x3ef13f0e
.long 0xbf6d0000,0x3ec43f35,0x3f6d0000,0xbec4bf35,0x3dc93f6d,0x3ef1bf7b,0xbf46bec4,0x3e953f55
.long 0x3f55bf35,0xbf7b3ec4,0x3f0e3f35,0xbe48bf6d,0xbf62bec4,0x3f463f0e,0xbe95bf6d,0x3dc93f7b
.long 0x3f80,0xbf80,0x3f80,0xbf80,0x3f62bec4,0xbf463f0e,0x3e95bf6d,0xbdc93f7b
.long 0xbf55bf35,0x3f7b3ec4,0xbf0e3f35,0x3e48bf6d,0xbdc93f6d,0xbef1bf7b,0x3f46bec4,0xbe953f55
.long 0x3f6d0000,0xbec43f35,0xbf6d0000,0x3ec4bf35,0xbf46bf6d,0x3f753e48,0x3f7f3ec4,0xbef13f0e
.long 0xbe483f35,0xbf55bf6d,0xbf7bbf35,0x3f0ebec4,0x3f753ec4,0x3dc93f55,0x3f623f6d,0xbf223e48
.long 0xbf35bf80,0x3f350000,0xbf35bf80,0x3f350000,0xbe953ec4,0xbf7fbf55,0x3ef13f6d,0xbf46be48
.long 0x3f7b3f35,0x3f0e3f6d,0xbe48bf35,0x3f553ec4,0xbf22bf6d,0x3e95be48,0xbdc93ec4,0xbf62bf0e
.long 0xbec40000,0xbf6dbf35,0x3ec40000,0x3f6d3f35,0x3f7f3f6d,0x3f623f7b,0xbf22bec4,0xbf75bf55
.long 0xbf0ebf35,0xbe48bec4,0x3f553f35,0x3f7b3f6d,0xbef1bec4,0xbf22bf0e,0xbf75bf6d,0xbf7fbf7b
.long 0xbf803f80,0xbf803f80,0xbf803f80,0xbf803f80,0x3f7fbf80,0x3f75bf7b,0x3f22bf35,0x3ef1bf0e
.long 0xbf7b3f80,0xbf553f6d,0x3e480000,0x3f0ebec4,0x3f75bf80,0x3f22bf55,0xbf623f35,0xbf7f3f7b
.long 0xbf6d3f80,0xbec43f35,0x3f6dbf80,0x3ec4bf35,0x3f62bf80,0x3dc9bf0e,0xbe953f35,0x3f22be48
.long 0xbf553f80,0x3e483ec4,0xbf0e0000,0xbf7b3f6d,0x3f46bf80,0xbef1be48,0x3f7fbf35,0x3e95bf55
.long 0xbf353f80,0x3f350000,0xbf353f80,0x3f350000,0x3f22bf80,0xbf623e48,0xbdc9bf35,0xbf753f55
.long 0xbf0e3f80,0x3f7bbec4,0x3f550000,0x3e48bf6d,0x3ef1bf80,0xbf7f3f0e,0xbf753f35,0x3f463e48
.long 0xbec43f80,0x3f6dbf35,0x3ec4bf80,0xbf6d3f35,0x3e95bf80,0xbf463f55,0x3ef13f35,0x3dc9bf7b
.long 0xbe483f80,0x3f0ebf6d,0xbf7b0000,0x3f553ec4,0x3dc9bf80,0xbe953f7b,0x3f46bf35,0xbf623f0e
.long 0x3f80,0xbf80,0x3f80,0xbf80,0xbdc9bf80,0x3e953f7b,0xbf46bf35,0x3f623f0e
.long 0x3e483f80,0xbf0ebf6d,0x3f7b0000,0xbf553ec4,0xbe95bf80,0x3f463f55,0xbef13f35,0xbdc9bf7b
.long 0x3ec43f80,0xbf6dbf35,0xbec4bf80,0x3f6d3f35,0xbef1bf80,0x3f7f3f0e,0x3f753f35,0xbf463e48
.long 0x3f0e3f80,0xbf7bbec4,0xbf550000,0xbe48bf6d,0xbf22bf80,0x3f623e48,0x3dc9bf35,0x3f753f55
.long 0x3f353f80,0xbf350000,0x3f353f80,0xbf350000,0xbf46bf80,0x3ef1be48,0xbf7fbf35,0xbe95bf55
.long 0x3f553f80,0xbe483ec4,0x3f0e0000,0x3f7b3f6d,0xbf62bf80,0xbdc9bf0e,0x3e953f35,0xbf22be48
.long 0x3f6d3f80,0x3ec43f35,0xbf6dbf80,0xbec4bf35,0xbf75bf80,0xbf22bf55,0x3f623f35,0x3f7f3f7b
.long 0x3f7b3f80,0x3f553f6d,0xbe480000,0xbf0ebec4,0xbf7fbf80,0xbf75bf7b,0xbf22bf35,0xbef1bf0e
.long 0xbf803f80,0xbf803f80,0xbf803f80,0xbf803f80,0x3f62bf6d,0x3f46bf55,0x3e95bec4,0x3dc9be48
.long 0xbf0e3f35,0xbe483ec4,0x3f55bf35,0x3f7bbf6d,0x3dc9bec4,0xbef13e48,0xbf463f6d,0xbe953f0e
.long 0x3ec40000,0x3f6dbf35,0xbec40000,0xbf6d3f35,0xbf463ec4,0xbf753f7b,0x3f7fbf6d,0x3ef1bf55
.long 0x3f7bbf35,0x3f0ebf6d,0xbe483f35,0x3f55bec4,0xbf753f6d,0x3dc93f0e,0xbf623ec4,0xbf223f7b
.long 0x3f35bf80,0xbf350000,0x3f35bf80,0xbf350000,0xbe953f6d,0x3f7fbf0e,0x3ef13ec4,0x3f46bf7b
.long 0xbe48bf35,0xbf553f6d,0xbf7b3f35,0x3f0e3ec4,0x3f223ec4,0x3e95bf7b,0x3dc9bf6d,0xbf623f55
.long 0xbf6d0000,0x3ec43f35,0x3f6d0000,0xbec4bf35,0x3f7fbec4,0xbf62be48,0xbf223f6d,0x3f75bf0e
.long 0xbf553f35,0x3f7bbec4,0xbf0ebf35,0x3e483f6d,0x3ef1bf6d,0xbf223f55,0x3f75bec4,0xbf7f3e48
.long 0x3f80,0xbf80,0x3f80,0xbf80,0xbef1bf6d,0x3f223f55,0xbf75bec4,0x3f7f3e48
.long 0x3f553f35,0xbf7bbec4,0x3f0ebf35,0xbe483f6d,0xbf7fbec4,0x3f62be48,0x3f223f6d,0xbf75bf0e
.long 0x3f6d0000,0xbec43f35,0xbf6d0000,0x3ec4bf35,0xbf223ec4,0xbe95bf7b,0xbdc9bf6d,0x3f623f55
.long 0x3e48bf35,0x3f553f6d,0x3f7b3f35,0xbf0e3ec4,0x3e953f6d,0xbf7fbf0e,0xbef13ec4,0xbf46bf7b
.long 0xbf35bf80,0x3f350000,0xbf35bf80,0x3f350000,0x3f753f6d,0xbdc93f0e,0x3f623ec4,0x3f223f7b
.long 0xbf7bbf35,0xbf0ebf6d,0x3e483f35,0xbf55bec4,0x3f463ec4,0x3f753f7b,0xbf7fbf6d,0xbef1bf55
.long 0xbec40000,0xbf6dbf35,0x3ec40000,0x3f6d3f35,0xbdc9bec4,0x3ef13e48,0x3f463f6d,0x3e953f0e
.long 0x3f0e3f35,0x3e483ec4,0xbf55bf35,0xbf7bbf6d,0xbf62bf6d,0xbf46bf55,0xbe95bec4,0xbdc9be48
.long 0xbf803f80,0xbf803f80,0xbf803f80,0xbf803f80,0xbdc90000,0xbe953e48,0xbf463f35,0xbf623f55
.long 0x3f7bbf80,0x3f55bf6d,0xbe480000,0xbf0e3ec4,0x3e950000,0x3f46bf0e,0x3ef1bf35,0xbdc9be48
.long 0xbf6d3f80,0xbec43f35,0x3f6dbf80,0x3ec4bf35,0xbef10000,0xbf7f3f55,0x3f75bf35,0x3f46bf7b
.long 0x3f55bf80,0xbe48bec4,0x3f0e0000,0x3f7bbf6d,0x3f220000,0x3f62bf7b,0xbdc93f35,0x3f75bf0e
.long 0xbf353f80,0x3f350000,0xbf353f80,0x3f350000,0xbf460000,0xbef13f7b,0xbf7f3f35,0x3e953f0e
.long 0x3f0ebf80,0xbf7b3ec4,0xbf550000,0xbe483f6d,0x3f620000,0xbdc9bf55,0xbe95bf35,0xbf223f7b
.long 0xbec43f80,0x3f6dbf35,0x3ec4bf80,0xbf6d3f35,0xbf750000,0x3f223f0e,0x3f62bf35,0xbf7f3e48
.long 0x3e48bf80,0xbf0e3f6d,0x3f7b0000,0xbf55bec4,0x3f7f0000,0xbf75be48,0x3f223f35,0xbef1bf55
.long 0x3f80,0xbf80,0x3f80,0xbf80,0xbf7f0000,0x3f75be48,0xbf223f35,0x3ef1bf55
.long 0xbe48bf80,0x3f0e3f6d,0xbf7b0000,0x3f55bec4,0x3f750000,0xbf223f0e,0xbf62bf35,0x3f7f3e48
.long 0x3ec43f80,0xbf6dbf35,0xbec4bf80,0x3f6d3f35,0xbf620000,0x3dc9bf55,0x3e95bf35,0x3f223f7b
.long 0xbf0ebf80,0x3f7b3ec4,0x3f550000,0x3e483f6d,0x3f460000,0x3ef13f7b,0x3f7f3f35,0xbe953f0e
.long 0x3f353f80,0xbf350000,0x3f353f80,0xbf350000,0xbf220000,0xbf62bf7b,0x3dc93f35,0xbf75bf0e
.long 0xbf55bf80,0x3e48bec4,0xbf0e0000,0xbf7bbf6d,0x3ef10000,0x3f7f3f55,0xbf75bf35,0xbf46bf7b
.long 0x3f6d3f80,0x3ec43f35,0xbf6dbf80,0xbec4bf35,0xbe950000,0xbf46bf0e,0xbef1bf35,0x3dc9be48
.long 0xbf7bbf80,0xbf55bf6d,0x3e480000,0x3f0e3ec4,0x3dc90000,0x3e953e48,0x3f463f35,0x3f623f55
.long 0xbf803f80,0xbf803f80,0xbf803f80,0xbf803f80,0xbef13ec4,0xbf223f0e,0xbf753f6d,0xbf7f3f7b
.long 0x3f0ebf35,0x3e48bec4,0xbf553f35,0xbf7b3f6d,0x3f7fbf6d,0x3f62bf7b,0xbf223ec4,0xbf753f55
.long 0x3ec40000,0x3f6dbf35,0xbec40000,0xbf6d3f35,0xbf223f6d,0x3e953e48,0xbdc9bec4,0xbf623f0e
.long 0xbf7b3f35,0xbf0e3f6d,0x3e48bf35,0xbf553ec4,0xbe95bec4,0xbf7f3f55,0x3ef1bf6d,0xbf463e48
.long 0x3f35bf80,0xbf350000,0x3f35bf80,0xbf350000,0x3f75bec4,0x3dc9bf55,0x3f62bf6d,0xbf22be48
.long 0x3e483f35,0x3f55bf6d,0x3f7bbf35,0xbf0ebec4,0xbf463f6d,0x3f75be48,0x3f7fbec4,0xbef1bf0e
.long 0xbf6d0000,0x3ec43f35,0x3f6d0000,0xbec4bf35,0xbdc9bf6d,0xbef13f7b,0x3f463ec4,0xbe95bf55
.long 0x3f55bf35,0xbf7b3ec4,0x3f0e3f35,0xbe48bf6d,0x3f623ec4,0xbf46bf0e,0x3e953f6d,0xbdc9bf7b
.long 0x3f80,0xbf80,0x3f80,0xbf80,0xbf623ec4,0x3f46bf0e,0xbe953f6d,0x3dc9bf7b
.long 0xbf55bf35,0x3f7b3ec4,0xbf0e3f35,0x3e48bf6d,0x3dc9bf6d,0x3ef13f7b,0xbf463ec4,0x3e95bf55
.long 0x3f6d0000,0xbec43f35,0xbf6d0000,0x3ec4bf35,0x3f463f6d,0xbf75be48,0xbf7fbec4,0x3ef1bf0e
.long 0xbe483f35,0xbf55bf6d,0xbf7bbf35,0x3f0ebec4,0xbf75bec4,0xbdc9bf55,0xbf62bf6d,0x3f22be48
.long 0xbf35bf80,0x3f350000,0xbf35bf80,0x3f350000,0x3e95bec4,0x3f7f3f55,0xbef1bf6d,0x3f463e48
.long 0x3f7b3f35,0x3f0e3f6d,0xbe48bf35,0x3f553ec4,0x3f223f6d,0xbe953e48,0x3dc9bec4,0x3f623f0e
.long 0xbec40000,0xbf6dbf35,0x3ec40000,0x3f6d3f35,0xbf7fbf6d,0xbf62bf7b,0x3f223ec4,0x3f753f55
.long 0xbf0ebf35,0xbe48bec4,0x3f553f35,0x3f7b3f6d,0x3ef13ec4,0x3f223f0e,0x3f753f6d,0x3f7f3f7b
.long 0x0,0x0,0x0,0x0,0x3dc90000,0x3e953e48,0x3f463f35,0x3f623f55
.long 0x3e480000,0x3f0e3ec4,0x3f7b3f80,0x3f553f6d,0x3e950000,0x3f463f0e,0x3ef13f35,0xbdc93e48
.long 0x3ec40000,0x3f6d3f35,0xbec40000,0xbf6dbf35,0x3ef10000,0x3f7f3f55,0xbf75bf35,0xbf46bf7b
.long 0x3f0e0000,0x3f7b3f6d,0xbf55bf80,0x3e48bec4,0x3f220000,0x3f623f7b,0xbdc9bf35,0x3f753f0e
.long 0x3f350000,0x3f353f80,0x3f350000,0x3f353f80,0x3f460000,0x3ef13f7b,0x3f7f3f35,0xbe953f0e
.long 0x3f550000,0x3e483f6d,0x3f0e3f80,0xbf7bbec4,0x3f620000,0xbdc93f55,0xbe953f35,0xbf22bf7b
.long 0x3f6d0000,0xbec43f35,0xbf6d0000,0x3ec4bf35,0x3f750000,0xbf223f0e,0xbf62bf35,0x3f7f3e48
.long 0x3f7b0000,0xbf553ec4,0xbe48bf80,0x3f0e3f6d,0x3f7f0000,0xbf753e48,0x3f22bf35,0xbef13f55
.long 0x3f800000,0xbf800000,0x3f800000,0xbf800000,0x3f7f0000,0xbf75be48,0x3f223f35,0xbef1bf55
.long 0x3f7b0000,0xbf55bec4,0xbe483f80,0x3f0ebf6d,0x3f750000,0xbf22bf0e,0xbf623f35,0x3f7fbe48
.long 0x3f6d0000,0xbec4bf35,0xbf6d0000,0x3ec43f35,0x3f620000,0xbdc9bf55,0xbe95bf35,0xbf223f7b
.long 0x3f550000,0x3e48bf6d,0x3f0ebf80,0xbf7b3ec4,0x3f460000,0x3ef1bf7b,0x3f7fbf35,0xbe95bf0e
.long 0x3f350000,0x3f35bf80,0x3f350000,0x3f35bf80,0x3f220000,0x3f62bf7b,0xbdc93f35,0x3f75bf0e
.long 0x3f0e0000,0x3f7bbf6d,0xbf553f80,0x3e483ec4,0x3ef10000,0x3f7fbf55,0xbf753f35,0xbf463f7b
.long 0x3ec40000,0x3f6dbf35,0xbec40000,0xbf6d3f35,0x3e950000,0x3f46bf0e,0x3ef1bf35,0xbdc9be48
.long 0x3e480000,0x3f0ebec4,0x3f7bbf80,0x3f55bf6d,0x3dc90000,0x3e95be48,0x3f46bf35,0x3f62bf55
.long 0x0,0x0,0x0,0x0,0x3ef13ec4,0x3f223f0e,0x3f753f6d,0x3f7f3f7b
.long 0x3f553f35,0x3f7b3f6d,0x3f0e3f35,0x3e483ec4,0x3f7f3f6d,0x3f623f7b,0xbf22bec4,0xbf75bf55
.long 0x3f6d3f80,0x3ec43f35,0xbf6dbf80,0xbec4bf35,0x3f223f6d,0xbe953e48,0x3dc9bec4,0x3f623f0e
.long 0x3e483f35,0xbf55bec4,0x3f7b3f35,0x3f0e3f6d,0xbe953ec4,0xbf7fbf55,0x3ef13f6d,0xbf46be48
.long 0xbf350000,0xbf35bf80,0xbf350000,0xbf35bf80,0xbf75bec4,0xbdc9bf55,0xbf62bf6d,0x3f22be48
.long 0xbf7bbf35,0x3f0ebec4,0x3e48bf35,0x3f553f6d,0xbf46bf6d,0x3f753e48,0x3f7f3ec4,0xbef13f0e
.long 0xbec4bf80,0x3f6d3f35,0x3ec43f80,0xbf6dbf35,0x3dc9bf6d,0x3ef13f7b,0xbf463ec4,0x3e95bf55
.long 0x3f0ebf35,0xbe483f6d,0xbf55bf35,0x3f7b3ec4,0x3f62bec4,0xbf463f0e,0x3e95bf6d,0xbdc93f7b
.long 0x3f800000,0xbf800000,0x3f800000,0xbf800000,0x3f623ec4,0xbf46bf0e,0x3e953f6d,0xbdc9bf7b
.long 0x3f0e3f35,0xbe48bf6d,0xbf553f35,0x3f7bbec4,0x3dc93f6d,0x3ef1bf7b,0xbf46bec4,0x3e953f55
.long 0xbec43f80,0x3f6dbf35,0x3ec4bf80,0xbf6d3f35,0xbf463f6d,0x3f75be48,0x3f7fbec4,0xbef1bf0e
.long 0xbf7b3f35,0x3f0e3ec4,0x3e483f35,0x3f55bf6d,0xbf753ec4,0xbdc93f55,0xbf623f6d,0x3f223e48
.long 0xbf350000,0xbf353f80,0xbf350000,0xbf353f80,0xbe95bec4,0xbf7f3f55,0x3ef1bf6d,0xbf463e48
.long 0x3e48bf35,0xbf553ec4,0x3f7bbf35,0x3f0ebf6d,0x3f22bf6d,0xbe95be48,0x3dc93ec4,0x3f62bf0e
.long 0x3f6dbf80,0x3ec4bf35,0xbf6d3f80,0xbec43f35,0x3f7fbf6d,0x3f62bf7b,0xbf223ec4,0xbf753f55
.long 0x3f55bf35,0x3f7bbf6d,0x3f0ebf35,0x3e48bec4,0x3ef1bec4,0x3f22bf0e,0x3f75bf6d,0x3f7fbf7b
.long 0x0,0x0,0x0,0x0,0x3f7f3f80,0x3f753f7b,0x3f223f35,0x3ef13f0e
.long 0xbe480000,0xbf0ebec4,0xbf7bbf80,0xbf55bf6d,0xbf75bf80,0xbf22bf55,0x3f623f35,0x3f7f3f7b
.long 0x3ec40000,0x3f6d3f35,0xbec40000,0xbf6dbf35,0x3f623f80,0x3dc93f0e,0xbe95bf35,0x3f223e48
.long 0xbf0e0000,0xbf7bbf6d,0x3f553f80,0xbe483ec4,0xbf46bf80,0x3ef1be48,0xbf7fbf35,0xbe95bf55
.long 0x3f350000,0x3f353f80,0x3f350000,0x3f353f80,0x3f223f80,0xbf62be48,0xbdc93f35,0xbf75bf55
.long 0xbf550000,0xbe48bf6d,0xbf0ebf80,0x3f7b3ec4,0xbef1bf80,0x3f7f3f0e,0x3f753f35,0xbf463e48
.long 0x3f6d0000,0xbec43f35,0xbf6d0000,0x3ec4bf35,0x3e953f80,0xbf46bf55,0x3ef1bf35,0x3dc93f7b
.long 0xbf7b0000,0x3f55bec4,0x3e483f80,0xbf0ebf6d,0xbdc9bf80,0x3e953f7b,0xbf46bf35,0x3f623f0e
.long 0x3f800000,0xbf800000,0x3f800000,0xbf800000,0xbdc93f80,0x3e95bf7b,0xbf463f35,0x3f62bf0e
.long 0xbf7b0000,0x3f553ec4,0x3e48bf80,0xbf0e3f6d,0x3e95bf80,0xbf463f55,0x3ef13f35,0x3dc9bf7b
.long 0x3f6d0000,0xbec4bf35,0xbf6d0000,0x3ec43f35,0xbef13f80,0x3f7fbf0e,0x3f75bf35,0xbf46be48
.long 0xbf550000,0xbe483f6d,0xbf0e3f80,0x3f7bbec4,0x3f22bf80,0xbf623e48,0xbdc9bf35,0xbf753f55
.long 0x3f350000,0x3f35bf80,0x3f350000,0x3f35bf80,0xbf463f80,0x3ef13e48,0xbf7f3f35,0xbe953f55
.long 0xbf0e0000,0xbf7b3f6d,0x3f55bf80,0xbe48bec4,0x3f62bf80,0x3dc9bf0e,0xbe953f35,0x3f22be48
.long 0x3ec40000,0x3f6dbf35,0xbec40000,0xbf6d3f35,0xbf753f80,0xbf223f55,0x3f62bf35,0x3f7fbf7b
.long 0xbe480000,0xbf0e3ec4,0xbf7b3f80,0xbf553f6d,0x3f7fbf80,0x3f75bf7b,0x3f22bf35,0x3ef1bf0e
.long 0x0,0x0,0x0,0x0,0x3f623f6d,0x3f463f55,0x3e953ec4,0x3dc93e48
.long 0xbf55bf35,0xbf7bbf6d,0xbf0ebf35,0xbe48bec4,0xbdc9bec4,0x3ef13e48,0x3f463f6d,0x3e953f0e
.long 0x3f6d3f80,0x3ec43f35,0xbf6dbf80,0xbec4bf35,0xbf46bec4,0xbf75bf7b,0x3f7f3f6d,0x3ef13f55
.long 0xbe48bf35,0x3f553ec4,0xbf7bbf35,0xbf0ebf6d,0x3f753f6d,0xbdc93f0e,0x3f623ec4,0x3f223f7b
.long 0xbf350000,0xbf35bf80,0xbf350000,0xbf35bf80,0xbe95bf6d,0x3f7f3f0e,0x3ef1bec4,0x3f463f7b
.long 0x3f7b3f35,0xbf0e3ec4,0xbe483f35,0xbf55bf6d,0xbf223ec4,0xbe95bf7b,0xbdc9bf6d,0x3f623f55
.long 0xbec4bf80,0x3f6d3f35,0x3ec43f80,0xbf6dbf35,0x3f7f3ec4,0xbf623e48,0xbf22bf6d,0x3f753f0e
.long 0xbf0e3f35,0x3e48bf6d,0x3f553f35,0xbf7bbec4,0xbef1bf6d,0x3f223f55,0xbf75bec4,0x3f7f3e48
.long 0x3f800000,0xbf800000,0x3f800000,0xbf800000,0xbef13f6d,0x3f22bf55,0xbf753ec4,0x3f7fbe48
.long 0xbf0ebf35,0x3e483f6d,0x3f55bf35,0xbf7b3ec4,0x3f7fbec4,0xbf62be48,0xbf223f6d,0x3f75bf0e
.long 0xbec43f80,0x3f6dbf35,0x3ec4bf80,0xbf6d3f35,0xbf22bec4,0xbe953f7b,0xbdc93f6d,0x3f62bf55
.long 0x3f7bbf35,0xbf0ebec4,0xbe48bf35,0xbf553f6d,0xbe953f6d,0x3f7fbf0e,0x3ef13ec4,0x3f46bf7b
.long 0xbf350000,0xbf353f80,0xbf350000,0xbf353f80,0x3f75bf6d,0xbdc9bf0e,0x3f62bec4,0x3f22bf7b
.long 0xbe483f35,0x3f55bec4,0xbf7b3f35,0xbf0e3f6d,0xbf463ec4,0xbf753f7b,0x3f7fbf6d,0x3ef1bf55
.long 0x3f6dbf80,0x3ec4bf35,0xbf6d3f80,0xbec43f35,0xbdc93ec4,0x3ef1be48,0x3f46bf6d,0x3e95bf0e
.long 0xbf553f35,0xbf7b3f6d,0xbf0e3f35,0xbe483ec4,0x3f62bf6d,0x3f46bf55,0x3e95bec4,0x3dc9be48
.long 0x0,0x0,0x0,0x0,0xbdc90000,0xbe95be48,0xbf46bf35,0xbf62bf55
.long 0x3e480000,0x3f0e3ec4,0x3f7b3f80,0x3f553f6d,0xbe950000,0xbf46bf0e,0xbef1bf35,0x3dc9be48
.long 0x3ec40000,0x3f6d3f35,0xbec40000,0xbf6dbf35,0xbef10000,0xbf7fbf55,0x3f753f35,0x3f463f7b
.long 0x3f0e0000,0x3f7b3f6d,0xbf55bf80,0x3e48bec4,0xbf220000,0xbf62bf7b,0x3dc93f35,0xbf75bf0e
.long 0x3f350000,0x3f353f80,0x3f350000,0x3f353f80,0xbf460000,0xbef1bf7b,0xbf7fbf35,0x3e95bf0e
.long 0x3f550000,0x3e483f6d,0x3f0e3f80,0xbf7bbec4,0xbf620000,0x3dc9bf55,0x3e95bf35,0x3f223f7b
.long 0x3f6d0000,0xbec43f35,0xbf6d0000,0x3ec4bf35,0xbf750000,0x3f22bf0e,0x3f623f35,0xbf7fbe48
.long 0x3f7b0000,0xbf553ec4,0xbe48bf80,0x3f0e3f6d,0xbf7f0000,0x3f75be48,0xbf223f35,0x3ef1bf55
.long 0x3f800000,0xbf800000,0x3f800000,0xbf800000,0xbf7f0000,0x3f753e48,0xbf22bf35,0x3ef13f55
.long 0x3f7b0000,0xbf55bec4,0xbe483f80,0x3f0ebf6d,0xbf750000,0x3f223f0e,0x3f62bf35,0xbf7f3e48
.long 0x3f6d0000,0xbec4bf35,0xbf6d0000,0x3ec43f35,0xbf620000,0x3dc93f55,0x3e953f35,0x3f22bf7b
.long 0x3f550000,0x3e48bf6d,0x3f0ebf80,0xbf7b3ec4,0xbf460000,0xbef13f7b,0xbf7f3f35,0x3e953f0e
.long 0x3f350000,0x3f35bf80,0x3f350000,0x3f35bf80,0xbf220000,0xbf623f7b,0x3dc9bf35,0xbf753f0e
.long 0x3f0e0000,0x3f7bbf6d,0xbf553f80,0x3e483ec4,0xbef10000,0xbf7f3f55,0x3f75bf35,0x3f46bf7b
.long 0x3ec40000,0x3f6dbf35,0xbec40000,0xbf6d3f35,0xbe950000,0xbf463f0e,0xbef13f35,0x3dc93e48
.long 0x3e480000,0x3f0ebec4,0x3f7bbf80,0x3f55bf6d,0xbdc90000,0xbe953e48,0xbf463f35,0xbf623f55
.long 0x0,0x0,0x0,0x0,0xbef1bec4,0xbf22bf0e,0xbf75bf6d,0xbf7fbf7b
.long 0x3f553f35,0x3f7b3f6d,0x3f0e3f35,0x3e483ec4,0xbf7fbf6d,0xbf62bf7b,0x3f223ec4,0x3f753f55
.long 0x3f6d3f80,0x3ec43f35,0xbf6dbf80,0xbec4bf35,0xbf22bf6d,0x3e95be48,0xbdc93ec4,0xbf62bf0e
.long 0x3e483f35,0xbf55bec4,0x3f7b3f35,0x3f0e3f6d,0x3e95bec4,0x3f7f3f55,0xbef1bf6d,0x3f463e48
.long 0xbf350000,0xbf35bf80,0xbf350000,0xbf35bf80,0x3f753ec4,0x3dc93f55,0x3f623f6d,0xbf223e48
.long 0xbf7bbf35,0x3f0ebec4,0x3e48bf35,0x3f553f6d,0x3f463f6d,0xbf75be48,0xbf7fbec4,0x3ef1bf0e
.long 0xbec4bf80,0x3f6d3f35,0x3ec43f80,0xbf6dbf35,0xbdc93f6d,0xbef1bf7b,0x3f46bec4,0xbe953f55
.long 0x3f0ebf35,0xbe483f6d,0xbf55bf35,0x3f7b3ec4,0xbf623ec4,0x3f46bf0e,0xbe953f6d,0x3dc9bf7b
.long 0x3f800000,0xbf800000,0x3f800000,0xbf800000,0xbf62bec4,0x3f463f0e,0xbe95bf6d,0x3dc93f7b
.long 0x3f0e3f35,0xbe48bf6d,0xbf553f35,0x3f7bbec4,0xbdc9bf6d,0xbef13f7b,0x3f463ec4,0xbe95bf55
.long 0xbec43f80,0x3f6dbf35,0x3ec4bf80,0xbf6d3f35,0x3f46bf6d,0xbf753e48,0xbf7f3ec4,0x3ef13f0e
.long 0xbf7b3f35,0x3f0e3ec4,0x3e483f35,0x3f55bf6d,0x3f75bec4,0x3dc9bf55,0x3f62bf6d,0xbf22be48
.long 0xbf350000,0xbf353f80,0xbf350000,0xbf353f80,0x3e953ec4,0x3f7fbf55,0xbef13f6d,0x3f46be48
.long 0x3e48bf35,0xbf553ec4,0x3f7bbf35,0x3f0ebf6d,0xbf223f6d,0x3e953e48,0xbdc9bec4,0xbf623f0e
.long 0x3f6dbf80,0x3ec4bf35,0xbf6d3f80,0xbec43f35,0xbf7f3f6d,0xbf623f7b,0x3f22bec4,0x3f75bf55
.long 0x3f55bf35,0x3f7bbf6d,0x3f0ebf35,0x3e48bec4,0xbef13ec4,0xbf223f0e,0xbf753f6d,0xbf7f3f7b
.long 0x0,0x0,0x0,0x0,0xbf7fbf80,0xbf75bf7b,0xbf22bf35,0xbef1bf0e
.long 0xbe480000,0xbf0ebec4,0xbf7bbf80,0xbf55bf6d,0x3f753f80,0x3f223f55,0xbf62bf35,0xbf7fbf7b
.long 0x3ec40000,0x3f6d3f35,0xbec40000,0xbf6dbf35,0xbf62bf80,0xbdc9bf0e,0x3e953f35,0xbf22be48
.long 0xbf0e0000,0xbf7bbf6d,0x3f553f80,0xbe483ec4,0x3f463f80,0xbef13e48,0x3f7f3f35,0x3e953f55
.long 0x3f350000,0x3f353f80,0x3f350000,0x3f353f80,0xbf22bf80,0x3f623e48,0x3dc9bf35,0x3f753f55
.long 0xbf550000,0xbe48bf6d,0xbf0ebf80,0x3f7b3ec4,0x3ef13f80,0xbf7fbf0e,0xbf75bf35,0x3f46be48
.long 0x3f6d0000,0xbec43f35,0xbf6d0000,0x3ec4bf35,0xbe95bf80,0x3f463f55,0xbef13f35,0xbdc9bf7b
.long 0xbf7b0000,0x3f55bec4,0x3e483f80,0xbf0ebf6d,0x3dc93f80,0xbe95bf7b,0x3f463f35,0xbf62bf0e
.long 0x3f800000,0xbf800000,0x3f800000,0xbf800000,0x3dc9bf80,0xbe953f7b,0x3f46bf35,0xbf623f0e
.long 0xbf7b0000,0x3f553ec4,0x3e48bf80,0xbf0e3f6d,0xbe953f80,0x3f46bf55,0xbef1bf35,0xbdc93f7b
.long 0x3f6d0000,0xbec4bf35,0xbf6d0000,0x3ec43f35,0x3ef1bf80,0xbf7f3f0e,0xbf753f35,0x3f463e48
.long 0xbf550000,0xbe483f6d,0xbf0e3f80,0x3f7bbec4,0xbf223f80,0x3f62be48,0x3dc93f35,0x3f75bf55
.long 0x3f350000,0x3f35bf80,0x3f350000,0x3f35bf80,0x3f46bf80,0xbef1be48,0x3f7fbf35,0x3e95bf55
.long 0xbf0e0000,0xbf7b3f6d,0x3f55bf80,0xbe48bec4,0xbf623f80,0xbdc93f0e,0x3e95bf35,0xbf223e48
.long 0x3ec40000,0x3f6dbf35,0xbec40000,0xbf6d3f35,0x3f75bf80,0x3f22bf55,0xbf623f35,0xbf7f3f7b
.long 0xbe480000,0xbf0e3ec4,0xbf7b3f80,0xbf553f6d,0xbf7f3f80,0xbf753f7b,0xbf223f35,0xbef13f0e
.long 0x0,0x0,0x0,0x0,0xbf62bf6d,0xbf46bf55,0xbe95bec4,0xbdc9be48
.long 0xbf55bf35,0xbf7bbf6d,0xbf0ebf35,0xbe48bec4,0x3dc93ec4,0xbef1be48,0xbf46bf6d,0xbe95bf0e
.long 0x3f6d3f80,0x3ec43f35,0xbf6dbf80,0xbec4bf35,0x3f463ec4,0x3f753f7b,0xbf7fbf6d,0xbef1bf55
.long 0xbe48bf35,0x3f553ec4,0xbf7bbf35,0xbf0ebf6d,0xbf75bf6d,0x3dc9bf0e,0xbf62bec4,0xbf22bf7b
.long 0xbf350000,0xbf35bf80,0xbf350000,0xbf35bf80,0x3e953f6d,0xbf7fbf0e,0xbef13ec4,0xbf46bf7b
.long 0x3f7b3f35,0xbf0e3ec4,0xbe483f35,0xbf55bf6d,0x3f22bec4,0x3e953f7b,0x3dc93f6d,0xbf62bf55
.long 0xbec4bf80,0x3f6d3f35,0x3ec43f80,0xbf6dbf35,0xbf7fbec4,0x3f62be48,0x3f223f6d,0xbf75bf0e
.long 0xbf0e3f35,0x3e48bf6d,0x3f553f35,0xbf7bbec4,0x3ef13f6d,0xbf22bf55,0x3f753ec4,0xbf7fbe48
.long 0x3f800000,0xbf800000,0x3f800000,0xbf800000,0x3ef1bf6d,0xbf223f55,0x3f75bec4,0xbf7f3e48
.long 0xbf0ebf35,0x3e483f6d,0x3f55bf35,0xbf7b3ec4,0xbf7f3ec4,0x3f623e48,0x3f22bf6d,0xbf753f0e
.long 0xbec43f80,0x3f6dbf35,0x3ec4bf80,0xbf6d3f35,0x3f223ec4,0x3e95bf7b,0x3dc9bf6d,0xbf623f55
.long 0x3f7bbf35,0xbf0ebec4,0xbe48bf35,0xbf553f6d,0x3e95bf6d,0xbf7f3f0e,0xbef1bec4,0xbf463f7b
.long 0xbf350000,0xbf353f80,0xbf350000,0xbf353f80,0xbf753f6d,0x3dc93f0e,0xbf623ec4,0xbf223f7b
.long 0xbe483f35,0x3f55bec4,0xbf7b3f35,0xbf0e3f6d,0x3f46bec4,0x3f75bf7b,0xbf7f3f6d,0xbef13f55
.long 0x3f6dbf80,0x3ec4bf35,0xbf6d3f80,0xbec43f35,0x3dc9bec4,0xbef13e48,0xbf463f6d,0xbe953f0e
.long 0xbf553f35,0xbf7b3f6d,0xbf0e3f35,0xbe483ec4,0xbf623f6d,0xbf463f55,0xbe953ec4,0xbdc93e48
.long 0x0,0x0,0x0,0x0,0xbdc90000,0xbe953e48,0xbf463f35,0xbf623f55
.long 0xbe480000,0xbf0e3ec4,0xbf7b3f80,0xbf553f6d,0xbe950000,0xbf463f0e,0xbef13f35,0x3dc93e48
.long 0xbec40000,0xbf6d3f35,0x3ec40000,0x3f6dbf35,0xbef10000,0xbf7f3f55,0x3f75bf35,0x3f46bf7b
.long 0xbf0e0000,0xbf7b3f6d,0x3f55bf80,0xbe48bec4,0xbf220000,0xbf623f7b,0x3dc9bf35,0xbf753f0e
.long 0xbf350000,0xbf353f80,0xbf350000,0xbf353f80,0xbf460000,0xbef13f7b,0xbf7f3f35,0x3e953f0e
.long 0xbf550000,0xbe483f6d,0xbf0e3f80,0x3f7bbec4,0xbf620000,0x3dc93f55,0x3e953f35,0x3f22bf7b
.long 0xbf6d0000,0x3ec43f35,0x3f6d0000,0xbec4bf35,0xbf750000,0x3f223f0e,0x3f62bf35,0xbf7f3e48
.long 0xbf7b0000,0x3f553ec4,0x3e48bf80,0xbf0e3f6d,0xbf7f0000,0x3f753e48,0xbf22bf35,0x3ef13f55
.long 0xbf800000,0x3f800000,0xbf800000,0x3f800000,0xbf7f0000,0x3f75be48,0xbf223f35,0x3ef1bf55
.long 0xbf7b0000,0x3f55bec4,0x3e483f80,0xbf0ebf6d,0xbf750000,0x3f22bf0e,0x3f623f35,0xbf7fbe48
.long 0xbf6d0000,0x3ec4bf35,0x3f6d0000,0xbec43f35,0xbf620000,0x3dc9bf55,0x3e95bf35,0x3f223f7b
.long 0xbf550000,0xbe48bf6d,0xbf0ebf80,0x3f7b3ec4,0xbf460000,0xbef1bf7b,0xbf7fbf35,0x3e95bf0e
.long 0xbf350000,0xbf35bf80,0xbf350000,0xbf35bf80,0xbf220000,0xbf62bf7b,0x3dc93f35,0xbf75bf0e
.long 0xbf0e0000,0xbf7bbf6d,0x3f553f80,0xbe483ec4,0xbef10000,0xbf7fbf55,0x3f753f35,0x3f463f7b
.long 0xbec40000,0xbf6dbf35,0x3ec40000,0x3f6d3f35,0xbe950000,0xbf46bf0e,0xbef1bf35,0x3dc9be48
.long 0xbe480000,0xbf0ebec4,0xbf7bbf80,0xbf55bf6d,0xbdc90000,0xbe95be48,0xbf46bf35,0xbf62bf55
.long 0x0,0x0,0x0,0x0,0xbef13ec4,0xbf223f0e,0xbf753f6d,0xbf7f3f7b
.long 0xbf553f35,0xbf7b3f6d,0xbf0e3f35,0xbe483ec4,0xbf7f3f6d,0xbf623f7b,0x3f22bec4,0x3f75bf55
.long 0xbf6d3f80,0xbec43f35,0x3f6dbf80,0x3ec4bf35,0xbf223f6d,0x3e953e48,0xbdc9bec4,0xbf623f0e
.long 0xbe483f35,0x3f55bec4,0xbf7b3f35,0xbf0e3f6d,0x3e953ec4,0x3f7fbf55,0xbef13f6d,0x3f46be48
.long 0x3f350000,0x3f35bf80,0x3f350000,0x3f35bf80,0x3f75bec4,0x3dc9bf55,0x3f62bf6d,0xbf22be48
.long 0x3f7bbf35,0xbf0ebec4,0xbe48bf35,0xbf553f6d,0x3f46bf6d,0xbf753e48,0xbf7f3ec4,0x3ef13f0e
.long 0x3ec4bf80,0xbf6d3f35,0xbec43f80,0x3f6dbf35,0xbdc9bf6d,0xbef13f7b,0x3f463ec4,0xbe95bf55
.long 0xbf0ebf35,0x3e483f6d,0x3f55bf35,0xbf7b3ec4,0xbf62bec4,0x3f463f0e,0xbe95bf6d,0x3dc93f7b
.long 0xbf800000,0x3f800000,0xbf800000,0x3f800000,0xbf623ec4,0x3f46bf0e,0xbe953f6d,0x3dc9bf7b
.long 0xbf0e3f35,0x3e48bf6d,0x3f553f35,0xbf7bbec4,0xbdc93f6d,0xbef1bf7b,0x3f46bec4,0xbe953f55
.long 0x3ec43f80,0xbf6dbf35,0xbec4bf80,0x3f6d3f35,0x3f463f6d,0xbf75be48,0xbf7fbec4,0x3ef1bf0e
.long 0x3f7b3f35,0xbf0e3ec4,0xbe483f35,0xbf55bf6d,0x3f753ec4,0x3dc93f55,0x3f623f6d,0xbf223e48
.long 0x3f350000,0x3f353f80,0x3f350000,0x3f353f80,0x3e95bec4,0x3f7f3f55,0xbef1bf6d,0x3f463e48
.long 0xbe48bf35,0x3f553ec4,0xbf7bbf35,0xbf0ebf6d,0xbf22bf6d,0x3e95be48,0xbdc93ec4,0xbf62bf0e
.long 0xbf6dbf80,0xbec4bf35,0x3f6d3f80,0x3ec43f35,0xbf7fbf6d,0xbf62bf7b,0x3f223ec4,0x3f753f55
.long 0xbf55bf35,0xbf7bbf6d,0xbf0ebf35,0xbe48bec4,0xbef1bec4,0xbf22bf0e,0xbf75bf6d,0xbf7fbf7b
.long 0x0,0x0,0x0,0x0,0xbf7f3f80,0xbf753f7b,0xbf223f35,0xbef13f0e
.long 0x3e480000,0x3f0ebec4,0x3f7bbf80,0x3f55bf6d,0x3f75bf80,0x3f22bf55,0xbf623f35,0xbf7f3f7b
.long 0xbec40000,0xbf6d3f35,0x3ec40000,0x3f6dbf35,0xbf623f80,0xbdc93f0e,0x3e95bf35,0xbf223e48
.long 0x3f0e0000,0x3f7bbf6d,0xbf553f80,0x3e483ec4,0x3f46bf80,0xbef1be48,0x3f7fbf35,0x3e95bf55
.long 0xbf350000,0xbf353f80,0xbf350000,0xbf353f80,0xbf223f80,0x3f62be48,0x3dc93f35,0x3f75bf55
.long 0x3f550000,0x3e48bf6d,0x3f0ebf80,0xbf7b3ec4,0x3ef1bf80,0xbf7f3f0e,0xbf753f35,0x3f463e48
.long 0xbf6d0000,0x3ec43f35,0x3f6d0000,0xbec4bf35,0xbe953f80,0x3f46bf55,0xbef1bf35,0xbdc93f7b
.long 0x3f7b0000,0xbf55bec4,0xbe483f80,0x3f0ebf6d,0x3dc9bf80,0xbe953f7b,0x3f46bf35,0xbf623f0e
.long 0xbf800000,0x3f800000,0xbf800000,0x3f800000,0x3dc93f80,0xbe95bf7b,0x3f463f35,0xbf62bf0e
.long 0x3f7b0000,0xbf553ec4,0xbe48bf80,0x3f0e3f6d,0xbe95bf80,0x3f463f55,0xbef13f35,0xbdc9bf7b
.long 0xbf6d0000,0x3ec4bf35,0x3f6d0000,0xbec43f35,0x3ef13f80,0xbf7fbf0e,0xbf75bf35,0x3f46be48
.long 0x3f550000,0x3e483f6d,0x3f0e3f80,0xbf7bbec4,0xbf22bf80,0x3f623e48,0x3dc9bf35,0x3f753f55
.long 0xbf350000,0xbf35bf80,0xbf350000,0xbf35bf80,0x3f463f80,0xbef13e48,0x3f7f3f35,0x3e953f55
.long 0x3f0e0000,0x3f7b3f6d,0xbf55bf80,0x3e48bec4,0xbf62bf80,0xbdc9bf0e,0x3e953f35,0xbf22be48
.long 0xbec40000,0xbf6dbf35,0x3ec40000,0x3f6d3f35,0x3f753f80,0x3f223f55,0xbf62bf35,0xbf7fbf7b
.long 0x3e480000,0x3f0e3ec4,0x3f7b3f80,0x3f553f6d,0xbf7fbf80,0xbf75bf7b,0xbf22bf35,0xbef1bf0e
.long 0x0,0x0,0x0,0x0,0xbf623f6d,0xbf463f55,0xbe953ec4,0xbdc93e48
.long 0x3f55bf35,0x3f7bbf6d,0x3f0ebf35,0x3e48bec4,0x3dc9bec4,0xbef13e48,0xbf463f6d,0xbe953f0e
.long 0xbf6d3f80,0xbec43f35,0x3f6dbf80,0x3ec4bf35,0x3f46bec4,0x3f75bf7b,0xbf7f3f6d,0xbef13f55
.long 0x3e48bf35,0xbf553ec4,0x3f7bbf35,0x3f0ebf6d,0xbf753f6d,0x3dc93f0e,0xbf623ec4,0xbf223f7b
.long 0x3f350000,0x3f35bf80,0x3f350000,0x3f35bf80,0x3e95bf6d,0xbf7f3f0e,0xbef1bec4,0xbf463f7b
.long 0xbf7b3f35,0x3f0e3ec4,0x3e483f35,0x3f55bf6d,0x3f223ec4,0x3e95bf7b,0x3dc9bf6d,0xbf623f55
.long 0x3ec4bf80,0xbf6d3f35,0xbec43f80,0x3f6dbf35,0xbf7f3ec4,0x3f623e48,0x3f22bf6d,0xbf753f0e
.long 0x3f0e3f35,0xbe48bf6d,0xbf553f35,0x3f7bbec4,0x3ef1bf6d,0xbf223f55,0x3f75bec4,0xbf7f3e48
.long 0xbf800000,0x3f800000,0xbf800000,0x3f800000,0x3ef13f6d,0xbf22bf55,0x3f753ec4,0xbf7fbe48
.long 0x3f0ebf35,0xbe483f6d,0xbf55bf35,0x3f7b3ec4,0xbf7fbec4,0x3f62be48,0x3f223f6d,0xbf75bf0e
.long 0x3ec43f80,0xbf6dbf35,0xbec4bf80,0x3f6d3f35,0x3f22bec4,0x3e953f7b,0x3dc93f6d,0xbf62bf55
.long 0xbf7bbf35,0x3f0ebec4,0x3e48bf35,0x3f553f6d,0x3e953f6d,0xbf7fbf0e,0xbef13ec4,0xbf46bf7b
.long 0x3f350000,0x3f353f80,0x3f350000,0x3f353f80,0xbf75bf6d,0x3dc9bf0e,0xbf62bec4,0xbf22bf7b
.long 0x3e483f35,0xbf55bec4,0x3f7b3f35,0x3f0e3f6d,0x3f463ec4,0x3f753f7b,0xbf7fbf6d,0xbef1bf55
.long 0xbf6dbf80,0xbec4bf35,0x3f6d3f80,0x3ec43f35,0x3dc93ec4,0xbef1be48,0xbf46bf6d,0xbe95bf0e
.long 0x3f553f35,0x3f7b3f6d,0x3f0e3f35,0x3e483ec4,0xbf62bf6d,0xbf46bf55,0xbe95bec4,0xbdc9be48
.long 0x0,0x0,0x0,0x0,0x3dc90000,0x3e95be48,0x3f46bf35,0x3f62bf55
.long 0xbe480000,0xbf0e3ec4,0xbf7b3f80,0xbf553f6d,0x3e950000,0x3f46bf0e,0x3ef1bf35,0xbdc9be48
.long 0xbec40000,0xbf6d3f35,0x3ec40000,0x3f6dbf35,0x3ef10000,0x3f7fbf55,0xbf753f35,0xbf463f7b
.long 0xbf0e0000,0xbf7b3f6d,0x3f55bf80,0xbe48bec4,0x3f220000,0x3f62bf7b,0xbdc93f35,0x3f75bf0e
.long 0xbf350000,0xbf353f80,0xbf350000,0xbf353f80,0x3f460000,0x3ef1bf7b,0x3f7fbf35,0xbe95bf0e
.long 0xbf550000,0xbe483f6d,0xbf0e3f80,0x3f7bbec4,0x3f620000,0xbdc9bf55,0xbe95bf35,0xbf223f7b
.long 0xbf6d0000,0x3ec43f35,0x3f6d0000,0xbec4bf35,0x3f750000,0xbf22bf0e,0xbf623f35,0x3f7fbe48
.long 0xbf7b0000,0x3f553ec4,0x3e48bf80,0xbf0e3f6d,0x3f7f0000,0xbf75be48,0x3f223f35,0xbef1bf55
.long 0xbf800000,0x3f800000,0xbf800000,0x3f800000,0x3f7f0000,0xbf753e48,0x3f22bf35,0xbef13f55
.long 0xbf7b0000,0x3f55bec4,0x3e483f80,0xbf0ebf6d,0x3f750000,0xbf223f0e,0xbf62bf35,0x3f7f3e48
.long 0xbf6d0000,0x3ec4bf35,0x3f6d0000,0xbec43f35,0x3f620000,0xbdc93f55,0xbe953f35,0xbf22bf7b
.long 0xbf550000,0xbe48bf6d,0xbf0ebf80,0x3f7b3ec4,0x3f460000,0x3ef13f7b,0x3f7f3f35,0xbe953f0e
.long 0xbf350000,0xbf35bf80,0xbf350000,0xbf35bf80,0x3f220000,0x3f623f7b,0xbdc9bf35,0x3f753f0e
.long 0xbf0e0000,0xbf7bbf6d,0x3f553f80,0xbe483ec4,0x3ef10000,0x3f7f3f55,0xbf75bf35,0xbf46bf7b
.long 0xbec40000,0xbf6dbf35,0x3ec40000,0x3f6d3f35,0x3e950000,0x3f463f0e,0x3ef13f35,0xbdc93e48
.long 0xbe480000,0xbf0ebec4,0xbf7bbf80,0xbf55bf6d,0x3dc90000,0x3e953e48,0x3f463f35,0x3f623f55
.long 0x0,0x0,0x0,0x0,0x3ef1bec4,0x3f22bf0e,0x3f75bf6d,0x3f7fbf7b
.long 0xbf553f35,0xbf7b3f6d,0xbf0e3f35,0xbe483ec4,0x3f7fbf6d,0x3f62bf7b,0xbf223ec4,0xbf753f55
.long 0xbf6d3f80,0xbec43f35,0x3f6dbf80,0x3ec4bf35,0x3f22bf6d,0xbe95be48,0x3dc93ec4,0x3f62bf0e
.long 0xbe483f35,0x3f55bec4,0xbf7b3f35,0xbf0e3f6d,0xbe95bec4,0xbf7f3f55,0x3ef1bf6d,0xbf463e48
.long 0x3f350000,0x3f35bf80,0x3f350000,0x3f35bf80,0xbf753ec4,0xbdc93f55,0xbf623f6d,0x3f223e48
.long 0x3f7bbf35,0xbf0ebec4,0xbe48bf35,0xbf553f6d,0xbf463f6d,0x3f75be48,0x3f7fbec4,0xbef1bf0e
.long 0x3ec4bf80,0xbf6d3f35,0xbec43f80,0x3f6dbf35,0x3dc93f6d,0x3ef1bf7b,0xbf46bec4,0x3e953f55
.long 0xbf0ebf35,0x3e483f6d,0x3f55bf35,0xbf7b3ec4,0x3f623ec4,0xbf46bf0e,0x3e953f6d,0xbdc9bf7b
.long 0xbf800000,0x3f800000,0xbf800000,0x3f800000,0x3f62bec4,0xbf463f0e,0x3e95bf6d,0xbdc93f7b
.long 0xbf0e3f35,0x3e48bf6d,0x3f553f35,0xbf7bbec4,0x3dc9bf6d,0x3ef13f7b,0xbf463ec4,0x3e95bf55
.long 0x3ec43f80,0xbf6dbf35,0xbec4bf80,0x3f6d3f35,0xbf46bf6d,0x3f753e48,0x3f7f3ec4,0xbef13f0e
.long 0x3f7b3f35,0xbf0e3ec4,0xbe483f35,0xbf55bf6d,0xbf75bec4,0xbdc9bf55,0xbf62bf6d,0x3f22be48
.long 0x3f350000,0x3f353f80,0x3f350000,0x3f353f80,0xbe953ec4,0xbf7fbf55,0x3ef13f6d,0xbf46be48
.long 0xbe48bf35,0x3f553ec4,0xbf7bbf35,0xbf0ebf6d,0x3f223f6d,0xbe953e48,0x3dc9bec4,0x3f623f0e
.long 0xbf6dbf80,0xbec4bf35,0x3f6d3f80,0x3ec43f35,0x3f7f3f6d,0x3f623f7b,0xbf22bec4,0xbf75bf55
.long 0xbf55bf35,0xbf7bbf6d,0xbf0ebf35,0xbe48bec4,0x3ef13ec4,0x3f223f0e,0x3f753f6d,0x3f7f3f7b
.long 0x0,0x0,0x0,0x0,0x3f7fbf80,0x3f75bf7b,0x3f22bf35,0x3ef1bf0e
.long 0x3e480000,0x3f0ebec4,0x3f7bbf80,0x3f55bf6d,0xbf753f80,0xbf223f55,0x3f62bf35,0x3f7fbf7b
.long 0xbec40000,0xbf6d3f35,0x3ec40000,0x3f6dbf35,0x3f62bf80,0x3dc9bf0e,0xbe953f35,0x3f22be48
.long 0x3f0e0000,0x3f7bbf6d,0xbf553f80,0x3e483ec4,0xbf463f80,0x3ef13e48,0xbf7f3f35,0xbe953f55
.long 0xbf350000,0xbf353f80,0xbf350000,0xbf353f80,0x3f22bf80,0xbf623e48,0xbdc9bf35,0xbf753f55
.long 0x3f550000,0x3e48bf6d,0x3f0ebf80,0xbf7b3ec4,0xbef13f80,0x3f7fbf0e,0x3f75bf35,0xbf46be48
.long 0xbf6d0000,0x3ec43f35,0x3f6d0000,0xbec4bf35,0x3e95bf80,0xbf463f55,0x3ef13f35,0x3dc9bf7b
.long 0x3f7b0000,0xbf55bec4,0xbe483f80,0x3f0ebf6d,0xbdc93f80,0x3e95bf7b,0xbf463f35,0x3f62bf0e
.long 0xbf800000,0x3f800000,0xbf800000,0x3f800000,0xbdc9bf80,0x3e953f7b,0xbf46bf35,0x3f623f0e
.long 0x3f7b0000,0xbf553ec4,0xbe48bf80,0x3f0e3f6d,0x3e953f80,0xbf46bf55,0x3ef1bf35,0x3dc93f7b
.long 0xbf6d0000,0x3ec4bf35,0x3f6d0000,0xbec43f35,0xbef1bf80,0x3f7f3f0e,0x3f753f35,0xbf463e48
.long 0x3f550000,0x3e483f6d,0x3f0e3f80,0xbf7bbec4,0x3f223f80,0xbf62be48,0xbdc93f35,0xbf75bf55
.long 0xbf350000,0xbf35bf80,0xbf350000,0xbf35bf80,0xbf46bf80,0x3ef1be48,0xbf7fbf35,0xbe95bf55
.long 0x3f0e0000,0x3f7b3f6d,0xbf55bf80,0x3e48bec4,0x3f623f80,0x3dc93f0e,0xbe95bf35,0x3f223e48
.long 0xbec40000,0xbf6dbf35,0x3ec40000,0x3f6d3f35,0xbf75bf80,0xbf22bf55,0x3f623f35,0x3f7f3f7b
.long 0x3e480000,0x3f0e3ec4,0x3f7b3f80,0x3f553f6d,0x3f7f3f80,0x3f753f7b,0x3f223f35,0x3ef13f0e
.long 0x0,0x0,0x0,0x0,0x3f62bf6d,0x3f46bf55,0x3e95bec4,0x3dc9be48
.long 0x3f55bf35,0x3f7bbf6d,0x3f0ebf35,0x3e48bec4,0xbdc93ec4,0x3ef1be48,0x3f46bf6d,0x3e95bf0e
.long 0xbf6d3f80,0xbec43f35,0x3f6dbf80,0x3ec4bf35,0xbf463ec4,0xbf753f7b,0x3f7fbf6d,0x3ef1bf55
.long 0x3e48bf35,0xbf553ec4,0x3f7bbf35,0x3f0ebf6d,0x3f75bf6d,0xbdc9bf0e,0x3f62bec4,0x3f22bf7b
.long 0x3f350000,0x3f35bf80,0x3f350000,0x3f35bf80,0xbe953f6d,0x3f7fbf0e,0x3ef13ec4,0x3f46bf7b
.long 0xbf7b3f35,0x3f0e3ec4,0x3e483f35,0x3f55bf6d,0xbf22bec4,0xbe953f7b,0xbdc93f6d,0x3f62bf55
.long 0x3ec4bf80,0xbf6d3f35,0xbec43f80,0x3f6dbf35,0x3f7fbec4,0xbf62be48,0xbf223f6d,0x3f75bf0e
.long 0x3f0e3f35,0xbe48bf6d,0xbf553f35,0x3f7bbec4,0xbef13f6d,0x3f22bf55,0xbf753ec4,0x3f7fbe48
.long 0xbf800000,0x3f800000,0xbf800000,0x3f800000,0xbef1bf6d,0x3f223f55,0xbf75bec4,0x3f7f3e48
.long 0x3f0ebf35,0xbe483f6d,0xbf55bf35,0x3f7b3ec4,0x3f7f3ec4,0xbf623e48,0xbf22bf6d,0x3f753f0e
.long 0x3ec43f80,0xbf6dbf35,0xbec4bf80,0x3f6d3f35,0xbf223ec4,0xbe95bf7b,0xbdc9bf6d,0x3f623f55
.long 0xbf7bbf35,0x3f0ebec4,0x3e48bf35,0x3f553f6d,0xbe95bf6d,0x3f7f3f0e,0x3ef1bec4,0x3f463f7b
.long 0x3f350000,0x3f353f80,0x3f350000,0x3f353f80,0x3f753f6d,0xbdc93f0e,0x3f623ec4,0x3f223f7b
.long 0x3e483f35,0xbf55bec4,0x3f7b3f35,0x3f0e3f6d,0xbf46bec4,0xbf75bf7b,0x3f7f3f6d,0x3ef13f55
.long 0xbf6dbf80,0xbec4bf35,0x3f6d3f80,0x3ec43f35,0xbdc9bec4,0x3ef13e48,0x3f463f6d,0x3e953f0e
.long 0x3f553f35,0x3f7b3f6d,0x3f0e3f35,0x3e483ec4,0x3f623f6d,0x3f463f55,0x3e953ec4,0x3dc93e48
.long 0x0,0x0,0x0,0x0,0xbdc90000,0xbe95be48,0xbf46bf35,0xbf62bf55
.long 0xbe480000,0xbf0ebec4,0xbf7bbf80,0xbf55bf6d,0xbe950000,0xbf46bf0e,0xbef1bf35,0x3dc9be48
.long 0xbec40000,0xbf6dbf35,0x3ec40000,0x3f6d3f35,0xbef10000,0xbf7fbf55,0x3f753f35,0x3f463f7b
.long 0xbf0e0000,0xbf7bbf6d,0x3f553f80,0xbe483ec4,0xbf220000,0xbf62bf7b,0x3dc93f35,0xbf75bf0e
.long 0xbf350000,0xbf35bf80,0xbf350000,0xbf35bf80,0xbf460000,0xbef1bf7b,0xbf7fbf35,0x3e95bf0e
.long 0xbf550000,0xbe48bf6d,0xbf0ebf80,0x3f7b3ec4,0xbf620000,0x3dc9bf55,0x3e95bf35,0x3f223f7b
.long 0xbf6d0000,0x3ec4bf35,0x3f6d0000,0xbec43f35,0xbf750000,0x3f22bf0e,0x3f623f35,0xbf7fbe48
.long 0xbf7b0000,0x3f55bec4,0x3e483f80,0xbf0ebf6d,0xbf7f0000,0x3f75be48,0xbf223f35,0x3ef1bf55
.long 0xbf800000,0x3f800000,0xbf800000,0x3f800000,0xbf7f0000,0x3f753e48,0xbf22bf35,0x3ef13f55
.long 0xbf7b0000,0x3f553ec4,0x3e48bf80,0xbf0e3f6d,0xbf750000,0x3f223f0e,0x3f62bf35,0xbf7f3e48
.long 0xbf6d0000,0x3ec43f35,0x3f6d0000,0xbec4bf35,0xbf620000,0x3dc93f55,0x3e953f35,0x3f22bf7b
.long 0xbf550000,0xbe483f6d,0xbf0e3f80,0x3f7bbec4,0xbf460000,0xbef13f7b,0xbf7f3f35,0x3e953f0e
.long 0xbf350000,0xbf353f80,0xbf350000,0xbf353f80,0xbf220000,0xbf623f7b,0x3dc9bf35,0xbf753f0e
.long 0xbf0e0000,0xbf7b3f6d,0x3f55bf80,0xbe48bec4,0xbef10000,0xbf7f3f55,0x3f75bf35,0x3f46bf7b
.long 0xbec40000,0xbf6d3f35,0x3ec40000,0x3f6dbf35,0xbe950000,0xbf463f0e,0xbef13f35,0x3dc93e48
.long 0xbe480000,0xbf0e3ec4,0xbf7b3f80,0xbf553f6d,0xbdc90000,0xbe953e48,0xbf463f35,0xbf623f55
.long 0x0,0x0,0x0,0x0,0xbef1bec4,0xbf22bf0e,0xbf75bf6d,0xbf7fbf7b
.long 0xbf55bf35,0xbf7bbf6d,0xbf0ebf35,0xbe48bec4,0xbf7fbf6d,0xbf62bf7b,0x3f223ec4,0x3f753f55
.long 0xbf6dbf80,0xbec4bf35,0x3f6d3f80,0x3ec43f35,0xbf22bf6d,0x3e95be48,0xbdc93ec4,0xbf62bf0e
.long 0xbe48bf35,0x3f553ec4,0xbf7bbf35,0xbf0ebf6d,0x3e95bec4,0x3f7f3f55,0xbef1bf6d,0x3f463e48
.long 0x3f350000,0x3f353f80,0x3f350000,0x3f353f80,0x3f753ec4,0x3dc93f55,0x3f623f6d,0xbf223e48
.long 0x3f7b3f35,0xbf0e3ec4,0xbe483f35,0xbf55bf6d,0x3f463f6d,0xbf75be48,0xbf7fbec4,0x3ef1bf0e
.long 0x3ec43f80,0xbf6dbf35,0xbec4bf80,0x3f6d3f35,0xbdc93f6d,0xbef1bf7b,0x3f46bec4,0xbe953f55
.long 0xbf0e3f35,0x3e48bf6d,0x3f553f35,0xbf7bbec4,0xbf623ec4,0x3f46bf0e,0xbe953f6d,0x3dc9bf7b
.long 0xbf800000,0x3f800000,0xbf800000,0x3f800000,0xbf62bec4,0x3f463f0e,0xbe95bf6d,0x3dc93f7b
.long 0xbf0ebf35,0x3e483f6d,0x3f55bf35,0xbf7b3ec4,0xbdc9bf6d,0xbef13f7b,0x3f463ec4,0xbe95bf55
.long 0x3ec4bf80,0xbf6d3f35,0xbec43f80,0x3f6dbf35,0x3f46bf6d,0xbf753e48,0xbf7f3ec4,0x3ef13f0e
.long 0x3f7bbf35,0xbf0ebec4,0xbe48bf35,0xbf553f6d,0x3f75bec4,0x3dc9bf55,0x3f62bf6d,0xbf22be48
.long 0x3f350000,0x3f35bf80,0x3f350000,0x3f35bf80,0x3e953ec4,0x3f7fbf55,0xbef13f6d,0x3f46be48
.long 0xbe483f35,0x3f55bec4,0xbf7b3f35,0xbf0e3f6d,0xbf223f6d,0x3e953e48,0xbdc9bec4,0xbf623f0e
.long 0xbf6d3f80,0xbec43f35,0x3f6dbf80,0x3ec4bf35,0xbf7f3f6d,0xbf623f7b,0x3f22bec4,0x3f75bf55
.long 0xbf553f35,0xbf7b3f6d,0xbf0e3f35,0xbe483ec4,0xbef13ec4,0xbf223f0e,0xbf753f6d,0xbf7f3f7b
.long 0x0,0x0,0x0,0x0,0xbf7fbf80,0xbf75bf7b,0xbf22bf35,0xbef1bf0e
.long 0x3e480000,0x3f0e3ec4,0x3f7b3f80,0x3f553f6d,0x3f753f80,0x3f223f55,0xbf62bf35,0xbf7fbf7b
.long 0xbec40000,0xbf6dbf35,0x3ec40000,0x3f6d3f35,0xbf62bf80,0xbdc9bf0e,0x3e953f35,0xbf22be48
.long 0x3f0e0000,0x3f7b3f6d,0xbf55bf80,0x3e48bec4,0x3f463f80,0xbef13e48,0x3f7f3f35,0x3e953f55
.long 0xbf350000,0xbf35bf80,0xbf350000,0xbf35bf80,0xbf22bf80,0x3f623e48,0x3dc9bf35,0x3f753f55
.long 0x3f550000,0x3e483f6d,0x3f0e3f80,0xbf7bbec4,0x3ef13f80,0xbf7fbf0e,0xbf75bf35,0x3f46be48
.long 0xbf6d0000,0x3ec4bf35,0x3f6d0000,0xbec43f35,0xbe95bf80,0x3f463f55,0xbef13f35,0xbdc9bf7b
.long 0x3f7b0000,0xbf553ec4,0xbe48bf80,0x3f0e3f6d,0x3dc93f80,0xbe95bf7b,0x3f463f35,0xbf62bf0e
.long 0xbf800000,0x3f800000,0xbf800000,0x3f800000,0x3dc9bf80,0xbe953f7b,0x3f46bf35,0xbf623f0e
.long 0x3f7b0000,0xbf55bec4,0xbe483f80,0x3f0ebf6d,0xbe953f80,0x3f46bf55,0xbef1bf35,0xbdc93f7b
.long 0xbf6d0000,0x3ec43f35,0x3f6d0000,0xbec4bf35,0x3ef1bf80,0xbf7f3f0e,0xbf753f35,0x3f463e48
.long 0x3f550000,0x3e48bf6d,0x3f0ebf80,0xbf7b3ec4,0xbf223f80,0x3f62be48,0x3dc93f35,0x3f75bf55
.long 0xbf350000,0xbf353f80,0xbf350000,0xbf353f80,0x3f46bf80,0xbef1be48,0x3f7fbf35,0x3e95bf55
.long 0x3f0e0000,0x3f7bbf6d,0xbf553f80,0x3e483ec4,0xbf623f80,0xbdc93f0e,0x3e95bf35,0xbf223e48
.long 0xbec40000,0xbf6d3f35,0x3ec40000,0x3f6dbf35,0x3f75bf80,0x3f22bf55,0xbf623f35,0xbf7f3f7b
.long 0x3e480000,0x3f0ebec4,0x3f7bbf80,0x3f55bf6d,0xbf7f3f80,0xbf753f7b,0xbf223f35,0xbef13f0e
.long 0x0,0x0,0x0,0x0,0xbf62bf6d,0xbf46bf55,0xbe95bec4,0xbdc9be48
.long 0x3f553f35,0x3f7b3f6d,0x3f0e3f35,0x3e483ec4,0x3dc93ec4,0xbef1be48,0xbf46bf6d,0xbe95bf0e
.long 0xbf6dbf80,0xbec4bf35,0x3f6d3f80,0x3ec43f35,0x3f463ec4,0x3f753f7b,0xbf7fbf6d,0xbef1bf55
.long 0x3e483f35,0xbf55bec4,0x3f7b3f35,0x3f0e3f6d,0xbf75bf6d,0x3dc9bf0e,0xbf62bec4,0xbf22bf7b
.long 0x3f350000,0x3f353f80,0x3f350000,0x3f353f80,0x3e953f6d,0xbf7fbf0e,0xbef13ec4,0xbf46bf7b
.long 0xbf7bbf35,0x3f0ebec4,0x3e48bf35,0x3f553f6d,0x3f22bec4,0x3e953f7b,0x3dc93f6d,0xbf62bf55
.long 0x3ec43f80,0xbf6dbf35,0xbec4bf80,0x3f6d3f35,0xbf7fbec4,0x3f62be48,0x3f223f6d,0xbf75bf0e
.long 0x3f0ebf35,0xbe483f6d,0xbf55bf35,0x3f7b3ec4,0x3ef13f6d,0xbf22bf55,0x3f753ec4,0xbf7fbe48
.long 0xbf800000,0x3f800000,0xbf800000,0x3f800000,0x3ef1bf6d,0xbf223f55,0x3f75bec4,0xbf7f3e48
.long 0x3f0e3f35,0xbe48bf6d,0xbf553f35,0x3f7bbec4,0xbf7f3ec4,0x3f623e48,0x3f22bf6d,0xbf753f0e
.long 0x3ec4bf80,0xbf6d3f35,0xbec43f80,0x3f6dbf35,0x3f223ec4,0x3e95bf7b,0x3dc9bf6d,0xbf623f55
.long 0xbf7b3f35,0x3f0e3ec4,0x3e483f35,0x3f55bf6d,0x3e95bf6d,0xbf7f3f0e,0xbef1bec4,0xbf463f7b
.long 0x3f350000,0x3f35bf80,0x3f350000,0x3f35bf80,0xbf753f6d,0x3dc93f0e,0xbf623ec4,0xbf223f7b
.long 0x3e48bf35,0xbf553ec4,0x3f7bbf35,0x3f0ebf6d,0x3f46bec4,0x3f75bf7b,0xbf7f3f6d,0xbef13f55
.long 0xbf6d3f80,0xbec43f35,0x3f6dbf80,0x3ec4bf35,0x3dc9bec4,0xbef13e48,0xbf463f6d,0xbe953f0e
.long 0x3f55bf35,0x3f7bbf6d,0x3f0ebf35,0x3e48bec4,0xbf623f6d,0xbf463f55,0xbe953ec4,0xbdc93e48
.long 0x0,0x0,0x0,0x0,0x3dc90000,0x3e953e48,0x3f463f35,0x3f623f55
.long 0xbe480000,0xbf0ebec4,0xbf7bbf80,0xbf55bf6d,0x3e950000,0x3f463f0e,0x3ef13f35,0xbdc93e48
.long 0xbec40000,0xbf6dbf35,0x3ec40000,0x3f6d3f35,0x3ef10000,0x3f7f3f55,0xbf75bf35,0xbf46bf7b
.long 0xbf0e0000,0xbf7bbf6d,0x3f553f80,0xbe483ec4,0x3f220000,0x3f623f7b,0xbdc9bf35,0x3f753f0e
.long 0xbf350000,0xbf35bf80,0xbf350000,0xbf35bf80,0x3f460000,0x3ef13f7b,0x3f7f3f35,0xbe953f0e
.long 0xbf550000,0xbe48bf6d,0xbf0ebf80,0x3f7b3ec4,0x3f620000,0xbdc93f55,0xbe953f35,0xbf22bf7b
.long 0xbf6d0000,0x3ec4bf35,0x3f6d0000,0xbec43f35,0x3f750000,0xbf223f0e,0xbf62bf35,0x3f7f3e48
.long 0xbf7b0000,0x3f55bec4,0x3e483f80,0xbf0ebf6d,0x3f7f0000,0xbf753e48,0x3f22bf35,0xbef13f55
.long 0xbf800000,0x3f800000,0xbf800000,0x3f800000,0x3f7f0000,0xbf75be48,0x3f223f35,0xbef1bf55
.long 0xbf7b0000,0x3f553ec4,0x3e48bf80,0xbf0e3f6d,0x3f750000,0xbf22bf0e,0xbf623f35,0x3f7fbe48
.long 0xbf6d0000,0x3ec43f35,0x3f6d0000,0xbec4bf35,0x3f620000,0xbdc9bf55,0xbe95bf35,0xbf223f7b
.long 0xbf550000,0xbe483f6d,0xbf0e3f80,0x3f7bbec4,0x3f460000,0x3ef1bf7b,0x3f7fbf35,0xbe95bf0e
.long 0xbf350000,0xbf353f80,0xbf350000,0xbf353f80,0x3f220000,0x3f62bf7b,0xbdc93f35,0x3f75bf0e
.long 0xbf0e0000,0xbf7b3f6d,0x3f55bf80,0xbe48bec4,0x3ef10000,0x3f7fbf55,0xbf753f35,0xbf463f7b
.long 0xbec40000,0xbf6d3f35,0x3ec40000,0x3f6dbf35,0x3e950000,0x3f46bf0e,0x3ef1bf35,0xbdc9be48
.long 0xbe480000,0xbf0e3ec4,0xbf7b3f80,0xbf553f6d,0x3dc90000,0x3e95be48,0x3f46bf35,0x3f62bf55
.long 0x0,0x0,0x0,0x0,0x3ef13ec4,0x3f223f0e,0x3f753f6d,0x3f7f3f7b
.long 0xbf55bf35,0xbf7bbf6d,0xbf0ebf35,0xbe48bec4,0x3f7f3f6d,0x3f623f7b,0xbf22bec4,0xbf75bf55
.long 0xbf6dbf80,0xbec4bf35,0x3f6d3f80,0x3ec43f35,0x3f223f6d,0xbe953e48,0x3dc9bec4,0x3f623f0e
.long 0xbe48bf35,0x3f553ec4,0xbf7bbf35,0xbf0ebf6d,0xbe953ec4,0xbf7fbf55,0x3ef13f6d,0xbf46be48
.long 0x3f350000,0x3f353f80,0x3f350000,0x3f353f80,0xbf75bec4,0xbdc9bf55,0xbf62bf6d,0x3f22be48
.long 0x3f7b3f35,0xbf0e3ec4,0xbe483f35,0xbf55bf6d,0xbf46bf6d,0x3f753e48,0x3f7f3ec4,0xbef13f0e
.long 0x3ec43f80,0xbf6dbf35,0xbec4bf80,0x3f6d3f35,0x3dc9bf6d,0x3ef13f7b,0xbf463ec4,0x3e95bf55
.long 0xbf0e3f35,0x3e48bf6d,0x3f553f35,0xbf7bbec4,0x3f62bec4,0xbf463f0e,0x3e95bf6d,0xbdc93f7b
.long 0xbf800000,0x3f800000,0xbf800000,0x3f800000,0x3f623ec4,0xbf46bf0e,0x3e953f6d,0xbdc9bf7b
.long 0xbf0ebf35,0x3e483f6d,0x3f55bf35,0xbf7b3ec4,0x3dc93f6d,0x3ef1bf7b,0xbf46bec4,0x3e953f55
.long 0x3ec4bf80,0xbf6d3f35,0xbec43f80,0x3f6dbf35,0xbf463f6d,0x3f75be48,0x3f7fbec4,0xbef1bf0e
.long 0x3f7bbf35,0xbf0ebec4,0xbe48bf35,0xbf553f6d,0xbf753ec4,0xbdc93f55,0xbf623f6d,0x3f223e48
.long 0x3f350000,0x3f35bf80,0x3f350000,0x3f35bf80,0xbe95bec4,0xbf7f3f55,0x3ef1bf6d,0xbf463e48
.long 0xbe483f35,0x3f55bec4,0xbf7b3f35,0xbf0e3f6d,0x3f22bf6d,0xbe95be48,0x3dc93ec4,0x3f62bf0e
.long 0xbf6d3f80,0xbec43f35,0x3f6dbf80,0x3ec4bf35,0x3f7fbf6d,0x3f62bf7b,0xbf223ec4,0xbf753f55
.long 0xbf553f35,0xbf7b3f6d,0xbf0e3f35,0xbe483ec4,0x3ef1bec4,0x3f22bf0e,0x3f75bf6d,0x3f7fbf7b
.long 0x0,0x0,0x0,0x0,0x3f7f3f80,0x3f753f7b,0x3f223f35,0x3ef13f0e
.long 0x3e480000,0x3f0e3ec4,0x3f7b3f80,0x3f553f6d,0xbf75bf80,0xbf22bf55,0x3f623f35,0x3f7f3f7b
.long 0xbec40000,0xbf6dbf35,0x3ec40000,0x3f6d3f35,0x3f623f80,0x3dc93f0e,0xbe95bf35,0x3f223e48
.long 0x3f0e0000,0x3f7b3f6d,0xbf55bf80,0x3e48bec4,0xbf46bf80,0x3ef1be48,0xbf7fbf35,0xbe95bf55
.long 0xbf350000,0xbf35bf80,0xbf350000,0xbf35bf80,0x3f223f80,0xbf62be48,0xbdc93f35,0xbf75bf55
.long 0x3f550000,0x3e483f6d,0x3f0e3f80,0xbf7bbec4,0xbef1bf80,0x3f7f3f0e,0x3f753f35,0xbf463e48
.long 0xbf6d0000,0x3ec4bf35,0x3f6d0000,0xbec43f35,0x3e953f80,0xbf46bf55,0x3ef1bf35,0x3dc93f7b
.long 0x3f7b0000,0xbf553ec4,0xbe48bf80,0x3f0e3f6d,0xbdc9bf80,0x3e953f7b,0xbf46bf35,0x3f623f0e
.long 0xbf800000,0x3f800000,0xbf800000,0x3f800000,0xbdc93f80,0x3e95bf7b,0xbf463f35,0x3f62bf0e
.long 0x3f7b0000,0xbf55bec4,0xbe483f80,0x3f0ebf6d,0x3e95bf80,0xbf463f55,0x3ef13f35,0x3dc9bf7b
.long 0xbf6d0000,0x3ec43f35,0x3f6d0000,0xbec4bf35,0xbef13f80,0x3f7fbf0e,0x3f75bf35,0xbf46be48
.long 0x3f550000,0x3e48bf6d,0x3f0ebf80,0xbf7b3ec4,0x3f22bf80,0xbf623e48,0xbdc9bf35,0xbf753f55
.long 0xbf350000,0xbf353f80,0xbf350000,0xbf353f80,0xbf463f80,0x3ef13e48,0xbf7f3f35,0xbe953f55
.long 0x3f0e0000,0x3f7bbf6d,0xbf553f80,0x3e483ec4,0x3f62bf80,0x3dc9bf0e,0xbe953f35,0x3f22be48
.long 0xbec40000,0xbf6d3f35,0x3ec40000,0x3f6dbf35,0xbf753f80,0xbf223f55,0x3f62bf35,0x3f7fbf7b
.long 0x3e480000,0x3f0ebec4,0x3f7bbf80,0x3f55bf6d,0x3f7fbf80,0x3f75bf7b,0x3f22bf35,0x3ef1bf0e
.long 0x0,0x0,0x0,0x0,0x3f623f6d,0x3f463f55,0x3e953ec4,0x3dc93e48
.long 0x3f553f35,0x3f7b3f6d,0x3f0e3f35,0x3e483ec4,0xbdc9bec4,0x3ef13e48,0x3f463f6d,0x3e953f0e
.long 0xbf6dbf80,0xbec4bf35,0x3f6d3f80,0x3ec43f35,0xbf46bec4,0xbf75bf7b,0x3f7f3f6d,0x3ef13f55
.long 0x3e483f35,0xbf55bec4,0x3f7b3f35,0x3f0e3f6d,0x3f753f6d,0xbdc93f0e,0x3f623ec4,0x3f223f7b
.long 0x3f350000,0x3f353f80,0x3f350000,0x3f353f80,0xbe95bf6d,0x3f7f3f0e,0x3ef1bec4,0x3f463f7b
.long 0xbf7bbf35,0x3f0ebec4,0x3e48bf35,0x3f553f6d,0xbf223ec4,0xbe95bf7b,0xbdc9bf6d,0x3f623f55
.long 0x3ec43f80,0xbf6dbf35,0xbec4bf80,0x3f6d3f35,0x3f7f3ec4,0xbf623e48,0xbf22bf6d,0x3f753f0e
.long 0x3f0ebf35,0xbe483f6d,0xbf55bf35,0x3f7b3ec4,0xbef1bf6d,0x3f223f55,0xbf75bec4,0x3f7f3e48
.long 0xbf800000,0x3f800000,0xbf800000,0x3f800000,0xbef13f6d,0x3f22bf55,0xbf753ec4,0x3f7fbe48
.long 0x3f0e3f35,0xbe48bf6d,0xbf553f35,0x3f7bbec4,0x3f7fbec4,0xbf62be48,0xbf223f6d,0x3f75bf0e
.long 0x3ec4bf80,0xbf6d3f35,0xbec43f80,0x3f6dbf35,0xbf22bec4,0xbe953f7b,0xbdc93f6d,0x3f62bf55
.long 0xbf7b3f35,0x3f0e3ec4,0x3e483f35,0x3f55bf6d,0xbe953f6d,0x3f7fbf0e,0x3ef13ec4,0x3f46bf7b
.long 0x3f350000,0x3f35bf80,0x3f350000,0x3f35bf80,0x3f75bf6d,0xbdc9bf0e,0x3f62bec4,0x3f22bf7b
.long 0x3e48bf35,0xbf553ec4,0x3f7bbf35,0x3f0ebf6d,0xbf463ec4,0xbf753f7b,0x3f7fbf6d,0x3ef1bf55
.long 0xbf6d3f80,0xbec43f35,0x3f6dbf80,0x3ec4bf35,0xbdc93ec4,0x3ef1be48,0x3f46bf6d,0x3e95bf0e
.long 0x3f55bf35,0x3f7bbf6d,0x3f0ebf35,0x3e48bec4,0x3f62bf6d,0x3f46bf55,0x3e95bec4,0x3dc9be48
.long 0x0,0x0,0x0,0x0,0x3dc90000,0x3e95be48,0x3f46bf35,0x3f62bf55
.long 0x3e480000,0x3f0ebec4,0x3f7bbf80,0x3f55bf6d,0x3e950000,0x3f46bf0e,0x3ef1bf35,0xbdc9be48
.long 0x3ec40000,0x3f6dbf35,0xbec40000,0xbf6d3f35,0x3ef10000,0x3f7fbf55,0xbf753f35,0xbf463f7b
.long 0x3f0e0000,0x3f7bbf6d,0xbf553f80,0x3e483ec4,0x3f220000,0x3f62bf7b,0xbdc93f35,0x3f75bf0e
.long 0x3f350000,0x3f35bf80,0x3f350000,0x3f35bf80,0x3f460000,0x3ef1bf7b,0x3f7fbf35,0xbe95bf0e
.long 0x3f550000,0x3e48bf6d,0x3f0ebf80,0xbf7b3ec4,0x3f620000,0xbdc9bf55,0xbe95bf35,0xbf223f7b
.long 0x3f6d0000,0xbec4bf35,0xbf6d0000,0x3ec43f35,0x3f750000,0xbf22bf0e,0xbf623f35,0x3f7fbe48
.long 0x3f7b0000,0xbf55bec4,0xbe483f80,0x3f0ebf6d,0x3f7f0000,0xbf75be48,0x3f223f35,0xbef1bf55
.long 0x3f800000,0xbf800000,0x3f800000,0xbf800000,0x3f7f0000,0xbf753e48,0x3f22bf35,0xbef13f55
.long 0x3f7b0000,0xbf553ec4,0xbe48bf80,0x3f0e3f6d,0x3f750000,0xbf223f0e,0xbf62bf35,0x3f7f3e48
.long 0x3f6d0000,0xbec43f35,0xbf6d0000,0x3ec4bf35,0x3f620000,0xbdc93f55,0xbe953f35,0xbf22bf7b
.long 0x3f550000,0x3e483f6d,0x3f0e3f80,0xbf7bbec4,0x3f460000,0x3ef13f7b,0x3f7f3f35,0xbe953f0e
.long 0x3f350000,0x3f353f80,0x3f350000,0x3f353f80,0x3f220000,0x3f623f7b,0xbdc9bf35,0x3f753f0e
.long 0x3f0e0000,0x3f7b3f6d,0xbf55bf80,0x3e48bec4,0x3ef10000,0x3f7f3f55,0xbf75bf35,0xbf46bf7b
.long 0x3ec40000,0x3f6d3f35,0xbec40000,0xbf6dbf35,0x3e950000,0x3f463f0e,0x3ef13f35,0xbdc93e48
.long 0x3e480000,0x3f0e3ec4,0x3f7b3f80,0x3f553f6d,0x3dc90000,0x3e953e48,0x3f463f35,0x3f623f55
.long 0x0,0x0,0x0,0x0,0x3ef1bec4,0x3f22bf0e,0x3f75bf6d,0x3f7fbf7b
.long 0x3f55bf35,0x3f7bbf6d,0x3f0ebf35,0x3e48bec4,0x3f7fbf6d,0x3f62bf7b,0xbf223ec4,0xbf753f55
.long 0x3f6dbf80,0x3ec4bf35,0xbf6d3f80,0xbec43f35,0x3f22bf6d,0xbe95be48,0x3dc93ec4,0x3f62bf0e
.long 0x3e48bf35,0xbf553ec4,0x3f7bbf35,0x3f0ebf6d,0xbe95bec4,0xbf7f3f55,0x3ef1bf6d,0xbf463e48
.long 0xbf350000,0xbf353f80,0xbf350000,0xbf353f80,0xbf753ec4,0xbdc93f55,0xbf623f6d,0x3f223e48
.long 0xbf7b3f35,0x3f0e3ec4,0x3e483f35,0x3f55bf6d,0xbf463f6d,0x3f75be48,0x3f7fbec4,0xbef1bf0e
.long 0xbec43f80,0x3f6dbf35,0x3ec4bf80,0xbf6d3f35,0x3dc93f6d,0x3ef1bf7b,0xbf46bec4,0x3e953f55
.long 0x3f0e3f35,0xbe48bf6d,0xbf553f35,0x3f7bbec4,0x3f623ec4,0xbf46bf0e,0x3e953f6d,0xbdc9bf7b
.long 0x3f800000,0xbf800000,0x3f800000,0xbf800000,0x3f62bec4,0xbf463f0e,0x3e95bf6d,0xbdc93f7b
.long 0x3f0ebf35,0xbe483f6d,0xbf55bf35,0x3f7b3ec4,0x3dc9bf6d,0x3ef13f7b,0xbf463ec4,0x3e95bf55
.long 0xbec4bf80,0x3f6d3f35,0x3ec43f80,0xbf6dbf35,0xbf46bf6d,0x3f753e48,0x3f7f3ec4,0xbef13f0e
.long 0xbf7bbf35,0x3f0ebec4,0x3e48bf35,0x3f553f6d,0xbf75bec4,0xbdc9bf55,0xbf62bf6d,0x3f22be48
.long 0xbf350000,0xbf35bf80,0xbf350000,0xbf35bf80,0xbe953ec4,0xbf7fbf55,0x3ef13f6d,0xbf46be48
.long 0x3e483f35,0xbf55bec4,0x3f7b3f35,0x3f0e3f6d,0x3f223f6d,0xbe953e48,0x3dc9bec4,0x3f623f0e
.long 0x3f6d3f80,0x3ec43f35,0xbf6dbf80,0xbec4bf35,0x3f7f3f6d,0x3f623f7b,0xbf22bec4,0xbf75bf55
.long 0x3f553f35,0x3f7b3f6d,0x3f0e3f35,0x3e483ec4,0x3ef13ec4,0x3f223f0e,0x3f753f6d,0x3f7f3f7b
.long 0x0,0x0,0x0,0x0,0x3f7fbf80,0x3f75bf7b,0x3f22bf35,0x3ef1bf0e
.long 0xbe480000,0xbf0e3ec4,0xbf7b3f80,0xbf553f6d,0xbf753f80,0xbf223f55,0x3f62bf35,0x3f7fbf7b
.long 0x3ec40000,0x3f6dbf35,0xbec40000,0xbf6d3f35,0x3f62bf80,0x3dc9bf0e,0xbe953f35,0x3f22be48
.long 0xbf0e0000,0xbf7b3f6d,0x3f55bf80,0xbe48bec4,0xbf463f80,0x3ef13e48,0xbf7f3f35,0xbe953f55
.long 0x3f350000,0x3f35bf80,0x3f350000,0x3f35bf80,0x3f22bf80,0xbf623e48,0xbdc9bf35,0xbf753f55
.long 0xbf550000,0xbe483f6d,0xbf0e3f80,0x3f7bbec4,0xbef13f80,0x3f7fbf0e,0x3f75bf35,0xbf46be48
.long 0x3f6d0000,0xbec4bf35,0xbf6d0000,0x3ec43f35,0x3e95bf80,0xbf463f55,0x3ef13f35,0x3dc9bf7b
.long 0xbf7b0000,0x3f553ec4,0x3e48bf80,0xbf0e3f6d,0xbdc93f80,0x3e95bf7b,0xbf463f35,0x3f62bf0e
.long 0x3f800000,0xbf800000,0x3f800000,0xbf800000,0xbdc9bf80,0x3e953f7b,0xbf46bf35,0x3f623f0e
.long 0xbf7b0000,0x3f55bec4,0x3e483f80,0xbf0ebf6d,0x3e953f80,0xbf46bf55,0x3ef1bf35,0x3dc93f7b
.long 0x3f6d0000,0xbec43f35,0xbf6d0000,0x3ec4bf35,0xbef1bf80,0x3f7f3f0e,0x3f753f35,0xbf463e48
.long 0xbf550000,0xbe48bf6d,0xbf0ebf80,0x3f7b3ec4,0x3f223f80,0xbf62be48,0xbdc93f35,0xbf75bf55
.long 0x3f350000,0x3f353f80,0x3f350000,0x3f353f80,0xbf46bf80,0x3ef1be48,0xbf7fbf35,0xbe95bf55
.long 0xbf0e0000,0xbf7bbf6d,0x3f553f80,0xbe483ec4,0x3f623f80,0x3dc93f0e,0xbe95bf35,0x3f223e48
.long 0x3ec40000,0x3f6d3f35,0xbec40000,0xbf6dbf35,0xbf75bf80,0xbf22bf55,0x3f623f35,0x3f7f3f7b
.long 0xbe480000,0xbf0ebec4,0xbf7bbf80,0xbf55bf6d,0x3f7f3f80,0x3f753f7b,0x3f223f35,0x3ef13f0e
.long 0x0,0x0,0x0,0x0,0x3f62bf6d,0x3f46bf55,0x3e95bec4,0x3dc9be48
.long 0xbf553f35,0xbf7b3f6d,0xbf0e3f35,0xbe483ec4,0xbdc93ec4,0x3ef1be48,0x3f46bf6d,0x3e95bf0e
.long 0x3f6dbf80,0x3ec4bf35,0xbf6d3f80,0xbec43f35,0xbf463ec4,0xbf753f7b,0x3f7fbf6d,0x3ef1bf55
.long 0xbe483f35,0x3f55bec4,0xbf7b3f35,0xbf0e3f6d,0x3f75bf6d,0xbdc9bf0e,0x3f62bec4,0x3f22bf7b
.long 0xbf350000,0xbf353f80,0xbf350000,0xbf353f80,0xbe953f6d,0x3f7fbf0e,0x3ef13ec4,0x3f46bf7b
.long 0x3f7bbf35,0xbf0ebec4,0xbe48bf35,0xbf553f6d,0xbf22bec4,0xbe953f7b,0xbdc93f6d,0x3f62bf55
.long 0xbec43f80,0x3f6dbf35,0x3ec4bf80,0xbf6d3f35,0x3f7fbec4,0xbf62be48,0xbf223f6d,0x3f75bf0e
.long 0xbf0ebf35,0x3e483f6d,0x3f55bf35,0xbf7b3ec4,0xbef13f6d,0x3f22bf55,0xbf753ec4,0x3f7fbe48
.long 0x3f800000,0xbf800000,0x3f800000,0xbf800000,0xbef1bf6d,0x3f223f55,0xbf75bec4,0x3f7f3e48
.long 0xbf0e3f35,0x3e48bf6d,0x3f553f35,0xbf7bbec4,0x3f7f3ec4,0xbf623e48,0xbf22bf6d,0x3f753f0e
.long 0xbec4bf80,0x3f6d3f35,0x3ec43f80,0xbf6dbf35,0xbf223ec4,0xbe95bf7b,0xbdc9bf6d,0x3f623f55
.long 0x3f7b3f35,0xbf0e3ec4,0xbe483f35,0xbf55bf6d,0xbe95bf6d,0x3f7f3f0e,0x3ef1bec4,0x3f463f7b
.long 0xbf350000,0xbf35bf80,0xbf350000,0xbf35bf80,0x3f753f6d,0xbdc93f0e,0x3f623ec4,0x3f223f7b
.long 0xbe48bf35,0x3f553ec4,0xbf7bbf35,0xbf0ebf6d,0xbf46bec4,0xbf75bf7b,0x3f7f3f6d,0x3ef13f55
.long 0x3f6d3f80,0x3ec43f35,0xbf6dbf80,0xbec4bf35,0xbdc9bec4,0x3ef13e48,0x3f463f6d,0x3e953f0e
.long 0xbf55bf35,0xbf7bbf6d,0xbf0ebf35,0xbe48bec4,0x3f623f6d,0x3f463f55,0x3e953ec4,0x3dc93e48
.long 0x0,0x0,0x0,0x0,0xbdc90000,0xbe953e48,0xbf463f35,0xbf623f55
.long 0x3e480000,0x3f0ebec4,0x3f7bbf80,0x3f55bf6d,0xbe950000,0xbf463f0e,0xbef13f35,0x3dc93e48
.long 0x3ec40000,0x3f6dbf35,0xbec40000,0xbf6d3f35,0xbef10000,0xbf7f3f55,0x3f75bf35,0x3f46bf7b
.long 0x3f0e0000,0x3f7bbf6d,0xbf553f80,0x3e483ec4,0xbf220000,0xbf623f7b,0x3dc9bf35,0xbf753f0e
.long 0x3f350000,0x3f35bf80,0x3f350000,0x3f35bf80,0xbf460000,0xbef13f7b,0xbf7f3f35,0x3e953f0e
.long 0x3f550000,0x3e48bf6d,0x3f0ebf80,0xbf7b3ec4,0xbf620000,0x3dc93f55,0x3e953f35,0x3f22bf7b
.long 0x3f6d0000,0xbec4bf35,0xbf6d0000,0x3ec43f35,0xbf750000,0x3f223f0e,0x3f62bf35,0xbf7f3e48
.long 0x3f7b0000,0xbf55bec4,0xbe483f80,0x3f0ebf6d,0xbf7f0000,0x3f753e48,0xbf22bf35,0x3ef13f55
.long 0x3f800000,0xbf800000,0x3f800000,0xbf800000,0xbf7f0000,0x3f75be48,0xbf223f35,0x3ef1bf55
.long 0x3f7b0000,0xbf553ec4,0xbe48bf80,0x3f0e3f6d,0xbf750000,0x3f22bf0e,0x3f623f35,0xbf7fbe48
.long 0x3f6d0000,0xbec43f35,0xbf6d0000,0x3ec4bf35,0xbf620000,0x3dc9bf55,0x3e95bf35,0x3f223f7b
.long 0x3f550000,0x3e483f6d,0x3f0e3f80,0xbf7bbec4,0xbf460000,0xbef1bf7b,0xbf7fbf35,0x3e95bf0e
.long 0x3f350000,0x3f353f80,0x3f350000,0x3f353f80,0xbf220000,0xbf62bf7b,0x3dc93f35,0xbf75bf0e
.long 0x3f0e0000,0x3f7b3f6d,0xbf55bf80,0x3e48bec4,0xbef10000,0xbf7fbf55,0x3f753f35,0x3f463f7b
.long 0x3ec40000,0x3f6d3f35,0xbec40000,0xbf6dbf35,0xbe950000,0xbf46bf0e,0xbef1bf35,0x3dc9be48
.long 0x3e480000,0x3f0e3ec4,0x3f7b3f80,0x3f553f6d,0xbdc90000,0xbe95be48,0xbf46bf35,0xbf62bf55
.long 0x0,0x0,0x0,0x0,0xbef13ec4,0xbf223f0e,0xbf753f6d,0xbf7f3f7b
.long 0x3f55bf35,0x3f7bbf6d,0x3f0ebf35,0x3e48bec4,0xbf7f3f6d,0xbf623f7b,0x3f22bec4,0x3f75bf55
.long 0x3f6dbf80,0x3ec4bf35,0xbf6d3f80,0xbec43f35,0xbf223f6d,0x3e953e48,0xbdc9bec4,0xbf623f0e
.long 0x3e48bf35,0xbf553ec4,0x3f7bbf35,0x3f0ebf6d,0x3e953ec4,0x3f7fbf55,0xbef13f6d,0x3f46be48
.long 0xbf350000,0xbf353f80,0xbf350000,0xbf353f80,0x3f75bec4,0x3dc9bf55,0x3f62bf6d,0xbf22be48
.long 0xbf7b3f35,0x3f0e3ec4,0x3e483f35,0x3f55bf6d,0x3f46bf6d,0xbf753e48,0xbf7f3ec4,0x3ef13f0e
.long 0xbec43f80,0x3f6dbf35,0x3ec4bf80,0xbf6d3f35,0xbdc9bf6d,0xbef13f7b,0x3f463ec4,0xbe95bf55
.long 0x3f0e3f35,0xbe48bf6d,0xbf553f35,0x3f7bbec4,0xbf62bec4,0x3f463f0e,0xbe95bf6d,0x3dc93f7b
.long 0x3f800000,0xbf800000,0x3f800000,0xbf800000,0xbf623ec4,0x3f46bf0e,0xbe953f6d,0x3dc9bf7b
.long 0x3f0ebf35,0xbe483f6d,0xbf55bf35,0x3f7b3ec4,0xbdc93f6d,0xbef1bf7b,0x3f46bec4,0xbe953f55
.long 0xbec4bf80,0x3f6d3f35,0x3ec43f80,0xbf6dbf35,0x3f463f6d,0xbf75be48,0xbf7fbec4,0x3ef1bf0e
.long 0xbf7bbf35,0x3f0ebec4,0x3e48bf35,0x3f553f6d,0x3f753ec4,0x3dc93f55,0x3f623f6d,0xbf223e48
.long 0xbf350000,0xbf35bf80,0xbf350000,0xbf35bf80,0x3e95bec4,0x3f7f3f55,0xbef1bf6d,0x3f463e48
.long 0x3e483f35,0xbf55bec4,0x3f7b3f35,0x3f0e3f6d,0xbf22bf6d,0x3e95be48,0xbdc93ec4,0xbf62bf0e
.long 0x3f6d3f80,0x3ec43f35,0xbf6dbf80,0xbec4bf35,0xbf7fbf6d,0xbf62bf7b,0x3f223ec4,0x3f753f55
.long 0x3f553f35,0x3f7b3f6d,0x3f0e3f35,0x3e483ec4,0xbef1bec4,0xbf22bf0e,0xbf75bf6d,0xbf7fbf7b
.long 0x0,0x0,0x0,0x0,0xbf7f3f80,0xbf753f7b,0xbf223f35,0xbef13f0e
.long 0xbe480000,0xbf0e3ec4,0xbf7b3f80,0xbf553f6d,0x3f75bf80,0x3f22bf55,0xbf623f35,0xbf7f3f7b
.long 0x3ec40000,0x3f6dbf35,0xbec40000,0xbf6d3f35,0xbf623f80,0xbdc93f0e,0x3e95bf35,0xbf223e48
.long 0xbf0e0000,0xbf7b3f6d,0x3f55bf80,0xbe48bec4,0x3f46bf80,0xbef1be48,0x3f7fbf35,0x3e95bf55
.long 0x3f350000,0x3f35bf80,0x3f350000,0x3f35bf80,0xbf223f80,0x3f62be48,0x3dc93f35,0x3f75bf55
.long 0xbf550000,0xbe483f6d,0xbf0e3f80,0x3f7bbec4,0x3ef1bf80,0xbf7f3f0e,0xbf753f35,0x3f463e48
.long 0x3f6d0000,0xbec4bf35,0xbf6d0000,0x3ec43f35,0xbe953f80,0x3f46bf55,0xbef1bf35,0xbdc93f7b
.long 0xbf7b0000,0x3f553ec4,0x3e48bf80,0xbf0e3f6d,0x3dc9bf80,0xbe953f7b,0x3f46bf35,0xbf623f0e
.long 0x3f800000,0xbf800000,0x3f800000,0xbf800000,0x3dc93f80,0xbe95bf7b,0x3f463f35,0xbf62bf0e
.long 0xbf7b0000,0x3f55bec4,0x3e483f80,0xbf0ebf6d,0xbe95bf80,0x3f463f55,0xbef13f35,0xbdc9bf7b
.long 0x3f6d0000,0xbec43f35,0xbf6d0000,0x3ec4bf35,0x3ef13f80,0xbf7fbf0e,0xbf75bf35,0x3f46be48
.long 0xbf550000,0xbe48bf6d,0xbf0ebf80,0x3f7b3ec4,0xbf22bf80,0x3f623e48,0x3dc9bf35,0x3f753f55
.long 0x3f350000,0x3f353f80,0x3f350000,0x3f353f80,0x3f463f80,0xbef13e48,0x3f7f3f35,0x3e953f55
.long 0xbf0e0000,0xbf7bbf6d,0x3f553f80,0xbe483ec4,0xbf62bf80,0xbdc9bf0e,0x3e953f35,0xbf22be48
.long 0x3ec40000,0x3f6d3f35,0xbec40000,0xbf6dbf35,0x3f753f80,0x3f223f55,0xbf62bf35,0xbf7fbf7b
.long 0xbe480000,0xbf0ebec4,0xbf7bbf80,0xbf55bf6d,0xbf7fbf80,0xbf75bf7b,0xbf22bf35,0xbef1bf0e
.long 0x0,0x0,0x0,0x0,0xbf623f6d,0xbf463f55,0xbe953ec4,0xbdc93e48
.long 0xbf553f35,0xbf7b3f6d,0xbf0e3f35,0xbe483ec4,0x3dc9bec4,0xbef13e48,0xbf463f6d,0xbe953f0e
.long 0x3f6dbf80,0x3ec4bf35,0xbf6d3f80,0xbec43f35,0x3f46bec4,0x3f75bf7b,0xbf7f3f6d,0xbef13f55
.long 0xbe483f35,0x3f55bec4,0xbf7b3f35,0xbf0e3f6d,0xbf753f6d,0x3dc93f0e,0xbf623ec4,0xbf223f7b
.long 0xbf350000,0xbf353f80,0xbf350000,0xbf353f80,0x3e95bf6d,0xbf7f3f0e,0xbef1bec4,0xbf463f7b
.long 0x3f7bbf35,0xbf0ebec4,0xbe48bf35,0xbf553f6d,0x3f223ec4,0x3e95bf7b,0x3dc9bf6d,0xbf623f55
.long 0xbec43f80,0x3f6dbf35,0x3ec4bf80,0xbf6d3f35,0xbf7f3ec4,0x3f623e48,0x3f22bf6d,0xbf753f0e
.long 0xbf0ebf35,0x3e483f6d,0x3f55bf35,0xbf7b3ec4,0x3ef1bf6d,0xbf223f55,0x3f75bec4,0xbf7f3e48
.long 0x3f800000,0xbf800000,0x3f800000,0xbf800000,0x3ef13f6d,0xbf22bf55,0x3f753ec4,0xbf7fbe48
.long 0xbf0e3f35,0x3e48bf6d,0x3f553f35,0xbf7bbec4,0xbf7fbec4,0x3f62be48,0x3f223f6d,0xbf75bf0e
.long 0xbec4bf80,0x3f6d3f35,0x3ec43f80,0xbf6dbf35,0x3f22bec4,0x3e953f7b,0x3dc93f6d,0xbf62bf55
.long 0x3f7b3f35,0xbf0e3ec4,0xbe483f35,0xbf55bf6d,0x3e953f6d,0xbf7fbf0e,0xbef13ec4,0xbf46bf7b
.long 0xbf350000,0xbf35bf80,0xbf350000,0xbf35bf80,0xbf75bf6d,0x3dc9bf0e,0xbf62bec4,0xbf22bf7b
.long 0xbe48bf35,0x3f553ec4,0xbf7bbf35,0xbf0ebf6d,0x3f463ec4,0x3f753f7b,0xbf7fbf6d,0xbef1bf55
.long 0x3f6d3f80,0x3ec43f35,0xbf6dbf80,0xbec4bf35,0x3dc93ec4,0xbef1be48,0xbf46bf6d,0xbe95bf0e
.long 0xbf55bf35,0xbf7bbf6d,0xbf0ebf35,0xbe48bec4,0xbf62bf6d,0xbf46bf55,0xbe95bec4,0xbdc9be48
.long 0x3f800000,0x80000000,0x3f800000,0x80000000,0x3f800000,0x80000000,0x3f7fffb1,0xbb490fc6
.long 0x3f800000,0x80000000,0x3f7ffec4,0xbbc90f88,0x3f800000,0x80000000,0x3f7ffd39,0xbc16cb58
.long 0x3f800000,0x80000000,0x3f7ffb11,0xbc490e90,0x3f800000,0x80000000,0x3f7ff84a,0xbc7b514b
.long 0x3f800000,0x80000000,0x3f7ff4e6,0xbc96c9b6,0x3f800000,0x80000000,0x3f7ff0e3,0xbcafea69
.long 0x3f800000,0x80000000,0x3f7fec43,0xbcc90ab0,0x3f800000,0x80000000,0x3f7fe705,0xbce22a7a
.long 0x3f800000,0x80000000,0x3f7fe129,0xbcfb49ba,0x3f800000,0x80000000,0x3f7fdaaf,0xbd0a342f
.long 0x3f800000,0x80000000,0x3f7fd397,0xbd16c32c,0x3f800000,0x80000000,0x3f7fcbe2,0xbd2351cb
.long 0x3f800000,0x80000000,0x3f7fc38f,0xbd2fe007,0x3f800000,0x80000000,0x3f7fba9e,0xbd3c6dd5
.long 0x3f800000,0x80000000,0x3f7fb10f,0xbd48fb30,0x3f800000,0x80000000,0x3f7fa6e3,0xbd55880e
.long 0x3f800000,0x80000000,0x3f7f9c18,0xbd621469,0x3f800000,0x80000000,0x3f7f90b1,0xbd6ea038
.long 0x3f800000,0x80000000,0x3f7f84ab,0xbd7b2b74,0x3f800000,0x80000000,0x3f7f7808,0xbd83db0a
.long 0x3f800000,0x80000000,0x3f7f6ac7,0xbd8a200a,0x3f800000,0x80000000,0x3f7f5ce9,0xbd9064b4
.long 0x3f800000,0x80000000,0x3f7f4e6d,0xbd96a905,0x3f800000,0x80000000,0x3f7f3f54,0xbd9cecf9
.long 0x3f800000,0x80000000,0x3f7f2f9d,0xbda3308c,0x3f800000,0x80000000,0x3f7f1f49,0xbda973ba
.long 0x3f800000,0x80000000,0x3f7f0e58,0xbdafb680,0x3f800000,0x80000000,0x3f7efcc9,0xbdb5f8da
.long 0x3f800000,0x80000000,0x3f7eea9d,0xbdbc3ac3,0x3f800000,0x80000000,0x3f7ed7d4,0xbdc27c39
.long 0x3f800000,0x80000000,0x3f800000,0x80000000,0x3f7ffb11,0xbc490e90,0x3f7ff84a,0xbc7b514b
.long 0x3f7fec43,0xbcc90ab0,0x3f7fe129,0xbcfb49ba,0x3f7fd397,0xbd16c32c,0x3f7fba9e,0xbd3c6dd5
.long 0x3f7fb10f,0xbd48fb30,0x3f7f84ab,0xbd7b2b74,0x3f7f84ab,0xbd7b2b74,0x3f7f3f54,0xbd9cecf9
.long 0x3f7f4e6d,0xbd96a905,0x3f7eea9d,0xbdbc3ac3,0x3f7f0e58,0xbdafb680,0x3f7e868b,0xbddb7d37
.long 0x3f7ec46d,0xbdc8bd36,0x3f7e1324,0xbdfab273,0x3f7e70b0,0xbde1bc2e,0x3f7d906e,0xbe0cec4a
.long 0x3f7e1324,0xbdfab273,0x3f7cfe73,0xbe1c76de,0x3f7dabcc,0xbe09cf86,0x3f7c5d3a,0xbe2bf804
.long 0x3f7d3aac,0xbe164083,0x3f7baccd,0xbe3b6ecf,0x3f7cbfc9,0xbe22abb6,0x3f7aed37,0xbe4ada4f
.long 0x3f7c3b28,0xbe2f10a2,0x3f7a1e84,0xbe5a3997,0x3f7baccd,0xbe3b6ecf,0x3f7940c0,0xbe698bba
.long 0x3f7b14be,0xbe47c5c2,0x3f7853f8,0xbe78cfcc,0x3f7a7302,0xbe541501,0x3f77583a,0xbe840270
.long 0x3f79c79d,0xbe605c13,0x3f764d97,0xbe8b9507,0x3f791298,0xbe6c9a7f,0x3f75341d,0xbe931f35
.long 0x3f7853f8,0xbe78cfcc,0x3f740bdd,0xbe9aa086,0x3f778bc5,0xbe827dc0,0x3f72d4eb,0xbea21887
.long 0x3f76ba07,0xbe888e93,0x3f718f57,0xbea986c4,0x3f75dec6,0xbe8e9a22,0x3f703b37,0xbeb0eacb
.long 0x3f74fa0b,0xbe94a031,0x3f6ed89e,0xbeb8442a,0x3f740bdd,0xbe9aa086,0x3f6d67a1,0xbebf926f
.long 0x3f731447,0xbea09ae5,0x3f6be858,0xbec6d529,0x3f721352,0xbea68f12,0x3f6a5ad9,0xbece0bea
.long 0x3f710908,0xbeac7cd4,0x3f68bf3c,0xbed53641,0x3f6ff573,0xbeb263ef,0x3f671599,0xbedc53c1
.long 0x3f6ed89e,0xbeb8442a,0x3f655e0b,0xbee363fa,0x3f6db293,0xbebe1d4a,0x3f6398ac,0xbeea6681
.long 0x3f800000,0x80000000,0x3f800000,0x80000000,0x3f7ffec4,0xbbc90f88,0x3f7ffd39,0xbc16cb58
.long 0x3f7ffb11,0xbc490e90,0x3f7ff4e6,0xbc96c9b6,0x3f7ff4e6,0xbc96c9b6,0x3f7fe705,0xbce22a7a
.long 0x3f7fec43,0xbcc90ab0,0x3f7fd397,0xbd16c32c,0x3f7fe129,0xbcfb49ba,0x3f7fba9e,0xbd3c6dd5
.long 0x3f7fd397,0xbd16c32c,0x3f7f9c18,0xbd621469,0x3f7fc38f,0xbd2fe007,0x3f7f7808,0xbd83db0a
.long 0x3f7fb10f,0xbd48fb30,0x3f7f4e6d,0xbd96a905,0x3f7f9c18,0xbd621469,0x3f7f1f49,0xbda973ba
.long 0x3f7f84ab,0xbd7b2b74,0x3f7eea9d,0xbdbc3ac3,0x3f7f6ac7,0xbd8a200a,0x3f7eb069,0xbdcefdb7
.long 0x3f7f4e6d,0xbd96a905,0x3f7e70b0,0xbde1bc2e,0x3f7f2f9d,0xbda3308c,0x3f7e2b72,0xbdf475c0
.long 0x3f7f0e58,0xbdafb680,0x3f7de0b1,0xbe039502,0x3f7eea9d,0xbdbc3ac3,0x3f7d906e,0xbe0cec4a
.long 0x3f7ec46d,0xbdc8bd36,0x3f7d3aac,0xbe164083,0x3f7e9bc9,0xbdd53db9,0x3f7cdf6c,0xbe1f917b
.long 0x3f7e70b0,0xbde1bc2e,0x3f7c7eb0,0xbe28defc,0x3f7e4323,0xbdee3876,0x3f7c187a,0xbe3228d4
.long 0x3f7e1324,0xbdfab273,0x3f7baccd,0xbe3b6ecf,0x3f7de0b1,0xbe039502,0x3f7b3bab,0xbe44b0b9
.long 0x3f7dabcc,0xbe09cf86,0x3f7ac516,0xbe4dee60,0x3f7d7474,0xbe1008b7,0x3f7a4910,0xbe57278f
.long 0x3f7d3aac,0xbe164083,0x3f79c79d,0xbe605c13,0x3f7cfe73,0xbe1c76de,0x3f7940c0,0xbe698bba
.long 0x3f7cbfc9,0xbe22abb6,0x3f78b47b,0xbe72b651,0x3f7c7eb0,0xbe28defc,0x3f7822d1,0xbe7bdba4
.long 0x3f7c3b28,0xbe2f10a2,0x3f778bc5,0xbe827dc0,0x3f7bf531,0xbe354098,0x3f76ef5b,0xbe870ada
.long 0x3f7baccd,0xbe3b6ecf,0x3f764d97,0xbe8b9507,0x3f7b61fc,0xbe419b37,0x3f75a67b,0xbe901c2c
.long 0x3f800000,0x80000000,0x3f800000,0x80000000,0x3f7ff4e6,0xbc96c9b6,0x3f7ff0e3,0xbcafea69
.long 0x3f7fd397,0xbd16c32c,0x3f7fc38f,0xbd2fe007,0x3f7f9c18,0xbd621469,0x3f7f7808,0xbd83db0a
.long 0x3f7f4e6d,0xbd96a905,0x3f7f0e58,0xbdafb680,0x3f7eea9d,0xbdbc3ac3,0x3f7e868b,0xbddb7d37
.long 0x3f7e70b0,0xbde1bc2e,0x3f7de0b1,0xbe039502,0x3f7de0b1,0xbe039502,0x3f7d1cdd,0xbe195be0
.long 0x3f7d3aac,0xbe164083,0x3f7c3b28,0xbe2f10a2,0x3f7c7eb0,0xbe28defc,0x3f7b3bab,0xbe44b0b9
.long 0x3f7baccd,0xbe3b6ecf,0x3f7a1e84,0xbe5a3997,0x3f7ac516,0xbe4dee60,0x3f78e3d6,0xbe6fa8b2
.long 0x3f79c79d,0xbe605c13,0x3f778bc5,0xbe827dc0,0x3f78b47b,0xbe72b651,0x3f76167a,0xbe8d17c0
.long 0x3f778bc5,0xbe827dc0,0x3f748422,0xbe97a117,0x3f764d97,0xbe8b9507,0x3f72d4eb,0xbea21887
.long 0x3f74fa0b,0xbe94a031,0x3f710908,0xbeac7cd4,0x3f73913f,0xbe9d9e78,0x3f6f20b0,0xbeb6ccc3
.long 0x3f721352,0xbea68f12,0x3f6d1c1d,0xbec1071e,0x3f708066,0xbeaf713a,0x3f6afb8c,0xbecb2aae
.long 0x3f6ed89e,0xbeb8442a,0x3f68bf3c,0xbed53641,0x3f6d1c1d,0xbec1071e,0x3f666771,0xbedf28a9
.long 0x3f6b4b0c,0xbec9b953,0x3f63f473,0xbee900b7,0x3f696591,0xbed25a09,0x3f61668a,0xbef2bd43
.long 0x3f676bd8,0xbedae880,0x3f5ebe05,0xbefc5d27,0x3f655e0b,0xbee363fa,0x3f5bfb34,0xbf02ef9f
.long 0x3f633c5a,0xbeebcbbb,0x3f591e6a,0xbf07a136,0x3f6106f2,0xbef41f07,0x3f5627fe,0xbf0c42c9
.long 0x3f5ebe05,0xbefc5d27,0x3f531849,0xbf10d3cd,0x3f5c61c7,0xbf0242b1,0x3f4fefa8,0xbf1553b7
.long 0x3f59f26a,0xbf064b82,0x3f4cae79,0xbf19c200,0x3f577026,0xbf0a48ad,0x3f495521,0xbf1e1e22
.long 0x3f800000,0x80000000,0x3f800000,0x80000000,0x3f7fec43,0xbcc90ab0,0x3f7fe705,0xbce22a7a
.long 0x3f7fb10f,0xbd48fb30,0x3f7f9c18,0xbd621469,0x3f7f4e6d,0xbd96a905,0x3f7f1f49,0xbda973ba
.long 0x3f7ec46d,0xbdc8bd36,0x3f7e70b0,0xbde1bc2e,0x3f7e1324,0xbdfab273,0x3f7d906e,0xbe0cec4a
.long 0x3f7d3aac,0xbe164083,0x3f7c7eb0,0xbe28defc,0x3f7c3b28,0xbe2f10a2,0x3f7b3bab,0xbe44b0b9
.long 0x3f7b14be,0xbe47c5c2,0x3f79c79d,0xbe605c13,0x3f79c79d,0xbe605c13,0x3f7822d1,0xbe7bdba4
.long 0x3f7853f8,0xbe78cfcc,0x3f764d97,0xbe8b9507,0x3f76ba07,0xbe888e93,0x3f74484b,0xbe9920fe
.long 0x3f74fa0b,0xbe94a031,0x3f721352,0xbea68f12,0x3f731447,0xbea09ae5,0x3f6faf1b,0xbeb3dca5
.long 0x3f710908,0xbeac7cd4,0x3f6d1c1d,0xbec1071e,0x3f6ed89e,0xbeb8442a,0x3f6a5ad9,0xbece0bea
.long 0x3f6c835e,0xbec3ef15,0x3f676bd8,0xbedae880,0x3f6a09a7,0xbecf7bca,0x3f644fac,0xbee79a5d
.long 0x3f676bd8,0xbedae880,0x3f6106f2,0xbef41f07,0x3f64aa59,0xbee63375,0x3f5d924d,0xbf003a06
.long 0x3f61c598,0xbef15aea,0x3f59f26a,0xbf064b82,0x3f5ebe05,0xbefc5d27,0x3f5627fe,0xbf0c42c9
.long 0x3f5b941a,0xbf039c3d,0x3f5233c6,0xbf121eb0,0x3f584853,0xbf08f59b,0x3f4e1689,0xbf17de12
.long 0x3f54db31,0xbf0e39da,0x3f49d112,0xbf1d7fd1,0x3f514d3d,0xbf13682a,0x3f456439,0xbf2302d3
.long 0x3f4d9f02,0xbf187fc0,0x3f40d0da,0xbf286605,0x3f49d112,0xbf1d7fd1,0x3f3c17d9,0xbf2da859
.long 0x3f45e403,0xbf226799,0x3f373a23,0xbf32c8c9,0x3f41d870,0xbf273656,0x3f3238aa,0xbf37c655
.long 0x3f3daef9,0xbf2beb4a,0x3f2d1469,0xbf3ca003,0x3f396842,0xbf3085bb,0x3f27ce61,0xbf4154e1
.long 0x3f800000,0x80000000,0x3f800000,0x80000000,0x3f7fd397,0xbd16c32c,0x3f7fcbe2,0xbd2351cb
.long 0x3f7f4e6d,0xbd96a905,0x3f7f2f9d,0xbda3308c,0x3f7e70b0,0xbde1bc2e,0x3f7e2b72,0xbdf475c0
.long 0x3f7d3aac,0xbe164083,0x3f7cbfc9,0xbe22abb6,0x3f7baccd,0xbe3b6ecf,0x3f7aed37,0xbe4ada4f
.long 0x3f79c79d,0xbe605c13,0x3f78b47b,0xbe72b651,0x3f778bc5,0xbe827dc0,0x3f76167a,0xbe8d17c0
.long 0x3f74fa0b,0xbe94a031,0x3f731447,0xbea09ae5,0x3f721352,0xbea68f12,0x3f6faf1b,0xbeb3dca5
.long 0x3f6ed89e,0xbeb8442a,0x3f6be858,0xbec6d529,0x3f6b4b0c,0xbec9b953,0x3f67c187,0xbed97cb9
.long 0x3f676bd8,0xbedae880,0x3f633c5a,0xbeebcbbb,0x3f633c5a,0xbeebcbbb,0x3f5e5aa6,0xbefdbabb
.long 0x3f5ebe05,0xbefc5d27,0x3f591e6a,0xbf07a136,0x3f59f26a,0xbf064b82,0x3f5389c7,0xbf102dd5
.long 0x3f54db31,0xbf0e39da,0x3f4d9f02,0xbf187fc0,0x3f4f7a1f,0xbf15f6d9,0x3f476085,0xbf209393
.long 0x3f49d112,0xbf1d7fd1,0x3f40d0da,0xbf286605,0x3f43e200,0xbf24d225,0x3f39f2ac,0xbf2ff3e6
.long 0x3f3daef9,0xbf2beb4a,0x3f32c8c9,0xbf373a23,0x3f373a23,0xbf32c8c9,0x3f2b561b,0xbf3e35c5
.long 0x3f3085bb,0xbf396842,0x3f239da9,0xbf44e3f5,0x3f299415,0xbf3fc767,0x3f1ba299,0xbf4b41fa
.long 0x3f226799,0xbf45e403,0x3f13682a,0xbf514d3d,0x3f1b02c6,0xbf4bbbf8,0x3f0af1b7,0xbf570348
.long 0x3f13682a,0xbf514d3d,0x3f0242b1,0xbf5c61c7,0x3f0b9a6b,0xbf5695e5,0x3ef2bd43,0xbf61668a
.long 0x3f039c3d,0xbf5b941a,0x3ee0924f,0xbf660f88,0x3ef6e0cb,0xbf604621,0x3ece0bea,0xbf6a5ad9
.long 0x3ee63375,0xbf64aa59,0x3ebb31a0,0xbf6e46be,0x3ed53641,0xbf68bf3c,0x3ea80b1f,0xbf71d19f
.long 0x3f800000,0x80000000,0x3f800000,0x80000000,0x3f7fe129,0xbcfb49ba,0x3f7fdaaf,0xbd0a342f
.long 0x3f7f84ab,0xbd7b2b74,0x3f7f6ac7,0xbd8a200a,0x3f7eea9d,0xbdbc3ac3,0x3f7eb069,0xbdcefdb7
.long 0x3f7e1324,0xbdfab273,0x3f7dabcc,0xbe09cf86,0x3f7cfe73,0xbe1c76de,0x3f7c5d3a,0xbe2bf804
.long 0x3f7baccd,0xbe3b6ecf,0x3f7ac516,0xbe4dee60,0x3f7a1e84,0xbe5a3997,0x3f78e3d6,0xbe6fa8b2
.long 0x3f7853f8,0xbe78cfcc,0x3f76ba07,0xbe888e93,0x3f764d97,0xbe8b9507,0x3f74484b,0xbe9920fe
.long 0x3f740bdd,0xbe9aa086,0x3f718f57,0xbea986c4,0x3f718f57,0xbea986c4,0x3f6e8ff8,0xbeb9bb1e
.long 0x3f6ed89e,0xbeb8442a,0x3f6b4b0c,0xbec9b953,0x3f6be858,0xbec6d529,0x3f67c187,0xbed97cb9
.long 0x3f68bf3c,0xbed53641,0x3f63f473,0xbee900b7,0x3f655e0b,0xbee363fa,0x3f5fe4e9,0xbef840c8
.long 0x3f61c598,0xbef15aea,0x3f5b941a,0xbf039c3d,0x3f5df6be,0xbeff17b2,0x3f570348,0xbf0af1b7
.long 0x3f59f26a,0xbf064b82,0x3f5233c6,0xbf121eb0,0x3f55b993,0xbf0cead0,0x3f4d26fd,0xbf19210f
.long 0x3f514d3d,0xbf13682a,0x3f47de65,0xbf1ff6cb,0x3f4cae79,0xbf19c200,0x3f425b89,0xbf269de3
.long 0x3f47de65,0xbf1ff6cb,0x3f3ca003,0xbf2d1469,0x3f42de29,0xbf26050a,0x3f36ad7f,0xbf33587a
.long 0x3f3daef9,0xbf2beb4a,0x3f3085bb,0xbf396842,0x3f385216,0xbf31a81d,0x3f2a2a80,0xbf3f41fc
.long 0x3f32c8c9,0xbf373a23,0x3f239da9,0xbf44e3f5,0x3f2d1469,0xbf3ca003,0x3f1ce11f,0xbf4a4c87
.long 0x3f273656,0xbf41d870,0x3f15f6d9,0xbf4f7a1f,0x3f212ff9,0xbf46e22a,0x3f0ee0db,0xbf546b3b
.long 0x3f1b02c6,0xbf4bbbf8,0x3f07a136,0xbf591e6a,0x3f14b039,0xbf5064af,0x3f003a06,0xbf5d924d
.long 0x3f800000,0x80000000,0x3f800000,0x80000000,0x3f7fc38f,0xbd2fe007,0x3f7fba9e,0xbd3c6dd5
.long 0x3f7f0e58,0xbdafb680,0x3f7eea9d,0xbdbc3ac3,0x3f7de0b1,0xbe039502,0x3f7d906e,0xbe0cec4a
.long 0x3f7c3b28,0xbe2f10a2,0x3f7baccd,0xbe3b6ecf,0x3f7a1e84,0xbe5a3997,0x3f7940c0,0xbe698bba
.long 0x3f778bc5,0xbe827dc0,0x3f764d97,0xbe8b9507,0x3f748422,0xbe97a117,0x3f72d4eb,0xbea21887
.long 0x3f710908,0xbeac7cd4,0x3f6ed89e,0xbeb8442a,0x3f6d1c1d,0xbec1071e,0x3f6a5ad9,0xbece0bea
.long 0x3f68bf3c,0xbed53641,0x3f655e0b,0xbee363fa,0x3f63f473,0xbee900b7,0x3f5fe4e9,0xbef840c8
.long 0x3f5ebe05,0xbefc5d27,0x3f59f26a,0xbf064b82,0x3f591e6a,0xbf07a136,0x3f5389c7,0xbf102dd5
.long 0x3f531849,0xbf10d3cd,0x3f4cae79,0xbf19c200,0x3f4cae79,0xbf19c200,0x3f456439,0xbf2302d3
.long 0x3f45e403,0xbf226799,0x3f3daef9,0xbf2beb4a,0x3f3ebc1b,0xbf2ac082,0x3f3592e7,0xbf34768f
.long 0x3f373a23,0xbf32c8c9,0x3f2d1469,0xbf3ca003,0x3f2f61a5,0xbf3a7ca4,0x3f24381a,0xbf446337
.long 0x3f273656,0xbf41d870,0x3f1b02c6,0xbf4bbbf8,0x3f1ebc12,0xbf48d8b3,0x3f11796b,0xbf52a649
.long 0x3f15f6d9,0xbf4f7a1f,0x3f07a136,0xbf591e6a,0x3f0cead0,0xbf55b993,0x3efafef7,0xbf5f20db
.long 0x3f039c3d,0xbf5b941a,0x3ee63375,0xbf64aa59,0x3ef41f07,0xbf6106f2,0x3ed0eb2a,0xbf69b7e4
.long 0x3ee0924f,0xbf660f88,0x3ebb31a0,0xbf6e46be,0x3ecc9b8b,0xbf6aab7b,0x3ea5129f,0xbf725470
.long 0x3eb8442a,0xbf6ed89e,0x3e8e9a22,0xbf75dec6,0x3ea395c5,0xbf7294f8,0x3e6fa8b2,0xbf78e3d6
.long 0x3e8e9a22,0xbf75dec6,0x3e419b37,0xbf7b61fc,0x3e72b651,0xbf78b47b,0x3e1324ca,0xbf7d57de
.long 0x3f800000,0x80000000,0x3f800000,0x80000000,0x3f7fb10f,0xbd48fb30,0x3f7fa6e3,0xbd55880e
.long 0x3f7ec46d,0xbdc8bd36,0x3f7e9bc9,0xbdd53db9,0x3f7d3aac,0xbe164083,0x3f7cdf6c,0xbe1f917b
.long 0x3f7b14be,0xbe47c5c2,0x3f7a7302,0xbe541501,0x3f7853f8,0xbe78cfcc,0x3f77583a,0xbe840270
.long 0x3f74fa0b,0xbe94a031,0x3f73913f,0xbe9d9e78,0x3f710908,0xbeac7cd4,0x3f6f20b0,0xbeb6ccc3
.long 0x3f6c835e,0xbec3ef15,0x3f6a09a7,0xbecf7bca,0x3f676bd8,0xbedae880,0x3f644fac,0xbee79a5d
.long 0x3f61c598,0xbef15aea,0x3f5df6be,0xbeff17b2,0x3f5b941a,0xbf039c3d,0x3f570348,0xbf0af1b7
.long 0x3f54db31,0xbf0e39da,0x3f4f7a1f,0xbf15f6d9,0x3f4d9f02,0xbf187fc0,0x3f476085,0xbf209393
.long 0x3f45e403,0xbf226799,0x3f3ebc1b,0xbf2ac082,0x3f3daef9,0xbf2beb4a,0x3f3592e7,0xbf34768f
.long 0x3f3504f3,0xbf3504f3,0x3f2beb4a,0xbf3daef9,0x3f2beb4a,0xbf3daef9,0x3f21cbfb,0xbf466354
.long 0x3f226799,0xbf45e403,0x3f173c07,0xbf4e8d90,0x3f187fc0,0xbf4d9f02,0x3f0c42c9,0xbf5627fe
.long 0x3f0e39da,0xbf54db31,0x3f00e7e4,0xbf5d2d53,0x3f039c3d,0xbf5b941a,0x3eea6681,0xbf6398ac
.long 0x3ef15aea,0xbf61c598,0x3ed25a09,0xbf696591,0x3edae880,0xbf676bd8,0x3eb9bb1e,0xbf6e8ff8
.long 0x3ec3ef15,0xbf6c835e,0x3ea09ae5,0xbf731447,0x3eac7cd4,0xbf710908,0x3e870ada,0xbf76ef5b
.long 0x3e94a031,0xbf74fa0b,0x3e5a3997,0xbf7a1e84,0x3e78cfcc,0xbf7853f8,0x3e25c58c,0xbf7c9f8a
.long 0x3e47c5c2,0xbf7b14be,0x3de1bc2e,0xbf7e70b0,0x3e164083,0xbf7d3aac,0x3d6ea038,0xbf7f90b1
.long 0x3dc8bd36,0xbf7ec46d,0x3bc90f88,0xbf7ffec4,0x3d48fb30,0xbf7fb10f,0xbd3c6dd5,0xbf7fba9e
.long 0x3f800000,0x80000000,0x3f800000,0x80000000,0x3f7f84ab,0xbd7b2b74,0x3f7f7808,0xbd83db0a
.long 0x3f7e1324,0xbdfab273,0x3f7de0b1,0xbe039502,0x3f7baccd,0xbe3b6ecf,0x3f7b3bab,0xbe44b0b9
.long 0x3f7853f8,0xbe78cfcc,0x3f778bc5,0xbe827dc0,0x3f740bdd,0xbe9aa086,0x3f72d4eb,0xbea21887
.long 0x3f6ed89e,0xbeb8442a,0x3f6d1c1d,0xbec1071e,0x3f68bf3c,0xbed53641,0x3f666771,0xbedf28a9
.long 0x3f61c598,0xbef15aea,0x3f5ebe05,0xbefc5d27,0x3f59f26a,0xbf064b82,0x3f5627fe,0xbf0c42c9
.long 0x3f514d3d,0xbf13682a,0x3f4cae79,0xbf19c200,0x3f47de65,0xbf1ff6cb,0x3f425b89,0xbf269de3
.long 0x3f3daef9,0xbf2beb4a,0x3f373a23,0xbf32c8c9,0x3f32c8c9,0xbf373a23,0x3f2b561b,0xbf3e35c5
.long 0x3f273656,0xbf41d870,0x3f1ebc12,0xbf48d8b3,0x3f1b02c6,0xbf4bbbf8,0x3f11796b,0xbf52a649
.long 0x3f0e39da,0xbf54db31,0x3f039c3d,0xbf5b941a,0x3f00e7e4,0xbf5d2d53,0x3eea6681,0xbf6398ac
.long 0x3ee63375,0xbf64aa59,0x3ecc9b8b,0xbf6aab7b,0x3ec9b953,0xbf6b4b0c,0x3eadf73c,0xbf70c501
.long 0x3eac7cd4,0xbf710908,0x3e8e9a22,0xbf75dec6,0x3e8e9a22,0xbf75dec6,0x3e5d4b1a,0xbf79f35e
.long 0x3e605c13,0xbf79c79d,0x3e1c76de,0xbf7cfe73,0x3e22abb6,0xbf7cbfc9,0x3db5f8da,0xbf7efcc9
.long 0x3dc8bd36,0xbf7ec46d,0x3cc90ab0,0xbf7fec43,0x3d16c32c,0xbf7fd397,0xbd2351cb,0xbf7fcbe2
.long 0xbcc90ab0,0xbf7fec43,0xbdd53db9,0xbf7e9bc9,0xbdafb680,0xbf7f0e58,0xbe2bf804,0xbf7c5d3a
.long 0xbe164083,0xbf7d3aac,0xbe6c9a7f,0xbf791298,0xbe541501,0xbf7a7302,0xbe9620d2,0xbf74bf62
.long 0xbe888e93,0xbf76ba07,0xbeb554ec,0xbf6f6830,0xbea68f12,0xbf721352,0xbed3c867,0xbf6912ae
.long 0x3f800000,0x80000000,0x3f800000,0x80000000,0x3f7f9c18,0xbd621469,0x3f7f90b1,0xbd6ea038
.long 0x3f7e70b0,0xbde1bc2e,0x3f7e4323,0xbdee3876,0x3f7c7eb0,0xbe28defc,0x3f7c187a,0xbe3228d4
.long 0x3f79c79d,0xbe605c13,0x3f791298,0xbe6c9a7f,0x3f764d97,0xbe8b9507,0x3f75341d,0xbe931f35
.long 0x3f721352,0xbea68f12,0x3f708066,0xbeaf713a,0x3f6d1c1d,0xbec1071e,0x3f6afb8c,0xbecb2aae
.long 0x3f676bd8,0xbedae880,0x3f64aa59,0xbee63375,0x3f6106f2,0xbef41f07,0x3f5d924d,0xbf003a06
.long 0x3f59f26a,0xbf064b82,0x3f55b993,0xbf0cead0,0x3f5233c6,0xbf121eb0,0x3f4d26fd,0xbf19210f
.long 0x3f49d112,0xbf1d7fd1,0x3f43e200,0xbf24d225,0x3f40d0da,0xbf286605,0x3f39f2ac,0xbf2ff3e6
.long 0x3f373a23,0xbf32c8c9,0x3f2f61a5,0xbf3a7ca4,0x3f2d1469,0xbf3ca003,0x3f24381a,0xbf446337
.long 0x3f226799,0xbf45e403,0x3f187fc0,0xbf4d9f02,0x3f173c07,0xbf4e8d90,0x3f0c42c9,0xbf5627fe
.long 0x3f0b9a6b,0xbf5695e5,0x3eff17b2,0xbf5df6be,0x3eff17b2,0xbf5df6be,0x3ee4cbfe,0xbf650479
.long 0x3ee63375,0xbf64aa59,0x3ec9b953,0xbf6b4b0c,0x3ecc9b8b,0xbf6aab7b,0x3eadf73c,0xbf70c501
.long 0x3eb263ef,0xbf6ff573,0x3e919ddd,0xbf756d97,0x3e97a117,0xbf748422,0x3e698bba,0xbf7940c0
.long 0x3e78cfcc,0xbf7853f8,0x3e2f10a2,0xbf7c3b28,0x3e419b37,0xbf7b61fc,0x3de7fa9a,0xbf7e5a38
.long 0x3e09cf86,0xbf7dabcc,0x3d621469,0xbf7f9c18,0x3da3308c,0xbf7f2f9d,0xbb490fc6,0xbf7fffb1
.long 0x3cc90ab0,0xbf7fec43,0xbd7b2b74,0xbf7f84ab,0xbcfb49ba,0xbf7fe129,0xbdf475c0,0xbf7e2b72
.long 0xbdafb680,0xbf7f0e58,0xbe354098,0xbf7bf531,0xbe1008b7,0xbf7d7474,0xbe6fa8b2,0xbf78e3d6
.long 0x3f800000,0x80000000,0x3f800000,0x80000000,0x3f7f6ac7,0xbd8a200a,0x3f7f5ce9,0xbd9064b4
.long 0x3f7dabcc,0xbe09cf86,0x3f7d7474,0xbe1008b7,0x3f7ac516,0xbe4dee60,0x3f7a4910,0xbe57278f
.long 0x3f76ba07,0xbe888e93,0x3f75dec6,0xbe8e9a22,0x3f718f57,0xbea986c4,0x3f703b37,0xbeb0eacb
.long 0x3f6b4b0c,0xbec9b953,0x3f696591,0xbed25a09,0x3f63f473,0xbee900b7,0x3f61668a,0xbef2bd43
.long 0x3f5b941a,0xbf039c3d,0x3f584853,0xbf08f59b,0x3f5233c6,0xbf121eb0,0x3f4e1689,0xbf17de12
.long 0x3f47de65,0xbf1ff6cb,0x3f42de29,0xbf26050a,0x3f3ca003,0xbf2d1469,0x3f36ad7f,0xbf33587a
.long 0x3f3085bb,0xbf396842,0x3f299415,0xbf3fc767,0x3f239da9,0xbf44e3f5,0x3f1ba299,0xbf4b41fa
.long 0x3f15f6d9,0xbf4f7a1f,0x3f0cead0,0xbf55b993,0x3f07a136,0xbf591e6a,0x3efafef7,0xbf5f20db
.long 0x3ef15aea,0xbf61c598,0x3edae880,0xbf676bd8,0x3ed25a09,0xbf696591,0x3eb9bb1e,0xbf6e8ff8
.long 0x3eb263ef,0xbf6ff573,0x3e97a117,0xbf748422,0x3e919ddd,0xbf756d97,0x3e698bba,0xbf7940c0
.long 0x3e605c13,0xbf79c79d,0x3e22abb6,0xbf7cbfc9,0x3e1c76de,0xbf7cfe73,0x3db5f8da,0xbf7efcc9
.long 0x3dafb680,0xbf7f0e58,0x3c96c9b6,0xbf7ff4e6,0x3c96c9b6,0xbf7ff4e6,0xbd55880e,0xbf7fa6e3
.long 0xbd48fb30,0xbf7fb10f,0xbdfab273,0xbf7e1324,0xbdee3876,0xbf7e4323,0xbe44b0b9,0xbf7b3bab
.long 0xbe3b6ecf,0xbf7baccd,0xbe8586ce,0xbf772417,0xbe7ee6e1,0xbf77f110,0xbea80b1f,0xbf71d19f
.long 0xbea09ae5,0xbf731447,0xbec9b953,0xbf6b4b0c,0xbec1071e,0xbf6d1c1d,0xbeea6681,0xbf6398ac
.long 0xbee0924f,0xbf660f88,0xbf04f484,0xbf5ac450,0xbeff17b2,0xbf5df6be,0xbf140c5f,0xbf50d937
.long 0x3f800000,0x80000000,0x3f800000,0x80000000,0x3f7f4e6d,0xbd96a905,0x3f7f3f54,0xbd9cecf9
.long 0x3f7d3aac,0xbe164083,0x3f7cfe73,0xbe1c76de,0x3f79c79d,0xbe605c13,0x3f7940c0,0xbe698bba
.long 0x3f74fa0b,0xbe94a031,0x3f740bdd,0xbe9aa086,0x3f6ed89e,0xbeb8442a,0x3f6d67a1,0xbebf926f
.long 0x3f676bd8,0xbedae880,0x3f655e0b,0xbee363fa,0x3f5ebe05,0xbefc5d27,0x3f5bfb34,0xbf02ef9f
.long 0x3f54db31,0xbf0e39da,0x3f514d3d,0xbf13682a,0x3f49d112,0xbf1d7fd1,0x3f456439,0xbf2302d3
.long 0x3f3daef9,0xbf2beb4a,0x3f385216,0xbf31a81d,0x3f3085bb,0xbf396842,0x3f2a2a80,0xbf3f41fc
.long 0x3f226799,0xbf45e403,0x3f1b02c6,0xbf4bbbf8,0x3f13682a,0xbf514d3d,0x3f0af1b7,0xbf570348
.long 0x3f039c3d,0xbf5b941a,0x3ef41f07,0xbf6106f2,0x3ee63375,0xbf64aa59,0x3ed0eb2a,0xbf69b7e4
.long 0x3ec3ef15,0xbf6c835e,0x3eac7cd4,0xbf710908,0x3ea09ae5,0xbf731447,0x3e870ada,0xbf76ef5b
.long 0x3e78cfcc,0xbf7853f8,0x3e419b37,0xbf7b61fc,0x3e2f10a2,0xbf7c3b28,0x3de7fa9a,0xbf7e5a38
.long 0x3dc8bd36,0xbf7ec46d,0x3d16c32c,0xbf7fd397,0x3cc90ab0,0xbf7fec43,0xbd2351cb,0xbf7fcbe2
.long 0xbd48fb30,0xbf7fb10f,0xbdee3876,0xbf7e4323,0xbdfab273,0xbf7e1324,0xbe44b0b9,0xbf7b3bab
.long 0xbe47c5c2,0xbf7b14be,0xbe888e93,0xbf76ba07,0xbe888e93,0xbf76ba07,0xbeadf73c,0xbf70c501
.long 0xbeac7cd4,0xbf710908,0xbed25a09,0xbf696591,0xbecf7bca,0xbf6a09a7,0xbef58035,0xbf60a6cf
.long 0xbef15aea,0xbf61c598,0xbf0b9a6b,0xbf5695e5,0xbf08f59b,0xbf584853,0xbf1ba299,0xbf4b41fa
.long 0xbf187fc0,0xbf4d9f02,0xbf2ac082,0xbf3ebc1b,0xbf273656,0xbf41d870,0xbf38dd65,0xbf311722
.long 0x3f800000,0x80000000,0x3f800000,0x80000000,0x3f7f0e58,0xbdafb680,0x3f7efcc9,0xbdb5f8da
.long 0x3f7c3b28,0xbe2f10a2,0x3f7bf531,0xbe354098,0x3f778bc5,0xbe827dc0,0x3f76ef5b,0xbe870ada
.long 0x3f710908,0xbeac7cd4,0x3f6ff573,0xbeb263ef,0x3f68bf3c,0xbed53641,0x3f671599,0xbedc53c1
.long 0x3f5ebe05,0xbefc5d27,0x3f5c61c7,0xbf0242b1,0x3f531849,0xbf10d3cd,0x3f4fefa8,0xbf1553b7
.long 0x3f45e403,0xbf226799,0x3f41d870,0xbf273656,0x3f373a23,0xbf32c8c9,0x3f3238aa,0xbf37c655
.long 0x3f273656,0xbf41d870,0x3f212ff9,0xbf46e22a,0x3f15f6d9,0xbf4f7a1f,0x3f0ee0db,0xbf546b3b
.long 0x3f039c3d,0xbf5b941a,0x3ef6e0cb,0xbf604621,0x3ee0924f,0xbf660f88,0x3ece0bea,0xbf6a5ad9
.long 0x3eb8442a,0xbf6ed89e,0x3ea395c5,0xbf7294f8,0x3e8e9a22,0xbf75dec6,0x3e6fa8b2,0xbf78e3d6
.long 0x3e47c5c2,0xbf7b14be,0x3e164083,0xbf7d3aac,0x3de1bc2e,0xbf7e70b0,0x3d6ea038,0xbf7f90b1
.long 0x3cc90ab0,0xbf7fec43,0xbcfb49ba,0xbf7fe129,0xbd7b2b74,0xbf7f84ab,0xbdf475c0,0xbf7e2b72
.long 0xbe164083,0xbf7d3aac,0xbe541501,0xbf7a7302,0xbe6c9a7f,0xbf791298,0xbe9620d2,0xbf74bf62
.long 0xbea09ae5,0xbf731447,0xbec1071e,0xbf6d1c1d,0xbec9b953,0xbf6b4b0c,0xbeea6681,0xbf6398ac
.long 0xbef15aea,0xbf61c598,0xbf08f59b,0xbf584853,0xbf0b9a6b,0xbf5695e5,0xbf1ba299,0xbf4b41fa
.long 0xbf1d7fd1,0xbf49d112,0xbf2d1469,0xbf3ca003,0xbf2e3bde,0xbf3b8f3b,0xbf3d27b8,0xbf2c800f
.long 0xbf3daef9,0xbf2beb4a,0xbf4bbbf8,0xbf1b02c6,0xbf4bbbf8,0xbf1b02c6,0xbf58b3a1,0xbf084b92
.long 0xbf584853,0xbf08f59b,0xbf63f473,0xbee900b7,0xbf633c5a,0xbeebcbbb,0xbf6d67a1,0xbebf926f
.long 0x3f800000,0x80000000,0x3f800000,0x80000000,0x3f7f2f9d,0xbda3308c,0x3f7f1f49,0xbda973ba
.long 0x3f7cbfc9,0xbe22abb6,0x3f7c7eb0,0xbe28defc,0x3f78b47b,0xbe72b651,0x3f7822d1,0xbe7bdba4
.long 0x3f731447,0xbea09ae5,0x3f721352,0xbea68f12,0x3f6be858,0xbec6d529,0x3f6a5ad9,0xbece0bea
.long 0x3f633c5a,0xbeebcbbb,0x3f6106f2,0xbef41f07,0x3f591e6a,0xbf07a136,0x3f5627fe,0xbf0c42c9
.long 0x3f4d9f02,0xbf187fc0,0x3f49d112,0xbf1d7fd1,0x3f40d0da,0xbf286605,0x3f3c17d9,0xbf2da859
.long 0x3f32c8c9,0xbf373a23,0x3f2d1469,0xbf3ca003,0x3f239da9,0xbf44e3f5,0x3f1ce11f,0xbf4a4c87
.long 0x3f13682a,0xbf514d3d,0x3f0b9a6b,0xbf5695e5,0x3f0242b1,0xbf5c61c7,0x3ef2bd43,0xbf61668a
.long 0x3ee0924f,0xbf660f88,0x3ecc9b8b,0xbf6aab7b,0x3ebb31a0,0xbf6e46be,0x3ea5129f,0xbf725470
.long 0x3e94a031,0xbf74fa0b,0x3e78cfcc,0xbf7853f8,0x3e5a3997,0xbf7a1e84,0x3e25c58c,0xbf7c9f8a
.long 0x3e09cf86,0xbf7dabcc,0x3da3308c,0xbf7f2f9d,0x3d621469,0xbf7f9c18,0xbb490fc6,0xbf7fffb1
.long 0xbcc90ab0,0xbf7fec43,0xbdafb680,0xbf7f0e58,0xbdd53db9,0xbf7e9bc9,0xbe2bf804,0xbf7c5d3a
.long 0xbe3b6ecf,0xbf7baccd,0xbe7ee6e1,0xbf77f110,0xbe8586ce,0xbf772417,0xbea80b1f,0xbf71d19f
.long 0xbeac7cd4,0xbf710908,0xbecf7bca,0xbf6a09a7,0xbed25a09,0xbf696591,0xbef58035,0xbf60a6cf
.long 0xbef6e0cb,0xbf604621,0xbf0cead0,0xbf55b993,0xbf0cead0,0xbf55b993,0xbf1e1e22,0xbf495521
.long 0xbf1d7fd1,0xbf49d112,0xbf2e3bde,0xbf3b8f3b,0xbf2d1469,0xbf3ca003,0xbf3d27b8,0xbf2c800f
.long 0xbf3b8f3b,0xbf2e3bde,0xbf4ac77f,0xbf1c420c,0xbf48d8b3,0xbf1ebc12,0xbf570348,0xbf0af1b7
.long 0x3f800000,0x80000000,0x3f800000,0x80000000,0x3f7eea9d,0xbdbc3ac3,0x3f7ed7d4,0xbdc27c39
.long 0x3f7baccd,0xbe3b6ecf,0x3f7b61fc,0xbe419b37,0x3f764d97,0xbe8b9507,0x3f75a67b,0xbe901c2c
.long 0x3f6ed89e,0xbeb8442a,0x3f6db293,0xbebe1d4a,0x3f655e0b,0xbee363fa,0x3f6398ac,0xbeea6681
.long 0x3f59f26a,0xbf064b82,0x3f577026,0xbf0a48ad,0x3f4cae79,0xbf19c200,0x3f495521,0xbf1e1e22
.long 0x3f3daef9,0xbf2beb4a,0x3f396842,0xbf3085bb,0x3f2d1469,0xbf3ca003,0x3f27ce61,0xbf4154e1
.long 0x3f1b02c6,0xbf4bbbf8,0x3f14b039,0xbf5064af,0x3f07a136,0xbf591e6a,0x3f003a06,0xbf5d924d
.long 0x3ee63375,0xbf64aa59,0x3ed53641,0xbf68bf3c,0x3ebb31a0,0xbf6e46be,0x3ea80b1f,0xbf71d19f
.long 0x3e8e9a22,0xbf75dec6,0x3e72b651,0xbf78b47b,0x3e419b37,0xbf7b61fc,0x3e1324ca,0xbf7d57de
.long 0x3dc8bd36,0xbf7ec46d,0x3d48fb30,0xbf7fb10f,0x3bc90f88,0xbf7ffec4,0xbd3c6dd5,0xbf7fba9e
.long 0xbdafb680,0xbf7f0e58,0xbe1008b7,0xbf7d7474,0xbe354098,0xbf7bf531,0xbe6fa8b2,0xbf78e3d6
.long 0xbe888e93,0xbf76ba07,0xbea68f12,0xbf721352,0xbeb554ec,0xbf6f6830,0xbed3c867,0xbf6912ae
.long 0xbee0924f,0xbf660f88,0xbeff17b2,0xbf5df6be,0xbf04f484,0xbf5ac450,0xbf140c5f,0xbf50d937
.long 0xbf187fc0,0xbf4d9f02,0xbf273656,0xbf41d870,0xbf2ac082,0xbf3ebc1b,0xbf38dd65,0xbf311722
.long 0xbf3b8f3b,0xbf2e3bde,0xbf48d8b3,0xbf1ebc12,0xbf4ac77f,0xbf1c420c,0xbf570348,0xbf0af1b7
.long 0xbf584853,0xbf08f59b,0xbf633c5a,0xbeebcbbb,0xbf63f473,0xbee900b7,0xbf6d67a1,0xbebf926f
.long 0xbf6db293,0xbebe1d4a,0xbf756d97,0xbe919ddd,0xbf756d97,0xbe919ddd,0xbf7b3bab,0xbe44b0b9
.long 0x3f800000,0x80000000,0x3f800000,0x80000000,0x3f7ec46d,0xbdc8bd36,0x3f7eb069,0xbdcefdb7
.long 0x3f7b14be,0xbe47c5c2,0x3f7ac516,0xbe4dee60,0x3f74fa0b,0xbe94a031,0x3f74484b,0xbe9920fe
.long 0x3f6c835e,0xbec3ef15,0x3f6b4b0c,0xbec9b953,0x3f61c598,0xbef15aea,0x3f5fe4e9,0xbef840c8
.long 0x3f54db31,0xbf0e39da,0x3f5233c6,0xbf121eb0,0x3f45e403,0xbf226799,0x3f425b89,0xbf269de3
.long 0x3f3504f3,0xbf3504f3,0x3f3085bb,0xbf396842,0x3f226799,0xbf45e403,0x3f1ce11f,0xbf4a4c87
.long 0x3f0e39da,0xbf54db31,0x3f07a136,0xbf591e6a,0x3ef15aea,0xbf61c598,0x3ee1fb6a,0xbf65b710
.long 0x3ec3ef15,0xbf6c835e,0x3eb263ef,0xbf6ff573,0x3e94a031,0xbf74fa0b,0x3e80f8c0,0xbf77beb7
.long 0x3e47c5c2,0xbf7b14be,0x3e1c76de,0xbf7cfe73,0x3dc8bd36,0xbf7ec46d,0x3d55880e,0xbf7fa6e3
.long 0x248d3132,0xbf800000,0xbd48fb30,0xbf7fb10f,0xbdc8bd36,0xbf7ec46d,0xbe195be0,0xbf7d1cdd
.long 0xbe47c5c2,0xbf7b14be,0xbe7ee6e1,0xbf77f110,0xbe94a031,0xbf74fa0b,0xbeb0eacb,0xbf703b37
.long 0xbec3ef15,0xbf6c835e,0xbee0924f,0xbf660f88,0xbef15aea,0xbf61c598,0xbf06f686,0xbf5988ad
.long 0xbf0e39da,0xbf54db31,0xbf1c420c,0xbf4ac77f,0xbf226799,0xbf45e403,0xbf2ff3e6,0xbf39f2ac
.long 0xbf3504f3,0xbf3504f3,0xbf41d870,0xbf273656,0xbf45e403,0xbf226799,0xbf51c0c2,0xbf12c39a
.long 0xbf54db31,0xbf0e39da,0xbf5f8327,0xbef9a02d,0xbf61c598,0xbef15aea,0xbf6afb8c,0xbecb2aae
.long 0xbf6c835e,0xbec3ef15,0xbf740bdd,0xbe9aa086,0xbf74fa0b,0xbe94a031,0xbf7a9c59,0xbe5101f1
.long 0xbf7b14be,0xbe47c5c2,0xbf7e9bc9,0xbdd53db9,0xbf7ec46d,0xbdc8bd36,0xbf7fffb1,0xbb490fc6
.long 0x3f800000,0x80000000,0x3f800000,0x80000000,0x3f7e70b0,0xbde1bc2e,0x3f7e5a38,0xbde7fa9a
.long 0x3f79c79d,0xbe605c13,0x3f796e4e,0xbe667c66,0x3f721352,0xbea68f12,0x3f714c7a,0xbeab0201
.long 0x3f676bd8,0xbedae880,0x3f660f88,0xbee0924f,0x3f59f26a,0xbf064b82,0x3f57dc7f,0xbf099f4e
.long 0x3f49d112,0xbf1d7fd1,0x3f46e22a,0xbf212ff9,0x3f373a23,0xbf32c8c9,0x3f33587a,0xbf36ad7f
.long 0x3f226799,0xbf45e403,0x3f1d7fd1,0xbf49d112,0x3f0b9a6b,0xbf5695e5,0x3f05a02c,0xbf5a5ba0
.long 0x3ee63375,0xbf64aa59,0x3ed8106b,0xbf6816a8,0x3eb263ef,0xbf6ff573,0x3ea21887,0xbf72d4eb
.long 0x3e78cfcc,0xbf7853f8,0x3e541501,0xbf7a7302,0x3e09cf86,0xbf7dabcc,0x3dc27c39,0xbf7ed7d4
.long 0x3cc90ab0,0xbf7fec43,0xbc96c9b6,0xbf7ff4e6,0xbdafb680,0xbf7f0e58,0xbe06b26e,0xbf7dc68c
.long 0xbe47c5c2,0xbf7b14be,0xbe78cfcc,0xbf7853f8,0xbe9aa086,0xbf740bdd,0xbeb3dca5,0xbf6faf1b
.long 0xbecf7bca,0xbf6a09a7,0xbee900b7,0xbf63f473,0xbf00e7e4,0xbf5d2d53,0xbf0d9281,0xbf554aa4
.long 0xbf187fc0,0xbf4d9f02,0xbf24d225,0xbf43e200,0xbf2e3bde,0xbf3b8f3b,0xbf39f2ac,0xbf2ff3e6
.long 0xbf41d870,0xbf273656,0xbf4cae79,0xbf19c200,0xbf531849,0xbf10d3cd,0xbf5cc7d1,0xbf019573
.long 0xbf61c598,0xbef15aea,0xbf6a09a7,0xbecf7bca,0xbf6db293,0xbebe1d4a,0xbf74484b,0xbe9920fe
.long 0xbf76ba07,0xbe888e93,0xbf7b61fc,0xbe419b37,0xbf7cbfc9,0xbe22abb6,0xbf7f3f54,0xbd9cecf9
.long 0xbf7fb10f,0xbd48fb30,0xbf7fd397,0x3d16c32c,0xbf7f84ab,0x3d7b2b74,0xbf7d1cdd,0x3e195be0
.long 0xbf7c3b28,0x3e2f10a2,0xbf772417,0x3e8586ce,0xbf75dec6,0x3e8e9a22,0xbf6dfcf2,0x3ebca7af
.long 0x3f800000,0x80000000,0x3f800000,0x80000000,0x3f7e9bc9,0xbdd53db9,0x3f7e868b,0xbddb7d37
.long 0x3f7a7302,0xbe541501,0x3f7a1e84,0xbe5a3997,0x3f73913f,0xbe9d9e78,0x3f72d4eb,0xbea21887
.long 0x3f6a09a7,0xbecf7bca,0x3f68bf3c,0xbed53641,0x3f5df6be,0xbeff17b2,0x3f5bfb34,0xbf02ef9f
.long 0x3f4f7a1f,0xbf15f6d9,0x3f4cae79,0xbf19c200,0x3f3ebc1b,0xbf2ac082,0x3f3b0629,0xbf2ecef7
.long 0x3f2beb4a,0xbf3daef9,0x3f273656,0xbf41d870,0x3f173c07,0xbf4e8d90,0x3f11796b,0xbf52a649
.long 0x3f00e7e4,0xbf5d2d53,0x3ef41f07,0xbf6106f2,0x3ed25a09,0xbf696591,0x3ec27b55,0xbf6cd007
.long 0x3ea09ae5,0xbf731447,0x3e8e9a22,0xbf75dec6,0x3e5a3997,0xbf7a1e84,0x3e3228d4,0xbf7c187a
.long 0x3de1bc2e,0xbf7e70b0,0x3d8a200a,0xbf7f6ac7,0x3bc90f88,0xbf7ffec4,0xbd2351cb,0xbf7fcbe2
.long 0xbdc8bd36,0xbf7ec46d,0xbe164083,0xbf7d3aac,0xbe4dee60,0xbf7ac516,0xbe80f8c0,0xbf77beb7
.long 0xbe9aa086,0xbf740bdd,0xbeb554ec,0xbf6f6830,0xbecc9b8b,0xbf6aab7b,0xbee79a5d,0xbf644fac
.long 0xbefc5d27,0xbf5ebe05,0xbf0b9a6b,0xbf5695e5,0xbf14b039,0xbf5064af,0xbf21cbfb,0xbf466354
.long 0xbf299415,0xbf3fc767,0xbf36206c,0xbf33e7bc,0xbf3ca003,0xbf2d1469,0xbf485bca,0xbf1f599f
.long 0xbf4d9f02,0xbf187fc0,0xbf584853,0xbf08f59b,0xbf5c61c7,0xbf0242b1,0xbf65b710,0xbee1fb6a
.long 0xbf68bf3c,0xbed53641,0xbf708066,0xbeaf713a,0xbf7294f8,0xbea395c5,0xbf788486,0xbe75c35a
.long 0xbf79c79d,0xbe605c13,0xbf7dabcc,0xbe09cf86,0xbf7e4323,0xbdee3876,0xbf7fe705,0xbce22a7a
.long 0xbf7ffb11,0xbc490e90,0xbf7f2f9d,0x3da3308c,0xbf7eea9d,0x3dbc3ac3,0xbf7b87b2,0x3e3e853e
.long 0x3f800000,0x80000000,0x3f800000,0x80000000,0x3f7e4323,0xbdee3876,0x3f7e2b72,0xbdf475c0
.long 0x3f791298,0xbe6c9a7f,0x3f78b47b,0xbe72b651,0x3f708066,0xbeaf713a,0x3f6faf1b,0xbeb3dca5
.long 0x3f64aa59,0xbee63375,0x3f633c5a,0xbeebcbbb,0x3f55b993,0xbf0cead0,0x3f5389c7,0xbf102dd5
.long 0x3f43e200,0xbf24d225,0x3f40d0da,0xbf286605,0x3f2f61a5,0xbf3a7ca4,0x3f2b561b,0xbf3e35c5
.long 0x3f187fc0,0xbf4d9f02,0x3f13682a,0xbf514d3d,0x3eff17b2,0xbf5df6be,0x3ef2bd43,0xbf61668a
.long 0x3ec9b953,0xbf6b4b0c,0x3ebb31a0,0xbf6e46be,0x3e919ddd,0xbf756d97,0x3e80f8c0,0xbf77beb7
.long 0x3e2f10a2,0xbf7c3b28,0x3e09cf86,0xbf7dabcc,0x3d621469,0xbf7f9c18,0x3c7b514b,0xbf7ff84a
.long 0xbd7b2b74,0xbf7f84ab,0xbdd53db9,0xbf7e9bc9,0xbe354098,0xbf7bf531,0xbe636c83,0xbf799b43
.long 0xbe94a031,0xbf74fa0b,0xbeac7cd4,0xbf710908,0xbecc9b8b,0xbf6aab7b,0xbee4cbfe,0xbf650479
.long 0xbf00e7e4,0xbf5d2d53,0xbf0cead0,0xbf55b993,0xbf19c200,0xbf4cae79,0xbf256bcb,0xbf436051
.long 0xbf3085bb,0xbf396842,0xbf3b8f3b,0xbf2e3bde,0xbf44e3f5,0xbf239da9,0xbf4f0417,0xbf16999f
.long 0xbf5695e5,0xbf0b9a6b,0xbf5f8327,0xbef9a02d,0xbf655e0b,0xbee363fa,0xbf6cd007,0xbec27b55
.long 0xbf710908,0xbeac7cd4,0xbf76ba07,0xbe888e93,0xbf796e4e,0xbe667c66,0xbf7d1cdd,0xbe195be0
.long 0xbf7e70b0,0xbde1bc2e,0xbf7fe129,0xbcfb49ba,0xbf7ffec4,0x3bc90f88,0xbf7efcc9,0x3db5f8da
.long 0xbf7e1324,0x3dfab273,0xbf7a7302,0x3e541501,0xbf78b47b,0x3e72b651,0xbf725470,0x3ea5129f
.long 0xbf6ff573,0x3eb263ef,0xbf66becc,0x3eddbe79,0xbf63f473,0x3ee900b7,0xbf57dc7f,0x3f099f4e
.long 0x3f800000,0x80000000,0x3f800000,0x80000000,0x3f7e1324,0xbdfab273,0x3f7dfa38,0xbe007745
.long 0x3f7853f8,0xbe78cfcc,0x3f77f110,0xbe7ee6e1,0x3f6ed89e,0xbeb8442a,0x3f6dfcf2,0xbebca7af
.long 0x3f61c598,0xbef15aea,0x3f604621,0xbef6e0cb,0x3f514d3d,0xbf13682a,0x3f4f0417,0xbf16999f
.long 0x3f3daef9,0xbf2beb4a,0x3f3a7ca4,0xbf2f61a5,0x3f273656,0xbf41d870,0x3f2302d3,0xbf456439
.long 0x3f0e39da,0xbf54db31,0x3f08f59b,0xbf584853,0x3ee63375,0xbf64aa59,0x3ed97cb9,0xbf67c187
.long 0x3eac7cd4,0xbf710908,0x3e9d9e78,0xbf73913f,0x3e605c13,0xbf79c79d,0x3e3e853e,0xbf7b87b2
.long 0x3dc8bd36,0xbf7ec46d,0x3d7b2b74,0xbf7f84ab,0xbcc90ab0,0xbf7fec43,0xbd83db0a,0xbf7f7808
.long 0xbe164083,0xbf7d3aac,0xbe419b37,0xbf7b61fc,0xbe888e93,0xbf76ba07,0xbe9f1cdf,0xbf73530e
.long 0xbec3ef15,0xbf6c835e,0xbedae880,0xbf676bd8,0xbefc5d27,0xbf5ebe05,0xbf099f4e,0xbf57dc7f
.long 0xbf187fc0,0xbf4d9f02,0xbf239da9,0xbf44e3f5,0xbf3085bb,0xbf396842,0xbf3b0629,0xbf2ecef7
.long 0xbf45e403,0xbf226799,0xbf4f7a1f,0xbf15f6d9,0xbf584853,0xbf08f59b,0xbf60a6cf,0xbef58035
.long 0xbf676bd8,0xbedae880,0xbf6e46be,0xbebb31a0,0xbf731447,0xbea09ae5,0xbf7822d1,0xbe7bdba4
.long 0xbf7b14be,0xbe47c5c2,0xbf7e1324,0xbdfab273,0xbf7f4e6d,0xbd96a905,0xbf7fffb1,0x3b490fc6
.long 0xbf7fb10f,0x3d48fb30,0xbf7de0b1,0x3e039502,0xbf7c3b28,0x3e2f10a2,0xbf77beb7,0x3e80f8c0
.long 0xbf74fa0b,0x3e94a031,0xbf6db293,0x3ebe1d4a,0xbf6a09a7,0x3ecf7bca,0xbf5fe4e9,0x3ef840c8
.long 0xbf5b941a,0x3f039c3d,0xbf4e8d90,0x3f173c07,0xbf49d112,0x3f1d7fd1,0xbf39f2ac,0x3f2ff3e6
.long 0x3f800000,0x80000000,0x3f800000,0x80000000,0x3f7dabcc,0xbe09cf86,0x3f7d906e,0xbe0cec4a
.long 0x3f76ba07,0xbe888e93,0x3f764d97,0xbe8b9507,0x3f6b4b0c,0xbec9b953,0x3f6a5ad9,0xbece0bea
.long 0x3f5b941a,0xbf039c3d,0x3f59f26a,0xbf064b82,0x3f47de65,0xbf1ff6cb,0x3f456439,0xbf2302d3
.long 0x3f3085bb,0xbf396842,0x3f2d1469,0xbf3ca003,0x3f15f6d9,0xbf4f7a1f,0x3f11796b,0xbf52a649
.long 0x3ef15aea,0xbf61c598,0x3ee63375,0xbf64aa59,0x3eb263ef,0xbf6ff573,0x3ea5129f,0xbf725470
.long 0x3e605c13,0xbf79c79d,0x3e419b37,0xbf7b61fc,0x3dafb680,0xbf7f0e58,0x3d55880e,0xbf7fa6e3
.long 0xbd48fb30,0xbf7fb10f,0xbdafb680,0xbf7f0e58,0xbe3b6ecf,0xbf7baccd,0xbe636c83,0xbf799b43
.long 0xbea09ae5,0xbf731447,0xbeb554ec,0xbf6f6830,0xbee0924f,0xbf660f88,0xbef58035,0xbf60a6cf
.long 0xbf0e39da,0xbf54db31,0xbf187fc0,0xbf4d9f02,0xbf299415,0xbf3fc767,0xbf33587a,0xbf36ad7f
.long 0xbf41d870,0xbf273656,0xbf4ac77f,0xbf1c420c,0xbf5695e5,0xbf0b9a6b,0xbf5e5aa6,0xbefdbabb
.long 0xbf676bd8,0xbedae880,0xbf6db293,0xbebe1d4a,0xbf740bdd,0xbe9aa086,0xbf788486,0xbe75c35a
.long 0xbf7c3b28,0xbe2f10a2,0xbf7e9bc9,0xbdd53db9,0xbf7fd397,0xbd16c32c,0xbf7fdaaf,0x3d0a342f
.long 0xbf7ec46d,0x3dc8bd36,0xbf7c3b28,0x3e2f10a2,0xbf791298,0x3e6c9a7f,0xbf73ced9,0x3e9c1faf
.long 0xbf6ed89e,0x3eb8442a,0xbf66becc,0x3eddbe79,0xbf604621,0x3ef6e0cb,0xbf554aa4,0x3f0d9281
.long 0xbf4d9f02,0x3f187fc0,0xbf3fc767,0x3f299415,0xbf373a23,0x3f32c8c9,0xbf269de3,0x3f425b89
.long 0xbf1d7fd1,0x3f49d112,0xbf0a48ad,0x3f577026,0xbf00e7e4,0x3f5d2d53,0xbed6a399,0x3f686b39
.long 0x3f800000,0x80000000,0x3f800000,0x80000000,0x3f7de0b1,0xbe039502,0x3f7dc68c,0xbe06b26e
.long 0x3f778bc5,0xbe827dc0,0x3f772417,0xbe8586ce,0x3f6d1c1d,0xbec1071e,0x3f6c3624,0xbec5625c
.long 0x3f5ebe05,0xbefc5d27,0x3f5d2d53,0xbf00e7e4,0x3f4cae79,0xbf19c200,0x3f4a4c87,0xbf1ce11f
.long 0x3f373a23,0xbf32c8c9,0x3f33e7bc,0xbf36206c,0x3f1ebc12,0xbf48d8b3,0x3f1a6293,0xbf4c3578
.long 0x3f039c3d,0xbf5b941a,0x3efc5d27,0xbf5ebe05,0x3ecc9b8b,0xbf6aab7b,0x3ebf926f,0xbf6d67a1
.long 0x3e8e9a22,0xbf75dec6,0x3e7ee6e1,0xbf77f110,0x3e1c76de,0xbf7cfe73,0x3df475c0,0xbf7e2b72
.long 0x3cc90ab0,0xbf7fec43,0xbc490e90,0xbf7ffb11,0xbdd53db9,0xbf7e9bc9,0xbe1324ca,0xbf7d57de
.long 0xbe6c9a7f,0xbf791298,0xbe8b9507,0xbf764d97,0xbeb554ec,0xbf6f6830,0xbecb2aae,0xbf6afb8c
.long 0xbef15aea,0xbf61c598,0xbf039c3d,0xbf5b941a,0xbf14b039,0xbf5064af,0xbf1f599f,0xbf485bca
.long 0xbf2e3bde,0xbf3b8f3b,0xbf385216,0xbf31a81d,0xbf44e3f5,0xbf239da9,0xbf4e1689,0xbf17de12
.long 0xbf584853,0xbf08f59b,0xbf604621,0xbef6e0cb,0xbf6816a8,0xbed8106b,0xbf6e8ff8,0xbeb9bb1e
.long 0xbf740bdd,0xbe9aa086,0xbf78b47b,0xbe72b651,0xbf7bf531,0xbe354098,0xbf7e868b,0xbddb7d37
.long 0xbf7fb10f,0xbd48fb30,0xbf7fec43,0x3cc90ab0,0xbf7f2f9d,0x3da3308c,0xbf7cdf6c,0x3e1f917b
.long 0xbf7a7302,0x3e541501,0xbf756d97,0x3e919ddd,0xbf718f57,0x3ea986c4,0xbf69b7e4,0x3ed0eb2a
.long 0xbf64aa59,0x3ee63375,0xbf59f26a,0x3f064b82,0xbf53fac3,0x3f0f8784,0xbf466354,0x3f21cbfb
.long 0xbf3fc767,0x3f299415,0xbf2f61a5,0x3f3a7ca4,0xbf286605,0x3f40d0da,0xbf1553b7,0x3f4fefa8
.long 0x3f800000,0x80000000,0x3f800000,0x80000000,0x3f7d7474,0xbe1008b7,0x3f7d57de,0xbe1324ca
.long 0x3f75dec6,0xbe8e9a22,0x3f756d97,0xbe919ddd,0x3f696591,0xbed25a09,0x3f686b39,0xbed6a399
.long 0x3f584853,0xbf08f59b,0x3f5695e5,0xbf0b9a6b,0x3f42de29,0xbf26050a,0x3f404c5c,0xbf28fd41
.long 0x3f299415,0xbf3fc767,0x3f26050a,0xbf42de29,0x3f0cead0,0xbf55b993,0x3f084b92,0xbf58b3a1
.long 0x3edae880,0xbf676bd8,0x3ecf7bca,0xbf6a09a7,0x3e97a117,0xbf748422,0x3e8a11f7,0xbf76841b
.long 0x3e22abb6,0xbf7cbfc9,0x3e039502,0xbf7de0b1,0x3c96c9b6,0xbf7ff4e6,0xbc7b514b,0xbf7ff84a
.long 0xbdfab273,0xbf7e1324,0xbe22abb6,0xbf7cbfc9,0xbe8586ce,0xbf772417,0xbe9920fe,0xbf74484b
.long 0xbec9b953,0xbf6b4b0c,0xbeddbe79,0xbf66becc,0xbf04f484,0xbf5ac450,0xbf0ee0db,0xbf546b3b
.long 0xbf226799,0xbf45e403,0xbf2beb4a,0xbf3daef9,0xbf3ca003,0xbf2d1469,0xbf456439,0xbf2302d3
.long 0xbf531849,0xbf10d3cd,0xbf5ac450,0xbf04f484,0xbf655e0b,0xbee363fa,0xbf6b99fb,0xbec8477c
.long 0xbf731447,0xbea09ae5,0xbf778bc5,0xbe827dc0,0xbf7bf531,0xbe354098,0xbf7e5a38,0xbde7fa9a
.long 0xbf7fd397,0xbd16c32c,0xbf7fe129,0x3cfb49ba,0xbf7e9bc9,0x3dd53db9,0xbf7c187a,0x3e3228d4
.long 0xbf7853f8,0x3e78cfcc,0xbf731447,0x3ea09ae5,0xbf6d1c1d,0x3ec1071e,0xbf650479,0x3ee4cbfe
.long 0xbf5d2d53,0x3f00e7e4,0xbf5233c6,0x3f121eb0,0xbf48d8b3,0x3f1ebc12,0xbf3b0629,0x3f2ecef7
.long 0xbf3085bb,0x3f396842,0xbf1ff6cb,0x3f47de65,0xbf14b039,0x3f5064af,0xbf019573,0x3f5cc7d1
.long 0xbeebcbbb,0x3f633c5a,0xbec1071e,0x3f6d1c1d,0xbea986c4,0x3f718f57,0xbe75c35a,0x3f788486
.long 0x3f800000,0x80000000,0x3f800000,0x80000000,0x3f7d3aac,0xbe164083,0x3f7d1cdd,0xbe195be0
.long 0x3f74fa0b,0xbe94a031,0x3f748422,0xbe97a117,0x3f676bd8,0xbedae880,0x3f666771,0xbedf28a9
.long 0x3f54db31,0xbf0e39da,0x3f531849,0xbf10d3cd,0x3f3daef9,0xbf2beb4a,0x3f3b0629,0xbf2ecef7
.long 0x3f226799,0xbf45e403,0x3f1ebc12,0xbf48d8b3,0x3f039c3d,0xbf5b941a,0x3efdbabb,0xbf5e5aa6
.long 0x3ec3ef15,0xbf6c835e,0x3eb8442a,0xbf6ed89e,0x3e78cfcc,0xbf7853f8,0x3e5d4b1a,0xbf79f35e
.long 0x3dc8bd36,0xbf7ec46d,0x3d8a200a,0xbf7f6ac7,0xbd48fb30,0xbf7fb10f,0xbda973ba,0xbf7f1f49
.long 0xbe47c5c2,0xbf7b14be,0xbe6c9a7f,0xbf791298,0xbeac7cd4,0xbf710908,0xbebf926f,0xbf6d67a1
.long 0xbef15aea,0xbf61c598,0xbf0242b1,0xbf5c61c7,0xbf187fc0,0xbf4d9f02,0xbf21cbfb,0xbf466354
.long 0xbf3504f3,0xbf3504f3,0xbf3daef9,0xbf2beb4a,0xbf4d9f02,0xbf187fc0,0xbf554aa4,0xbf0d9281
.long 0xbf61c598,0xbef15aea,0xbf6816a8,0xbed8106b,0xbf710908,0xbeac7cd4,0xbf75a67b,0xbe901c2c
.long 0xbf7b14be,0xbe47c5c2,0xbf7dabcc,0xbe09cf86,0xbf7fb10f,0xbd48fb30,0xbf7ff84a,0x3c7b514b
.long 0xbf7ec46d,0x3dc8bd36,0xbf7c7eb0,0x3e28defc,0xbf7853f8,0x3e78cfcc,0xbf73530e,0x3e9f1cdf
.long 0xbf6c835e,0x3ec3ef15,0xbf64aa59,0x3ee63375,0xbf5b941a,0x3f039c3d,0xbf50d937,0x3f140c5f
.long 0xbf45e403,0x3f226799,0xbf385216,0x3f31a81d,0xbf2beb4a,0x3f3daef9,0xbf1ba299,0x3f4b41fa
.long 0xbf0e39da,0x3f54db31,0xbef6e0cb,0x3f604621,0xbedae880,0x3f676bd8,0xbeb0eacb,0x3f703b37
.long 0xbe94a031,0x3f74fa0b,0xbe4dee60,0x3f7ac516,0xbe164083,0x3f7d3aac,0xbd55880e,0x3f7fa6e3
.long 0x3f800000,0x80000000,0x3f800000,0x80000000,0x3f7cbfc9,0xbe22abb6,0x3f7c9f8a,0xbe25c58c
.long 0x3f731447,0xbea09ae5,0x3f7294f8,0xbea395c5,0x3f633c5a,0xbeebcbbb,0x3f62241a,0xbeeff7fb
.long 0x3f4d9f02,0xbf187fc0,0x3f4bbbf8,0xbf1b02c6,0x3f32c8c9,0xbf373a23,0x3f2ff3e6,0xbf39f2ac
.long 0x3f13682a,0xbf514d3d,0x3f0f8784,0xbf53fac3,0x3ee0924f,0xbf660f88,0x3ed6a399,0xbf686b39
.long 0x3e94a031,0xbf74fa0b,0x3e888e93,0xbf76ba07,0x3e09cf86,0xbf7dabcc,0x3ddb7d37,0xbf7e868b
.long 0xbcc90ab0,0xbf7fec43,0xbd621469,0xbf7f9c18,0xbe3b6ecf,0xbf7baccd,0xbe5d4b1a,0xbf79f35e
.long 0xbeac7cd4,0xbf710908,0xbebe1d4a,0xbf6db293,0xbef6e0cb,0xbf604621,0xbf044889,0xbf5b2c79
.long 0xbf1d7fd1,0xbf49d112,0xbf26050a,0xbf42de29,0xbf3b8f3b,0xbf2e3bde,0xbf436051,0xbf256bcb
.long 0xbf54db31,0xbf0e39da,0xbf5b941a,0xbf039c3d,0xbf68bf3c,0xbed53641,0xbf6dfcf2,0xbebca7af
.long 0xbf76ba07,0xbe888e93,0xbf7a1e84,0xbe5a3997,0xbf7e70b0,0xbde1bc2e,0xbf7fa6e3,0xbd55880e
.long 0xbf7fb10f,0x3d48fb30,0xbf7e70b0,0x3de1bc2e,0xbf7a7302,0x3e541501,0xbf76841b,0x3e8a11f7
.long 0xbf6ed89e,0x3eb8442a,0xbf6816a8,0x3ed8106b,0xbf5d2d53,0x3f00e7e4,0xbf5389c7,0x3f102dd5
.long 0xbf45e403,0x3f226799,0xbf396842,0x3f3085bb,0xbf299415,0x3f3fc767,0xbf1a6293,0x3f4c3578
.long 0xbf08f59b,0x3f584853,0xbeee9479,0x3f628210,0xbec9b953,0x3f6b4b0c,0xbea21887,0x3f72d4eb
.long 0xbe78cfcc,0x3f7853f8,0xbe22abb6,0x3f7cbfc9,0xbdafb680,0x3f7f0e58,0x3b490fc6,0x3f7fffb1
.long 0x3d96a905,0x3f7f4e6d,0x3e28defc,0x3f7c7eb0,0x3e6c9a7f,0x3f791298,0x3ea5129f,0x3f725470
.long 0x3f800000,0x80000000,0x3f800000,0x80000000,0x3f7cfe73,0xbe1c76de,0x3f7cdf6c,0xbe1f917b
.long 0x3f740bdd,0xbe9aa086,0x3f73913f,0xbe9d9e78,0x3f655e0b,0xbee363fa,0x3f644fac,0xbee79a5d
.long 0x3f514d3d,0xbf13682a,0x3f4f7a1f,0xbf15f6d9,0x3f385216,0xbf31a81d,0x3f3592e7,0xbf34768f
.long 0x3f1b02c6,0xbf4bbbf8,0x3f173c07,0xbf4e8d90,0x3ef41f07,0xbf6106f2,0x3eea6681,0xbf6398ac
.long 0x3eac7cd4,0xbf710908,0x3ea09ae5,0xbf731447,0x3e419b37,0xbf7b61fc,0x3e25c58c,0xbf7c9f8a
.long 0x3d16c32c,0xbf7fd397,0x3bc90f88,0xbf7ffec4,0xbdee3876,0xbf7e4323,0xbe195be0,0xbf7d1cdd
.long 0xbe888e93,0xbf76ba07,0xbe9aa086,0xbf740bdd,0xbed25a09,0xbf696591,0xbee4cbfe,0xbf650479
.long 0xbf0b9a6b,0xbf5695e5,0xbf14b039,0xbf5064af,0xbf2ac082,0xbf3ebc1b,0xbf33587a,0xbf36ad7f
.long 0xbf45e403,0xbf226799,0xbf4d9f02,0xbf187fc0,0xbf5c61c7,0xbf0242b1,0xbf62df7b,0xbeed3063
.long 0xbf6db293,0xbebe1d4a,0xbf7294f8,0xbea395c5,0xbf796e4e,0xbe667c66,0xbf7c5d3a,0xbe2bf804
.long 0xbf7f4e6d,0xbd96a905,0xbf7ffb11,0xbc490e90,0xbf7f2f9d,0x3da3308c,0xbf7d57de,0x3e1324ca
.long 0xbf791298,0x3e6c9a7f,0xbf748422,0x3e97a117,0xbf6d1c1d,0x3ec1071e,0xbf65b710,0x3ee1fb6a
.long 0xbf5b941a,0x3f039c3d,0xbf514d3d,0x3f13682a,0xbf44e3f5,0x3f239da9,0xbf37c655,0x3f3238aa
.long 0xbf299415,0x3f3fc767,0xbf19c200,0x3f4cae79,0xbf0a48ad,0x3f577026,0xbeeff7fb,0x3f62241a
.long 0xbecf7bca,0x3f6a09a7,0xbea68f12,0x3f721352,0xbe8586ce,0x3f772417,0xbe3228d4,0x3f7c187a
.long 0xbde1bc2e,0x3f7e70b0,0xbc96c9b6,0x3f7ff4e6,0x3d2fe007,0x3f7fc38f,0x3e0cec4a,0x3f7d906e
.long 0x3f800000,0x80000000,0x3f800000,0x80000000,0x3f7c7eb0,0xbe28defc,0x3f7c5d3a,0xbe2bf804
.long 0x3f721352,0xbea68f12,0x3f718f57,0xbea986c4,0x3f6106f2,0xbef41f07,0x3f5fe4e9,0xbef840c8
.long 0x3f49d112,0xbf1d7fd1,0x3f47de65,0xbf1ff6cb,0x3f2d1469,0xbf3ca003,0x3f2a2a80,0xbf3f41fc
.long 0x3f0b9a6b,0xbf5695e5,0x3f07a136,0xbf591e6a,0x3ecc9b8b,0xbf6aab7b,0x3ec27b55,0xbf6cd007
.long 0x3e78cfcc,0xbf7853f8,0x3e605c13,0xbf79c79d,0x3da3308c,0xbf7f2f9d,0x3d55880e,0xbf7fa6e3
.long 0xbdafb680,0xbf7f0e58,0xbdee3876,0xbf7e4323,0xbe7ee6e1,0xbf77f110,0xbe901c2c,0xbf75a67b
.long 0xbecf7bca,0xbf6a09a7,0xbee0924f,0xbf660f88,0xbf0cead0,0xbf55b993,0xbf1553b7,0xbf4fefa8
.long 0xbf2e3bde,0xbf3b8f3b,0xbf36206c,0xbf33e7bc,0xbf4ac77f,0xbf1c420c,0xbf51c0c2,0xbf12c39a
.long 0xbf61c598,0xbef15aea,0xbf676bd8,0xbedae880,0xbf7294f8,0xbea395c5,0xbf76841b,0xbe8a11f7
.long 0xbf7cbfc9,0xbe22abb6,0xbf7e9bc9,0xbdd53db9,0xbf7ffec4,0x3bc90f88,0xbf7f7808,0x3d83db0a
.long 0xbf7c3b28,0x3e2f10a2,0xbf791298,0x3e6c9a7f,0xbf718f57,0x3ea986c4,0xbf6b99fb,0x3ec8477c
.long 0xbf604621,0x3ef6e0cb,0xbf577026,0x3f0a48ad,0xbf48d8b3,0x3f1ebc12,0xbf3d27b8,0x3f2c800f
.long 0xbf2beb4a,0x3f3daef9,0xbf1d7fd1,0x3f49d112,0xbf0a48ad,0x3f577026,0xbef2bd43,0x3f61668a
.long 0xbec9b953,0x3f6b4b0c,0xbea395c5,0x3f7294f8,0xbe72b651,0x3f78b47b,0xbe1f917b,0x3f7cdf6c
.long 0xbd96a905,0x3f7f4e6d,0x3c490e90,0x3f7ffb11,0x3dbc3ac3,0x3f7eea9d,0x3e3857ec,0x3f7bd14d
.long 0x3e827dc0,0x3f778bc5,0x3eaf713a,0x3f708066,0x3ed25a09,0x3f696591,0x3efdbabb,0x3f5e5aa6
.long 0x3f800000,0x80000000,0x3f800000,0x80000000,0x3f7c3b28,0xbe2f10a2,0x3f7c187a,0xbe3228d4
.long 0x3f710908,0xbeac7cd4,0x3f708066,0xbeaf713a,0x3f5ebe05,0xbefc5d27,0x3f5d924d,0xbf003a06
.long 0x3f45e403,0xbf226799,0x3f43e200,0xbf24d225,0x3f273656,0xbf41d870,0x3f24381a,0xbf446337
.long 0x3f039c3d,0xbf5b941a,0x3eff17b2,0xbf5df6be,0x3eb8442a,0xbf6ed89e,0x3eadf73c,0xbf70c501
.long 0x3e47c5c2,0xbf7b14be,0x3e2f10a2,0xbf7c3b28,0x3cc90ab0,0xbf7fec43,0xbb490fc6,0xbf7fffb1
.long 0xbe164083,0xbf7d3aac,0xbe354098,0xbf7bf531,0xbea09ae5,0xbf731447,0xbeb0eacb,0xbf703b37
.long 0xbef15aea,0xbf61c598,0xbf00e7e4,0xbf5d2d53,0xbf1d7fd1,0xbf49d112,0xbf256bcb,0xbf436051
.long 0xbf3daef9,0xbf2beb4a,0xbf44e3f5,0xbf239da9,0xbf584853,0xbf08f59b,0xbf5e5aa6,0xbefdbabb
.long 0xbf6c835e,0xbec3ef15,0xbf710908,0xbeac7cd4,0xbf79c79d,0xbe605c13,0xbf7c5d3a,0xbe2bf804
.long 0xbf7fb10f,0xbd48fb30,0xbf7ffec4,0x3bc90f88,0xbf7e1324,0x3dfab273,0xbf7bd14d,0x3e3857ec
.long 0xbf74fa0b,0x3e94a031,0xbf6ff573,0x3eb263ef,0xbf64aa59,0x3ee63375,0xbf5cc7d1,0x3f019573
.long 0xbf4d9f02,0x3f187fc0,0xbf42de29,0x3f26050a,0xbf3085bb,0x3f396842,0xbf2302d3,0x3f456439
.long 0xbf0e39da,0x3f54db31,0xbefc5d27,0x3f5ebe05,0xbecf7bca,0x3f6a09a7,0xbeab0201,0x3f714c7a
.long 0xbe78cfcc,0x3f7853f8,0xbe28defc,0x3f7c7eb0,0xbd96a905,0x3f7f4e6d,0x3c16cb58,0x3f7ffd39
.long 0x3dc8bd36,0x3f7ec46d,0x3e3b6ecf,0x3f7baccd,0x3e888e93,0x3f76ba07,0x3eb3dca5,0x3f6faf1b
.long 0x3edae880,0x3f676bd8,0x3f0242b1,0x3f5c61c7,0x3f13682a,0x3f514d3d,0x3f269de3,0x3f425b89
.long 0x3f800000,0x80000000,0x3f800000,0x80000000,0x3f7baccd,0xbe3b6ecf,0x3f7b87b2,0xbe3e853e
.long 0x3f6ed89e,0xbeb8442a,0x3f6e46be,0xbebb31a0,0x3f59f26a,0xbf064b82,0x3f58b3a1,0xbf084b92
.long 0x3f3daef9,0xbf2beb4a,0x3f3b8f3b,0xbf2e3bde,0x3f1b02c6,0xbf4bbbf8,0x3f17de12,0xbf4e1689
.long 0x3ee63375,0xbf64aa59,0x3eddbe79,0xbf66becc,0x3e8e9a22,0xbf75dec6,0x3e840270,0xbf77583a
.long 0x3dc8bd36,0xbf7ec46d,0x3d96a905,0xbf7f4e6d,0xbdafb680,0xbf7f0e58,0xbde7fa9a,0xbf7e5a38
.long 0xbe888e93,0xbf76ba07,0xbe97a117,0xbf748422,0xbee0924f,0xbf660f88,0xbeeff7fb,0xbf62241a
.long 0xbf187fc0,0xbf4d9f02,0xbf1ff6cb,0xbf47de65,0xbf3b8f3b,0xbf2e3bde,0xbf425b89,0xbf269de3
.long 0xbf584853,0xbf08f59b,0xbf5df6be,0xbeff17b2,0xbf6db293,0xbebe1d4a,0xbf71d19f,0xbea80b1f
.long 0xbf7b14be,0xbe47c5c2,0xbf7d3aac,0xbe164083,0xbf7ffb11,0xbc490e90,0xbf7fcbe2,0x3d2351cb
.long 0xbf7c3b28,0x3e2f10a2,0xbf796e4e,0x3e667c66,0xbf6ff573,0x3eb263ef,0xbf6a5ad9,0x3ece0bea
.long 0xbf5b941a,0x3f039c3d,0xbf531849,0x3f10d3cd,0xbf3fc767,0x3f299415,0xbf34768f,0x3f3592e7
.long 0xbf1d7fd1,0x3f49d112,0xbf0f8784,0x3f53fac3,0xbeebcbbb,0x3f633c5a,0xbecb2aae,0x3f6afb8c
.long 0xbe94a031,0x3f74fa0b,0xbe605c13,0x3f79c79d,0xbde1bc2e,0x3f7e70b0,0xbd0a342f,0x3f7fdaaf
.long 0x3d96a905,0x3f7f4e6d,0x3e1c76de,0x3f7cfe73,0x3e827dc0,0x3f778bc5,0x3eab0201,0x3f714c7a
.long 0x3edae880,0x3f676bd8,0x3f00e7e4,0x3f5d2d53,0x3f15f6d9,0x3f4f7a1f,0x3f27ce61,0x3f4154e1
.long 0x3f396842,0x3f3085bb,0x3f48d8b3,0x3f1ebc12,0x3f5695e5,0x3f0b9a6b,0x3f62df7b,0x3eed3063
.long 0x3f800000,0x80000000,0x3f800000,0x80000000,0x3f7bf531,0xbe354098,0x3f7bd14d,0xbe3857ec
.long 0x3f6ff573,0xbeb263ef,0x3f6f6830,0xbeb554ec,0x3f5c61c7,0xbf0242b1,0x3f5b2c79,0xbf044889
.long 0x3f41d870,0xbf273656,0x3f3fc767,0xbf299415,0x3f212ff9,0xbf46e22a,0x3f1e1e22,0xbf495521
.long 0x3ef6e0cb,0xbf604621,0x3eee9479,0xbf628210,0x3ea395c5,0xbf7294f8,0x3e9920fe,0xbf74484b
.long 0x3e164083,0xbf7d3aac,0x3dfab273,0xbf7e1324,0xbcfb49ba,0xbf7fe129,0xbd6ea038,0xbf7f90b1
.long 0xbe541501,0xbf7a7302,0xbe72b651,0xbf78b47b,0xbec1071e,0xbf6d1c1d,0xbed0eb2a,0xbf69b7e4
.long 0xbf08f59b,0xbf584853,0xbf10d3cd,0xbf531849,0xbf2d1469,0xbf3ca003,0xbf34768f,0xbf3592e7
.long 0xbf4bbbf8,0xbf1b02c6,0xbf5233c6,0xbf121eb0,0xbf63f473,0xbee900b7,0xbf6912ae,0xbed3c867
.long 0xbf74fa0b,0xbe94a031,0xbf7853f8,0xbe78cfcc,0xbf7e4323,0xbdee3876,0xbf7f7808,0xbd83db0a
.long 0xbf7f84ab,0x3d7b2b74,0xbf7e4323,0x3dee3876,0xbf78b47b,0x3e72b651,0xbf74bf62,0x3e9620d2
.long 0xbf6a09a7,0x3ecf7bca,0xbf633c5a,0x3eebcbbb,0xbf53fac3,0x3f0f8784,0xbf4a4c87,0x3f1ce11f
.long 0xbf373a23,0x3f32c8c9,0xbf2ac082,0x3f3ebc1b,0xbf14b039,0x3f5064af,0xbf05a02c,0x3f5a5ba0
.long 0xbedae880,0x3f676bd8,0xbeb8442a,0x3f6ed89e,0xbe8586ce,0x3f772417,0xbe3e853e,0x3f7b87b2
.long 0xbdafb680,0x3f7f0e58,0xbbc90f88,0x3f7ffec4,0x3dbc3ac3,0x3f7eea9d,0x3e3228d4,0x3f7c187a
.long 0x3e888e93,0x3f76ba07,0x3eb263ef,0x3f6ff573,0x3eddbe79,0x3f66becc,0x3f02ef9f,0x3f5bfb34
.long 0x3f15f6d9,0x3f4f7a1f,0x3f286605,0x3f40d0da,0x3f385216,0x3f31a81d,0x3f485bca,0x3f1f599f
.long 0x3f800000,0x80000000,0x3f800000,0x80000000,0x3f7b61fc,0xbe419b37,0x3f7b3bab,0xbe44b0b9
.long 0x3f6db293,0xbebe1d4a,0x3f6d1c1d,0xbec1071e,0x3f577026,0xbf0a48ad,0x3f5627fe,0xbf0c42c9
.long 0x3f396842,0xbf3085bb,0x3f373a23,0xbf32c8c9,0x3f14b039,0xbf5064af,0x3f11796b,0xbf52a649
.long 0x3ed53641,0xbf68bf3c,0x3ecc9b8b,0xbf6aab7b,0x3e72b651,0xbf78b47b,0x3e5d4b1a,0xbf79f35e
.long 0x3d48fb30,0xbf7fb10f,0x3cc90ab0,0xbf7fec43,0xbe1008b7,0xbf7d7474,0xbe2bf804,0xbf7c5d3a
.long 0xbea68f12,0xbf721352,0xbeb554ec,0xbf6f6830,0xbeff17b2,0xbf5df6be,0xbf06f686,0xbf5988ad
.long 0xbf273656,0xbf41d870,0xbf2e3bde,0xbf3b8f3b,0xbf48d8b3,0xbf1ebc12,0xbf4f0417,0xbf16999f
.long 0xbf633c5a,0xbeebcbbb,0xbf6816a8,0xbed8106b,0xbf756d97,0xbe919ddd,0xbf788486,0xbe75c35a
.long 0xbf7ec46d,0xbdc8bd36,0xbf7fb10f,0xbd48fb30,0xbf7eea9d,0x3dbc3ac3,0xbf7d57de,0x3e1324ca
.long 0xbf75dec6,0x3e8e9a22,0xbf718f57,0x3ea986c4,0xbf63f473,0x3ee900b7,0xbf5cc7d1,0x3f019573
.long 0xbf49d112,0x3f1d7fd1,0xbf3fc767,0x3f299415,0xbf286605,0x3f40d0da,0xbf1ba299,0x3f4b41fa
.long 0xbf00e7e4,0x3f5d2d53,0xbee363fa,0x3f655e0b,0xbea986c4,0x3f718f57,0xbe870ada,0x3f76ef5b
.long 0xbe164083,0x3f7d3aac,0xbd96a905,0x3f7f4e6d,0x3d2fe007,0x3f7fc38f,0x3df475c0,0x3f7e2b72
.long 0x3e6c9a7f,0x3f791298,0x3e9d9e78,0x3f73913f,0x3ed25a09,0x3f696591,0x3ef840c8,0x3f5fe4e9
.long 0x3f13682a,0x3f514d3d,0x3f24d225,0x3f43e200,0x3f385216,0x3f31a81d,0x3f476085,0x3f209393
.long 0x3f5695e5,0x3f0b9a6b,0x3f628210,0x3eee9479,0x3f6d1c1d,0x3ec1071e,0x3f75341d,0x3e931f35
.long 0x35e38e39,0x0,0x35e38e39,0x0,0x35e38e39,0x0,0x35e38df3,0x31b2b8b0
.long 0x35e38e39,0x0,0x35e38d20,0x3232b879,0x35e38e39,0x0,0x35e38bc1,0x32860a16
.long 0x35e38e39,0x0,0x35e389d6,0x32b2b79c,0x35e38e39,0x0,0x35e3875e,0x32df64b5
.long 0x35e38e39,0x0,0x35e3845a,0x330608a2,0x35e38e39,0x0,0x35e380ca,0x331c5e96
.long 0x35e38e39,0x0,0x35e37cad,0x3332b42a,0x35e38e39,0x0,0x35e37804,0x33490950
.long 0x35e38e39,0x0,0x35e372cf,0x335f5dfa,0x35e38e39,0x0,0x35e36d0d,0x3375b21a
.long 0x35e38e39,0x0,0x35e366c0,0x338602d1,0x35e38e39,0x0,0x35e35fe5,0x33912c43
.long 0x35e38e39,0x0,0x35e3587f,0x339c555b,0x35e38e39,0x0,0x35e3508c,0x33a77e13
.long 0x35e38e39,0x0,0x35e3480d,0x33b2a663,0x35e38e39,0x0,0x35e33f02,0x33bdce45
.long 0x35e38e39,0x0,0x35e3356b,0x33c8f5b2,0x35e38e39,0x0,0x35e32b48,0x33d41ca3
.long 0x35e38e39,0x0,0x35e32098,0x33df4312,0x35e38e39,0x0,0x35e3155d,0x33ea68f6
.long 0x35e38e39,0x0,0x35e30995,0x33f58e4a,0x35e38e39,0x0,0x35e2fd41,0x34005983
.long 0x35e38e39,0x0,0x35e2f061,0x3405eb92,0x35e38e39,0x0,0x35e2e2f5,0x340b7d4f
.long 0x35e38e39,0x0,0x35e2d4fe,0x34110eb5,0x35e38e39,0x0,0x35e2c67a,0x34169fc2
.long 0x35e38e39,0x0,0x35e2b76b,0x341c3072,0x35e38e39,0x0,0x35e2a7cf,0x3421c0c2
.long 0x35e38e39,0x0,0x35e297a8,0x342750ae,0x35e38e39,0x0,0x35e286f5,0x342ce032
.long 0x35e38e39,0x0,0x35e38e39,0x0,0x35e389d6,0x32b2b79c,0x35e3875e,0x32df64b5
.long 0x35e37cad,0x3332b42a,0x35e372cf,0x335f5dfa,0x35e366c0,0x338602d1,0x35e3508c,0x33a77e13
.long 0x35e3480d,0x33b2a663,0x35e32098,0x33df4312,0x35e32098,0x33df4312,0x35e2e2f5,0x340b7d4f
.long 0x35e2f061,0x3405eb92,0x35e297a8,0x342750ae,0x35e2b76b,0x341c3072,0x35e23eb4,0x344319f8
.long 0x35e275b6,0x34326f4c,0x35e1d820,0x345ed782,0x35e22b47,0x3448a746,0x35e163f0,0x347a87a0
.long 0x35e1d820,0x345ed782,0x35e0e22d,0x348b1453,0x35e17c43,0x3474ff28,0x35e052de,0x3498dc76
.long 0x35e117b5,0x34858eae,0x35dfb60c,0x34a69b63,0x35e0aa7a,0x349098a1,0x35df0bbf,0x34b45046
.long 0x35e03495,0x349b9d02,0x35de5404,0x34c1fa4e,0x35dfb60c,0x34a69b63,0x35dd8ee3,0x34cf98a6
.long 0x35df2ee2,0x34b19357,0x35dcbc6b,0x34dd2a7c,0x35de9f1e,0x34bc8473,0x35dbdca6,0x34eaaf00
.long 0x35de06c5,0x34c76e4a,0x35daefa2,0x34f82561,0x35dd65dc,0x34d25071,0x35d9f56f,0x3502c668
.long 0x35dcbc6b,0x34dd2a7c,0x35d8ee1a,0x3509723e,0x35dc0a76,0x34e7fc01,0x35d7d9b4,0x351015cd
.long 0x35db5006,0x34f2c494,0x35d6b84e,0x3516b0ae,0x35da8d22,0x34fd83cb,0x35d589f8,0x351d427b
.long 0x35d9c1d1,0x35041c9e,0x35d44ec5,0x3523cad0,0x35d8ee1a,0x3509723e,0x35d306c8,0x352a4946
.long 0x35d81207,0x350ec292,0x35d1b215,0x3530bd7a,0x35d72d9f,0x35140d65,0x35d050c1,0x35372709
.long 0x35d640eb,0x35195283,0x35cee2e0,0x353d858f,0x35d54bf5,0x351e91b8,0x35cd6888,0x3543d8ab
.long 0x35d44ec5,0x3523cad0,0x35cbe1d1,0x354a1ffb,0x35d34966,0x3528fd97,0x35ca4ed2,0x35505b1e
.long 0x35e38e39,0x0,0x35e38e39,0x0,0x35e38d20,0x3232b879,0x35e38bc1,0x32860a16
.long 0x35e389d6,0x32b2b79c,0x35e3845a,0x330608a2,0x35e3845a,0x330608a2,0x35e37804,0x33490950
.long 0x35e37cad,0x3332b42a,0x35e366c0,0x338602d1,0x35e372cf,0x335f5dfa,0x35e3508c,0x33a77e13
.long 0x35e366c0,0x338602d1,0x35e3356b,0x33c8f5b2,0x35e3587f,0x339c555b,0x35e3155d,0x33ea68f6
.long 0x35e3480d,0x33b2a663,0x35e2f061,0x3405eb92,0x35e3356b,0x33c8f5b2,0x35e2c67a,0x34169fc2
.long 0x35e32098,0x33df4312,0x35e297a8,0x342750ae,0x35e30995,0x33f58e4a,0x35e263ec,0x3437fdf8
.long 0x35e2f061,0x3405eb92,0x35e22b47,0x3448a746,0x35e2d4fe,0x34110eb5,0x35e1edbb,0x34594c39
.long 0x35e2b76b,0x341c3072,0x35e1ab48,0x3469ec76,0x35e297a8,0x342750ae,0x35e163f0,0x347a87a0
.long 0x35e275b6,0x34326f4c,0x35e117b5,0x34858eae,0x35e25196,0x343d8c33,0x35e0c699,0x348dd6a6
.long 0x35e22b47,0x3448a746,0x35e0709c,0x34961b8b,0x35e202ca,0x3453c069,0x35e015c2,0x349e5d2e
.long 0x35e1d820,0x345ed782,0x35dfb60c,0x34a69b63,0x35e1ab48,0x3469ec76,0x35df517b,0x34aed5fa
.long 0x35e17c43,0x3474ff28,0x35dee813,0x34b70cc7,0x35e14b12,0x348007bf,0x35de79d6,0x34bf3f9b
.long 0x35e117b5,0x34858eae,0x35de06c5,0x34c76e4a,0x35e0e22d,0x348b1453,0x35dd8ee3,0x34cf98a6
.long 0x35e0aa7a,0x349098a1,0x35dd1234,0x34d7be81,0x35e0709c,0x34961b8b,0x35dc90b9,0x34dfdfae
.long 0x35e03495,0x349b9d02,0x35dc0a76,0x34e7fc01,0x35dff665,0x34a11cf9,0x35db7f6e,0x34f0134b
.long 0x35dfb60c,0x34a69b63,0x35daefa2,0x34f82561,0x35df738b,0x34ac1831,0x35da5b18,0x3500190b
.long 0x35e38e39,0x0,0x35e38e39,0x0,0x35e3845a,0x330608a2,0x35e380ca,0x331c5e96
.long 0x35e366c0,0x338602d1,0x35e3587f,0x339c555b,0x35e3356b,0x33c8f5b2,0x35e3155d,0x33ea68f6
.long 0x35e2f061,0x3405eb92,0x35e2b76b,0x341c3072,0x35e297a8,0x342750ae,0x35e23eb4,0x344319f8
.long 0x35e22b47,0x3448a746,0x35e1ab48,0x3469ec76,0x35e1ab48,0x3469ec76,0x35e0fd37,0x348851aa
.long 0x35e117b5,0x34858eae,0x35e03495,0x349b9d02,0x35e0709c,0x34961b8b,0x35df517b,0x34aed5fa
.long 0x35dfb60c,0x34a69b63,0x35de5404,0x34c1fa4e,0x35dee813,0x34b70cc7,0x35dd3c4c,0x34d507bb
.long 0x35de06c5,0x34c76e4a,0x35dc0a76,0x34e7fc01,0x35dd1234,0x34d7be81,0x35dabea6,0x34fad4e3
.long 0x35dc0a76,0x34e7fc01,0x35d95902,0x3506c814,0x35daefa2,0x34f82561,0x35d7d9b4,0x351015cd
.long 0x35d9c1d1,0x35041c9e,0x35d640eb,0x35195283,0x35d8811b,0x350c1b15,0x35d48ed6,0x35227d1f
.long 0x35d72d9f,0x35140d65,0x35d2c3a8,0x352b948c,0x35d5c777,0x351bf2de,0x35d0df99,0x353497b7
.long 0x35d44ec5,0x3523cad0,0x35cee2e0,0x353d858f,0x35d2c3a8,0x352b948c,0x35cccdba,0x35465d08
.long 0x35d12643,0x35334f66,0x35caa066,0x354f1d15,0x35cf76ba,0x353afab3,0x35c85b26,0x3557c4ae
.long 0x35cdb531,0x354295c7,0x35c5fe3e,0x356052cd,0x35cbe1d1,0x354a1ffb,0x35c389f6,0x3568c671
.long 0x35c9fcc1,0x355198a6,0x35c0fe97,0x35711e99,0x35c8062c,0x3558ff23,0x35be5c70,0x35795a49
.long 0x35c5fe3e,0x356052cd,0x35bba3cf,0x3580bc44,0x35c3e522,0x35679302,0x35b8d507,0x3584bc31
.long 0x35c1bb09,0x356ebf21,0x35b5f06c,0x3588ac72,0x35bf8021,0x3575d68a,0x35b2f656,0x358c8c90
.long 0x35e38e39,0x0,0x35e38e39,0x0,0x35e37cad,0x3332b42a,0x35e37804,0x33490950
.long 0x35e3480d,0x33b2a663,0x35e3356b,0x33c8f5b2,0x35e2f061,0x3405eb92,0x35e2c67a,0x34169fc2
.long 0x35e275b6,0x34326f4c,0x35e22b47,0x3448a746,0x35e1d820,0x345ed782,0x35e163f0,0x347a87a0
.long 0x35e117b5,0x34858eae,0x35e0709c,0x34961b8b,0x35e03495,0x349b9d02,0x35df517b,0x34aed5fa
.long 0x35df2ee2,0x34b19357,0x35de06c5,0x34c76e4a,0x35de06c5,0x34c76e4a,0x35dc90b9,0x34dfdfae
.long 0x35dcbc6b,0x34dd2a7c,0x35daefa2,0x34f82561,0x35db5006,0x34f2c494,0x35d923d1,0x35081d53
.long 0x35d9c1d1,0x35041c9e,0x35d72d9f,0x35140d65,0x35d81207,0x350ec292,0x35d50d6e,0x351fe093
.long 0x35d640eb,0x35195283,0x35d2c3a8,0x352b948c,0x35d44ec5,0x3523cad0,0x35d050c1,0x35372709
.long 0x35d23be2,0x352e29da,0x35cdb531,0x354295c7,0x35d00894,0x35386e09,0x35caf17d,0x354dde8c
.long 0x35cdb531,0x354295c7,0x35c8062c,0x3558ff23,0x35cb4216,0x354c9f84,0x35c4f3d3,0x3563f560
.long 0x35c8afa3,0x355689b3,0x35c1bb09,0x356ebf21,0x35c5fe3e,0x356052cd,0x35be5c70,0x35795a49
.long 0x35c32e50,0x3569f950,0x35bad8b0,0x3581e263,0x35c0404a,0x35737bbe,0x35b73079,0x3586fe49
.long 0x35bd349e,0x357cd8a0,0x35b36482,0x358bffd6,0x35ba0bc4,0x35830742,0x35af7588,0x3590e611
.long 0x35b6c63b,0x35878e00,0x35ab6450,0x3595b004,0x35b36482,0x358bffd6,0x35a731a4,0x359a5cc1
.long 0x35afe71f,0x35905c16,0x35a2de58,0x359eeb5d,0x35ac4e9d,0x3594a213,0x359e6b42,0x35a35af6
.long 0x35a89b88,0x3598d125,0x3599d941,0x35a7aaad,0x35a4ce73,0x359ce8a6,0x3595293a,0x35abd9ab
.long 0x35e38e39,0x0,0x35e38e39,0x0,0x35e366c0,0x338602d1,0x35e35fe5,0x33912c43
.long 0x35e2f061,0x3405eb92,0x35e2d4fe,0x34110eb5,0x35e22b47,0x3448a746,0x35e1edbb,0x34594c39
.long 0x35e117b5,0x34858eae,0x35e0aa7a,0x349098a1,0x35dfb60c,0x34a69b63,0x35df0bbf,0x34b45046
.long 0x35de06c5,0x34c76e4a,0x35dd1234,0x34d7be81,0x35dc0a76,0x34e7fc01,0x35dabea6,0x34fad4e3
.long 0x35d9c1d1,0x35041c9e,0x35d81207,0x350ec292,0x35d72d9f,0x35140d65,0x35d50d6e,0x351fe093
.long 0x35d44ec5,0x3523cad0,0x35d1b215,0x3530bd7a,0x35d12643,0x35334f66,0x35ce015c,0x3541526b
.long 0x35cdb531,0x354295c7,0x35c9fcc1,0x355198a6,0x35c9fcc1,0x355198a6,0x35c5a5e9,0x3561898a
.long 0x35c5fe3e,0x356052cd,0x35c0fe97,0x35711e99,0x35c1bb09,0x356ebf21,0x35bc08b1,0x358028bd
.long 0x35bd349e,0x357cd8a0,0x35b6c63b,0x35878e00,0x35b86c8e,0x35854d33,0x35b1395a,0x358ebc11
.long 0x35b36482,0x358bffd6,0x35ab6450,0x3595b004,0x35ae1e39,0x359281e8,0x35a5497d,0x359c6705
.long 0x35a89b88,0x3598d125,0x359eeb5d,0x35a2de58,0x35a2de58,0x359eeb5d,0x35984c89,0x35a9135a
.long 0x359ce8a6,0x35a4ce73,0x35916fb3,0x35af0384,0x3596bc84,0x35aa785c,0x358a57a4,0x35b4ac6d
.long 0x35905c16,0x35afe71f,0x35830742,0x35ba0bc4,0x3589c993,0x35b518dc,0x3577030d,0x35bf1f5c
.long 0x35830742,0x35ba0bc4,0x35679302,0x35c3e522,0x35782ef7,0x35bebe21,0x3557c4ae,0x35c85b26
.long 0x3569f950,0x35c32e50,0x35479e7f,0x35cc7f95,0x355b727b,0x35c75ac8,0x35372709,0x35d050c1
.long 0x354c9f84,0x35cb4216,0x35266500,0x35d3cd1b,0x353d858f,0x35cee2e0,0x35155f38,0x35d6f338
.long 0x35e38e39,0x0,0x35e38e39,0x0,0x35e372cf,0x335f5dfa,0x35e36d0d,0x3375b21a
.long 0x35e32098,0x33df4312,0x35e30995,0x33f58e4a,0x35e297a8,0x342750ae,0x35e263ec,0x3437fdf8
.long 0x35e1d820,0x345ed782,0x35e17c43,0x3474ff28,0x35e0e22d,0x348b1453,0x35e052de,0x3498dc76
.long 0x35dfb60c,0x34a69b63,0x35dee813,0x34b70cc7,0x35de5404,0x34c1fa4e,0x35dd3c4c,0x34d507bb
.long 0x35dcbc6b,0x34dd2a7c,0x35db5006,0x34f2c494,0x35daefa2,0x34f82561,0x35d923d1,0x35081d53
.long 0x35d8ee1a,0x3509723e,0x35d6b84e,0x3516b0ae,0x35d6b84e,0x3516b0ae,0x35d40e31,0x3525181b
.long 0x35d44ec5,0x3523cad0,0x35d12643,0x35334f66,0x35d1b215,0x3530bd7a,0x35ce015c,0x3541526b
.long 0x35cee2e0,0x353d858f,0x35caa066,0x354f1d15,0x35cbe1d1,0x354a1ffb,0x35c7045d,0x355cab5d
.long 0x35c8afa3,0x355689b3,0x35c32e50,0x3569f950,0x35c54d1b,0x3562bfbb,0x35bf1f5c,0x3577030d
.long 0x35c1bb09,0x356ebf21,0x35bad8b0,0x3581e263,0x35bdfa4a,0x357a8501,0x35b65b8c,0x35881d63
.long 0x35ba0bc4,0x35830742,0x35b1a93d,0x358e30b4,0x35b5f06c,0x3588ac72,0x35acc324,0x35941a91
.long 0x35b1a93d,0x358e30b4,0x35a7aaad,0x3599d941,0x35ad3741,0x359392b4,0x35a26155,0x359f6b17
.long 0x35a89b88,0x3598d125,0x359ce8a6,0x35a4ce73,0x35a3d730,0x359deac5,0x35974239,0x35aa01c4
.long 0x359eeb5d,0x35a2de58,0x35916fb3,0x35af0384,0x3599d941,0x35a7aaad,0x358b72c6,0x35b3d23f
.long 0x3594a213,0x35ac4e9d,0x35854d33,0x35b86c8e,0x358f4716,0x35b0c909,0x357e0186,0x35bcd118
.long 0x3589c993,0x35b518dc,0x35711e99,0x35c0fe97,0x35842ade,0x35b93d0e,0x3563f560,0x35c4f3d3
.long 0x35e38e39,0x0,0x35e38e39,0x0,0x35e3587f,0x339c555b,0x35e3508c,0x33a77e13
.long 0x35e2b76b,0x341c3072,0x35e297a8,0x342750ae,0x35e1ab48,0x3469ec76,0x35e163f0,0x347a87a0
.long 0x35e03495,0x349b9d02,0x35dfb60c,0x34a69b63,0x35de5404,0x34c1fa4e,0x35dd8ee3,0x34cf98a6
.long 0x35dc0a76,0x34e7fc01,0x35daefa2,0x34f82561,0x35d95902,0x3506c814,0x35d7d9b4,0x351015cd
.long 0x35d640eb,0x35195283,0x35d44ec5,0x3523cad0,0x35d2c3a8,0x352b948c,0x35d050c1,0x35372709
.long 0x35cee2e0,0x353d858f,0x35cbe1d1,0x354a1ffb,0x35caa066,0x354f1d15,0x35c7045d,0x355cab5d
.long 0x35c5fe3e,0x356052cd,0x35c1bb09,0x356ebf21,0x35c0fe97,0x35711e99,0x35bc08b1,0x358028bd
.long 0x35bba3cf,0x3580bc44,0x35b5f06c,0x3588ac72,0x35b5f06c,0x3588ac72,0x35af7588,0x3590e611
.long 0x35afe71f,0x35905c16,0x35a89b88,0x3598d125,0x35a98ac3,0x3597c790,0x35a16623,0x35a06963
.long 0x35a2de58,0x359eeb5d,0x3599d941,0x35a7aaad,0x359be504,0x35a5c420,0x3591f8fa,0x35ae9115
.long 0x3594a213,0x35ac4e9d,0x3589c993,0x35b518dc,0x358d18f3,0x35b287bc,0x35814f7c,0x35bb3e79
.long 0x35854d33,0x35b86c8e,0x35711e99,0x35c0fe97,0x357a8501,0x35bdfa4a,0x355f1b86,0x35c65618
.long 0x3569f950,0x35c32e50,0x354c9f84,0x35cb4216,0x3558ff23,0x35c8062c,0x3539b497,0x35cfbfe7
.long 0x35479e7f,0x35cc7f95,0x35266500,0x35d3cd1b,0x3535df98,0x35d0986d,0x3512bb38,0x35d76780
.long 0x3523cad0,0x35d44ec5,0x34fd83cb,0x35da8d22,0x351168af,0x35d7a0dd,0x34d507bb,0x35dd3c4c
.long 0x34fd83cb,0x35da8d22,0x34ac1831,0x35df738b,0x34d7be81,0x35dd1234,0x3482cb5f,0x35e131a9
.long 0x35e38e39,0x0,0x35e38e39,0x0,0x35e3480d,0x33b2a663,0x35e33f02,0x33bdce45
.long 0x35e275b6,0x34326f4c,0x35e25196,0x343d8c33,0x35e117b5,0x34858eae,0x35e0c699,0x348dd6a6
.long 0x35df2ee2,0x34b19357,0x35de9f1e,0x34bc8473,0x35dcbc6b,0x34dd2a7c,0x35dbdca6,0x34eaaf00
.long 0x35d9c1d1,0x35041c9e,0x35d8811b,0x350c1b15,0x35d640eb,0x35195283,0x35d48ed6,0x35227d1f
.long 0x35d23be2,0x352e29da,0x35d00894,0x35386e09,0x35cdb531,0x354295c7,0x35caf17d,0x354dde8c
.long 0x35c8afa3,0x355689b3,0x35c54d1b,0x3562bfbb,0x35c32e50,0x3569f950,0x35bf1f5c,0x3577030d
.long 0x35bd349e,0x357cd8a0,0x35b86c8e,0x35854d33,0x35b6c63b,0x35878e00,0x35b1395a,0x358ebc11
.long 0x35afe71f,0x35905c16,0x35a98ac3,0x3597c790,0x35a89b88,0x3598d125,0x35a16623,0x35a06963
.long 0x35a0e7f5,0x35a0e7f5,0x3598d125,0x35a89b88,0x3598d125,0x35a89b88,0x358fd1c3,0x35b0584a
.long 0x35905c16,0x35afe71f,0x35866e3f,0x35b79a47,0x35878e00,0x35b6c63b,0x35795a49,0x35be5c70
.long 0x357cd8a0,0x35bd349e,0x35652a79,0x35c49a11,0x3569f950,0x35c32e50,0x35505b1e,0x35ca4ed2
.long 0x355689b3,0x35c8afa3,0x353afab3,0x35cf76ba,0x354295c7,0x35cdb531,0x3525181b,0x35d40e31
.long 0x352e29da,0x35d23be2,0x350ec292,0x35d81207,0x35195283,0x35d640eb,0x34f0134b,0x35db7f6e
.long 0x35041c9e,0x35d9c1d1,0x34c1fa4e,0x35de5404,0x34dd2a7c,0x35dcbc6b,0x34935a44,0x35e08dd0
.long 0x34b19357,0x35df2ee2,0x3448a746,0x35e22b47,0x34858eae,0x35e117b5,0x33d41ca3,0x35e32b48
.long 0x34326f4c,0x35e275b6,0x3232b879,0x35e38d20,0x33b2a663,0x35e3480d,0xb3a77e13,0x35e3508c
.long 0x35e38e39,0x0,0x35e38e39,0x0,0x35e32098,0x33df4312,0x35e3155d,0x33ea68f6
.long 0x35e1d820,0x345ed782,0x35e1ab48,0x3469ec76,0x35dfb60c,0x34a69b63,0x35df517b,0x34aed5fa
.long 0x35dcbc6b,0x34dd2a7c,0x35dc0a76,0x34e7fc01,0x35d8ee1a,0x3509723e,0x35d7d9b4,0x351015cd
.long 0x35d44ec5,0x3523cad0,0x35d2c3a8,0x352b948c,0x35cee2e0,0x353d858f,0x35cccdba,0x35465d08
.long 0x35c8afa3,0x355689b3,0x35c5fe3e,0x356052cd,0x35c1bb09,0x356ebf21,0x35be5c70,0x35795a49
.long 0x35ba0bc4,0x35830742,0x35b5f06c,0x3588ac72,0x35b1a93d,0x358e30b4,0x35acc324,0x35941a91
.long 0x35a89b88,0x3598d125,0x35a2de58,0x359eeb5d,0x359eeb5d,0x35a2de58,0x35984c89,0x35a9135a
.long 0x3594a213,0x35ac4e9d,0x358d18f3,0x35b287bc,0x3589c993,0x35b518dc,0x35814f7c,0x35bb3e79
.long 0x357cd8a0,0x35bd349e,0x3569f950,0x35c32e50,0x35652a79,0x35c49a11,0x35505b1e,0x35ca4ed2
.long 0x354c9f84,0x35cb4216,0x3535df98,0x35d0986d,0x35334f66,0x35d12643,0x351aa2e0,0x35d60473
.long 0x35195283,0x35d640eb,0x34fd83cb,0x35da8d22,0x34fd83cb,0x35da8d22,0x34c4b489,0x35de2da9
.long 0x34c76e4a,0x35de06c5,0x348b1453,0x35e0e22d,0x349098a1,0x35e0aa7a,0x3421c0c2,0x35e2a7cf
.long 0x34326f4c,0x35e275b6,0x3332b42a,0x35e37cad,0x338602d1,0x35e366c0,0xb3912c43,0x35e35fe5
.long 0xb332b42a,0x35e37cad,0xb43d8c33,0x35e25196,0xb41c3072,0x35e2b76b,0xb498dc76,0x35e052de
.long 0xb4858eae,0x35e117b5,0xb4d25071,0x35dd65dc,0xb4bc8473,0x35de9f1e,0xb5057282,0x35d98dac
.long 0xb4f2c494,0x35db5006,0xb5212f0b,0x35d4ce63,0xb5140d65,0x35d72d9f,0xb53c405b,0x35cf2d0d
.long 0x35e38e39,0x0,0x35e38e39,0x0,0x35e3356b,0x33c8f5b2,0x35e32b48,0x33d41ca3
.long 0x35e22b47,0x3448a746,0x35e202ca,0x3453c069,0x35e0709c,0x34961b8b,0x35e015c2,0x349e5d2e
.long 0x35de06c5,0x34c76e4a,0x35dd65dc,0x34d25071,0x35daefa2,0x34f82561,0x35d9f56f,0x3502c668
.long 0x35d72d9f,0x35140d65,0x35d5c777,0x351bf2de,0x35d2c3a8,0x352b948c,0x35d0df99,0x353497b7
.long 0x35cdb531,0x354295c7,0x35cb4216,0x354c9f84,0x35c8062c,0x3558ff23,0x35c4f3d3,0x3563f560
.long 0x35c1bb09,0x356ebf21,0x35bdfa4a,0x357a8501,0x35bad8b0,0x3581e263,0x35b65b8c,0x35881d63
.long 0x35b36482,0x358bffd6,0x35ae1e39,0x359281e8,0x35ab6450,0x3595b004,0x35a5497d,0x359c6705
.long 0x35a2de58,0x359eeb5d,0x359be504,0x35a5c420,0x3599d941,0x35a7aaad,0x3591f8fa,0x35ae9115
.long 0x35905c16,0x35afe71f,0x35878e00,0x35b6c63b,0x35866e3f,0x35b79a47,0x35795a49,0x35be5c70
.long 0x35782ef7,0x35bebe21,0x3562bfbb,0x35c54d1b,0x3562bfbb,0x35c54d1b,0x354b5ffe,0x35cb9232
.long 0x354c9f84,0x35cb4216,0x35334f66,0x35d12643,0x3535df98,0x35d0986d,0x351aa2e0,0x35d60473
.long 0x351e91b8,0x35d54bf5,0x35016fe1,0x35da2886,0x3506c814,0x35d95902,0x34cf98a6,0x35dd8ee3
.long 0x34dd2a7c,0x35dcbc6b,0x349b9d02,0x35e03495,0x34ac1831,0x35df738b,0x344e3417,0x35e2174e
.long 0x3474ff28,0x35e17c43,0x33c8f5b2,0x35e3356b,0x34110eb5,0x35e2d4fe,0xb1b2b8b0,0x35e38df3
.long 0x3332b42a,0x35e37cad,0xb3df4312,0x35e32098,0xb35f5dfa,0x35e372cf,0xb4594c39,0x35e1edbb
.long 0xb41c3072,0x35e2b76b,0xb4a11cf9,0x35dff665,0xb48007bf,0x35e14b12,0xb4d507bb,0x35dd3c4c
.long 0x35e38e39,0x0,0x35e38e39,0x0,0x35e30995,0x33f58e4a,0x35e2fd41,0x34005983
.long 0x35e17c43,0x3474ff28,0x35e14b12,0x348007bf,0x35dee813,0x34b70cc7,0x35de79d6,0x34bf3f9b
.long 0x35db5006,0x34f2c494,0x35da8d22,0x34fd83cb,0x35d6b84e,0x3516b0ae,0x35d589f8,0x351d427b
.long 0x35d12643,0x35334f66,0x35cf76ba,0x353afab3,0x35caa066,0x354f1d15,0x35c85b26,0x3557c4ae
.long 0x35c32e50,0x3569f950,0x35c0404a,0x35737bbe,0x35bad8b0,0x3581e263,0x35b73079,0x3586fe49
.long 0x35b1a93d,0x358e30b4,0x35ad3741,0x359392b4,0x35a7aaad,0x3599d941,0x35a26155,0x359f6b17
.long 0x359ce8a6,0x35a4ce73,0x3596bc84,0x35aa785c,0x35916fb3,0x35af0384,0x358a57a4,0x35b4ac6d
.long 0x35854d33,0x35b86c8e,0x357a8501,0x35bdfa4a,0x35711e99,0x35c0fe97,0x355f1b86,0x35c65618
.long 0x355689b3,0x35c8afa3,0x354295c7,0x35cdb531,0x353afab3,0x35cf76ba,0x3525181b,0x35d40e31
.long 0x351e91b8,0x35d54bf5,0x3506c814,0x35d95902,0x35016fe1,0x35da2886,0x34cf98a6,0x35dd8ee3
.long 0x34c76e4a,0x35de06c5,0x349098a1,0x35e0aa7a,0x348b1453,0x35e0e22d,0x3421c0c2,0x35e2a7cf
.long 0x341c3072,0x35e2b76b,0x330608a2,0x35e3845a,0x330608a2,0x35e3845a,0xb3bdce45,0x35e33f02
.long 0xb3b2a663,0x35e3480d,0xb45ed782,0x35e1d820,0xb453c069,0x35e202ca,0xb4aed5fa,0x35df517b
.long 0xb4a69b63,0x35dfb60c,0xb4ed616f,0x35dbae4d,0xb4e29456,0x35dc6480,0xb5155f38,0x35d6f338
.long 0xb50ec292,0x35d81207,0xb5334f66,0x35d12643,0xb52b948c,0x35d2c3a8,0xb5505b1e,0x35ca4ed2
.long 0xb5479e7f,0x35cc7f95,0xb56c5d5c,0x35c2759c,0xb562bfbb,0x35c54d1b,0xb5839938,0x35b9a4a2
.long 0x35e38e39,0x0,0x35e38e39,0x0,0x35e2f061,0x3405eb92,0x35e2e2f5,0x340b7d4f
.long 0x35e117b5,0x34858eae,0x35e0e22d,0x348b1453,0x35de06c5,0x34c76e4a,0x35dd8ee3,0x34cf98a6
.long 0x35d9c1d1,0x35041c9e,0x35d8ee1a,0x3509723e,0x35d44ec5,0x3523cad0,0x35d306c8,0x352a4946
.long 0x35cdb531,0x354295c7,0x35cbe1d1,0x354a1ffb,0x35c5fe3e,0x356052cd,0x35c389f6,0x3568c671
.long 0x35bd349e,0x357cd8a0,0x35ba0bc4,0x35830742,0x35b36482,0x358bffd6,0x35af7588,0x3590e611
.long 0x35a89b88,0x3598d125,0x35a3d730,0x359deac5,0x359ce8a6,0x35a4ce73,0x35974239,0x35aa01c4
.long 0x35905c16,0x35afe71f,0x3589c993,0x35b518dc,0x35830742,0x35ba0bc4,0x3577030d,0x35bf1f5c
.long 0x3569f950,0x35c32e50,0x3558ff23,0x35c8062c,0x354c9f84,0x35cb4216,0x3539b497,0x35cfbfe7
.long 0x352e29da,0x35d23be2,0x35195283,0x35d640eb,0x350ec292,0x35d81207,0x34f0134b,0x35db7f6e
.long 0x34dd2a7c,0x35dcbc6b,0x34ac1831,0x35df738b,0x349b9d02,0x35e03495,0x344e3417,0x35e2174e
.long 0x34326f4c,0x35e275b6,0x338602d1,0x35e366c0,0x3332b42a,0x35e37cad,0xb3912c43,0x35e35fe5
.long 0xb3b2a663,0x35e3480d,0xb453c069,0x35e202ca,0xb45ed782,0x35e1d820,0xb4aed5fa,0x35df517b
.long 0xb4b19357,0x35df2ee2,0xb4f2c494,0x35db5006,0xb4f2c494,0x35db5006,0xb51aa2e0,0x35d60473
.long 0xb5195283,0x35d640eb,0xb53afab3,0x35cf76ba,0xb5386e09,0x35d00894,0xb55a3912,0x35c7b0b8
.long 0xb55689b3,0x35c8afa3,0xb5782ef7,0x35bebe21,0xb5737bbe,0x35c0404a,0xb58a57a4,0x35b4ac6d
.long 0xb5878e00,0x35b6c63b,0xb597c790,0x35a98ac3,0xb594a213,0x35ac4e9d,0xb5a45304,0x359d69e6
.long 0x35e38e39,0x0,0x35e38e39,0x0,0x35e2b76b,0x341c3072,0x35e2a7cf,0x3421c0c2
.long 0x35e03495,0x349b9d02,0x35dff665,0x34a11cf9,0x35dc0a76,0x34e7fc01,0x35db7f6e,0x34f0134b
.long 0x35d640eb,0x35195283,0x35d54bf5,0x351e91b8,0x35cee2e0,0x353d858f,0x35cd6888,0x3543d8ab
.long 0x35c5fe3e,0x356052cd,0x35c3e522,0x35679302,0x35bba3cf,0x3580bc44,0x35b8d507,0x3584bc31
.long 0x35afe71f,0x35905c16,0x35ac4e9d,0x3594a213,0x35a2de58,0x359eeb5d,0x359e6b42,0x35a35af6
.long 0x3594a213,0x35ac4e9d,0x358f4716,0x35b0c909,0x35854d33,0x35b86c8e,0x357e0186,0x35bcd118
.long 0x3569f950,0x35c32e50,0x355b727b,0x35c75ac8,0x35479e7f,0x35cc7f95,0x35372709,0x35d050c1
.long 0x3523cad0,0x35d44ec5,0x351168af,0x35d7a0dd,0x34fd83cb,0x35da8d22,0x34d507bb,0x35dd3c4c
.long 0x34b19357,0x35df2ee2,0x34858eae,0x35e117b5,0x3448a746,0x35e22b47,0x33d41ca3,0x35e32b48
.long 0x3332b42a,0x35e37cad,0xb35f5dfa,0x35e372cf,0xb3df4312,0x35e32098,0xb4594c39,0x35e1edbb
.long 0xb4858eae,0x35e117b5,0xb4bc8473,0x35de9f1e,0xb4d25071,0x35dd65dc,0xb5057282,0x35d98dac
.long 0xb50ec292,0x35d81207,0xb52b948c,0x35d2c3a8,0xb5334f66,0x35d12643,0xb5505b1e,0x35ca4ed2
.long 0xb55689b3,0x35c8afa3,0xb5737bbe,0x35c0404a,0xb5782ef7,0x35bebe21,0xb58a57a4,0x35b4ac6d
.long 0xb58bffd6,0x35b36482,0xb599d941,0x35a7aaad,0xb59adfe2,0x35a6b834,0xb5a8234e,0x35995562
.long 0xb5a89b88,0x3598d125,0xb5b518dc,0x3589c993,0xb5b518dc,0x3589c993,0xb5c09fac,0x35724d76
.long 0xb5c0404a,0x35737bbe,0xb5caa066,0x354f1d15,0xb5c9fcc1,0x355198a6,0xb5d306c8,0x352a4946
.long 0x35e38e39,0x0,0x35e38e39,0x0,0x35e2d4fe,0x34110eb5,0x35e2c67a,0x34169fc2
.long 0x35e0aa7a,0x349098a1,0x35e0709c,0x34961b8b,0x35dd1234,0x34d7be81,0x35dc90b9,0x34dfdfae
.long 0x35d81207,0x350ec292,0x35d72d9f,0x35140d65,0x35d1b215,0x3530bd7a,0x35d050c1,0x35372709
.long 0x35c9fcc1,0x355198a6,0x35c8062c,0x3558ff23,0x35c0fe97,0x35711e99,0x35be5c70,0x35795a49
.long 0x35b6c63b,0x35878e00,0x35b36482,0x358bffd6,0x35ab6450,0x3595b004,0x35a731a4,0x359a5cc1
.long 0x359eeb5d,0x35a2de58,0x3599d941,0x35a7aaad,0x35916fb3,0x35af0384,0x358b72c6,0x35b3d23f
.long 0x35830742,0x35ba0bc4,0x35782ef7,0x35bebe21,0x35679302,0x35c3e522,0x3557c4ae,0x35c85b26
.long 0x35479e7f,0x35cc7f95,0x3535df98,0x35d0986d,0x35266500,0x35d3cd1b,0x3512bb38,0x35d76780
.long 0x35041c9e,0x35d9c1d1,0x34dd2a7c,0x35dcbc6b,0x34c1fa4e,0x35de5404,0x34935a44,0x35e08dd0
.long 0x3474ff28,0x35e17c43,0x34110eb5,0x35e2d4fe,0x33c8f5b2,0x35e3356b,0xb1b2b8b0,0x35e38df3
.long 0xb332b42a,0x35e37cad,0xb41c3072,0x35e2b76b,0xb43d8c33,0x35e25196,0xb498dc76,0x35e052de
.long 0xb4a69b63,0x35dfb60c,0xb4e29456,0x35dc6480,0xb4ed616f,0x35dbae4d,0xb5155f38,0x35d6f338
.long 0xb5195283,0x35d640eb,0xb5386e09,0x35d00894,0xb53afab3,0x35cf76ba,0xb55a3912,0x35c7b0b8
.long 0xb55b727b,0x35c75ac8,0xb57a8501,0x35bdfa4a,0xb57a8501,0x35bdfa4a,0xb58c8c90,0x35b2f656
.long 0xb58bffd6,0x35b36482,0xb59adfe2,0x35a6b834,0xb599d941,0x35a7aaad,0xb5a8234e,0x35995562
.long 0xb5a6b834,0x359adfe2,0xb5b43f8d,0x358ae560,0xb5b287bc,0x358d18f3,0xb5bf1f5c,0x3577030d
.long 0x35e38e39,0x0,0x35e38e39,0x0,0x35e297a8,0x342750ae,0x35e286f5,0x342ce032
.long 0x35dfb60c,0x34a69b63,0x35df738b,0x34ac1831,0x35daefa2,0x34f82561,0x35da5b18,0x3500190b
.long 0x35d44ec5,0x3523cad0,0x35d34966,0x3528fd97,0x35cbe1d1,0x354a1ffb,0x35ca4ed2,0x35505b1e
.long 0x35c1bb09,0x356ebf21,0x35bf8021,0x3575d68a,0x35b5f06c,0x3588ac72,0x35b2f656,0x358c8c90
.long 0x35a89b88,0x3598d125,0x35a4ce73,0x359ce8a6,0x3599d941,0x35a7aaad,0x3595293a,0x35abd9ab
.long 0x3589c993,0x35b518dc,0x35842ade,0x35b93d0e,0x35711e99,0x35c0fe97,0x3563f560,0x35c4f3d3
.long 0x354c9f84,0x35cb4216,0x353d858f,0x35cee2e0,0x35266500,0x35d3cd1b,0x35155f38,0x35d6f338
.long 0x34fd83cb,0x35da8d22,0x34d7be81,0x35dd1234,0x34ac1831,0x35df738b,0x3482cb5f,0x35e131a9
.long 0x34326f4c,0x35e275b6,0x33b2a663,0x35e3480d,0x3232b879,0x35e38d20,0xb3a77e13,0x35e3508c
.long 0xb41c3072,0x35e2b76b,0xb48007bf,0x35e14b12,0xb4a11cf9,0x35dff665,0xb4d507bb,0x35dd3c4c
.long 0xb4f2c494,0x35db5006,0xb5140d65,0x35d72d9f,0xb5212f0b,0x35d4ce63,0xb53c405b,0x35cf2d0d
.long 0xb5479e7f,0x35cc7f95,0xb562bfbb,0x35c54d1b,0xb56c5d5c,0x35c2759c,0xb5839938,0x35b9a4a2
.long 0xb5878e00,0x35b6c63b,0xb594a213,0x35ac4e9d,0xb597c790,0x35a98ac3,0xb5a45304,0x359d69e6
.long 0xb5a6b834,0x359adfe2,0xb5b287bc,0x358d18f3,0xb5b43f8d,0x358ae560,0xb5bf1f5c,0x3577030d
.long 0xb5c0404a,0x35737bbe,0xb5c9fcc1,0x355198a6,0xb5caa066,0x354f1d15,0xb5d306c8,0x352a4946
.long 0xb5d34966,0x3528fd97,0xb5da2886,0x35016fe1,0xb5da2886,0x35016fe1,0xb5df517b,0x34aed5fa
.long 0x35e38e39,0x0,0x35e275b6,0x34326f4c,0x35e38e39,0x0,0x35e263ec,0x3437fdf8
.long 0x35e38e39,0x0,0x35e25196,0x343d8c33,0x35e38e39,0x0,0x35e23eb4,0x344319f8
.long 0x35e38e39,0x0,0x35e22b47,0x3448a746,0x35e38e39,0x0,0x35e2174e,0x344e3417
.long 0x35e38e39,0x0,0x35e202ca,0x3453c069,0x35e38e39,0x0,0x35e1edbb,0x34594c39
.long 0x35e38e39,0x0,0x35e1d820,0x345ed782,0x35e38e39,0x0,0x35e1c1f9,0x34646243
.long 0x35e38e39,0x0,0x35e1ab48,0x3469ec76,0x35e38e39,0x0,0x35e1940b,0x346f7619
.long 0x35e38e39,0x0,0x35e17c43,0x3474ff28,0x35e38e39,0x0,0x35e163f0,0x347a87a0
.long 0x35e38e39,0x0,0x35e14b12,0x348007bf,0x35e38e39,0x0,0x35e131a9,0x3482cb5f
.long 0x35e38e39,0x0,0x35e117b5,0x34858eae,0x35e38e39,0x0,0x35e0fd37,0x348851aa
.long 0x35e38e39,0x0,0x35e0e22d,0x348b1453,0x35e38e39,0x0,0x35e0c699,0x348dd6a6
.long 0x35e38e39,0x0,0x35e0aa7a,0x349098a1,0x35e38e39,0x0,0x35e08dd0,0x34935a44
.long 0x35e38e39,0x0,0x35e0709c,0x34961b8b,0x35e38e39,0x0,0x35e052de,0x3498dc76
.long 0x35e38e39,0x0,0x35e03495,0x349b9d02,0x35e38e39,0x0,0x35e015c2,0x349e5d2e
.long 0x35e38e39,0x0,0x35dff665,0x34a11cf9,0x35e38e39,0x0,0x35dfd67d,0x34a3dc60
.long 0x35e38e39,0x0,0x35dfb60c,0x34a69b63,0x35e38e39,0x0,0x35df9510,0x34a959fe
.long 0x35e38e39,0x0,0x35df738b,0x34ac1831,0x35e38e39,0x0,0x35df517b,0x34aed5fa
.long 0x35d23be2,0x352e29da,0x35c8afa3,0x355689b3,0x35d12643,0x35334f66,0x35c7045d,0x355cab5d
.long 0x35d00894,0x35386e09,0x35c54d1b,0x3562bfbb,0x35cee2e0,0x353d858f,0x35c389f6,0x3568c671
.long 0x35cdb531,0x354295c7,0x35c1bb09,0x356ebf21,0x35cc7f95,0x35479e7f,0x35bfe071,0x3574a96f
.long 0x35cb4216,0x354c9f84,0x35bdfa4a,0x357a8501,0x35c9fcc1,0x355198a6,0x35bc08b1,0x358028bd
.long 0x35c8afa3,0x355689b3,0x35ba0bc4,0x35830742,0x35c75ac8,0x355b727b,0x35b803a3,0x3585dde2
.long 0x35c5fe3e,0x356052cd,0x35b5f06c,0x3588ac72,0x35c49a11,0x35652a79,0x35b3d23f,0x358b72c6
.long 0x35c32e50,0x3569f950,0x35b1a93d,0x358e30b4,0x35c1bb09,0x356ebf21,0x35af7588,0x3590e611
.long 0x35c0404a,0x35737bbe,0x35ad3741,0x359392b4,0x35bebe21,0x35782ef7,0x35aaee8a,0x35963673
.long 0x35bd349e,0x357cd8a0,0x35a89b88,0x3598d125,0x35bba3cf,0x3580bc44,0x35a63e5e,0x359b62a3
.long 0x35ba0bc4,0x35830742,0x35a3d730,0x359deac5,0x35b86c8e,0x35854d33,0x35a16623,0x35a06963
.long 0x35b6c63b,0x35878e00,0x359eeb5d,0x35a2de58,0x35b518dc,0x3589c993,0x359c6705,0x35a5497d
.long 0x35b36482,0x358bffd6,0x3599d941,0x35a7aaad,0x35b1a93d,0x358e30b4,0x35974239,0x35aa01c4
.long 0x35afe71f,0x35905c16,0x3594a213,0x35ac4e9d,0x35ae1e39,0x359281e8,0x3591f8fa,0x35ae9115
.long 0x35ac4e9d,0x3594a213,0x358f4716,0x35b0c909,0x35aa785c,0x3596bc84,0x358c8c90,0x35b2f656
.long 0x35a89b88,0x3598d125,0x3589c993,0x35b518dc,0x35a6b834,0x359adfe2,0x3586fe49,0x35b73079
.long 0x35a4ce73,0x359ce8a6,0x35842ade,0x35b93d0e,0x35a2de58,0x359eeb5d,0x35814f7c,0x35bb3e79
.long 0x35df2ee2,0x34b19357,0x35d9c1d1,0x35041c9e,0x35dee813,0x34b70cc7,0x35d923d1,0x35081d53
.long 0x35de9f1e,0x34bc8473,0x35d8811b,0x350c1b15,0x35de5404,0x34c1fa4e,0x35d7d9b4,0x351015cd
.long 0x35de06c5,0x34c76e4a,0x35d72d9f,0x35140d65,0x35ddb762,0x34cce05a,0x35d67cde,0x351801c8
.long 0x35dd65dc,0x34d25071,0x35d5c777,0x351bf2de,0x35dd1234,0x34d7be81,0x35d50d6e,0x351fe093
.long 0x35dcbc6b,0x34dd2a7c,0x35d44ec5,0x3523cad0,0x35dc6480,0x34e29456,0x35d38b82,0x3527b17f
.long 0x35dc0a76,0x34e7fc01,0x35d2c3a8,0x352b948c,0x35dbae4d,0x34ed616f,0x35d1f73d,0x352f73e0
.long 0x35db5006,0x34f2c494,0x35d12643,0x35334f66,0x35daefa2,0x34f82561,0x35d050c1,0x35372709
.long 0x35da8d22,0x34fd83cb,0x35cf76ba,0x353afab3,0x35da2886,0x35016fe1,0x35ce9833,0x353eca4f
.long 0x35d9c1d1,0x35041c9e,0x35cdb531,0x354295c7,0x35d95902,0x3506c814,0x35cccdba,0x35465d08
.long 0x35d8ee1a,0x3509723e,0x35cbe1d1,0x354a1ffb,0x35d8811b,0x350c1b15,0x35caf17d,0x354dde8c
.long 0x35d81207,0x350ec292,0x35c9fcc1,0x355198a6,0x35d7a0dd,0x351168af,0x35c903a5,0x35554e35
.long 0x35d72d9f,0x35140d65,0x35c8062c,0x3558ff23,0x35d6b84e,0x3516b0ae,0x35c7045d,0x355cab5d
.long 0x35d640eb,0x35195283,0x35c5fe3e,0x356052cd,0x35d5c777,0x351bf2de,0x35c4f3d3,0x3563f560
.long 0x35d54bf5,0x351e91b8,0x35c3e522,0x35679302,0x35d4ce63,0x35212f0b,0x35c2d232,0x356b2b9e
.long 0x35d44ec5,0x3523cad0,0x35c1bb09,0x356ebf21,0x35d3cd1b,0x35266500,0x35c09fac,0x35724d76
.long 0x35d34966,0x3528fd97,0x35bf8021,0x3575d68a,0x35d2c3a8,0x352b948c,0x35be5c70,0x35795a49
.long 0x35bd349e,0x357cd8a0,0x35afe71f,0x35905c16,0x35bad8b0,0x3581e263,0x35acc324,0x35941a91
.long 0x35b86c8e,0x35854d33,0x35a98ac3,0x3597c790,0x35b5f06c,0x3588ac72,0x35a63e5e,0x359b62a3
.long 0x35b36482,0x358bffd6,0x35a2de58,0x359eeb5d,0x35b0c909,0x358f4716,0x359f6b17,0x35a26155
.long 0x35ae1e39,0x359281e8,0x359be504,0x35a5c420,0x35ab6450,0x3595b004,0x35984c89,0x35a9135a
.long 0x35a89b88,0x3598d125,0x3594a213,0x35ac4e9d,0x35a5c420,0x359be504,0x3590e611,0x35af7588
.long 0x35a2de58,0x359eeb5d,0x358d18f3,0x35b287bc,0x359fea6e,0x35a1e3ee,0x35893b2d,0x35b584dc
.long 0x359ce8a6,0x35a4ce73,0x35854d33,0x35b86c8e,0x3599d941,0x35a7aaad,0x35814f7c,0x35bb3e79
.long 0x3596bc84,0x35aa785c,0x357a8501,0x35bdfa4a,0x359392b4,0x35ad3741,0x35724d76,0x35c09fac
.long 0x35905c16,0x35afe71f,0x3569f950,0x35c32e50,0x358d18f3,0x35b287bc,0x3561898a,0x35c5a5e9
.long 0x3589c993,0x35b518dc,0x3558ff23,0x35c8062c,0x35866e3f,0x35b79a47,0x35505b1e,0x35ca4ed2
.long 0x35830742,0x35ba0bc4,0x35479e7f,0x35cc7f95,0x357f29cf,0x35bc6d1f,0x353eca4f,0x35ce9833
.long 0x35782ef7,0x35bebe21,0x3535df98,0x35d0986d,0x35711e99,0x35c0fe97,0x352cdf68,0x35d28006
.long 0x3569f950,0x35c32e50,0x3523cad0,0x35d44ec5,0x3562bfbb,0x35c54d1b,0x351aa2e0,0x35d60473
.long 0x355b727b,0x35c75ac8,0x351168af,0x35d7a0dd,0x35541232,0x35c9572b,0x35081d53,0x35d923d1
.long 0x354c9f84,0x35cb4216,0x34fd83cb,0x35da8d22,0x35451b16,0x35cd1b60,0x34eaaf00,0x35dbdca6
.long 0x353d858f,0x35cee2e0,0x34d7be81,0x35dd1234,0x3535df98,0x35d0986d,0x34c4b489,0x35de2da9
.long 0x35a0e7f5,0x35a0e7f5,0x35905c16,0x35afe71f,0x359ce8a6,0x35a4ce73,0x358b72c6,0x35b3d23f
.long 0x3598d125,0x35a89b88,0x35866e3f,0x35b79a47,0x3594a213,0x35ac4e9d,0x35814f7c,0x35bb3e79
.long 0x35905c16,0x35afe71f,0x35782ef7,0x35bebe21,0x358bffd6,0x35b36482,0x356d8e88,0x35c2188e
.long 0x35878e00,0x35b6c63b,0x3562bfbb,0x35c54d1b,0x35830742,0x35ba0bc4,0x3557c4ae,0x35c85b26
.long 0x357cd8a0,0x35bd349e,0x354c9f84,0x35cb4216,0x35737bbe,0x35c0404a,0x3541526b,0x35ce015c
.long 0x3569f950,0x35c32e50,0x3535df98,0x35d0986d,0x356052cd,0x35c5fe3e,0x352a4946,0x35d306c8
.long 0x355689b3,0x35c8afa3,0x351e91b8,0x35d54bf5,0x354c9f84,0x35cb4216,0x3512bb38,0x35d76780
.long 0x354295c7,0x35cdb531,0x3506c814,0x35d95902,0x35386e09,0x35d00894,0x34f57546,0x35db2018
.long 0x352e29da,0x35d23be2,0x34dd2a7c,0x35dcbc6b,0x3523cad0,0x35d44ec5,0x34c4b489,0x35de2da9
.long 0x35195283,0x35d640eb,0x34ac1831,0x35df738b,0x350ec292,0x35d81207,0x34935a44,0x35e08dd0
.long 0x35041c9e,0x35d9c1d1,0x3474ff28,0x35e17c43,0x34f2c494,0x35db5006,0x344319f8,0x35e23eb4
.long 0x34dd2a7c,0x35dcbc6b,0x34110eb5,0x35e2d4fe,0x34c76e4a,0x35de06c5,0x33bdce45,0x35e33f02
.long 0x34b19357,0x35df2ee2,0x3332b42a,0x35e37cad,0x349b9d02,0x35e03495,0xb1b2b8b0,0x35e38df3
.long 0x34858eae,0x35e117b5,0xb35f5dfa,0x35e372cf,0x345ed782,0x35e1d820,0xb3d41ca3,0x35e32b48
.long 0x34326f4c,0x35e275b6,0xb41c3072,0x35e2b76b,0x3405eb92,0x35e2f061,0xb44e3417,0x35e2174e
.long 0x33b2a663,0x35e3480d,0xb48007bf,0x35e14b12,0x3332b42a,0x35e37cad,0xb498dc76,0x35e052de
.long 0x352e29da,0x35d23be2,0x35041c9e,0x35d9c1d1,0x351e91b8,0x35d54bf5,0x34e54872,0x35dc37bf
.long 0x350ec292,0x35d81207,0x34c1fa4e,0x35de5404,0x34fd83cb,0x35da8d22,0x349e5d2e,0x35e015c2
.long 0x34dd2a7c,0x35dcbc6b,0x3474ff28,0x35e17c43,0x34bc8473,0x35de9f1e,0x342ce032,0x35e286f5
.long 0x349b9d02,0x35e03495,0x33c8f5b2,0x35e3356b,0x3474ff28,0x35e17c43,0x32df64b5,0x35e3875e
.long 0x34326f4c,0x35e275b6,0xb332b42a,0x35e37cad,0x33df4312,0x35e32098,0xb3ea68f6,0x35e3155d
.long 0x3332b42a,0x35e37cad,0xb43d8c33,0x35e25196,0xb2b2b79c,0x35e389d6,0xb482cb5f,0x35e131a9
.long 0xb3b2a663,0x35e3480d,0xb4a69b63,0x35dfb60c,0xb41c3072,0x35e2b76b,0xb4ca2791,0x35dddf58
.long 0xb45ed782,0x35e1d820,0xb4ed616f,0x35dbae4d,0xb49098a1,0x35e0aa7a,0xb5081d53,0x35d923d1
.long 0xb4b19357,0x35df2ee2,0xb5195283,0x35d640eb,0xb4d25071,0x35dd65dc,0xb52a4946,0x35d306c8
.long 0xb4f2c494,0x35db5006,0xb53afab3,0x35cf76ba,0xb509723e,0x35d8ee1a,0xb54b5ffe,0x35cb9232
.long 0xb5195283,0x35d640eb,0xb55b727b,0x35c75ac8,0xb528fd97,0x35d34966,0xb56b2b9e,0x35c2d232
.long 0xb5386e09,0x35d00894,0xb57a8501,0x35bdfa4a,0xb5479e7f,0x35cc7f95,0xb584bc31,0x35b8d507
.long 0xb55689b3,0x35c8afa3,0xb58bffd6,0x35b36482,0xb5652a79,0x35c49a11,0xb5930a7b,0x35adaaf3
.long 0xb5737bbe,0x35c0404a,0xb599d941,0x35a7aaad,0xb580bc44,0x35bba3cf,0xb5a06963,0x35a16623
.long 0xb5878e00,0x35b6c63b,0xb5a6b834,0x359adfe2,0xb58e30b4,0x35b1a93d,0xb5acc324,0x35941a91
.long 0xb594a213,0x35ac4e9d,0xb5b287bc,0x358d18f3,0xb59adfe2,0x35a6b834,0xb5b803a3,0x3585dde2
.long 0x357cd8a0,0x35bd349e,0x355689b3,0x35c8afa3,0x35711e99,0x35c0fe97,0x3548df7b,0x35cc30f2
.long 0x35652a79,0x35c49a11,0x353afab3,0x35cf76ba,0x3558ff23,0x35c8062c,0x352cdf68,0x35d28006
.long 0x354c9f84,0x35cb4216,0x351e91b8,0x35d54bf5,0x35400e98,0x35ce4d07,0x351015cd,0x35d7d9b4
.long 0x35334f66,0x35d12643,0x35016fe1,0x35da2886,0x35266500,0x35d3cd1b,0x34e54872,0x35dc37bf
.long 0x35195283,0x35d640eb,0x34c76e4a,0x35de06c5,0x350c1b15,0x35d8811b,0x34a959fe,0x35df9510
.long 0x34fd83cb,0x35da8d22,0x348b1453,0x35e0e22d,0x34e29456,0x35dc6480,0x34594c39,0x35e1edbb
.long 0x34c76e4a,0x35de06c5,0x341c3072,0x35e2b76b,0x34ac1831,0x35df738b,0x33bdce45,0x35e33f02
.long 0x349098a1,0x35e0aa7a,0x330608a2,0x35e3845a,0x3469ec76,0x35e1ab48,0xb2df64b5,0x35e3875e
.long 0x34326f4c,0x35e275b6,0xb3b2a663,0x35e3480d,0x33f58e4a,0x35e30995,0xb4169fc2,0x35e2c67a
.long 0x338602d1,0x35e366c0,0xb453c069,0x35e202ca,0x3232b879,0x35e38d20,0xb48851aa,0x35e0fd37
.long 0xb332b42a,0x35e37cad,0xb4a69b63,0x35dfb60c,0xb3c8f5b2,0x35e3356b,0xb4c4b489,0x35de2da9
.long 0xb41c3072,0x35e2b76b,0xb4e29456,0x35dc6480,0xb453c069,0x35e202ca,0xb500190b,0x35da5b18
.long 0xb4858eae,0x35e117b5,0xb50ec292,0x35d81207,0xb4a11cf9,0x35dff665,0xb51d427b,0x35d589f8
.long 0xb4bc8473,0x35de9f1e,0xb52b948c,0x35d2c3a8,0xb4d7be81,0x35dd1234,0xb539b497,0x35cfbfe7
.long 0xb4f2c494,0x35db5006,0xb5479e7f,0x35cc7f95,0xb506c814,0x35d95902,0xb5554e35,0x35c903a5
.long 0xb5140d65,0x35d72d9f,0xb562bfbb,0x35c54d1b,0xb5212f0b,0x35d4ce63,0xb56fef27,0x35c15d0c
.long 0x34b19357,0x35df2ee2,0x34326f4c,0x35e275b6,0x348b1453,0x35e0e22d,0x33bdce45,0x35e33f02
.long 0x3448a746,0x35e22b47,0x3232b879,0x35e38d20,0x33f58e4a,0x35e30995,0xb3912c43,0x35e35fe5
.long 0x3332b42a,0x35e37cad,0xb41c3072,0x35e2b76b,0xb30608a2,0x35e3845a,0xb46f7619,0x35e1940b
.long 0xb3df4312,0x35e32098,0xb4a11cf9,0x35dff665,0xb43d8c33,0x35e25196,0xb4ca2791,0x35dddf58
.long 0xb4858eae,0x35e117b5,0xb4f2c494,0x35db5006,0xb4ac1831,0x35df738b,0xb50d6eff,0x35d849d4
.long 0xb4d25071,0x35dd65dc,0xb5212f0b,0x35d4ce63,0xb4f82561,0x35daefa2,0xb53497b7,0x35d0df99
.long 0xb50ec292,0x35d81207,0xb5479e7f,0x35cc7f95,0xb5212f0b,0x35d4ce63,0xb55a3912,0x35c7b0b8
.long 0xb5334f66,0x35d12643,0xb56c5d5c,0x35c2759c,0xb5451b16,0x35cd1b60,0xb57e0186,0x35bcd118
.long 0xb55689b3,0x35c8afa3,0xb5878e00,0x35b6c63b,0xb5679302,0x35c3e522,0xb58fd1c3,0x35b0584a
.long 0xb5782ef7,0x35bebe21,0xb597c790,0x35a98ac3,0xb5842ade,0x35b93d0e,0xb59f6b17,0x35a26155
.long 0xb58bffd6,0x35b36482,0xb5a6b834,0x359adfe2,0xb59392b4,0x35ad3741,0xb5adaaf3,0x35930a7b
.long 0xb59adfe2,0x35a6b834,0xb5b43f8d,0x358ae560,0xb5a1e3ee,0x359fea6e,0xb5ba7274,0x358274fb
.long 0xb5a89b88,0x3598d125,0xb5c0404a,0x35737bbe,0xb5af0384,0x35916fb3,0xb5c5a5e9,0x3561898a
.long 0xb5b518dc,0x3589c993,0xb5caa066,0x354f1d15,0xb5bad8b0,0x3581e263,0xb5cf2d0d,0x353c405b
.long 0xb5c0404a,0x35737bbe,0xb5d34966,0x3528fd97,0xb5c54d1b,0x3562bfbb,0xb5d6f338,0x35155f38
.long 0xb5c9fcc1,0x355198a6,0xb5da2886,0x35016fe1,0xb5ce4d07,0x35400e98,0xb5dce793,0x34da74c2
.long 0x1afb021f,0x35e38e39,0xb4326f4c,0x35e275b6,0xb3b2a663,0x35e3480d,0xb48851aa,0x35e0fd37
.long 0xb4326f4c,0x35e275b6,0xb4b70cc7,0x35dee813,0xb4858eae,0x35e117b5,0xb4e54872,0x35dc37bf
.long 0xb4b19357,0x35df2ee2,0xb509723e,0x35d8ee1a,0xb4dd2a7c,0x35dcbc6b,0xb51fe093,0x35d50d6e
.long 0xb5041c9e,0x35d9c1d1,0xb535df98,0x35d0986d,0xb5195283,0x35d640eb,0xb54b5ffe,0x35cb9232
.long 0xb52e29da,0x35d23be2,0xb56052cd,0x35c5fe3e,0xb54295c7,0x35cdb531,0xb574a96f,0x35bfe071
.long 0xb55689b3,0x35c8afa3,0xb5842ade,0x35b93d0e,0xb569f950,0x35c32e50,0xb58da4ff,0x35b218b4
.long 0xb57cd8a0,0x35bd349e,0xb596bc84,0x35aa785c,0xb5878e00,0x35b6c63b,0xb59f6b17,0x35a26155
.long 0xb5905c16,0x35afe71f,0xb5a7aaad,0x3599d941,0xb598d125,0x35a89b88,0xb5af7588,0x3590e611
.long 0xb5a0e7f5,0x35a0e7f5,0xb5b6c63b,0x35878e00,0xb5a89b88,0x3598d125,0xb5bd97ae,0x357baf1e
.long 0xb5afe71f,0x35905c16,0xb5c3e522,0x35679302,0xb5b6c63b,0x35878e00,0xb5c9aa34,0x3552d5ad
.long 0xb5bd349e,0x357cd8a0,0xb5cee2e0,0x353d858f,0xb5c32e50,0x3569f950,0xb5d38b82,0x3527b17f
.long 0xb5c8afa3,0x355689b3,0xb5d7a0dd,0x351168af,0xb5cdb531,0x354295c7,0xb5db2018,0x34f57546
.long 0xb5d23be2,0x352e29da,0xb5de06c5,0x34c76e4a,0xb5d640eb,0x35195283,0xb5e052de,0x3498dc76
.long 0xb5d9c1d1,0x35041c9e,0xb5e202ca,0x3453c069,0xb5dcbc6b,0x34dd2a7c,0xb5e3155d,0x33ea68f6
.long 0xb5df2ee2,0x34b19357,0xb5e389d6,0x32b2b79c,0xb5e117b5,0x34858eae,0xb5e35fe5,0xb3912c43
.long 0xb5e275b6,0x34326f4c,0xb5e297a8,0xb42750ae,0xb5e3480d,0x33b2a663,0xb5e131a9,0xb482cb5f
.long 0xb52e29da,0x35d23be2,0xb55689b3,0x35c8afa3,0xb5479e7f,0x35cc7f95,0xb56fef27,0x35c15d0c
.long 0xb56052cd,0x35c5fe3e,0xb5842ade,0x35b93d0e,0xb5782ef7,0x35bebe21,0xb58fd1c3,0x35b0584a
.long 0xb5878e00,0x35b6c63b,0xb59adfe2,0x35a6b834,0xb59281e8,0x35ae1e39,0xb5a5497d,0x359c6705
.long 0xb59ce8a6,0x35a4ce73,0xb5af0384,0x35916fb3,0xb5a6b834,0x359adfe2,0xb5b803a3,0x3585dde2
.long 0xb5afe71f,0x35905c16,0xb5c0404a,0x35737bbe,0xb5b86c8e,0x35854d33,0xb5c7b0b8,0x355a3912
.long 0xb5c0404a,0x35737bbe,0xb5ce4d07,0x35400e98,0xb5c75ac8,0x355b727b,0xb5d40e31,0x3525181b
.long 0xb5cdb531,0x354295c7,0xb5d8ee1a,0x3509723e,0xb5d34966,0x3528fd97,0xb5dce793,0x34da74c2
.long 0xb5d81207,0x350ec292,0xb5dff665,0x34a11cf9,0xb5dc0a76,0x34e7fc01,0xb5e2174e,0x344e3417
.long 0xb5df2ee2,0x34b19357,0xb5e3480d,0x33b2a663,0xb5e17c43,0x3474ff28,0xb5e3875e,0xb2df64b5
.long 0xb5e2f061,0x3405eb92,0xb5e2d4fe,0xb4110eb5,0xb5e389d6,0x32b2b79c,0xb5e131a9,0xb482cb5f
.long 0xb5e3480d,0xb3b2a663,0xb5de9f1e,0xb4bc8473,0xb5e22b47,0xb448a746,0xb5db2018,0xb4f57546
.long 0xb5e03495,0xb49b9d02,0xb5d6b84e,0xb516b0ae,0xb5dd65dc,0xb4d25071,0xb5d16c6d,0xb53206a7
.long 0xb5d9c1d1,0xb5041c9e,0xb5cb4216,0xb54c9f84,0xb5d54bf5,0xb51e91b8,0xb5c43fd6,0xb5665f05
.long 0xb5d00894,0xb5386e09,0xb5bc6d1f,0xb57f29cf,0xb5c9fcc1,0xb55198a6,0xb5b3d23f,0xb58b72c6
.long 0xb5c32e50,0xb569f950,0xb5aa785c,0xb596bc84,0xb5bba3cf,0xb580bc44,0xb5a06963,0xb5a16623
.long 0xb5b36482,0xb58bffd6,0xb595b004,0xb5ab6450,0xb5aa785c,0xb596bc84,0xb58a57a4,0xb5b4ac6d
.long 0xb4b19357,0x35df2ee2,0xb5041c9e,0x35d9c1d1,0xb4e29456,0x35dc6480,0xb51d427b,0x35d589f8
.long 0xb509723e,0x35d8ee1a,0xb535df98,0x35d0986d,0xb5212f0b,0x35d4ce63,0xb54dde8c,0x35caf17d
.long 0xb5386e09,0x35d00894,0xb5652a79,0x35c49a11,0xb54f1d15,0x35caa066,0xb57baf1e,0x35bd97ae
.long 0xb5652a79,0x35c49a11,0xb588ac72,0x35b5f06c,0xb57a8501,0x35bdfa4a,0xb5930a7b,0x35adaaf3
.long 0xb5878e00,0x35b6c63b,0xb59ce8a6,0x35a4ce73,0xb5916fb3,0x35af0384,0xb5a63e5e,0x359b62a3
.long 0xb59adfe2,0x35a6b834,0xb5af0384,0x35916fb3,0xb5a3d730,0x359deac5,0xb5b73079,0x3586fe49
.long 0xb5ac4e9d,0x3594a213,0xb5bebe21,0x35782ef7,0xb5b43f8d,0x358ae560,0xb5c5a5e9,0x3561898a
.long 0xb5bba3cf,0x3580bc44,0xb5cbe1d1,0x354a1ffb,0xb5c2759c,0x356c5d5c,0xb5d16c6d,0x353206a7
.long 0xb5c8afa3,0x355689b3,0xb5d640eb,0x35195283,0xb5ce4d07,0x35400e98,0xb5da5b18,0x3500190b
.long 0xb5d34966,0x3528fd97,0xb5ddb762,0x34cce05a,0xb5d7a0dd,0x351168af,0xb5e052de,0x3498dc76
.long 0xb5db5006,0x34f2c494,0xb5e22b47,0x3448a746,0xb5de5404,0x34c1fa4e,0xb5e33f02,0x33bdce45
.long 0xb5e0aa7a,0x349098a1,0xb5e38d20,0xb232b879,0xb5e25196,0x343d8c33,0xb5e3155d,0xb3ea68f6
.long 0xb5e3480d,0x33b2a663,0xb5e1d820,0xb45ed782,0xb5e38d20,0xb232b879,0xb5dfd67d,0xb4a3dc60
.long 0xb5e32098,0xb3df4312,0xb5dd1234,0xb4d7be81,0xb5e202ca,0xb453c069,0xb5d98dac,0xb5057282
.long 0xb5e03495,0xb49b9d02,0xb5d54bf5,0xb51e91b8,0xb5ddb762,0xb4cce05a,0xb5d050c1,0xb5372709
.long 0xb5da8d22,0xb4fd83cb,0xb5caa066,0xb54f1d15,0xb5d6b84e,0xb516b0ae,0xb5c43fd6,0xb5665f05
.long 0xb57cd8a0,0x35bd349e,0xb5905c16,0x35afe71f,0xb58ae560,0x35b43f8d,0xb59c6705,0x35a5497d
.long 0xb596bc84,0x35aa785c,0xb5a7aaad,0x3599d941,0xb5a1e3ee,0x359fea6e,0xb5b218b4,0x358da4ff
.long 0xb5ac4e9d,0x3594a213,0xb5bba3cf,0x3580bc44,0xb5b5f06c,0x3588ac72,0xb5c43fd6,0x35665f05
.long 0xb5bebe21,0x35782ef7,0xb5cbe1d1,0x354a1ffb,0xb5c6ad78,0x355de3b6,0xb5d28006,0x352cdf68
.long 0xb5cdb531,0x354295c7,0xb5d81207,0x350ec292,0xb5d3cd1b,0x35266500,0xb5dc90b9,0x34dfdfae
.long 0xb5d8ee1a,0x3509723e,0xb5dff665,0x34a11cf9,0xb5dd1234,0x34d7be81,0xb5e23eb4,0x344319f8
.long 0xb5e03495,0x349b9d02,0xb5e366c0,0x338602d1,0xb5e25196,0x343d8c33,0xb5e36d0d,0xb375b21a
.long 0xb5e366c0,0x338602d1,0xb5e25196,0xb43d8c33,0xb5e372cf,0xb35f5dfa,0xb5e015c2,0xb49e5d2e
.long 0xb5e275b6,0xb4326f4c,0xb5dcbc6b,0xb4dd2a7c,0xb5e0709c,0xb4961b8b,0xb5d849d4,0xb50d6eff
.long 0xb5dd65dc,0xb4d25071,0xb5d2c3a8,0xb52b948c,0xb5d95902,0xb506c814,0xb5cc30f2,0xb548df7b
.long 0xb5d44ec5,0xb523cad0,0xb5c49a11,0xb5652a79,0xb5ce4d07,0xb5400e98,0xb5bc08b1,0xb58028bd
.long 0xb5c75ac8,0xb55b727b,0xb5b287bc,0xb58d18f3,0xb5bf8021,0xb575d68a,0xb5a8234e,0xb5995562
.long 0xb5b6c63b,0xb5878e00,0xb59ce8a6,0xb5a4ce73,0xb5ad3741,0xb59392b4,0xb590e611,0xb5af7588
.long 0xb5a2de58,0xb59eeb5d,0xb5842ade,0xb5b93d0e,0xb597c790,0xb5a98ac3,0xb56d8e88,0xb5c2188e
.long 0xb58bffd6,0xb5b36482,0xb55198a6,0xb5c9fcc1,0xb57f29cf,0xb5bc6d1f,0xb53497b7,0xb5d0df99
.long 0xb5652a79,0xb5c49a11,0xb516b0ae,0xb5d6b84e,0xb54a1ffb,0xb5cbe1d1,0xb4f0134b,0xb5db7f6e
.long 0xb5a0e7f5,0x35a0e7f5,0xb5afe71f,0x35905c16,0xb5ac4e9d,0x3594a213,0xb5ba7274,0x358274fb
.long 0xb5b6c63b,0x35878e00,0xb5c3e522,0x35679302,0xb5c0404a,0x35737bbe,0xb5cc30f2,0x3548df7b
.long 0xb5c8afa3,0x355689b3,0xb5d34966,0x3528fd97,0xb5d00894,0x35386e09,0xb5d923d1,0x35081d53
.long 0xb5d640eb,0x35195283,0xb5ddb762,0x34cce05a,0xb5db5006,0x34f2c494,0xb5e0fd37,0x348851aa
.long 0xb5df2ee2,0x34b19357,0xb5e2f061,0x3405eb92,0xb5e1d820,0x345ed782,0xb5e38df3,0xb1b2b8b0
.long 0xb5e3480d,0x33b2a663,0xb5e2d4fe,0xb4110eb5,0xb5e37cad,0xb332b42a,0xb5e0c699,0xb48dd6a6
.long 0xb5e275b6,0xb4326f4c,0xb5dd65dc,0xb4d25071,0xb5e03495,0xb49b9d02,0xb5d8b7de,0xb50ac6d5
.long 0xb5dcbc6b,0xb4dd2a7c,0xb5d2c3a8,0xb52b948c,0xb5d81207,0xb50ec292,0xb5cb9232,0xb54b5ffe
.long 0xb5d23be2,0xb52e29da,0xb5c32e50,0xb569f950,0xb5cb4216,0xb54c9f84,0xb5b9a4a2,0xb5839938
.long 0xb5c32e50,0xb569f950,0xb5af0384,0xb5916fb3,0xb5ba0bc4,0xb5830742,0xb5a35af6,0xb59e6b42
.long 0xb5afe71f,0xb5905c16,0xb596bc84,0xb5aa785c,0xb5a4ce73,0xb59ce8a6,0xb5893b2d,0xb5b584dc
.long 0xb598d125,0xb5a89b88,0xb575d68a,0xb5bf8021,0xb58bffd6,0xb5b36482,0xb557c4ae,0xb5c85b26
.long 0xb57cd8a0,0xb5bd349e,0xb5386e09,0xb5d00894,0xb56052cd,0xb5c5fe3e,0xb51801c8,0xb5d67cde
.long 0xb54295c7,0xb5cdb531,0xb4ed616f,0xb5dbae4d,0xb523cad0,0xb5d44ec5,0xb4a959fe,0xb5df9510
.long 0xb5041c9e,0xb5d9c1d1,0xb448a746,0xb5e22b47,0xb4c76e4a,0xb5de06c5,0xb375b21a,0xb5e36d0d
.long 0xb4858eae,0xb5e117b5,0x339c555b,0xb5e3587f,0xb405eb92,0xb5e2f061,0x34594c39,0xb5e1edbb
.long 0xb5d23be2,0x352e29da,0xb5d9c1d1,0x35041c9e,0xb5d8ee1a,0x3509723e,0xb5dec3dd,0x34b9c8d6
.long 0xb5de06c5,0x34c76e4a,0xb5e202ca,0x3453c069,0xb5e17c43,0x3474ff28,0xb5e37804,0x33490950
.long 0xb5e3480d,0x33b2a663,0xb5e32098,0xb3df4312,0xb5e366c0,0xb38602d1,0xb5e0fd37,0xb48851aa
.long 0xb5e1d820,0xb45ed782,0xb5dd1234,0xb4d7be81,0xb5de9f1e,0xb4bc8473,0xb5d76780,0xb512bb38
.long 0xb5d9c1d1,0xb5041c9e,0xb5d00894,0xb5386e09,0xb5d34966,0xb528fd97,0xb5c7045d,0xb55cab5d
.long 0xb5cb4216,0xb54c9f84,0xb5bc6d1f,0xb57f29cf,0xb5c1bb09,0xb56ebf21,0xb5b0584a,0xb58fd1c3
.long 0xb5b6c63b,0xb5878e00,0xb5a2de58,0xb59eeb5d,0xb5aa785c,0xb596bc84,0xb5941a91,0xb5acc324
.long 0xb59ce8a6,0xb5a4ce73,0xb5842ade,0xb5b93d0e,0xb58e30b4,0xb5b1a93d,0xb5665f05,0xb5c43fd6
.long 0xb57cd8a0,0xb5bd349e,0xb54295c7,0xb5cdb531,0xb55b727b,0xb5c75ac8,0xb51d427b,0xb5d589f8
.long 0xb5386e09,0xb5d00894,0xb4ed616f,0xb5dbae4d,0xb5140d65,0xb5d72d9f,0xb49e5d2e,0xb5e015c2
.long 0xb4dd2a7c,0xb5dcbc6b,0xb41c3072,0xb5e2b76b,0xb49098a1,0xb5e0aa7a,0x31b2b8b0,0xb5e38df3
.long 0xb405eb92,0xb5e2f061,0x342750ae,0xb5e297a8,0x32b2b79c,0xb5e389d6,0x34a3dc60,0xb5dfd67d
.long 0x34326f4c,0xb5e275b6,0x34f2c494,0xb5db5006,0x34a69b63,0xb5dfb60c,0x351fe093,0xb5d50d6e
.long 0x34f2c494,0xb5db5006,0x35451b16,0xb5cd1b60,0x351e91b8,0xb5d54bf5,0x3568c671,0xb5c389f6
.long 0x354295c7,0xb5cdb531,0x35854d33,0xb5b86c8e,0x35652a79,0xb5c49a11,0x3595293a,0xb5abd9ab
.long 0x35830742,0xb5ba0bc4,0x35a3d730,0xb59deac5,0x359281e8,0xb5ae1e39,0x35b1395a,0xb58ebc11
.long 0xb5bd349e,0x357cd8a0,0xb5c8afa3,0x355689b3,0xb5c6ad78,0x355de3b6,0xb5d0df99,0x353497b7
.long 0xb5cee2e0,0x353d858f,0xb5d7a0dd,0x351168af,0xb5d5c777,0x351bf2de,0xb5dce793,0x34da74c2
.long 0xb5db5006,0x34f2c494,0xb5e0aa7a,0x349098a1,0xb5df738b,0x34ac1831,0xb5e2e2f5,0x340b7d4f
.long 0xb5e22b47,0x3448a746,0xb5e38d20,0xb232b879,0xb5e372cf,0x335f5dfa,0xb5e2a7cf,0xb421c0c2
.long 0xb5e3480d,0xb3b2a663,0xb5e03495,0xb49b9d02,0xb5e1ab48,0xb469ec76,0xb5dc37bf,0xb4e54872
.long 0xb5de9f1e,0xb4bc8473,0xb5d6b84e,0xb516b0ae,0xb5da2886,0xb5016fe1,0xb5cfbfe7,0xb539b497
.long 0xb5d44ec5,0xb523cad0,0xb5c75ac8,0xb55b727b,0xb5cd1b60,0xb5451b16,0xb5bd97ae,0xb57baf1e
.long 0xb5c49a11,0xb5652a79,0xb5b287bc,0xb58d18f3,0xb5bad8b0,0xb581e263,0xb5a63e5e,0xb59b62a3
.long 0xb5afe71f,0xb5905c16,0xb598d125,0xb5a89b88,0xb5a3d730,0xb59deac5,0xb58a57a4,0xb5b4ac6d
.long 0xb596bc84,0xb5aa785c,0xb575d68a,0xb5bf8021,0xb588ac72,0xb5b5f06c,0xb5554e35,0xb5c903a5
.long 0xb5737bbe,0xb5c0404a,0xb5334f66,0xb5d12643,0xb5541232,0xb5c9572b,0xb51015cd,0xb5d7d9b4
.long 0xb5334f66,0xb5d12643,0xb4d7be81,0xb5dd1234,0xb51168af,0xb5d7a0dd,0xb48dd6a6,0xb5e0c699
.long 0xb4dd2a7c,0xb5dcbc6b,0xb405eb92,0xb5e2f061,0xb4961b8b,0xb5e0709c,0x32860a16,0xb5e38bc1
.long 0xb41c3072,0xb5e2b76b,0x342750ae,0xb5e297a8,0xb232b879,0xb5e38d20,0x349e5d2e,0xb5e015c2
.long 0x3405eb92,0xb5e2f061,0x34e7fc01,0xb5dc0a76,0x348b1453,0xb5e0e22d,0x351801c8,0xb5d67cde
.long 0x34d25071,0xb5dd65dc,0x353afab3,0xb5cf76ba,0x350c1b15,0xb5d8811b,0x355cab5d,0xb5c7045d
.long 0xb5df2ee2,0x34b19357,0xb5e275b6,0x34326f4c,0xb5e25196,0x343d8c33,0xb5e38df3,0x31b2b8b0
.long 0xb5e389d6,0x32b2b79c,0xb5e297a8,0xb42750ae,0xb5e2d4fe,0xb4110eb5,0xb5df9510,0xb4a959fe
.long 0xb5e03495,0xb49b9d02,0xb5da8d22,0xb4fd83cb,0xb5dbae4d,0xb4ed616f,0xb5d38b82,0xb527b17f
.long 0xb5d54bf5,0xb51e91b8,0xb5caa066,0xb54f1d15,0xb5cd1b60,0xb5451b16,0xb5bfe071,0xb574a96f
.long 0xb5c32e50,0xb569f950,0xb5b36482,0xb58bffd6,0xb5b79a47,0xb5866e3f,0xb5a5497d,0xb59c6705
.long 0xb5aa785c,0xb596bc84,0xb595b004,0xb5ab6450,0xb59be504,0xb5a5c420,0xb584bc31,0xb5b8d507
.long 0xb58bffd6,0xb5b36482,0xb5652a79,0xb5c49a11,0xb575d68a,0xb5bf8021,0xb53eca4f,0xb5ce9833
.long 0xb55198a6,0xb5c9fcc1,0xb516b0ae,0xb5d6b84e,0xb52b948c,0xb5d2c3a8,0xb4da74c2,0xb5dce793
.long 0xb5041c9e,0xb5d9c1d1,0xb4858eae,0xb5e117b5,0xb4b70cc7,0xb5dee813,0xb3bdce45,0xb5e33f02
.long 0xb448a746,0xb5e22b47,0x339c555b,0xb5e3587f,0xb30608a2,0xb5e3845a,0x347a87a0,0xb5e163f0
.long 0x3405eb92,0xb5e2f061,0x34d25071,0xb5dd65dc,0x34961b8b,0xb5e0709c,0x3512bb38,0xb5d76780
.long 0x34e7fc01,0xb5dc0a76,0x353afab3,0xb5cf76ba,0x351bf2de,0xb5d5c777,0x3561898a,0xb5c5a5e9
.long 0x354295c7,0xb5cdb531,0x35830742,0xb5ba0bc4,0x35679302,0xb5c3e522,0x35941a91,0xb5acc324
.long 0x35854d33,0xb5b86c8e,0x35a3d730,0xb59deac5,0x3595b004,0xb5ab6450,0x35b218b4,0xb58da4ff
.long 0x35a4ce73,0xb59ce8a6,0x35bebe21,0xb5782ef7,0x35b287bc,0xb58d18f3,0x35c9aa34,0xb552d5ad
.long 0x35bebe21,0xb5782ef7,0x35d2c3a8,0xb52b948c,0x35c9572b,0xb5541232,0x35d9f56f,0xb502c668
.set CT0, 16256
.set CT1, 16256
.set CT2, 16256
.set CT3, 16256
.set CT4, 16256
.set CT5, 16256
.set CT6, 16255
.set CT7, 16255
.set CT8, 16255
.set CT9, 16255
.set CT10, 16254
.set CT11, 16254
.set CT12, 16254
.set CT13, 16253
.set CT14, 16253
.set CT15, 16253
.set CT16, 16252
.set CT17, 16252
.set CT18, 16251
.set CT19, 16251
.set CT20, 16250
.set CT21, 16249
.set CT22, 16249
.set CT23, 16248
.set CT24, 16247
.set CT25, 16247
.set CT26, 16246
.set CT27, 16245
.set CT28, 16244
.set CT29, 16243
.set CT30, 16242
.set CT31, 16242
.set CT32, 16241
.set CT33, 16240
.set CT34, 16239
.set CT35, 16238
.set CT36, 16237
.set CT37, 16235
.set CT38, 16234
.set CT39, 16233
.set CT40, 16232
.set CT41, 16231
.set CT42, 16230
.set CT43, 16228
.set CT44, 16227
.set CT45, 16226
.set CT46, 16224
.set CT47, 16223
.set CT48, 16222
.set CT49, 16220
.set CT50, 16219
.set CT51, 16217
.set CT52, 16216
.set CT53, 16214
.set CT54, 16213
.set CT55, 16211
.set CT56, 16210
.set CT57, 16208
.set CT58, 16206
.set CT59, 16205
.set CT60, 16203
.set CT61, 16201
.set CT62, 16200
.set CT63, 16198
.set CT64, 16196
.set CT65, 16194
.set CT66, 16192
.set CT67, 16191
.set CT68, 16189
.set CT69, 16187
.set CT70, 16185
.set CT71, 16183
.set CT72, 16181
.set CT73, 16179
.set CT74, 16177
.set CT75, 16175
.set CT76, 16173
.set CT77, 16171
.set CT78, 16169
.set CT79, 16167
.set CT80, 16165
.set CT81, 16162
.set CT82, 16160
.set CT83, 16158
.set CT84, 16156
.set CT85, 16154
.set CT86, 16151
.set CT87, 16149
.set CT88, 16147
.set CT89, 16145
.set CT90, 16142
.set CT91, 16140
.set CT92, 16138
.set CT93, 16135
.set CT94, 16133
.set CT95, 16130
.set CT96, 16128
.set CT97, 16123
.set CT98, 16118
.set CT99, 16113
.set CT100, 16108
.set CT101, 16103
.set CT102, 16098
.set CT103, 16093
.set CT104, 16088
.set CT105, 16083
.set CT106, 16078
.set CT107, 16073
.set CT108, 16068
.set CT109, 16063
.set CT110, 16058
.set CT111, 16052
.set CT112, 16047
.set CT113, 16042
.set CT114, 16037
.set CT115, 16031
.set CT116, 16026
.set CT117, 16021
.set CT118, 16015
.set CT119, 16010
.set CT120, 16005
.set CT121, 15998
.set CT122, 15987
.set CT123, 15977
.set CT124, 15966
.set CT125, 15955
.set CT126, 15944
.set CT127, 15933
.set CT128, 15922
.set CT129, 15911
.set CT130, 15900
.set CT131, 15889
.set CT132, 15878
.set CT133, 15861
.set CT134, 15839
.set CT135, 15817
.set CT136, 15794
.set CT137, 15772
.set CT138, 15750
.set CT139, 15711
.set CT140, 15667
.set CT141, 15622
.set CT142, 15539
.set CT143, 15411
.set CT144, 0
.set CT145, 48179
.set CT146, 48307
.set CT147, 48390
.set CT148, 48435
.set CT149, 48479
.set CT150, 48518
.set CT151, 48540
.set CT152, 48562
.set CT153, 48585
.set CT154, 48607
.set CT155, 48629
.set CT156, 48646
.set CT157, 48657
.set CT158, 48668
.set CT159, 48679
.set CT160, 48690
.set CT161, 48701
.set CT162, 48712
.set CT163, 48723
.set CT164, 48734
.set CT165, 48745
.set CT166, 48755
.set CT167, 48766
.set CT168, 48773
.set CT169, 48778
.set CT170, 48783
.set CT171, 48789
.set CT172, 48794
.set CT173, 48799
.set CT174, 48805
.set CT175, 48810
.set CT176, 48815
.set CT177, 48820
.set CT178, 48826
.set CT179, 48831
.set CT180, 48836
.set CT181, 48841
.set CT182, 48846
.set CT183, 48851
.set CT184, 48856
.set CT185, 48861
.set CT186, 48866
.set CT187, 48871
.set CT188, 48876
.set CT189, 48881
.set CT190, 48886
.set CT191, 48891
.set CT192, 48896
.set CT193, 48898
.set CT194, 48901
.set CT195, 48903
.set CT196, 48906
.set CT197, 48908
.set CT198, 48910
.set CT199, 48913
.set CT200, 48915
.set CT201, 48917
.set CT202, 48919
.set CT203, 48922
.set CT204, 48924
.set CT205, 48926
.set CT206, 48928
.set CT207, 48930
.set CT208, 48933
.set CT209, 48935
.set CT210, 48937
.set CT211, 48939
.set CT212, 48941
.set CT213, 48943
.set CT214, 48945
.set CT215, 48947
.set CT216, 48949
.set CT217, 48951
.set CT218, 48953
.set CT219, 48955
.set CT220, 48957
.set CT221, 48959
.set CT222, 48960
.set CT223, 48962
.set CT224, 48964
.set CT225, 48966
.set CT226, 48968
.set CT227, 48969
.set CT228, 48971
.set CT229, 48973
.set CT230, 48974
.set CT231, 48976
.set CT232, 48978
.set CT233, 48979
.set CT234, 48981
.set CT235, 48982
.set CT236, 48984
.set CT237, 48985
.set CT238, 48987
.set CT239, 48988
.set CT240, 48990
.set CT241, 48991
.set CT242, 48992
.set CT243, 48994
.set CT244, 48995
.set CT245, 48996
.set CT246, 48998
.set CT247, 48999
.set CT248, 49000
.set CT249, 49001
.set CT250, 49002
.set CT251, 49003
.set CT252, 49005
.set CT253, 49006
.set CT254, 49007
.set CT255, 49008
.set CT256, 49009
.set CT257, 49010
.set CT258, 49010
.set CT259, 49011
.set CT260, 49012
.set CT261, 49013
.set CT262, 49014
.set CT263, 49015
.set CT264, 49015
.set CT265, 49016
.set CT266, 49017
.set CT267, 49017
.set CT268, 49018
.set CT269, 49019
.set CT270, 49019
.set CT271, 49020
.set CT272, 49020
.set CT273, 49021
.set CT274, 49021
.set CT275, 49021
.set CT276, 49022
.set CT277, 49022
.set CT278, 49022
.set CT279, 49023
.set CT280, 49023
.set CT281, 49023
.set CT282, 49023
.set CT283, 49024
.set CT284, 49024
.set CT285, 49024
.set CT286, 49024
.set CT287, 49024
.set CT288, 49024
.set CT289, 49024
.set CT290, 49024
.set CT291, 49024
.set CT292, 49024
.set CT293, 49024
.set CT294, 49023
.set CT295, 49023
.set CT296, 49023
.set CT297, 49023
.set CT298, 49022
.set CT299, 49022
.set CT300, 49022
.set CT301, 49021
.set CT302, 49021
.set CT303, 49021
.set CT304, 49020
.set CT305, 49020
.set CT306, 49019
.set CT307, 49019
.set CT308, 49018
.set CT309, 49017
.set CT310, 49017
.set CT311, 49016
.set CT312, 49015
.set CT313, 49015
.set CT314, 49014
.set CT315, 49013
.set CT316, 49012
.set CT317, 49011
.set CT318, 49010
.set CT319, 49010
.set CT320, 49009
.set CT321, 49008
.set CT322, 49007
.set CT323, 49006
.set CT324, 49005
.set CT325, 49003
.set CT326, 49002
.set CT327, 49001
.set CT328, 49000
.set CT329, 48999
.set CT330, 48998
.set CT331, 48996
.set CT332, 48995
.set CT333, 48994
.set CT334, 48992
.set CT335, 48991
.set CT336, 48990
.set CT337, 48988
.set CT338, 48987
.set CT339, 48985
.set CT340, 48984
.set CT341, 48982
.set CT342, 48981
.set CT343, 48979
.set CT344, 48978
.set CT345, 48976
.set CT346, 48974
.set CT347, 48973
.set CT348, 48971
.set CT349, 48969
.set CT350, 48968
.set CT351, 48966
.set CT352, 48964
.set CT353, 48962
.set CT354, 48960
.set CT355, 48959
.set CT356, 48957
.set CT357, 48955
.set CT358, 48953
.set CT359, 48951
.set CT360, 48949
.set CT361, 48947
.set CT362, 48945
.set CT363, 48943
.set CT364, 48941
.set CT365, 48939
.set CT366, 48937
.set CT367, 48935
.set CT368, 48933
.set CT369, 48930
.set CT370, 48928
.set CT371, 48926
.set CT372, 48924
.set CT373, 48922
.set CT374, 48919
.set CT375, 48917
.set CT376, 48915
.set CT377, 48913
.set CT378, 48910
.set CT379, 48908
.set CT380, 48906
.set CT381, 48903
.set CT382, 48901
.set CT383, 48898
.set CT384, 48896
.set CT385, 48891
.set CT386, 48886
.set CT387, 48881
.set CT388, 48876
.set CT389, 48871
.set CT390, 48866
.set CT391, 48861
.set CT392, 48856
.set CT393, 48851
.set CT394, 48846
.set CT395, 48841
.set CT396, 48836
.set CT397, 48831
.set CT398, 48826
.set CT399, 48820
.set CT400, 48815
.set CT401, 48810
.set CT402, 48805
.set CT403, 48799
.set CT404, 48794
.set CT405, 48789
.set CT406, 48783
.set CT407, 48778
.set CT408, 48773
.set CT409, 48766
.set CT410, 48755
.set CT411, 48745
.set CT412, 48734
.set CT413, 48723
.set CT414, 48712
.set CT415, 48701
.set CT416, 48690
.set CT417, 48679
.set CT418, 48668
.set CT419, 48657
.set CT420, 48646
.set CT421, 48629
.set CT422, 48607
.set CT423, 48585
.set CT424, 48562
.set CT425, 48540
.set CT426, 48518
.set CT427, 48479
.set CT428, 48435
.set CT429, 48390
.set CT430, 48307
.set CT431, 48179
.set CT432, 0
.set CT433, 15411
.set CT434, 15539
.set CT435, 15622
.set CT436, 15667
.set CT437, 15711
.set CT438, 15750
.set CT439, 15772
.set CT440, 15794
.set CT441, 15817
.set CT442, 15839
.set CT443, 15861
.set CT444, 15878
.set CT445, 15889
.set CT446, 15900
.set CT447, 15911
.set CT448, 15922
.set CT449, 15933
.set CT450, 15944
.set CT451, 15955
.set CT452, 15966
.set CT453, 15977
.set CT454, 15987
.set CT455, 15998
.set CT456, 16005
.set CT457, 16010
.set CT458, 16015
.set CT459, 16021
.set CT460, 16026
.set CT461, 16031
.set CT462, 16037
.set CT463, 16042
.set CT464, 16047
.set CT465, 16052
.set CT466, 16058
.set CT467, 16063
.set CT468, 16068
.set CT469, 16073
.set CT470, 16078
.set CT471, 16083
.set CT472, 16088
.set CT473, 16093
.set CT474, 16098
.set CT475, 16103
.set CT476, 16108
.set CT477, 16113
.set CT478, 16118
.set CT479, 16123
.set CT480, 16128
.set CT481, 16130
.set CT482, 16133
.set CT483, 16135
.set CT484, 16138
.set CT485, 16140
.set CT486, 16142
.set CT487, 16145
.set CT488, 16147
.set CT489, 16149
.set CT490, 16151
.set CT491, 16154
.set CT492, 16156
.set CT493, 16158
.set CT494, 16160
.set CT495, 16162
.set CT496, 16165
.set CT497, 16167
.set CT498, 16169
.set CT499, 16171
.set CT500, 16173
.set CT501, 16175
.set CT502, 16177
.set CT503, 16179
.set CT504, 16181
.set CT505, 16183
.set CT506, 16185
.set CT507, 16187
.set CT508, 16189
.set CT509, 16191
.set CT510, 16192
.set CT511, 16194
.set CT512, 16196
.set CT513, 16198
.set CT514, 16200
.set CT515, 16201
.set CT516, 16203
.set CT517, 16205
.set CT518, 16206
.set CT519, 16208
.set CT520, 16210
.set CT521, 16211
.set CT522, 16213
.set CT523, 16214
.set CT524, 16216
.set CT525, 16217
.set CT526, 16219
.set CT527, 16220
.set CT528, 16222
.set CT529, 16223
.set CT530, 16224
.set CT531, 16226
.set CT532, 16227
.set CT533, 16228
.set CT534, 16230
.set CT535, 16231
.set CT536, 16232
.set CT537, 16233
.set CT538, 16234
.set CT539, 16235
.set CT540, 16237
.set CT541, 16238
.set CT542, 16239
.set CT543, 16240
.set CT544, 16241
.set CT545, 16242
.set CT546, 16242
.set CT547, 16243
.set CT548, 16244
.set CT549, 16245
.set CT550, 16246
.set CT551, 16247
.set CT552, 16247
.set CT553, 16248
.set CT554, 16249
.set CT555, 16249
.set CT556, 16250
.set CT557, 16251
.set CT558, 16251
.set CT559, 16252
.set CT560, 16252
.set CT561, 16253
.set CT562, 16253
.set CT563, 16253
.set CT564, 16254
.set CT565, 16254
.set CT566, 16254
.set CT567, 16255
.set CT568, 16255
.set CT569, 16255
.set CT570, 16255
.set CT571, 16256
.set CT572, 16256
.set CT573, 16256
.set CT574, 16256
.set CT575, 16256
.altmacro
.macro EC i
.short CT\i
.endm
.p2align 8
FTAB:
.set dd,0
.rept 576
.set ix,0
.rept 289
EC %ix
.set ix,(ix+dd)%576
.endr
.set ix,(dd+144)%576
.rept 287
EC %ix
.set ix,(ix+dd)%576
.endr
.set dd,dd+1
.endr
.set HALFP, 16128
.set HALFN, 48896
.p2align 8
GTR:
.rept 576
.short HALFP
.endr
.set cc,1
.rept 287
.set ix,0
.rept 576
EC %ix
.set ix,(ix+cc)%576
.endr
.set cc,cc+1
.endr
.rept 288
.short HALFP
.short HALFN
.endr
.set cc,1
.rept 287
.set ix,144
.rept 576
EC %ix
.set ix,(ix+cc)%576
.endr
.set cc,cc+1
.endr
.noaltmacro
```
